```python
import torch

def _softmax(x, axis=-1):
    return torch.softmax(x, dim=axis)
def _gelu(x):
    return torch.nn.functional.gelu(x, approximate="tanh")
def _silu(x):
    return torch.nn.functional.silu(x)
def _sigmoid(x):
    return torch.sigmoid(x)
def _layernorm(x, axis=-1, eps=1e-5):
    m = x.mean(dim=axis, keepdim=True)
    v = x.var(dim=axis, keepdim=True, unbiased=False)
    return (x - m) / torch.sqrt(v + eps)
def _scatter_add(tgt, idx, src, axis=0):
    return tgt.clone().index_add_(axis, idx, src)
def _segment_sum(src, seg, n):
    out = torch.zeros((n,) + src.shape[1:], dtype=src.dtype)
    return out.index_add_(0, seg, src)
def _pad(x, pw):
    flat = tuple(v for pair in reversed(pw) for v in pair)
    return torch.nn.functional.pad(x, flat)

kernel_name = 'concat_heads__ssm_conv_s4__grouped_kv_mqa__prompt'

def setup_inputs():

    _w = (lambda a: (lambda t: t.to(torch.bfloat16) if t.is_floating_point() else t)(torch.as_tensor(a)))
    def _A_setup():
        B, L, D, N = 1, 2048, 640, 128
        A_re = -(lambda _x: torch.exp(torch.as_tensor(_x)))((lambda *s: torch.randn(*s, dtype=torch.bfloat16) * 6.4)(D, N))
        A_im = torch.pi * (lambda *s: torch.randn(*s, dtype=torch.bfloat16) * 0.1)(D, N)
        B_re = (lambda *s: torch.randn(*s, dtype=torch.bfloat16) * 0.1)(D, N)
        B_im = (lambda *s: torch.randn(*s, dtype=torch.bfloat16) * 0.1)(D, N)
        C_re = (lambda *s: torch.randn(*s, dtype=torch.bfloat16) * 0.1)(D, N)
        C_im = (lambda *s: torch.randn(*s, dtype=torch.bfloat16) * 0.1)(D, N)
        log_dt = (lambda *s: torch.randn(*s, dtype=torch.bfloat16) * 0.1)(D) * 0.5 - 4.0
        Dskip = (lambda *s: torch.randn(*s, dtype=torch.bfloat16) * 0.1)(D)
        return {
            "u": _w((lambda *s: torch.randn(*s, dtype=torch.bfloat16) * 0.05)(B, L, D)),
            "A_re": _w(A_re),
            "A_im": _w(A_im),
            "B_re": _w(B_re),
            "B_im": _w(B_im),
            "C_re": _w(C_re),
            "C_im": _w(C_im),
            "log_dt": _w(log_dt),
            "Dskip": _w(Dskip),
        }
    _A_in = _A_setup()

    def _B_setup():
        B, S, D, H = 1, 2048, 640, 32
        Dh = D // H
        return {
            "x": _w((lambda *s: torch.randn(*s, dtype=torch.bfloat16) * 0.05)(B, S, D)),
            "wq": _w((lambda *s: torch.randn(*s, dtype=torch.bfloat16) * 0.8)(D, H * Dh)),
            "wk": _w((lambda *s: torch.randn(*s, dtype=torch.bfloat16) * 0.8)(D, Dh)),
            "wv": _w((lambda *s: torch.randn(*s, dtype=torch.bfloat16) * 0.05)(D, Dh)),
            "wo": _w((lambda *s: torch.randn(*s, dtype=torch.bfloat16) * 0.05)(H * Dh, D)),
        }
    _B_in = _B_setup()

    return {
        "A_u": _A_in["u"],
        "A_A_re": _A_in["A_re"],
        "A_A_im": _A_in["A_im"],
        "A_B_re": _A_in["B_re"],
        "A_B_im": _A_in["B_im"],
        "A_C_re": _A_in["C_re"],
        "A_C_im": _A_in["C_im"],
        "A_log_dt": _A_in["log_dt"],
        "A_Dskip": _A_in["Dskip"],
        "B_x": _B_in["x"],
        "B_wq": _B_in["wq"],
        "B_wk": _B_in["wk"],
        "B_wv": _B_in["wv"],
        "B_wo": _B_in["wo"],
    }

def reference(A_u, A_A_re, A_A_im, A_B_re, A_B_im, A_C_re, A_C_im, A_log_dt, A_Dskip, B_x, B_wq, B_wk, B_wv, B_wo):
    def _A_ref(u, A_re, A_im, B_re, B_im, C_re, C_im, log_dt, Dskip):
        Bsz, L, D = u.shape
        dt = torch.exp(log_dt)[:, None]
        A = A_re + 1j * A_im
        Bc = B_re + 1j * B_im
        Cc = C_re + 1j * C_im
        logdA = dt * A
        dB = dt * Bc
        l = (lambda x, dt: x.to(dt))(torch.arange(L), A_re.dtype)
        P = torch.exp(logdA[:, :, None] * l[None, None, :])
        K = torch.einsum("dn,dnl,dn->dl", Cc, P, dB).real
        L2 = 2 * L
        Kp = _pad(K, ((0, 0), (0, L)))
        up = (lambda x, *d: x.permute(*d))(u, 0, 2, 1)
        up = _pad(up, ((0, 0), (0, 0), (0, L)))
        Kf = (lambda x, axes=(-2,-1): torch.fft.rfft2(x.float(), dim=axes))(Kp[:, None, :], axes=(-2, -1))
        Uf = (lambda x, axes=(-2,-1): torch.fft.rfft2(x.float(), dim=axes))(up[:, :, None, :], axes=(-2, -1))
        Yf = Uf * Kf[None, :, :, :]
        y = (lambda x, s, axes=(-2,-1): torch.fft.irfft2(x, s=s, dim=axes).to(torch.bfloat16))(Yf, (1, L2), axes=(-2, -1))[:, :, 0, :L]
        y = (lambda x, *d: x.permute(*d))(y, 0, 2, 1) + u * Dskip[None, None, :]
        return y

    def _B_ref(x, wq, wk, wv, wo):
        B, S, D = x.shape
        H = 32
        Dh = D // H
        q = (lambda x, *d: x.permute(*d))((x @ wq).reshape(B, S, H, Dh), 0, 2, 1, 3)
        k = x @ wk
        v = x @ wv
        scores = torch.einsum("bhqd,bkd->bhqk", q, k) * (Dh ** -0.5)
        p = _softmax(scores, axis=-1)
        o = torch.einsum("bhqk,bkd->bhqd", p, v)
        return (lambda x, *d: x.permute(*d))(o, 0, 2, 1, 3).reshape(B, S, H * Dh) @ wo

    a = _A_ref(A_u, A_A_re, A_A_im, A_B_re, A_B_im, A_C_re, A_C_im, A_log_dt, A_Dskip)
    b = _B_ref(B_x, B_wq, B_wk, B_wv, B_wo)
    return torch.concatenate([a, b], axis=-1)
```

```asm
; @launch grid=(256,1,1) block=(256,1,1) lds=161088
.amdgcn_target "amdgcn-amd-amdhsa--gfx950"
.text
.globl concat_heads__ssm_conv_s4__grouped_kv_mqa__prompt_kernel
.p2align 8
.type concat_heads__ssm_conv_s4__grouped_kv_mqa__prompt_kernel,@function
concat_heads__ssm_conv_s4__grouped_kv_mqa__prompt_kernel:
    s_load_dwordx16 s[64:79], s[0:1], 0
    s_load_dwordx16 s[80:95], s[0:1], 64
    s_load_dwordx2 s[4:5], s[0:1], 128
    s_mov_b32 s3, s2
    s_cmp_ge_u32 s2, 256
    s_cbranch_scc1 mg_end
    s_getpc_b64 s[24:25]
mg_pc0:
    v_lshlrev_b32 v12, 7, v0
    global_load_dword v247, v12, s[24:25]
    v_and_b32 v1, 63, v0
    v_lshrrev_b32 v12, 6, v0
    v_lshlrev_b32 v4, 4, v1
    v_readfirstlane_b32 s20, v12
    v_and_b32 v2, 15, v1
    v_lshrrev_b32 v3, 4, v1
    s_sub_u32 s52, s3, 160
    s_and_b32 s24, s3, 7
    s_lshr_b32 s25, s3, 3
    s_lshr_b32 s26, s52, 3
    s_cmp_ge_u32 s3, 160
    s_cselect_b32 s25, s26, s25
    s_cselect_b32 s26, 8, 16
    s_cselect_b32 s27, 20, 0
    s_cselect_b32 s28, 28, 16
    s_lshr_b32 s22, s25, 3
    s_lshl_b32 s22, s22, 3
    s_add_u32 s22, s22, s24
    s_add_u32 s22, s22, s27
    s_and_b32 s23, s25, 7
    s_lshr_b32 s29, s24, 1
    s_add_u32 s29, s29, s28
    s_and_b32 s30, s24, 1
    s_lshl_b32 s30, s30, 2
    s_add_u32 s30, s30, s25
    s_sub_u32 s30, s30, s26
    s_cmp_ge_u32 s25, s26
    s_cselect_b32 s22, s29, s22
    s_cselect_b32 s23, s30, s23
    s_lshr_b32 s53, s52, 5
    s_min_u32 s53, s53, 2
    s_cselect_b32 s53, s53, s53
    s_cmp_lt_u32 s3, 160
    s_cselect_b32 s53, 2, s53
    s_and_b32 s54, s52, 31
    s_cmp_lt_u32 s53, 2
    s_cselect_b32 s54, s54, s22
    s_lshl_b32 s32, s20, 10
    s_lshl_b32 s31, s20, 11
    s_and_b32 s33, s3, 7
    s_mul_i32 s33, s33, 20
    s_lshr_b32 s34, s3, 3
    s_add_u32 s33, s33, s34
    s_min_u32 s33, s33, 159
    s_lshl_b32 s34, s33, 2
    s_add_u32 s34, s34, s20
    s_movk_i32 s27, 1280
    v_lshrrev_b32 v12, 3, v1
    v_and_b32 v13, 7, v1
    v_xor_b32 v13, v13, v12
    v_lshlrev_b32 v13, 4, v13
    s_lshl_b32 s21, s20, 4
    v_add_u32 v12, s21, v12
    v_mad_u32_u24 v200, v12, s27, v13
    v_add_u32 v201, 10240, v200
    s_mov_b32 s26, 6554
    s_add_u32 s21, s20, 0
    s_lshl_b32 s21, s21, 6
    v_add_u32 v12, s21, v1
    v_mul_u32_u24 v13, s26, v12
    v_lshrrev_b32 v13, 16, v13
    v_mul_u32_u24 v14, 10, v13
    v_sub_u32 v14, v12, v14
    v_lshlrev_b32 v14, 4, v14
    v_and_b32 v15, 0x33, v13
    v_bfe_u32 v5, v13, 2, 1
    v_lshl_or_b32 v15, v5, 3, v15
    v_bfe_u32 v5, v13, 3, 1
    v_lshl_or_b32 v15, v5, 2, v15
    v_mad_u32_u24 v202, v15, s27, v14
    s_add_u32 s21, s20, 4
    s_lshl_b32 s21, s21, 6
    v_add_u32 v12, s21, v1
    v_mul_u32_u24 v13, s26, v12
    v_lshrrev_b32 v13, 16, v13
    v_mul_u32_u24 v14, 10, v13
    v_sub_u32 v14, v12, v14
    v_lshlrev_b32 v14, 4, v14
    v_and_b32 v15, 0x33, v13
    v_bfe_u32 v5, v13, 2, 1
    v_lshl_or_b32 v15, v5, 3, v15
    v_bfe_u32 v5, v13, 3, 1
    v_lshl_or_b32 v15, v5, 2, v15
    v_mad_u32_u24 v203, v15, s27, v14
    s_add_u32 s21, s20, 8
    s_lshl_b32 s21, s21, 6
    v_add_u32 v12, s21, v1
    v_mul_u32_u24 v13, s26, v12
    v_lshrrev_b32 v13, 16, v13
    v_mul_u32_u24 v14, 10, v13
    v_sub_u32 v14, v12, v14
    v_lshlrev_b32 v14, 4, v14
    v_and_b32 v15, 0x33, v13
    v_bfe_u32 v5, v13, 2, 1
    v_lshl_or_b32 v15, v5, 3, v15
    v_bfe_u32 v5, v13, 3, 1
    v_lshl_or_b32 v15, v5, 2, v15
    v_mad_u32_u24 v204, v15, s27, v14
    v_mov_b32 v12, 0x80000000
    v_cmp_gt_u32 vcc, 64, v13
    s_nop 1
    v_cndmask_b32 v204, v12, v204, vcc
    s_waitcnt lgkmcnt(0)
    s_mul_i32 s21, s54, 81920
    s_add_u32 s8, s82, s21
    s_addc_u32 s9, s83, 0
    s_mov_b32 s10, 81920
    s_mov_b32 s11, 0x20000
    s_mul_i32 s21, s23, 160
    s_add_u32 s40, s84, s21
    s_addc_u32 s41, s85, 0
    s_mov_b32 s42, 0
    s_mov_b32 s43, 0x20000
    s_sub_u32 s42, 819200, s21
    s_cmp_lt_u32 s53, 2
    s_cbranch_scc1 mg_kvpro
    s_add_u32 m0, s31, 0
    s_movk_i32 s36, 0
    buffer_load_dwordx4 v200, s[8:11], s36 offen lds
    s_add_u32 m0, s31, 1024
    s_nop 0
    buffer_load_dwordx4 v201, s[8:11], s36 offen lds
    s_add_u32 m0, s32, 107520
    s_mov_b32 s38, 0
    buffer_load_dwordx4 v202, s[40:43], s38 offen lds
    s_add_u32 m0, s32, 111616
    s_nop 0
    buffer_load_dwordx4 v203, s[40:43], s38 offen lds
    s_add_u32 s39, s32, 115712
    s_cmp_lt_u32 s20, 2
    s_cselect_b32 m0, s39, 160000
    s_nop 0
    buffer_load_dwordx4 v204, s[40:43], s38 offen lds
    s_cmp_ge_u32 s3, 160
    s_cbranch_scc1 mg_nokp
    v_lshlrev_b32 v12, 2, v1
    s_lshl_b32 s24, s34, 8
    v_add_u32 v13, s24, v12
    global_load_dword v104, v13, s[66:67]
    global_load_dword v105, v13, s[68:69]
    global_load_dword v106, v13, s[70:71]
    global_load_dword v107, v13, s[72:73]
    global_load_dword v108, v13, s[74:75]
    global_load_dword v109, v13, s[76:77]
    s_lshl_b32 s24, s34, 1
    v_mov_b32 v14, s24
    global_load_ushort v110, v14, s[78:79]
    global_load_ushort v198, v14, s[80:81]
    s_mul_i32 s21, s20, 25872
    s_add_u32 s21, s21, 0
    v_lshlrev_b32 v14, 3, v1
    v_add_u32 v196, s21, v14
    v_add_u32 v197, 17424, v196
    v_add_u32 v15, 0, v2
    v_mul_u32_u24 v15, 528, v15
    v_lshl_add_u32 v15, v3, 4, v15
    v_add_u32 v112, s21, v15
    v_add_u32 v15, 16, v2
    v_mul_u32_u24 v15, 528, v15
    v_lshl_add_u32 v15, v3, 4, v15
    v_add_u32 v113, s21, v15
    v_add_u32 v15, 0, v2
    v_bfe_u32 v12, v15, 1, 1
    v_add3_u32 v15, v15, v12, 0
    v_lshrrev_b32 v15, 1, v15
    v_lshlrev_b32 v15, 1, v15
    v_mul_u32_u24 v15, 528, v15
    v_lshl_add_u32 v15, v3, 4, v15
    v_add_u32 v114, s21, v15
    v_add_u32 v15, 16, v2
    v_bfe_u32 v12, v15, 1, 1
    v_add3_u32 v15, v15, v12, 0
    v_lshrrev_b32 v15, 1, v15
    v_lshlrev_b32 v15, 1, v15
    v_mul_u32_u24 v15, 528, v15
    v_lshl_add_u32 v15, v3, 4, v15
    v_add_u32 v115, s21, v15
    v_add_u32 v15, 0, v2
    v_bfe_u32 v12, v15, 2, 1
    v_add3_u32 v15, v15, v12, 1
    v_lshrrev_b32 v15, 2, v15
    v_lshlrev_b32 v15, 2, v15
    v_mul_u32_u24 v15, 528, v15
    v_lshl_add_u32 v15, v3, 4, v15
    v_add_u32 v116, s21, v15
    v_add_u32 v15, 16, v2
    v_bfe_u32 v12, v15, 2, 1
    v_add3_u32 v15, v15, v12, 1
    v_lshrrev_b32 v15, 2, v15
    v_lshlrev_b32 v15, 2, v15
    v_mul_u32_u24 v15, 528, v15
    v_lshl_add_u32 v15, v3, 4, v15
    v_add_u32 v117, s21, v15
    v_add_u32 v15, 0, v2
    v_bfe_u32 v12, v15, 3, 1
    v_add3_u32 v15, v15, v12, 3
    v_lshrrev_b32 v15, 3, v15
    v_lshlrev_b32 v15, 3, v15
    v_mul_u32_u24 v15, 528, v15
    v_lshl_add_u32 v15, v3, 4, v15
    v_add_u32 v118, s21, v15
    v_add_u32 v15, 16, v2
    v_bfe_u32 v12, v15, 3, 1
    v_add3_u32 v15, v15, v12, 3
    v_lshrrev_b32 v15, 3, v15
    v_lshlrev_b32 v15, 3, v15
    v_mul_u32_u24 v15, 528, v15
    v_lshl_add_u32 v15, v3, 4, v15
    v_add_u32 v119, s21, v15
    v_mul_u32_u24 v15, 528, v2
    v_lshl_add_u32 v15, v3, 4, v15
    v_add_u32 v15, 17424, v15
    v_add_u32 v111, s21, v15
mg_nokp:
    s_lshl_b32 s21, s20, 4
    v_add_u32 v12, s21, v2
    s_add_u32 m0, s31, 8192
    s_movk_i32 s36, 128
    buffer_load_dwordx4 v200, s[8:11], s36 offen lds
    v_lshlrev_b32 v12, 7, v12
    v_and_b32 v13, 7, v2
    v_xor_b32 v14, v13, v3
    v_lshl_add_u32 v222, v14, 4, v12
    s_add_u32 m0, s31, 9216
    s_nop 0
    buffer_load_dwordx4 v201, s[8:11], s36 offen lds
    v_add_u32 v14, 4, v3
    v_xor_b32 v14, v13, v14
    v_lshl_add_u32 v223, v14, 4, v12
    v_add_u32 v233, 65536, v222
    s_add_u32 m0, s32, 117760
    s_mov_b32 s38, 81920
    buffer_load_dwordx4 v202, s[40:43], s38 offen lds
    v_add_u32 v234, 65536, v223
    v_lshrrev_b32 v12, 1, v3
    v_lshlrev_b32 v12, 4, v12
    v_and_b32 v13, 1, v3
    s_add_u32 m0, s32, 121856
    s_nop 0
    buffer_load_dwordx4 v203, s[40:43], s38 offen lds
    v_lshl_add_u32 v12, v13, 2, v12
    v_lshrrev_b32 v13, 2, v2
    v_add_u32 v12, v12, v13
    v_mul_u32_u24 v12, 160, v12
    s_add_u32 s39, s32, 125952
    s_cmp_lt_u32 s20, 2
    s_cselect_b32 m0, s39, 160000
    s_nop 0
    buffer_load_dwordx4 v204, s[40:43], s38 offen lds
    v_and_b32 v13, 3, v2
    v_lshl_add_u32 v224, v13, 3, v12
    v_add_u32 v235, 65536, v224
    v_add_u32 v236, 0x20000, v224
    s_add_u32 m0, s31, 16384
    s_movk_i32 s36, 256
    buffer_load_dwordx4 v200, s[8:11], s36 offen lds
    s_and_b32 s21, s20, 1
    s_lshl_b32 s21, s21, 4
    v_add_u32 v15, s21, v2
    s_lshr_b32 s24, s20, 1
    s_mul_i32 s24, s24, 1280
    s_add_u32 s24, s24, 104448
    v_lshlrev_b32 v14, 3, v15
    v_add_u32 v14, s24, v14
    v_lshlrev_b32 v13, 4, v3
    s_add_u32 m0, s31, 17408
    s_nop 0
    buffer_load_dwordx4 v201, s[8:11], s36 offen lds
    v_and_b32 v13, 16, v13
    v_cmp_lt_u32 vcc, 1, v3
    v_mov_b32 v12, 0x82008000
    v_mov_b32 v6, 0x82088008
    v_cndmask_b32 v12, v12, v6, vcc
    v_lshrrev_b32 v12, v13, v12
    v_bfe_u32 v6, v12, 15, 1
    s_add_u32 m0, s32, 128000
    s_mov_b32 s38, 163840
    buffer_load_dwordx4 v202, s[40:43], s38 offen lds
    v_and_b32 v12, 0x7fff, v12
    v_mul_u32_u24 v6, v6, v15
    v_lshl_add_u32 v6, v6, 3, v14
    v_add_u32 v226, v6, v12
    s_add_u32 m0, s32, 132096
    s_nop 0
    buffer_load_dwordx4 v203, s[40:43], s38 offen lds
    v_mov_b32 v12, 0x8a000400
    v_mov_b32 v6, 0x8a088c00
    v_cndmask_b32 v12, v12, v6, vcc
    v_lshrrev_b32 v12, v13, v12
    v_bfe_u32 v6, v12, 15, 1
    v_and_b32 v12, 0x7fff, v12
    s_add_u32 s39, s32, 136192
    s_cmp_lt_u32 s20, 2
    s_cselect_b32 m0, s39, 160000
    s_nop 0
    buffer_load_dwordx4 v204, s[40:43], s38 offen lds
    v_mul_u32_u24 v6, v6, v15
    v_lshl_add_u32 v6, v6, 3, v14
    v_add_u32 v227, v6, v12
    v_mov_b32 v12, 0xe008c08
    s_add_u32 m0, s31, 24576
    s_movk_i32 s36, 384
    buffer_load_dwordx4 v200, s[8:11], s36 offen lds
    v_mov_b32 v6, 0x96009400
    v_cndmask_b32 v12, v12, v6, vcc
    v_lshrrev_b32 v12, v13, v12
    v_bfe_u32 v6, v12, 15, 1
    v_and_b32 v12, 0x7fff, v12
    v_mul_u32_u24 v6, v6, v15
    s_add_u32 m0, s31, 25600
    s_nop 0
    buffer_load_dwordx4 v201, s[8:11], s36 offen lds
    v_lshl_add_u32 v6, v6, 3, v14
    v_add_u32 v228, v6, v12
    v_mov_b32 v12, 0x96089408
    v_mov_b32 v6, 0x9e001800
    v_cndmask_b32 v12, v12, v6, vcc
    v_lshrrev_b32 v12, v13, v12
    s_add_u32 m0, s32, 138240
    s_mov_b32 s38, 245760
    buffer_load_dwordx4 v202, s[40:43], s38 offen lds
    v_bfe_u32 v6, v12, 15, 1
    v_and_b32 v12, 0x7fff, v12
    v_mul_u32_u24 v6, v6, v15
    v_lshl_add_u32 v6, v6, 3, v14
    s_add_u32 m0, s32, 142336
    s_nop 0
    buffer_load_dwordx4 v203, s[40:43], s38 offen lds
    v_add_u32 v229, v6, v12
    v_mov_b32 v12, 0x9e08a000
    v_mov_b32 v6, 0x2200a008
    v_cndmask_b32 v12, v12, v6, vcc
    v_lshrrev_b32 v12, v13, v12
    v_bfe_u32 v6, v12, 15, 1
    s_add_u32 s39, s32, 146432
    s_cmp_lt_u32 s20, 2
    s_cselect_b32 m0, s39, 160000
    s_nop 0
    buffer_load_dwordx4 v204, s[40:43], s38 offen lds
    v_and_b32 v12, 0x7fff, v12
    v_mul_u32_u24 v6, v6, v15
    v_lshl_add_u32 v6, v6, 3, v14
    v_add_u32 v230, v6, v12
    v_add_u32 v231, 104448, v4
    v_lshlrev_b32 v232, 3, v1
    v_mov_b32 v12, 0x80000000
    v_lshlrev_b32 v5, 3, v1
    v_cmp_gt_u32 vcc, 32, v1
    v_and_b32 v13, 31, v1
    s_nop 0
    v_cndmask_b32 v5, v12, v5, vcc
    v_cmp_gt_u32 vcc, 21, v13
    s_nop 1
    v_cndmask_b32 v8, v12, v4, vcc
    s_getpc_b64 s[24:25]
mga_pc:
    s_lshr_b32 s26, s3, 3
    s_lshl_b32 s26, s26, 2
    s_add_u32 s26, s26, s20
    s_mul_i32 s26, s26, 768
    v_min_u32 v12, 5, v1
    v_lshlrev_b32 v12, 7, v12
    v_add_u32 v12, s26, v12
    v_min_u32 v12, mg_end-mga_pc-4, v12
    global_load_dword v249, v12, s[24:25]
    s_lshl_b32 s26, s3, 2
    s_add_u32 s26, s26, s20
    s_lshl_b32 s26, s26, 6
    v_add_u32 v12, s26, v1
    v_lshlrev_b32 v13, 7, v12
    s_mov_b32 s12, s82
    s_mov_b32 s13, s83
    s_mov_b32 s14, 2621440
    s_mov_b32 s15, 0x20000
    buffer_load_dword v250, v13, s[12:15], 0 offen
    v_subrev_u32 v13, 0x280000, v13
    s_mov_b32 s12, s84
    s_mov_b32 s13, s85
    s_mov_b32 s14, 819200
    s_mov_b32 s15, 0x20000
    buffer_load_dword v251, v13, s[12:15], 0 offen
    s_cmp_ge_u32 s3, 160
    s_cbranch_scc1 mg_noks
    s_waitcnt vmcnt(18)
    v_lshlrev_b32 v110, 16, v110
    v_mul_f32 v110, 0x3fb8aa3b, v110
    v_exp_f32 v110, v110
    s_nop 0
    v_cvt_pk_bf16_f32 v110, v110, v110
    v_lshlrev_b32 v110, 16, v110
    v_lshlrev_b32 v176, 16, v104
    v_lshlrev_b32 v177, 16, v105
    v_lshlrev_b32 v178, 16, v106
    v_lshlrev_b32 v179, 16, v107
    v_lshlrev_b32 v180, 16, v108
    v_lshlrev_b32 v181, 16, v109
    v_mul_f32 v192, v110, v176
    v_mul_f32 v193, v110, v177
    v_mul_f32 v178, v110, v178
    v_mul_f32 v179, v110, v179
    v_mul_f32 v192, 0x3fb8aa3b, v192
    v_mul_f32 v193, 0x3e22f983, v193
    v_mul_f32 v188, v180, v178
    v_mul_f32 v189, v180, v179
    v_fma_f32 v188, -v181, v179, v188
    v_fma_f32 v189, v181, v178, v189
    v_exp_f32 v182, v192
    v_fract_f32 v183, v193
    v_cos_f32 v194, v183
    v_sin_f32 v195, v183
    s_nop 0
    v_mul_f32 v120, v182, v194
    v_mul_f32 v121, v182, v195
    v_mul_f32 v182, 0x42000000, v192
    v_mul_f32 v183, 0x42000000, v193
    v_exp_f32 v182, v182
    v_fract_f32 v183, v183
    v_cos_f32 v194, v183
    v_sin_f32 v195, v183
    s_nop 0
    v_mul_f32 v124, v182, v194
    v_mul_f32 v125, v182, v195
    v_and_b32 v176, 0xffff0000, v104
    v_and_b32 v177, 0xffff0000, v105
    v_and_b32 v178, 0xffff0000, v106
    v_and_b32 v179, 0xffff0000, v107
    v_and_b32 v180, 0xffff0000, v108
    v_and_b32 v181, 0xffff0000, v109
    v_mul_f32 v192, v110, v176
    v_mul_f32 v193, v110, v177
    v_mul_f32 v178, v110, v178
    v_mul_f32 v179, v110, v179
    v_mul_f32 v192, 0x3fb8aa3b, v192
    v_mul_f32 v193, 0x3e22f983, v193
    v_mul_f32 v190, v180, v178
    v_mul_f32 v191, v180, v179
    v_fma_f32 v190, -v181, v179, v190
    v_fma_f32 v191, v181, v178, v191
    v_exp_f32 v182, v192
    v_fract_f32 v183, v193
    v_cos_f32 v194, v183
    v_sin_f32 v195, v183
    s_nop 0
    v_mul_f32 v122, v182, v194
    v_mul_f32 v123, v182, v195
    v_mul_f32 v182, 0x42000000, v192
    v_mul_f32 v183, 0x42000000, v193
    v_exp_f32 v182, v182
    v_fract_f32 v183, v183
    v_cos_f32 v194, v183
    v_sin_f32 v195, v183
    s_nop 0
    v_mul_f32 v126, v182, v194
    v_mul_f32 v127, v182, v195
    v_mov_b32 v176, v188
    v_mov_b32 v177, v189
    v_mov_b32 v178, v190
    v_mov_b32 v179, v191
mg_noks:
    s_branch mg_qgemm
mg_kvpro:
    s_cmp_eq_u32 s53, 0
    s_cselect_b32 s24, s86, s88
    s_cselect_b32 s25, s87, s89
    s_mov_b32 s12, s24
    s_mov_b32 s13, s25
    s_mov_b32 s14, 25600
    s_mov_b32 s15, 0x20000
    s_add_u32 s28, s32, 0
    s_add_u32 m0, s28, 81920
    s_nop 0
    buffer_load_dwordx4 v4, s[12:15], s28 offen lds
    s_add_u32 s28, s32, 4096
    s_add_u32 m0, s28, 81920
    s_nop 0
    buffer_load_dwordx4 v4, s[12:15], s28 offen lds
    s_add_u32 s28, s32, 8192
    s_add_u32 m0, s28, 81920
    s_nop 0
    buffer_load_dwordx4 v4, s[12:15], s28 offen lds
    s_add_u32 s28, s32, 12288
    s_add_u32 m0, s28, 81920
    s_nop 0
    buffer_load_dwordx4 v4, s[12:15], s28 offen lds
    s_add_u32 s28, s32, 16384
    s_add_u32 m0, s28, 81920
    s_nop 0
    buffer_load_dwordx4 v4, s[12:15], s28 offen lds
    s_add_u32 s28, s32, 20480
    s_add_u32 m0, s28, 81920
    s_nop 0
    buffer_load_dwordx4 v4, s[12:15], s28 offen lds
    s_cmp_eq_u32 s20, 0
    s_mov_b32 s29, 106496
    s_cselect_b32 m0, s29, 160000
    s_mov_b32 s30, 0x7fff0000
    s_cselect_b32 s28, 24576, s30
    buffer_load_dwordx4 v4, s[12:15], s28 offen lds
    s_lshl_b32 s21, s20, 4
    v_add_u32 v12, s21, v2
    s_add_u32 m0, s31, 0
    s_movk_i32 s36, 0
    buffer_load_dwordx4 v200, s[8:11], s36 offen lds
    v_lshlrev_b32 v12, 7, v12
    v_and_b32 v13, 7, v2
    v_xor_b32 v14, v13, v3
    s_add_u32 m0, s31, 1024
    s_nop 0
    buffer_load_dwordx4 v201, s[8:11], s36 offen lds
    v_lshl_add_u32 v222, v14, 4, v12
    v_add_u32 v14, 4, v3
    v_xor_b32 v14, v13, v14
    s_add_u32 m0, s31, 8192
    s_movk_i32 s36, 128
    buffer_load_dwordx4 v200, s[8:11], s36 offen lds
    v_lshl_add_u32 v223, v14, 4, v12
    v_add_u32 v233, 65536, v222
    v_add_u32 v234, 65536, v223
    s_add_u32 m0, s31, 9216
    s_nop 0
    buffer_load_dwordx4 v201, s[8:11], s36 offen lds
    v_lshrrev_b32 v12, 1, v3
    v_lshlrev_b32 v12, 4, v12
    v_and_b32 v13, 1, v3
    s_add_u32 m0, s31, 16384
    s_movk_i32 s36, 256
    buffer_load_dwordx4 v200, s[8:11], s36 offen lds
    v_lshl_add_u32 v12, v13, 2, v12
    v_lshrrev_b32 v13, 2, v2
    v_add_u32 v12, v12, v13
    s_add_u32 m0, s31, 17408
    s_nop 0
    buffer_load_dwordx4 v201, s[8:11], s36 offen lds
    v_mul_u32_u24 v12, 160, v12
    v_and_b32 v13, 3, v2
    v_lshl_add_u32 v224, v13, 3, v12
    s_add_u32 m0, s31, 24576
    s_movk_i32 s36, 384
    buffer_load_dwordx4 v200, s[8:11], s36 offen lds
    v_add_u32 v235, 65536, v224
    v_add_u32 v236, 0x20000, v224
    s_and_b32 s21, s20, 1
    s_lshl_b32 s21, s21, 4
    v_add_u32 v15, s21, v2
    s_add_u32 m0, s31, 25600
    s_nop 0
    buffer_load_dwordx4 v201, s[8:11], s36 offen lds
    s_lshr_b32 s24, s20, 1
    s_mul_i32 s24, s24, 1280
    s_add_u32 s24, s24, 104448
    v_lshlrev_b32 v14, 3, v15
    v_add_u32 v14, s24, v14
    v_lshlrev_b32 v13, 4, v3
    s_add_u32 m0, s31, 32768
    s_movk_i32 s36, 512
    buffer_load_dwordx4 v200, s[8:11], s36 offen lds
    v_and_b32 v13, 16, v13
    v_cmp_lt_u32 vcc, 1, v3
    v_mov_b32 v12, 0x82008000
    v_mov_b32 v6, 0x82088008
    v_cndmask_b32 v12, v12, v6, vcc
    v_lshrrev_b32 v12, v13, v12
    s_add_u32 m0, s31, 33792
    s_nop 0
    buffer_load_dwordx4 v201, s[8:11], s36 offen lds
    v_bfe_u32 v6, v12, 15, 1
    v_and_b32 v12, 0x7fff, v12
    v_mul_u32_u24 v6, v6, v15
    s_add_u32 m0, s31, 40960
    s_movk_i32 s36, 640
    buffer_load_dwordx4 v200, s[8:11], s36 offen lds
    v_lshl_add_u32 v6, v6, 3, v14
    v_add_u32 v226, v6, v12
    v_mov_b32 v12, 0x8a000400
    s_add_u32 m0, s31, 41984
    s_nop 0
    buffer_load_dwordx4 v201, s[8:11], s36 offen lds
    v_mov_b32 v6, 0x8a088c00
    v_cndmask_b32 v12, v12, v6, vcc
    v_lshrrev_b32 v12, v13, v12
    v_bfe_u32 v6, v12, 15, 1
    v_and_b32 v12, 0x7fff, v12
    s_add_u32 m0, s31, 49152
    s_movk_i32 s36, 768
    buffer_load_dwordx4 v200, s[8:11], s36 offen lds
    v_mul_u32_u24 v6, v6, v15
    v_lshl_add_u32 v6, v6, 3, v14
    v_add_u32 v227, v6, v12
    s_add_u32 m0, s31, 50176
    s_nop 0
    buffer_load_dwordx4 v201, s[8:11], s36 offen lds
    v_mov_b32 v12, 0xe008c08
    v_mov_b32 v6, 0x96009400
    v_cndmask_b32 v12, v12, v6, vcc
    v_lshrrev_b32 v12, v13, v12
    v_bfe_u32 v6, v12, 15, 1
    s_add_u32 m0, s31, 57344
    s_movk_i32 s36, 896
    buffer_load_dwordx4 v200, s[8:11], s36 offen lds
    v_and_b32 v12, 0x7fff, v12
    v_mul_u32_u24 v6, v6, v15
    v_lshl_add_u32 v6, v6, 3, v14
    s_add_u32 m0, s31, 58368
    s_nop 0
    buffer_load_dwordx4 v201, s[8:11], s36 offen lds
    v_add_u32 v228, v6, v12
    v_mov_b32 v12, 0x96089408
    v_mov_b32 v6, 0x9e001800
    v_cndmask_b32 v12, v12, v6, vcc
    v_lshrrev_b32 v12, v13, v12
    s_add_u32 m0, s31, 65536
    s_movk_i32 s36, 1024
    buffer_load_dwordx4 v200, s[8:11], s36 offen lds
    v_bfe_u32 v6, v12, 15, 1
    v_and_b32 v12, 0x7fff, v12
    v_mul_u32_u24 v6, v6, v15
    s_add_u32 m0, s31, 66560
    s_nop 0
    buffer_load_dwordx4 v201, s[8:11], s36 offen lds
    v_lshl_add_u32 v6, v6, 3, v14
    v_add_u32 v229, v6, v12
    v_mov_b32 v12, 0x9e08a000
    s_add_u32 m0, s31, 73728
    s_movk_i32 s36, 1152
    buffer_load_dwordx4 v200, s[8:11], s36 offen lds
    v_mov_b32 v6, 0x2200a008
    v_cndmask_b32 v12, v12, v6, vcc
    v_lshrrev_b32 v12, v13, v12
    v_bfe_u32 v6, v12, 15, 1
    v_and_b32 v12, 0x7fff, v12
    s_add_u32 m0, s31, 74752
    s_nop 0
    buffer_load_dwordx4 v201, s[8:11], s36 offen lds
    v_mul_u32_u24 v6, v6, v15
    v_lshl_add_u32 v6, v6, 3, v14
    v_add_u32 v230, v6, v12
    v_add_u32 v231, 104448, v4
    v_lshlrev_b32 v232, 3, v1
    v_mov_b32 v12, 0x80000000
    v_lshlrev_b32 v5, 3, v1
    v_cmp_gt_u32 vcc, 32, v1
    v_and_b32 v13, 31, v1
    s_nop 0
    v_cndmask_b32 v5, v12, v5, vcc
    v_cmp_gt_u32 vcc, 21, v13
    s_nop 1
    v_cndmask_b32 v8, v12, v4, vcc
    s_getpc_b64 s[24:25]
mgb_pc:
    s_lshr_b32 s26, s3, 3
    s_lshl_b32 s26, s26, 2
    s_add_u32 s26, s26, s20
    s_mul_i32 s26, s26, 768
    v_min_u32 v12, 5, v1
    v_lshlrev_b32 v12, 7, v12
    v_add_u32 v12, s26, v12
    v_min_u32 v12, mg_end-mgb_pc-4, v12
    global_load_dword v249, v12, s[24:25]
    s_lshl_b32 s26, s3, 2
    s_add_u32 s26, s26, s20
    s_lshl_b32 s26, s26, 6
    v_add_u32 v12, s26, v1
    v_lshlrev_b32 v13, 7, v12
    s_mov_b32 s12, s82
    s_mov_b32 s13, s83
    s_mov_b32 s14, 2621440
    s_mov_b32 s15, 0x20000
    buffer_load_dword v250, v13, s[12:15], 0 offen
    v_subrev_u32 v13, 0x280000, v13
    s_mov_b32 s12, s84
    s_mov_b32 s13, s85
    s_mov_b32 s14, 819200
    s_mov_b32 s15, 0x20000
    buffer_load_dword v251, v13, s[12:15], 0 offen
    v_lshrrev_b32 v12, 2, v2
    v_lshl_add_u32 v12, v3, 3, v12
    v_mul_u32_u24 v12, 40, v12
    v_and_b32 v13, 3, v2
    v_lshl_add_u32 v12, v13, 3, v12
    v_add_u32 v176, 81920, v12
    v_mov_b32 v64, 0
    v_mov_b32 v65, 0
    v_mov_b32 v66, 0
    v_mov_b32 v67, 0
    v_mov_b32 v68, 0
    v_mov_b32 v69, 0
    v_mov_b32 v70, 0
    v_mov_b32 v71, 0
    s_mul_i32 s21, s22, 81920
    s_add_u32 s56, s82, s21
    s_addc_u32 s57, s83, 0
    s_mov_b32 s58, 81920
    s_mov_b32 s59, 0x20000
    s_waitcnt vmcnt(18)
    s_barrier
    s_cmp_eq_u32 s53, 0
    s_cbranch_scc0 mg_b_vpart
    ds_read_b128 v[104:107], v222 offset:0
    ds_read_b64_tr_b16 v[72:73], v176 offset:0
    ds_read_b64_tr_b16 v[74:75], v176 offset:160
    ds_read_b64_tr_b16 v[76:77], v176 offset:32
    ds_read_b64_tr_b16 v[78:79], v176 offset:192
    ds_read_b128 v[108:111], v223 offset:0
    ds_read_b64_tr_b16 v[80:81], v176 offset:1280
    ds_read_b64_tr_b16 v[82:83], v176 offset:1440
    ds_read_b64_tr_b16 v[84:85], v176 offset:1312
    ds_read_b64_tr_b16 v[86:87], v176 offset:1472
    s_waitcnt lgkmcnt(5)
    v_mfma_f32_16x16x32_bf16 v[64:67], v[72:75], v[104:107], v[64:67]
    v_mfma_f32_16x16x32_bf16 v[68:71], v[76:79], v[104:107], v[68:71]
    s_waitcnt vmcnt(16)
    ds_read_b128 v[104:107], v222 offset:8192
    ds_read_b64_tr_b16 v[72:73], v176 offset:2560
    ds_read_b64_tr_b16 v[74:75], v176 offset:2720
    ds_read_b64_tr_b16 v[76:77], v176 offset:2592
    ds_read_b64_tr_b16 v[78:79], v176 offset:2752
    s_waitcnt lgkmcnt(5)
    v_mfma_f32_16x16x32_bf16 v[64:67], v[80:83], v[108:111], v[64:67]
    v_mfma_f32_16x16x32_bf16 v[68:71], v[84:87], v[108:111], v[68:71]
    ds_read_b128 v[108:111], v223 offset:8192
    ds_read_b64_tr_b16 v[80:81], v176 offset:3840
    ds_read_b64_tr_b16 v[82:83], v176 offset:4000
    ds_read_b64_tr_b16 v[84:85], v176 offset:3872
    ds_read_b64_tr_b16 v[86:87], v176 offset:4032
    s_add_u32 m0, s31, 0
    s_movk_i32 s36, 0
    buffer_load_dwordx4 v200, s[56:59], s36 offen lds
    s_add_u32 m0, s31, 1024
    s_nop 0
    buffer_load_dwordx4 v201, s[56:59], s36 offen lds
    s_waitcnt lgkmcnt(5)
    v_mfma_f32_16x16x32_bf16 v[64:67], v[72:75], v[104:107], v[64:67]
    v_mfma_f32_16x16x32_bf16 v[68:71], v[76:79], v[104:107], v[68:71]
    s_waitcnt vmcnt(16)
    ds_read_b128 v[104:107], v222 offset:16384
    ds_read_b64_tr_b16 v[72:73], v176 offset:5120
    ds_read_b64_tr_b16 v[74:75], v176 offset:5280
    ds_read_b64_tr_b16 v[76:77], v176 offset:5152
    ds_read_b64_tr_b16 v[78:79], v176 offset:5312
    s_waitcnt lgkmcnt(5)
    v_mfma_f32_16x16x32_bf16 v[64:67], v[80:83], v[108:111], v[64:67]
    v_mfma_f32_16x16x32_bf16 v[68:71], v[84:87], v[108:111], v[68:71]
    ds_read_b128 v[108:111], v223 offset:16384
    ds_read_b64_tr_b16 v[80:81], v176 offset:6400
    ds_read_b64_tr_b16 v[82:83], v176 offset:6560
    ds_read_b64_tr_b16 v[84:85], v176 offset:6432
    ds_read_b64_tr_b16 v[86:87], v176 offset:6592
    s_add_u32 m0, s31, 8192
    s_movk_i32 s36, 128
    buffer_load_dwordx4 v200, s[56:59], s36 offen lds
    s_add_u32 m0, s31, 9216
    s_nop 0
    buffer_load_dwordx4 v201, s[56:59], s36 offen lds
    s_waitcnt lgkmcnt(5)
    v_mfma_f32_16x16x32_bf16 v[64:67], v[72:75], v[104:107], v[64:67]
    v_mfma_f32_16x16x32_bf16 v[68:71], v[76:79], v[104:107], v[68:71]
    s_waitcnt vmcnt(16)
    ds_read_b128 v[104:107], v222 offset:24576
    ds_read_b64_tr_b16 v[72:73], v176 offset:7680
    ds_read_b64_tr_b16 v[74:75], v176 offset:7840
    ds_read_b64_tr_b16 v[76:77], v176 offset:7712
    ds_read_b64_tr_b16 v[78:79], v176 offset:7872
    s_waitcnt lgkmcnt(5)
    v_mfma_f32_16x16x32_bf16 v[64:67], v[80:83], v[108:111], v[64:67]
    v_mfma_f32_16x16x32_bf16 v[68:71], v[84:87], v[108:111], v[68:71]
    ds_read_b128 v[108:111], v223 offset:24576
    ds_read_b64_tr_b16 v[80:81], v176 offset:8960
    ds_read_b64_tr_b16 v[82:83], v176 offset:9120
    ds_read_b64_tr_b16 v[84:85], v176 offset:8992
    ds_read_b64_tr_b16 v[86:87], v176 offset:9152
    s_add_u32 m0, s31, 16384
    s_movk_i32 s36, 256
    buffer_load_dwordx4 v200, s[56:59], s36 offen lds
    s_add_u32 m0, s31, 17408
    s_nop 0
    buffer_load_dwordx4 v201, s[56:59], s36 offen lds
    s_waitcnt lgkmcnt(5)
    v_mfma_f32_16x16x32_bf16 v[64:67], v[72:75], v[104:107], v[64:67]
    v_mfma_f32_16x16x32_bf16 v[68:71], v[76:79], v[104:107], v[68:71]
    s_waitcnt vmcnt(16)
    ds_read_b128 v[104:107], v222 offset:32768
    ds_read_b64_tr_b16 v[72:73], v176 offset:10240
    ds_read_b64_tr_b16 v[74:75], v176 offset:10400
    ds_read_b64_tr_b16 v[76:77], v176 offset:10272
    ds_read_b64_tr_b16 v[78:79], v176 offset:10432
    s_waitcnt lgkmcnt(5)
    v_mfma_f32_16x16x32_bf16 v[64:67], v[80:83], v[108:111], v[64:67]
    v_mfma_f32_16x16x32_bf16 v[68:71], v[84:87], v[108:111], v[68:71]
    ds_read_b128 v[108:111], v223 offset:32768
    ds_read_b64_tr_b16 v[80:81], v176 offset:11520
    ds_read_b64_tr_b16 v[82:83], v176 offset:11680
    ds_read_b64_tr_b16 v[84:85], v176 offset:11552
    ds_read_b64_tr_b16 v[86:87], v176 offset:11712
    s_add_u32 m0, s32, 107520
    s_mov_b32 s38, 0
    buffer_load_dwordx4 v202, s[40:43], s38 offen lds
    s_add_u32 m0, s31, 24576
    s_movk_i32 s36, 384
    buffer_load_dwordx4 v200, s[56:59], s36 offen lds
    s_add_u32 m0, s31, 25600
    s_nop 0
    buffer_load_dwordx4 v201, s[56:59], s36 offen lds
    s_waitcnt lgkmcnt(5)
    v_mfma_f32_16x16x32_bf16 v[64:67], v[72:75], v[104:107], v[64:67]
    v_mfma_f32_16x16x32_bf16 v[68:71], v[76:79], v[104:107], v[68:71]
    s_waitcnt vmcnt(17)
    ds_read_b128 v[104:107], v222 offset:40960
    ds_read_b64_tr_b16 v[72:73], v176 offset:12800
    ds_read_b64_tr_b16 v[74:75], v176 offset:12960
    ds_read_b64_tr_b16 v[76:77], v176 offset:12832
    ds_read_b64_tr_b16 v[78:79], v176 offset:12992
    s_add_u32 m0, s32, 111616
    s_nop 0
    buffer_load_dwordx4 v203, s[40:43], s38 offen lds
    s_waitcnt lgkmcnt(5)
    v_mfma_f32_16x16x32_bf16 v[64:67], v[80:83], v[108:111], v[64:67]
    v_mfma_f32_16x16x32_bf16 v[68:71], v[84:87], v[108:111], v[68:71]
    ds_read_b128 v[108:111], v223 offset:40960
    ds_read_b64_tr_b16 v[80:81], v176 offset:14080
    ds_read_b64_tr_b16 v[82:83], v176 offset:14240
    ds_read_b64_tr_b16 v[84:85], v176 offset:14112
    ds_read_b64_tr_b16 v[86:87], v176 offset:14272
    s_add_u32 s39, s32, 115712
    s_cmp_lt_u32 s20, 2
    s_cselect_b32 m0, s39, 160000
    s_nop 0
    buffer_load_dwordx4 v204, s[40:43], s38 offen lds
    s_waitcnt lgkmcnt(5)
    v_mfma_f32_16x16x32_bf16 v[64:67], v[72:75], v[104:107], v[64:67]
    v_mfma_f32_16x16x32_bf16 v[68:71], v[76:79], v[104:107], v[68:71]
    s_waitcnt vmcnt(17)
    ds_read_b128 v[104:107], v222 offset:49152
    ds_read_b64_tr_b16 v[72:73], v176 offset:15360
    ds_read_b64_tr_b16 v[74:75], v176 offset:15520
    ds_read_b64_tr_b16 v[76:77], v176 offset:15392
    ds_read_b64_tr_b16 v[78:79], v176 offset:15552
    s_add_u32 m0, s32, 117760
    s_mov_b32 s38, 81920
    buffer_load_dwordx4 v202, s[40:43], s38 offen lds
    s_waitcnt lgkmcnt(5)
    v_mfma_f32_16x16x32_bf16 v[64:67], v[80:83], v[108:111], v[64:67]
    v_mfma_f32_16x16x32_bf16 v[68:71], v[84:87], v[108:111], v[68:71]
    ds_read_b128 v[108:111], v223 offset:49152
    ds_read_b64_tr_b16 v[80:81], v176 offset:16640
    ds_read_b64_tr_b16 v[82:83], v176 offset:16800
    ds_read_b64_tr_b16 v[84:85], v176 offset:16672
    ds_read_b64_tr_b16 v[86:87], v176 offset:16832
    s_add_u32 m0, s32, 121856
    s_nop 0
    buffer_load_dwordx4 v203, s[40:43], s38 offen lds
    s_waitcnt lgkmcnt(5)
    v_mfma_f32_16x16x32_bf16 v[64:67], v[72:75], v[104:107], v[64:67]
    v_mfma_f32_16x16x32_bf16 v[68:71], v[76:79], v[104:107], v[68:71]
    s_waitcnt vmcnt(17)
    ds_read_b128 v[104:107], v222 offset:57344
    ds_read_b64_tr_b16 v[72:73], v176 offset:17920
    ds_read_b64_tr_b16 v[74:75], v176 offset:18080
    ds_read_b64_tr_b16 v[76:77], v176 offset:17952
    ds_read_b64_tr_b16 v[78:79], v176 offset:18112
    s_add_u32 s39, s32, 125952
    s_cmp_lt_u32 s20, 2
    s_cselect_b32 m0, s39, 160000
    s_nop 0
    buffer_load_dwordx4 v204, s[40:43], s38 offen lds
    s_waitcnt lgkmcnt(5)
    v_mfma_f32_16x16x32_bf16 v[64:67], v[80:83], v[108:111], v[64:67]
    v_mfma_f32_16x16x32_bf16 v[68:71], v[84:87], v[108:111], v[68:71]
    ds_read_b128 v[108:111], v223 offset:57344
    ds_read_b64_tr_b16 v[80:81], v176 offset:19200
    ds_read_b64_tr_b16 v[82:83], v176 offset:19360
    ds_read_b64_tr_b16 v[84:85], v176 offset:19232
    ds_read_b64_tr_b16 v[86:87], v176 offset:19392
    s_add_u32 m0, s32, 128000
    s_mov_b32 s38, 163840
    buffer_load_dwordx4 v202, s[40:43], s38 offen lds
    s_waitcnt lgkmcnt(5)
    v_mfma_f32_16x16x32_bf16 v[64:67], v[72:75], v[104:107], v[64:67]
    v_mfma_f32_16x16x32_bf16 v[68:71], v[76:79], v[104:107], v[68:71]
    s_waitcnt vmcnt(17)
    ds_read_b128 v[104:107], v233 offset:0
    ds_read_b64_tr_b16 v[72:73], v176 offset:20480
    ds_read_b64_tr_b16 v[74:75], v176 offset:20640
    ds_read_b64_tr_b16 v[76:77], v176 offset:20512
    ds_read_b64_tr_b16 v[78:79], v176 offset:20672
    s_add_u32 m0, s32, 132096
    s_nop 0
    buffer_load_dwordx4 v203, s[40:43], s38 offen lds
    s_waitcnt lgkmcnt(5)
    v_mfma_f32_16x16x32_bf16 v[64:67], v[80:83], v[108:111], v[64:67]
    v_mfma_f32_16x16x32_bf16 v[68:71], v[84:87], v[108:111], v[68:71]
    ds_read_b128 v[108:111], v234 offset:0
    ds_read_b64_tr_b16 v[80:81], v176 offset:21760
    ds_read_b64_tr_b16 v[82:83], v176 offset:21920
    ds_read_b64_tr_b16 v[84:85], v176 offset:21792
    ds_read_b64_tr_b16 v[86:87], v176 offset:21952
    s_add_u32 s39, s32, 136192
    s_cmp_lt_u32 s20, 2
    s_cselect_b32 m0, s39, 160000
    s_nop 0
    buffer_load_dwordx4 v204, s[40:43], s38 offen lds
    s_waitcnt lgkmcnt(5)
    v_mfma_f32_16x16x32_bf16 v[64:67], v[72:75], v[104:107], v[64:67]
    v_mfma_f32_16x16x32_bf16 v[68:71], v[76:79], v[104:107], v[68:71]
    s_waitcnt vmcnt(17)
    ds_read_b128 v[104:107], v233 offset:8192
    ds_read_b64_tr_b16 v[72:73], v176 offset:23040
    ds_read_b64_tr_b16 v[74:75], v176 offset:23200
    ds_read_b64_tr_b16 v[76:77], v176 offset:23072
    ds_read_b64_tr_b16 v[78:79], v176 offset:23232
    s_add_u32 m0, s32, 138240
    s_mov_b32 s38, 245760
    buffer_load_dwordx4 v202, s[40:43], s38 offen lds
    s_waitcnt lgkmcnt(5)
    v_mfma_f32_16x16x32_bf16 v[64:67], v[80:83], v[108:111], v[64:67]
    v_mfma_f32_16x16x32_bf16 v[68:71], v[84:87], v[108:111], v[68:71]
    ds_read_b128 v[108:111], v234 offset:8192
    ds_read_b64_tr_b16 v[80:81], v176 offset:24320
    ds_read_b64_tr_b16 v[82:83], v176 offset:24480
    ds_read_b64_tr_b16 v[84:85], v176 offset:24352
    ds_read_b64_tr_b16 v[86:87], v176 offset:24512
    s_add_u32 m0, s32, 142336
    s_nop 0
    buffer_load_dwordx4 v203, s[40:43], s38 offen lds
    s_waitcnt lgkmcnt(5)
    v_mfma_f32_16x16x32_bf16 v[64:67], v[72:75], v[104:107], v[64:67]
    v_mfma_f32_16x16x32_bf16 v[68:71], v[76:79], v[104:107], v[68:71]
    s_add_u32 s39, s32, 146432
    s_cmp_lt_u32 s20, 2
    s_cselect_b32 m0, s39, 160000
    s_nop 0
    buffer_load_dwordx4 v204, s[40:43], s38 offen lds
    s_waitcnt lgkmcnt(0)
    v_mfma_f32_16x16x32_bf16 v[64:67], v[80:83], v[108:111], v[64:67]
    v_mfma_f32_16x16x32_bf16 v[68:71], v[84:87], v[108:111], v[68:71]
    s_lshr_b32 s21, s20, 1
    s_lshl_b32 s26, s54, 1
    s_add_u32 s21, s21, s26
    s_and_b32 s26, s20, 1
    s_mov_b32 s16, s4
    s_mov_b32 s17, s5
    s_mov_b32 s18, 262144
    s_mov_b32 s19, 0x20000
    v_mov_b32 v19, 0x80000000
    v_and_b32 v12, 1, v3
    v_cmp_gt_u32 vcc, 2, v3
    v_cvt_pk_bf16_f32 v112, v64, v65
    v_cvt_pk_bf16_f32 v113, v66, v67
    v_cvt_pk_bf16_f32 v116, v68, v69
    v_cvt_pk_bf16_f32 v117, v70, v71
    v_mov_b32 v120, v112
    v_mov_b32 v121, v113
    v_mov_b32 v122, v116
    v_mov_b32 v123, v117
    s_nop 1
    v_permlane32_swap_b32 v120, v114
    v_permlane32_swap_b32 v121, v115
    v_permlane32_swap_b32 v122, v118
    v_permlane32_swap_b32 v123, v119
    s_lshl_b32 s28, s26, 4
    v_add_u32 v14, s28, v2
    v_lshl_add_u32 v15, v12, 5, v14
    v_lshlrev_b32 v15, 4, v15
    s_lshl_b32 s28, s21, 10
    s_add_u32 s28, s28, 0
    v_add_u32 v15, s28, v15
    v_cndmask_b32 v15, v19, v15, vcc
    buffer_store_dwordx4 v[112:115], v15, s[16:19], 0 offen sc1
    v_lshlrev_b32 v14, 3, v14
    s_lshl_b32 s28, s21, 9
    s_add_u32 s28, s28, 65536
    v_add_u32 v14, s28, v14
    v_cmp_eq_u32 vcc, 0, v3
    s_nop 1
    v_cndmask_b32 v14, v19, v14, vcc
    buffer_store_dwordx2 v[116:117], v14, s[16:19], 0 offen sc1
    s_lshl_b32 s28, s54, 7
    s_add_u32 s28, s28, 17825792
    s_add_u32 s44, s4, s28
    s_addc_u32 s45, s5, 0
    s_mov_b32 s46, 128
    s_mov_b32 s47, 0x20000
    v_lshlrev_b32 v14, 2, v0
    v_mov_b32 v13, 0
    buffer_store_dword v13, v14, s[44:47], 0 offen sc1
    s_waitcnt vmcnt(0)
    s_barrier
    s_cmp_lg_u32 s20, 0
    s_cbranch_scc1 mg_b_nfk
    s_mov_b32 s44, s94
    s_mov_b32 s45, s95
    s_mov_b32 s46, 256
    s_mov_b32 s47, 0x20000
    s_lshl_b32 s28, s52, 2
    v_mov_b32 v14, s28
    v_mov_b32 v13, 1
    s_mov_b64 exec, 1
    buffer_store_dword v13, v14, s[44:47], 0 offen sc1
    s_mov_b64 exec, -1
mg_b_nfk:
    s_branch mg_b_ownx
mg_b_vpart:
    ds_read_b128 v[104:107], v222 offset:0
    ds_read_b64_tr_b16 v[72:73], v176 offset:0
    ds_read_b64_tr_b16 v[74:75], v176 offset:160
    ds_read_b64_tr_b16 v[76:77], v176 offset:32
    ds_read_b64_tr_b16 v[78:79], v176 offset:192
    ds_read_b128 v[108:111], v223 offset:0
    ds_read_b64_tr_b16 v[80:81], v176 offset:1280
    ds_read_b64_tr_b16 v[82:83], v176 offset:1440
    ds_read_b64_tr_b16 v[84:85], v176 offset:1312
    ds_read_b64_tr_b16 v[86:87], v176 offset:1472
    s_waitcnt lgkmcnt(5)
    v_mfma_f32_16x16x32_bf16 v[64:67], v[104:107], v[72:75], v[64:67]
    v_mfma_f32_16x16x32_bf16 v[68:71], v[104:107], v[76:79], v[68:71]
    s_waitcnt vmcnt(16)
    ds_read_b128 v[104:107], v222 offset:8192
    ds_read_b64_tr_b16 v[72:73], v176 offset:2560
    ds_read_b64_tr_b16 v[74:75], v176 offset:2720
    ds_read_b64_tr_b16 v[76:77], v176 offset:2592
    ds_read_b64_tr_b16 v[78:79], v176 offset:2752
    s_waitcnt lgkmcnt(5)
    v_mfma_f32_16x16x32_bf16 v[64:67], v[108:111], v[80:83], v[64:67]
    v_mfma_f32_16x16x32_bf16 v[68:71], v[108:111], v[84:87], v[68:71]
    ds_read_b128 v[108:111], v223 offset:8192
    ds_read_b64_tr_b16 v[80:81], v176 offset:3840
    ds_read_b64_tr_b16 v[82:83], v176 offset:4000
    ds_read_b64_tr_b16 v[84:85], v176 offset:3872
    ds_read_b64_tr_b16 v[86:87], v176 offset:4032
    s_add_u32 m0, s31, 0
    s_movk_i32 s36, 0
    buffer_load_dwordx4 v200, s[56:59], s36 offen lds
    s_add_u32 m0, s31, 1024
    s_nop 0
    buffer_load_dwordx4 v201, s[56:59], s36 offen lds
    s_waitcnt lgkmcnt(5)
    v_mfma_f32_16x16x32_bf16 v[64:67], v[104:107], v[72:75], v[64:67]
    v_mfma_f32_16x16x32_bf16 v[68:71], v[104:107], v[76:79], v[68:71]
    s_waitcnt vmcnt(16)
    ds_read_b128 v[104:107], v222 offset:16384
    ds_read_b64_tr_b16 v[72:73], v176 offset:5120
    ds_read_b64_tr_b16 v[74:75], v176 offset:5280
    ds_read_b64_tr_b16 v[76:77], v176 offset:5152
    ds_read_b64_tr_b16 v[78:79], v176 offset:5312
    s_waitcnt lgkmcnt(5)
    v_mfma_f32_16x16x32_bf16 v[64:67], v[108:111], v[80:83], v[64:67]
    v_mfma_f32_16x16x32_bf16 v[68:71], v[108:111], v[84:87], v[68:71]
    ds_read_b128 v[108:111], v223 offset:16384
    ds_read_b64_tr_b16 v[80:81], v176 offset:6400
    ds_read_b64_tr_b16 v[82:83], v176 offset:6560
    ds_read_b64_tr_b16 v[84:85], v176 offset:6432
    ds_read_b64_tr_b16 v[86:87], v176 offset:6592
    s_add_u32 m0, s31, 8192
    s_movk_i32 s36, 128
    buffer_load_dwordx4 v200, s[56:59], s36 offen lds
    s_add_u32 m0, s31, 9216
    s_nop 0
    buffer_load_dwordx4 v201, s[56:59], s36 offen lds
    s_waitcnt lgkmcnt(5)
    v_mfma_f32_16x16x32_bf16 v[64:67], v[104:107], v[72:75], v[64:67]
    v_mfma_f32_16x16x32_bf16 v[68:71], v[104:107], v[76:79], v[68:71]
    s_waitcnt vmcnt(16)
    ds_read_b128 v[104:107], v222 offset:24576
    ds_read_b64_tr_b16 v[72:73], v176 offset:7680
    ds_read_b64_tr_b16 v[74:75], v176 offset:7840
    ds_read_b64_tr_b16 v[76:77], v176 offset:7712
    ds_read_b64_tr_b16 v[78:79], v176 offset:7872
    s_waitcnt lgkmcnt(5)
    v_mfma_f32_16x16x32_bf16 v[64:67], v[108:111], v[80:83], v[64:67]
    v_mfma_f32_16x16x32_bf16 v[68:71], v[108:111], v[84:87], v[68:71]
    ds_read_b128 v[108:111], v223 offset:24576
    ds_read_b64_tr_b16 v[80:81], v176 offset:8960
    ds_read_b64_tr_b16 v[82:83], v176 offset:9120
    ds_read_b64_tr_b16 v[84:85], v176 offset:8992
    ds_read_b64_tr_b16 v[86:87], v176 offset:9152
    s_add_u32 m0, s31, 16384
    s_movk_i32 s36, 256
    buffer_load_dwordx4 v200, s[56:59], s36 offen lds
    s_add_u32 m0, s31, 17408
    s_nop 0
    buffer_load_dwordx4 v201, s[56:59], s36 offen lds
    s_waitcnt lgkmcnt(5)
    v_mfma_f32_16x16x32_bf16 v[64:67], v[104:107], v[72:75], v[64:67]
    v_mfma_f32_16x16x32_bf16 v[68:71], v[104:107], v[76:79], v[68:71]
    s_waitcnt vmcnt(16)
    ds_read_b128 v[104:107], v222 offset:32768
    ds_read_b64_tr_b16 v[72:73], v176 offset:10240
    ds_read_b64_tr_b16 v[74:75], v176 offset:10400
    ds_read_b64_tr_b16 v[76:77], v176 offset:10272
    ds_read_b64_tr_b16 v[78:79], v176 offset:10432
    s_waitcnt lgkmcnt(5)
    v_mfma_f32_16x16x32_bf16 v[64:67], v[108:111], v[80:83], v[64:67]
    v_mfma_f32_16x16x32_bf16 v[68:71], v[108:111], v[84:87], v[68:71]
    ds_read_b128 v[108:111], v223 offset:32768
    ds_read_b64_tr_b16 v[80:81], v176 offset:11520
    ds_read_b64_tr_b16 v[82:83], v176 offset:11680
    ds_read_b64_tr_b16 v[84:85], v176 offset:11552
    ds_read_b64_tr_b16 v[86:87], v176 offset:11712
    s_add_u32 m0, s32, 107520
    s_mov_b32 s38, 0
    buffer_load_dwordx4 v202, s[40:43], s38 offen lds
    s_add_u32 m0, s31, 24576
    s_movk_i32 s36, 384
    buffer_load_dwordx4 v200, s[56:59], s36 offen lds
    s_add_u32 m0, s31, 25600
    s_nop 0
    buffer_load_dwordx4 v201, s[56:59], s36 offen lds
    s_waitcnt lgkmcnt(5)
    v_mfma_f32_16x16x32_bf16 v[64:67], v[104:107], v[72:75], v[64:67]
    v_mfma_f32_16x16x32_bf16 v[68:71], v[104:107], v[76:79], v[68:71]
    s_waitcnt vmcnt(17)
    ds_read_b128 v[104:107], v222 offset:40960
    ds_read_b64_tr_b16 v[72:73], v176 offset:12800
    ds_read_b64_tr_b16 v[74:75], v176 offset:12960
    ds_read_b64_tr_b16 v[76:77], v176 offset:12832
    ds_read_b64_tr_b16 v[78:79], v176 offset:12992
    s_add_u32 m0, s32, 111616
    s_nop 0
    buffer_load_dwordx4 v203, s[40:43], s38 offen lds
    s_waitcnt lgkmcnt(5)
    v_mfma_f32_16x16x32_bf16 v[64:67], v[108:111], v[80:83], v[64:67]
    v_mfma_f32_16x16x32_bf16 v[68:71], v[108:111], v[84:87], v[68:71]
    ds_read_b128 v[108:111], v223 offset:40960
    ds_read_b64_tr_b16 v[80:81], v176 offset:14080
    ds_read_b64_tr_b16 v[82:83], v176 offset:14240
    ds_read_b64_tr_b16 v[84:85], v176 offset:14112
    ds_read_b64_tr_b16 v[86:87], v176 offset:14272
    s_add_u32 s39, s32, 115712
    s_cmp_lt_u32 s20, 2
    s_cselect_b32 m0, s39, 160000
    s_nop 0
    buffer_load_dwordx4 v204, s[40:43], s38 offen lds
    s_waitcnt lgkmcnt(5)
    v_mfma_f32_16x16x32_bf16 v[64:67], v[104:107], v[72:75], v[64:67]
    v_mfma_f32_16x16x32_bf16 v[68:71], v[104:107], v[76:79], v[68:71]
    s_waitcnt vmcnt(17)
    ds_read_b128 v[104:107], v222 offset:49152
    ds_read_b64_tr_b16 v[72:73], v176 offset:15360
    ds_read_b64_tr_b16 v[74:75], v176 offset:15520
    ds_read_b64_tr_b16 v[76:77], v176 offset:15392
    ds_read_b64_tr_b16 v[78:79], v176 offset:15552
    s_add_u32 m0, s32, 117760
    s_mov_b32 s38, 81920
    buffer_load_dwordx4 v202, s[40:43], s38 offen lds
    s_waitcnt lgkmcnt(5)
    v_mfma_f32_16x16x32_bf16 v[64:67], v[108:111], v[80:83], v[64:67]
    v_mfma_f32_16x16x32_bf16 v[68:71], v[108:111], v[84:87], v[68:71]
    ds_read_b128 v[108:111], v223 offset:49152
    ds_read_b64_tr_b16 v[80:81], v176 offset:16640
    ds_read_b64_tr_b16 v[82:83], v176 offset:16800
    ds_read_b64_tr_b16 v[84:85], v176 offset:16672
    ds_read_b64_tr_b16 v[86:87], v176 offset:16832
    s_add_u32 m0, s32, 121856
    s_nop 0
    buffer_load_dwordx4 v203, s[40:43], s38 offen lds
    s_waitcnt lgkmcnt(5)
    v_mfma_f32_16x16x32_bf16 v[64:67], v[104:107], v[72:75], v[64:67]
    v_mfma_f32_16x16x32_bf16 v[68:71], v[104:107], v[76:79], v[68:71]
    s_waitcnt vmcnt(17)
    ds_read_b128 v[104:107], v222 offset:57344
    ds_read_b64_tr_b16 v[72:73], v176 offset:17920
    ds_read_b64_tr_b16 v[74:75], v176 offset:18080
    ds_read_b64_tr_b16 v[76:77], v176 offset:17952
    ds_read_b64_tr_b16 v[78:79], v176 offset:18112
    s_add_u32 s39, s32, 125952
    s_cmp_lt_u32 s20, 2
    s_cselect_b32 m0, s39, 160000
    s_nop 0
    buffer_load_dwordx4 v204, s[40:43], s38 offen lds
    s_waitcnt lgkmcnt(5)
    v_mfma_f32_16x16x32_bf16 v[64:67], v[108:111], v[80:83], v[64:67]
    v_mfma_f32_16x16x32_bf16 v[68:71], v[108:111], v[84:87], v[68:71]
    ds_read_b128 v[108:111], v223 offset:57344
    ds_read_b64_tr_b16 v[80:81], v176 offset:19200
    ds_read_b64_tr_b16 v[82:83], v176 offset:19360
    ds_read_b64_tr_b16 v[84:85], v176 offset:19232
    ds_read_b64_tr_b16 v[86:87], v176 offset:19392
    s_add_u32 m0, s32, 128000
    s_mov_b32 s38, 163840
    buffer_load_dwordx4 v202, s[40:43], s38 offen lds
    s_waitcnt lgkmcnt(5)
    v_mfma_f32_16x16x32_bf16 v[64:67], v[104:107], v[72:75], v[64:67]
    v_mfma_f32_16x16x32_bf16 v[68:71], v[104:107], v[76:79], v[68:71]
    s_waitcnt vmcnt(17)
    ds_read_b128 v[104:107], v233 offset:0
    ds_read_b64_tr_b16 v[72:73], v176 offset:20480
    ds_read_b64_tr_b16 v[74:75], v176 offset:20640
    ds_read_b64_tr_b16 v[76:77], v176 offset:20512
    ds_read_b64_tr_b16 v[78:79], v176 offset:20672
    s_add_u32 m0, s32, 132096
    s_nop 0
    buffer_load_dwordx4 v203, s[40:43], s38 offen lds
    s_waitcnt lgkmcnt(5)
    v_mfma_f32_16x16x32_bf16 v[64:67], v[108:111], v[80:83], v[64:67]
    v_mfma_f32_16x16x32_bf16 v[68:71], v[108:111], v[84:87], v[68:71]
    ds_read_b128 v[108:111], v234 offset:0
    ds_read_b64_tr_b16 v[80:81], v176 offset:21760
    ds_read_b64_tr_b16 v[82:83], v176 offset:21920
    ds_read_b64_tr_b16 v[84:85], v176 offset:21792
    ds_read_b64_tr_b16 v[86:87], v176 offset:21952
    s_add_u32 s39, s32, 136192
    s_cmp_lt_u32 s20, 2
    s_cselect_b32 m0, s39, 160000
    s_nop 0
    buffer_load_dwordx4 v204, s[40:43], s38 offen lds
    s_waitcnt lgkmcnt(5)
    v_mfma_f32_16x16x32_bf16 v[64:67], v[104:107], v[72:75], v[64:67]
    v_mfma_f32_16x16x32_bf16 v[68:71], v[104:107], v[76:79], v[68:71]
    s_waitcnt vmcnt(17)
    ds_read_b128 v[104:107], v233 offset:8192
    ds_read_b64_tr_b16 v[72:73], v176 offset:23040
    ds_read_b64_tr_b16 v[74:75], v176 offset:23200
    ds_read_b64_tr_b16 v[76:77], v176 offset:23072
    ds_read_b64_tr_b16 v[78:79], v176 offset:23232
    s_add_u32 m0, s32, 138240
    s_mov_b32 s38, 245760
    buffer_load_dwordx4 v202, s[40:43], s38 offen lds
    s_waitcnt lgkmcnt(5)
    v_mfma_f32_16x16x32_bf16 v[64:67], v[108:111], v[80:83], v[64:67]
    v_mfma_f32_16x16x32_bf16 v[68:71], v[108:111], v[84:87], v[68:71]
    ds_read_b128 v[108:111], v234 offset:8192
    ds_read_b64_tr_b16 v[80:81], v176 offset:24320
    ds_read_b64_tr_b16 v[82:83], v176 offset:24480
    ds_read_b64_tr_b16 v[84:85], v176 offset:24352
    ds_read_b64_tr_b16 v[86:87], v176 offset:24512
    s_add_u32 m0, s32, 142336
    s_nop 0
    buffer_load_dwordx4 v203, s[40:43], s38 offen lds
    s_waitcnt lgkmcnt(5)
    v_mfma_f32_16x16x32_bf16 v[64:67], v[104:107], v[72:75], v[64:67]
    v_mfma_f32_16x16x32_bf16 v[68:71], v[104:107], v[76:79], v[68:71]
    s_add_u32 s39, s32, 146432
    s_cmp_lt_u32 s20, 2
    s_cselect_b32 m0, s39, 160000
    s_nop 0
    buffer_load_dwordx4 v204, s[40:43], s38 offen lds
    s_waitcnt lgkmcnt(0)
    v_mfma_f32_16x16x32_bf16 v[64:67], v[108:111], v[80:83], v[64:67]
    v_mfma_f32_16x16x32_bf16 v[68:71], v[108:111], v[84:87], v[68:71]
    s_lshr_b32 s21, s20, 1
    s_lshl_b32 s26, s54, 1
    s_add_u32 s21, s21, s26
    s_and_b32 s26, s20, 1
    s_mov_b32 s16, s4
    s_mov_b32 s17, s5
    s_mov_b32 s18, 262144
    s_mov_b32 s19, 0x20000
    v_mov_b32 v19, 0x80000000
    v_and_b32 v12, 1, v3
    v_cmp_gt_u32 vcc, 2, v3
    v_cvt_pk_bf16_f32 v112, v64, v65
    v_cvt_pk_bf16_f32 v113, v66, v67
    v_cvt_pk_bf16_f32 v116, v68, v69
    v_cvt_pk_bf16_f32 v117, v70, v71
    s_mov_b64 s[28:29], vcc
    v_cmp_eq_u32 vcc, 4, v2
    v_mov_b32 v13, 0x3f803f80
    s_nop 0
    v_cndmask_b32 v116, v116, v13, vcc
    v_cndmask_b32 v117, v117, v13, vcc
    s_mov_b64 vcc, s[28:29]
    v_mov_b32 v120, v112
    v_mov_b32 v121, v113
    v_mov_b32 v122, v116
    v_mov_b32 v123, v117
    s_nop 1
    v_permlane32_swap_b32 v120, v114
    v_permlane32_swap_b32 v121, v115
    v_permlane32_swap_b32 v122, v118
    v_permlane32_swap_b32 v123, v119
    v_lshl_add_u32 v15, v12, 5, v2
    v_lshlrev_b32 v15, 4, v15
    s_lshl_b32 s28, s21, 11
    s_lshl_b32 s29, s26, 10
    s_add_u32 s28, s28, s29
    s_add_u32 s28, s28, 131072
    v_add_u32 v15, s28, v15
    v_add_u32 v14, 256, v15
    v_cndmask_b32 v15, v19, v15, vcc
    v_cndmask_b32 v14, v19, v14, vcc
    buffer_store_dwordx4 v[112:115], v15, s[16:19], 0 offen sc1
    v_cmp_gt_u32 vcc, 5, v2
    s_nop 1
    v_cndmask_b32 v14, v19, v14, vcc
    buffer_store_dwordx4 v[116:119], v14, s[16:19], 0 offen sc1
    s_waitcnt vmcnt(0)
    s_barrier
    s_cmp_lg_u32 s20, 0
    s_cbranch_scc1 mg_b_nfv
    s_mov_b32 s44, s94
    s_mov_b32 s45, s95
    s_mov_b32 s46, 256
    s_mov_b32 s47, 0x20000
    s_lshl_b32 s28, s52, 2
    v_mov_b32 v14, s28
    v_mov_b32 v13, 1
    s_mov_b64 exec, 1
    buffer_store_dword v13, v14, s[44:47], 0 offen sc1
    s_mov_b64 exec, -1
mg_b_nfv:
mg_b_ownx:
    s_mul_i32 s21, s22, 81920
    s_add_u32 s8, s82, s21
    s_addc_u32 s9, s83, 0
    s_mov_b32 s10, 81920
    s_mov_b32 s11, 0x20000
mg_qgemm:
    s_waitcnt vmcnt(15)
    s_barrier
    ds_read_b128 v[56:59], v222 offset:0
    ds_read_b64_tr_b16 v[36:37], v235 offset:41984
    ds_read_b64_tr_b16 v[38:39], v235 offset:43264
    ds_read_b64_tr_b16 v[40:41], v235 offset:42016
    ds_read_b64_tr_b16 v[42:43], v235 offset:43296
    ds_read_b64_tr_b16 v[44:45], v235 offset:42048
    ds_read_b64_tr_b16 v[46:47], v235 offset:43328
    ds_read_b64_tr_b16 v[48:49], v235 offset:42080
    ds_read_b64_tr_b16 v[50:51], v235 offset:43360
    ds_read_b64_tr_b16 v[52:53], v235 offset:42112
    ds_read_b64_tr_b16 v[54:55], v235 offset:43392
    s_waitcnt lgkmcnt(4)
    v_mfma_f32_16x16x32_bf16 v[16:19], v[36:39], v[56:59], 0
    ds_read_b128 v[60:63], v223 offset:0
    ds_read_b64_tr_b16 v[36:37], v235 offset:47104
    s_lshl_b32 s29, s20, 1
    ds_read_b64_tr_b16 v[38:39], v235 offset:48384
    v_mfma_f32_16x16x32_bf16 v[20:23], v[40:43], v[56:59], 0
    s_add_u32 s28, s29, 2
    ds_read_b64_tr_b16 v[40:41], v235 offset:47136
    ds_read_b64_tr_b16 v[42:43], v235 offset:48416
    s_add_u32 m0, s31, 32768
    s_movk_i32 s36, 512
    buffer_load_dwordx4 v200, s[8:11], s36 offen lds
    s_and_b32 s28, s28, 7
    v_mfma_f32_16x16x32_bf16 v[24:27], v[44:47], v[56:59], 0
    ds_read_b64_tr_b16 v[44:45], v235 offset:47168
    ds_read_b64_tr_b16 v[46:47], v235 offset:48448
    s_mul_i32 s28, s28, 9216
    s_add_u32 m0, s31, 33792
    s_nop 0
    buffer_load_dwordx4 v201, s[8:11], s36 offen lds
    s_waitcnt lgkmcnt(7)
    v_mfma_f32_16x16x32_bf16 v[28:31], v[48:51], v[56:59], 0
    s_add_u32 s28, s28, 6144
    ds_read_b64_tr_b16 v[48:49], v235 offset:47200
    ds_read_b64_tr_b16 v[50:51], v235 offset:48480
    v_mfma_f32_16x16x32_bf16 v[32:35], v[52:55], v[56:59], 0
    v_add_u32 v238, s28, v4
    ds_read_b64_tr_b16 v[52:53], v235 offset:47232
    ds_read_b64_tr_b16 v[54:55], v235 offset:48512
    s_add_u32 s28, s29, 3
    s_waitcnt lgkmcnt(4)
    v_mfma_f32_16x16x32_bf16 v[16:19], v[36:39], v[60:63], v[16:19]
    s_waitcnt vmcnt(12)
    s_barrier
    ds_read_b128 v[56:59], v222 offset:8192
    s_and_b32 s28, s28, 7
    ds_read_b64_tr_b16 v[36:37], v235 offset:52224
    ds_read_b64_tr_b16 v[38:39], v235 offset:53504
    v_mfma_f32_16x16x32_bf16 v[20:23], v[40:43], v[60:63], v[20:23]
    s_mul_i32 s28, s28, 9216
    ds_read_b64_tr_b16 v[40:41], v235 offset:52256
    ds_read_b64_tr_b16 v[42:43], v235 offset:53536
    s_add_u32 m0, s31, 40960
    s_movk_i32 s36, 640
    buffer_load_dwordx4 v200, s[8:11], s36 offen lds
    s_add_u32 s28, s28, 6144
    v_mfma_f32_16x16x32_bf16 v[24:27], v[44:47], v[60:63], v[24:27]
    ds_read_b64_tr_b16 v[44:45], v235 offset:52288
    v_add_u32 v239, s28, v4
    ds_read_b64_tr_b16 v[46:47], v235 offset:53568
    s_add_u32 m0, s31, 41984
    s_nop 0
    buffer_load_dwordx4 v201, s[8:11], s36 offen lds
    s_waitcnt lgkmcnt(7)
    v_mfma_f32_16x16x32_bf16 v[28:31], v[48:51], v[60:63], v[28:31]
    s_add_u32 s28, s29, 4
    ds_read_b64_tr_b16 v[48:49], v235 offset:52320
    ds_read_b64_tr_b16 v[50:51], v235 offset:53600
    v_mfma_f32_16x16x32_bf16 v[32:35], v[52:55], v[60:63], v[32:35]
    s_and_b32 s28, s28, 7
    ds_read_b64_tr_b16 v[52:53], v235 offset:52352
    ds_read_b64_tr_b16 v[54:55], v235 offset:53632
    s_mul_i32 s28, s28, 9216
    s_waitcnt lgkmcnt(4)
    v_mfma_f32_16x16x32_bf16 v[16:19], v[36:39], v[56:59], v[16:19]
    ds_read_b128 v[60:63], v223 offset:8192
    s_add_u32 s28, s28, 3072
    ds_read_b64_tr_b16 v[36:37], v235 offset:57344
    ds_read_b64_tr_b16 v[38:39], v235 offset:58624
    v_mfma_f32_16x16x32_bf16 v[20:23], v[40:43], v[56:59], v[20:23]
    v_add_u32 v240, s28, v4
    ds_read_b64_tr_b16 v[40:41], v235 offset:57376
    ds_read_b64_tr_b16 v[42:43], v235 offset:58656
    s_add_u32 s28, s29, 5
    v_mfma_f32_16x16x32_bf16 v[24:27], v[44:47], v[56:59], v[24:27]
    ds_read_b64_tr_b16 v[44:45], v235 offset:57408
    s_and_b32 s28, s28, 7
    ds_read_b64_tr_b16 v[46:47], v235 offset:58688
    s_waitcnt lgkmcnt(7)
    v_mfma_f32_16x16x32_bf16 v[28:31], v[48:51], v[56:59], v[28:31]
    s_mul_i32 s28, s28, 9216
    ds_read_b64_tr_b16 v[48:49], v235 offset:57440
    ds_read_b64_tr_b16 v[50:51], v235 offset:58720
    v_mfma_f32_16x16x32_bf16 v[32:35], v[52:55], v[56:59], v[32:35]
    s_add_u32 s28, s28, 3072
    ds_read_b64_tr_b16 v[52:53], v235 offset:57472
    ds_read_b64_tr_b16 v[54:55], v235 offset:58752
    v_add_u32 v241, s28, v4
    s_waitcnt lgkmcnt(4)
    v_mfma_f32_16x16x32_bf16 v[16:19], v[36:39], v[60:63], v[16:19]
    s_waitcnt vmcnt(9)
    s_barrier
    ds_read_b128 v[56:59], v222 offset:16384
    s_add_u32 s28, s29, 6
    ds_read_b64_tr_b16 v[36:37], v235 offset:62464
    ds_read_b64_tr_b16 v[38:39], v235 offset:63744
    v_mfma_f32_16x16x32_bf16 v[20:23], v[40:43], v[60:63], v[20:23]
    s_and_b32 s28, s28, 7
    ds_read_b64_tr_b16 v[40:41], v235 offset:62496
    ds_read_b64_tr_b16 v[42:43], v235 offset:63776
    s_add_u32 m0, s31, 49152
    s_movk_i32 s36, 768
    buffer_load_dwordx4 v200, s[8:11], s36 offen lds
    s_mul_i32 s28, s28, 9216
    v_mfma_f32_16x16x32_bf16 v[24:27], v[44:47], v[60:63], v[24:27]
    ds_read_b64_tr_b16 v[44:45], v235 offset:62528
    ds_read_b64_tr_b16 v[46:47], v235 offset:63808
    s_add_u32 s28, s28, 0
    s_add_u32 m0, s31, 50176
    s_nop 0
    buffer_load_dwordx4 v201, s[8:11], s36 offen lds
    s_waitcnt lgkmcnt(7)
    v_mfma_f32_16x16x32_bf16 v[28:31], v[48:51], v[60:63], v[28:31]
    v_add_u32 v242, s28, v4
    ds_read_b64_tr_b16 v[48:49], v235 offset:62560
    ds_read_b64_tr_b16 v[50:51], v235 offset:63840
    s_add_u32 m0, s32, 107520
    s_mov_b32 s38, 327680
    buffer_load_dwordx4 v202, s[40:43], s38 offen lds
    v_mfma_f32_16x16x32_bf16 v[32:35], v[52:55], v[60:63], v[32:35]
    s_add_u32 s28, s29, 7
    ds_read_b64_tr_b16 v[52:53], v235 offset:62592
    ds_read_b64_tr_b16 v[54:55], v235 offset:63872
    s_and_b32 s28, s28, 7
    s_waitcnt lgkmcnt(4)
    v_mfma_f32_16x16x32_bf16 v[16:19], v[36:39], v[56:59], v[16:19]
    ds_read_b128 v[60:63], v223 offset:16384
    ds_read_b64_tr_b16 v[36:37], v236 offset:2048
    s_mul_i32 s28, s28, 9216
    ds_read_b64_tr_b16 v[38:39], v236 offset:3328
    v_mfma_f32_16x16x32_bf16 v[20:23], v[40:43], v[56:59], v[20:23]
    s_add_u32 s28, s28, 0
    ds_read_b64_tr_b16 v[40:41], v236 offset:2080
    ds_read_b64_tr_b16 v[42:43], v236 offset:3360
    s_add_u32 m0, s32, 111616
    s_nop 0
    buffer_load_dwordx4 v203, s[40:43], s38 offen lds
    v_add_u32 v243, s28, v4
    v_mfma_f32_16x16x32_bf16 v[24:27], v[44:47], v[56:59], v[24:27]
    ds_read_b64_tr_b16 v[44:45], v236 offset:2112
    ds_read_b64_tr_b16 v[46:47], v236 offset:3392
    s_mul_i32 s21, s20, 18432
    s_add_u32 s39, s32, 115712
    s_cmp_lt_u32 s20, 2
    s_cselect_b32 m0, s39, 160000
    s_nop 0
    buffer_load_dwordx4 v204, s[40:43], s38 offen lds
    s_waitcnt lgkmcnt(7)
    v_mfma_f32_16x16x32_bf16 v[28:31], v[48:51], v[56:59], v[28:31]
    v_add_u32 v221, s21, v4
    ds_read_b64_tr_b16 v[48:49], v236 offset:2144
    ds_read_b64_tr_b16 v[50:51], v236 offset:3424
    v_mfma_f32_16x16x32_bf16 v[32:35], v[52:55], v[56:59], v[32:35]
    v_and_b32 v13, 31, v1
    ds_read_b64_tr_b16 v[52:53], v236 offset:2176
    ds_read_b64_tr_b16 v[54:55], v236 offset:3456
    v_mul_u32_u24 v13, 160, v13
    s_waitcnt lgkmcnt(4)
    v_mfma_f32_16x16x32_bf16 v[16:19], v[36:39], v[60:63], v[16:19]
    s_waitcnt vmcnt(9)
    s_barrier
    v_lshrrev_b32 v14, 5, v1
    ds_read_b128 v[56:59], v222 offset:24576
    ds_read_b64_tr_b16 v[36:37], v236 offset:7168
    v_lshl_add_u32 v13, v14, 3, v13
    ds_read_b64_tr_b16 v[38:39], v236 offset:8448
    v_mfma_f32_16x16x32_bf16 v[20:23], v[40:43], v[60:63], v[20:23]
    s_mul_i32 s24, s20, 40
    ds_read_b64_tr_b16 v[40:41], v236 offset:7200
    ds_read_b64_tr_b16 v[42:43], v236 offset:8480
    v_add_u32 v207, s24, v13
    s_add_u32 m0, s31, 57344
    s_movk_i32 s36, 896
    buffer_load_dwordx4 v200, s[8:11], s36 offen lds
    v_mfma_f32_16x16x32_bf16 v[24:27], v[44:47], v[60:63], v[24:27]
    v_mov_b32 v12, 160000
    ds_read_b64_tr_b16 v[44:45], v236 offset:7232
    v_add_u32 v13, 32, v207
    ds_read_b64_tr_b16 v[46:47], v236 offset:8512
    s_add_u32 m0, s31, 58368
    s_nop 0
    buffer_load_dwordx4 v201, s[8:11], s36 offen lds
    s_waitcnt lgkmcnt(7)
    v_mfma_f32_16x16x32_bf16 v[28:31], v[48:51], v[60:63], v[28:31]
    ds_read_b64_tr_b16 v[48:49], v236 offset:7264
    ds_read_b64_tr_b16 v[50:51], v236 offset:8544
    s_add_u32 m0, s32, 117760
    s_mov_b32 s38, 409600
    buffer_load_dwordx4 v202, s[40:43], s38 offen lds
    v_mfma_f32_16x16x32_bf16 v[32:35], v[52:55], v[60:63], v[32:35]
    ds_read_b64_tr_b16 v[52:53], v236 offset:7296
    ds_read_b64_tr_b16 v[54:55], v236 offset:8576
    v_cmp_eq_u32 vcc, 0, v14
    v_add_u32 v15, 5152, v207
    s_nop 0
    v_cndmask_b32 v208, v12, v13, vcc
    v_cndmask_b32 v209, v12, v15, vcc
    s_waitcnt lgkmcnt(4)
    v_mfma_f32_16x16x32_bf16 v[16:19], v[36:39], v[56:59], v[16:19]
    ds_read_b128 v[60:63], v223 offset:24576
    ds_read_b64_tr_b16 v[36:37], v236 offset:12288
    v_lshrrev_b32 v13, 4, v1
    ds_read_b64_tr_b16 v[38:39], v236 offset:13568
    v_mfma_f32_16x16x32_bf16 v[20:23], v[40:43], v[56:59], v[20:23]
    v_mul_u32_u24 v13, 0x5000, v13
    ds_read_b64_tr_b16 v[40:41], v236 offset:12320
    ds_read_b64_tr_b16 v[42:43], v236 offset:13600
    s_add_u32 m0, s32, 121856
    s_nop 0
    buffer_load_dwordx4 v203, s[40:43], s38 offen lds
    v_and_b32 v14, 15, v1
    v_mfma_f32_16x16x32_bf16 v[24:27], v[44:47], v[56:59], v[24:27]
    ds_read_b64_tr_b16 v[44:45], v236 offset:12352
    ds_read_b64_tr_b16 v[46:47], v236 offset:13632
    v_lshl_add_u32 v210, v14, 4, v13
    s_add_u32 s39, s32, 125952
    s_cmp_lt_u32 s20, 2
    s_cselect_b32 m0, s39, 160000
    s_nop 0
    buffer_load_dwordx4 v204, s[40:43], s38 offen lds
    s_waitcnt lgkmcnt(7)
    v_mfma_f32_16x16x32_bf16 v[28:31], v[48:51], v[56:59], v[28:31]
    v_mul_u32_u24 v13, 160, v1
    ds_read_b64_tr_b16 v[48:49], v236 offset:12384
    ds_read_b64_tr_b16 v[50:51], v236 offset:13664
    v_mfma_f32_16x16x32_bf16 v[32:35], v[52:55], v[56:59], v[32:35]
    s_lshl_b32 s24, s20, 4
    ds_read_b64_tr_b16 v[52:53], v236 offset:12416
    ds_read_b64_tr_b16 v[54:55], v236 offset:13696
    v_add_u32 v213, s24, v13
    s_waitcnt lgkmcnt(4)
    v_mfma_f32_16x16x32_bf16 v[16:19], v[36:39], v[60:63], v[16:19]
    s_waitcnt vmcnt(5)
    s_barrier
    ds_read_b128 v[56:59], v222 offset:32768
    s_lshl_b32 s21, s20, 4
    ds_read_b64_tr_b16 v[36:37], v235 offset:41984
    ds_read_b64_tr_b16 v[38:39], v235 offset:43264
    v_mfma_f32_16x16x32_bf16 v[20:23], v[40:43], v[60:63], v[20:23]
    s_movk_i32 s26, 2560
    ds_read_b64_tr_b16 v[40:41], v235 offset:42016
    ds_read_b64_tr_b16 v[42:43], v235 offset:43296
    s_add_u32 m0, s31, 65536
    s_movk_i32 s36, 1024
    buffer_load_dwordx4 v200, s[8:11], s36 offen lds
    v_add_u32 v13, s21, v2
    v_mfma_f32_16x16x32_bf16 v[24:27], v[44:47], v[60:63], v[24:27]
    ds_read_b64_tr_b16 v[44:45], v235 offset:42048
    ds_read_b64_tr_b16 v[46:47], v235 offset:43328
    v_mul_u32_u24 v13, s26, v13
    s_add_u32 m0, s31, 66560
    s_nop 0
    buffer_load_dwordx4 v201, s[8:11], s36 offen lds
    s_waitcnt lgkmcnt(7)
    v_mfma_f32_16x16x32_bf16 v[28:31], v[48:51], v[60:63], v[28:31]
    v_lshl_add_u32 v205, v3, 3, v13
    ds_read_b64_tr_b16 v[48:49], v235 offset:42080
    ds_read_b64_tr_b16 v[50:51], v235 offset:43360
    s_add_u32 m0, s32, 128000
    s_mov_b32 s38, 491520
    buffer_load_dwordx4 v202, s[40:43], s38 offen lds
    v_mfma_f32_16x16x32_bf16 v[32:35], v[52:55], v[60:63], v[32:35]
    v_and_b32 v14, 1, v3
    ds_read_b64_tr_b16 v[52:53], v235 offset:42112
    ds_read_b64_tr_b16 v[54:55], v235 offset:43392
    v_lshl_add_u32 v13, v14, 5, v13
    s_waitcnt lgkmcnt(4)
    v_mfma_f32_16x16x32_bf16 v[16:19], v[36:39], v[56:59], v[16:19]
    ds_read_b128 v[60:63], v223 offset:32768
    ds_read_b64_tr_b16 v[36:37], v235 offset:47104
    v_lshrrev_b32 v14, 1, v3
    ds_read_b64_tr_b16 v[38:39], v235 offset:48384
    v_mfma_f32_16x16x32_bf16 v[20:23], v[40:43], v[56:59], v[20:23]
    v_lshl_add_u32 v245, v14, 4, v13
    ds_read_b64_tr_b16 v[40:41], v235 offset:47136
    ds_read_b64_tr_b16 v[42:43], v235 offset:48416
    s_add_u32 m0, s32, 132096
    s_nop 0
    buffer_load_dwordx4 v203, s[40:43], s38 offen lds
    s_lshl_b32 s21, s20, 6
    v_mfma_f32_16x16x32_bf16 v[24:27], v[44:47], v[56:59], v[24:27]
    ds_read_b64_tr_b16 v[44:45], v235 offset:47168
    ds_read_b64_tr_b16 v[46:47], v235 offset:48448
    v_add_u32 v13, s21, v1
    s_add_u32 s39, s32, 136192
    s_cmp_lt_u32 s20, 2
    s_cselect_b32 m0, s39, 160000
    s_nop 0
    buffer_load_dwordx4 v204, s[40:43], s38 offen lds
    s_waitcnt lgkmcnt(7)
    v_mfma_f32_16x16x32_bf16 v[28:31], v[48:51], v[56:59], v[28:31]
    v_mul_u32_u24 v13, s26, v13
    ds_read_b64_tr_b16 v[48:49], v235 offset:47200
    ds_read_b64_tr_b16 v[50:51], v235 offset:48480
    v_mfma_f32_16x16x32_bf16 v[32:35], v[52:55], v[56:59], v[32:35]
    s_lshl_b32 s21, s33, 3
    ds_read_b64_tr_b16 v[52:53], v235 offset:47232
    ds_read_b64_tr_b16 v[54:55], v235 offset:48512
    v_add_u32 v206, s21, v13
    s_waitcnt lgkmcnt(4)
    v_mfma_f32_16x16x32_bf16 v[16:19], v[36:39], v[60:63], v[16:19]
    s_waitcnt vmcnt(5)
    s_barrier
    ds_read_b128 v[56:59], v222 offset:40960
    v_add_u32 v12, 1, v2
    ds_read_b64_tr_b16 v[36:37], v235 offset:52224
    ds_read_b64_tr_b16 v[38:39], v235 offset:53504
    v_mfma_f32_16x16x32_bf16 v[20:23], v[40:43], v[60:63], v[20:23]
    v_and_b32 v12, 1, v12
    ds_read_b64_tr_b16 v[40:41], v235 offset:52256
    ds_read_b64_tr_b16 v[42:43], v235 offset:53536
    s_add_u32 m0, s31, 73728
    s_movk_i32 s36, 1152
    buffer_load_dwordx4 v200, s[8:11], s36 offen lds
    v_sub_u32 v13, v2, v12
    v_mfma_f32_16x16x32_bf16 v[24:27], v[44:47], v[60:63], v[24:27]
    ds_read_b64_tr_b16 v[44:45], v235 offset:52288
    ds_read_b64_tr_b16 v[46:47], v235 offset:53568
    v_add_u32 v13, 9, v13
    s_add_u32 m0, s31, 74752
    s_nop 0
    buffer_load_dwordx4 v201, s[8:11], s36 offen lds
    s_waitcnt lgkmcnt(7)
    v_mfma_f32_16x16x32_bf16 v[28:31], v[48:51], v[60:63], v[28:31]
    v_and_b32 v14, 1, v3
    ds_read_b64_tr_b16 v[48:49], v235 offset:52320
    ds_read_b64_tr_b16 v[50:51], v235 offset:53600
    s_add_u32 m0, s32, 138240
    s_mov_b32 s38, 573440
    buffer_load_dwordx4 v202, s[40:43], s38 offen lds
    v_mfma_f32_16x16x32_bf16 v[32:35], v[52:55], v[60:63], v[32:35]
    v_lshlrev_b32 v14, 3, v14
    ds_read_b64_tr_b16 v[52:53], v235 offset:52352
    ds_read_b64_tr_b16 v[54:55], v235 offset:53632
    v_sub_u32 v13, v13, v14
    s_waitcnt lgkmcnt(4)
    v_mfma_f32_16x16x32_bf16 v[16:19], v[36:39], v[56:59], v[16:19]
    ds_read_b128 v[60:63], v223 offset:40960
    ds_read_b64_tr_b16 v[36:37], v235 offset:57344
    v_lshrrev_b32 v15, 1, v3
    ds_read_b64_tr_b16 v[38:39], v235 offset:58624
    v_mfma_f32_16x16x32_bf16 v[20:23], v[40:43], v[56:59], v[20:23]
    v_lshl_add_u32 v13, v15, 4, v13
    ds_read_b64_tr_b16 v[40:41], v235 offset:57376
    ds_read_b64_tr_b16 v[42:43], v235 offset:58656
    s_add_u32 m0, s32, 142336
    s_nop 0
    buffer_load_dwordx4 v203, s[40:43], s38 offen lds
    v_lshlrev_b32 v13, 1, v13
    v_mfma_f32_16x16x32_bf16 v[24:27], v[44:47], v[56:59], v[24:27]
    ds_read_b64_tr_b16 v[44:45], v235 offset:57408
    ds_read_b64_tr_b16 v[46:47], v235 offset:58688
    v_xor_b32 v12, 1, v12
    s_add_u32 s39, s32, 146432
    s_cmp_lt_u32 s20, 2
    s_cselect_b32 m0, s39, 160000
    s_nop 0
    buffer_load_dwordx4 v204, s[40:43], s38 offen lds
    s_waitcnt lgkmcnt(7)
    v_mfma_f32_16x16x32_bf16 v[28:31], v[48:51], v[56:59], v[28:31]
    s_mov_b32 s24, 92096
    ds_read_b64_tr_b16 v[48:49], v235 offset:57440
    ds_read_b64_tr_b16 v[50:51], v235 offset:58720
    v_mfma_f32_16x16x32_bf16 v[32:35], v[52:55], v[56:59], v[32:35]
    v_mul_lo_u32 v12, v12, s24
    ds_read_b64_tr_b16 v[52:53], v235 offset:57472
    ds_read_b64_tr_b16 v[54:55], v235 offset:58752
    v_add_u32 v13, v13, v12
    s_waitcnt lgkmcnt(4)
    v_mfma_f32_16x16x32_bf16 v[16:19], v[36:39], v[60:63], v[16:19]
    s_waitcnt vmcnt(5)
    s_barrier
    ds_read_b128 v[56:59], v222 offset:49152
    s_mul_i32 s21, s20, 4160
    ds_read_b64_tr_b16 v[36:37], v235 offset:62464
    ds_read_b64_tr_b16 v[38:39], v235 offset:63744
    v_mfma_f32_16x16x32_bf16 v[20:23], v[40:43], v[60:63], v[20:23]
    s_add_u32 s24, s21, 64
    ds_read_b64_tr_b16 v[40:41], v235 offset:62496
    ds_read_b64_tr_b16 v[42:43], v235 offset:63776
    s_add_u32 m0, s32, 107520
    s_mov_b32 s38, 655360
    buffer_load_dwordx4 v202, s[40:43], s38 offen lds
    v_add_u32 v214, s24, v13
    v_mfma_f32_16x16x32_bf16 v[24:27], v[44:47], v[60:63], v[24:27]
    ds_read_b64_tr_b16 v[44:45], v235 offset:62528
    ds_read_b64_tr_b16 v[46:47], v235 offset:63808
    v_add_u32 v220, s21, v4
    s_add_u32 m0, s32, 111616
    s_nop 0
    buffer_load_dwordx4 v203, s[40:43], s38 offen lds
    s_waitcnt lgkmcnt(7)
    v_mfma_f32_16x16x32_bf16 v[28:31], v[48:51], v[60:63], v[28:31]
    v_lshlrev_b32 v13, 4, v2
    ds_read_b64_tr_b16 v[48:49], v235 offset:62560
    ds_read_b64_tr_b16 v[50:51], v235 offset:63840
    s_add_u32 s39, s32, 115712
    s_cmp_lt_u32 s20, 2
    s_cselect_b32 m0, s39, 160000
    s_nop 0
    buffer_load_dwordx4 v204, s[40:43], s38 offen lds
    v_mfma_f32_16x16x32_bf16 v[32:35], v[52:55], v[60:63], v[32:35]
    v_sub_u32 v13, 2040, v13
    ds_read_b64_tr_b16 v[52:53], v235 offset:62592
    ds_read_b64_tr_b16 v[54:55], v235 offset:63872
    v_lshl_add_u32 v13, v15, 4, v13
    s_waitcnt lgkmcnt(4)
    v_mfma_f32_16x16x32_bf16 v[16:19], v[36:39], v[56:59], v[16:19]
    ds_read_b128 v[60:63], v223 offset:49152
    v_sub_u32 v13, v13, v14
    ds_read_b64_tr_b16 v[36:37], v236 offset:2048
    ds_read_b64_tr_b16 v[38:39], v236 offset:3328
    v_mfma_f32_16x16x32_bf16 v[20:23], v[40:43], v[56:59], v[20:23]
    v_lshlrev_b32 v13, 1, v13
    ds_read_b64_tr_b16 v[40:41], v236 offset:2080
    ds_read_b64_tr_b16 v[42:43], v236 offset:3360
    s_mul_i32 s24, s20, 4608
    v_mfma_f32_16x16x32_bf16 v[24:27], v[44:47], v[56:59], v[24:27]
    ds_read_b64_tr_b16 v[44:45], v236 offset:2112
    s_add_u32 s24, s24, 70144
    ds_read_b64_tr_b16 v[46:47], v236 offset:3392
    s_waitcnt lgkmcnt(7)
    v_mfma_f32_16x16x32_bf16 v[28:31], v[48:51], v[56:59], v[28:31]
    v_add_u32 v215, s24, v13
    ds_read_b64_tr_b16 v[48:49], v236 offset:2144
    ds_read_b64_tr_b16 v[50:51], v236 offset:3424
    v_mfma_f32_16x16x32_bf16 v[32:35], v[52:55], v[56:59], v[32:35]
    v_lshlrev_b32 v13, 5, v2
    ds_read_b64_tr_b16 v[52:53], v236 offset:2176
    ds_read_b64_tr_b16 v[54:55], v236 offset:3456
    v_lshl_add_u32 v13, v3, 3, v13
    s_waitcnt lgkmcnt(4)
    v_mfma_f32_16x16x32_bf16 v[16:19], v[36:39], v[60:63], v[16:19]
    s_waitcnt vmcnt(3)
    s_barrier
    ds_read_b128 v[56:59], v222 offset:57344
    s_mul_i32 s24, s20, 576
    ds_read_b64_tr_b16 v[36:37], v236 offset:7168
    ds_read_b64_tr_b16 v[38:39], v236 offset:8448
    v_mfma_f32_16x16x32_bf16 v[20:23], v[40:43], v[60:63], v[20:23]
    s_add_u32 s24, s24, 16896
    ds_read_b64_tr_b16 v[40:41], v236 offset:7200
    ds_read_b64_tr_b16 v[42:43], v236 offset:8480
    s_add_u32 m0, s32, 117760
    s_mov_b32 s38, 737280
    buffer_load_dwordx4 v202, s[40:43], s38 offen lds
    v_add_u32 v216, s24, v13
    v_mfma_f32_16x16x32_bf16 v[24:27], v[44:47], v[60:63], v[24:27]
    ds_read_b64_tr_b16 v[44:45], v236 offset:7232
    ds_read_b64_tr_b16 v[46:47], v236 offset:8512
    v_and_b32 v13, 3, v2
    s_add_u32 m0, s32, 121856
    s_nop 0
    buffer_load_dwordx4 v203, s[40:43], s38 offen lds
    s_waitcnt lgkmcnt(7)
    v_mfma_f32_16x16x32_bf16 v[28:31], v[48:51], v[60:63], v[28:31]
    v_lshlrev_b32 v13, 3, v13
    ds_read_b64_tr_b16 v[48:49], v236 offset:7264
    ds_read_b64_tr_b16 v[50:51], v236 offset:8544
    s_add_u32 s39, s32, 125952
    s_cmp_lt_u32 s20, 2
    s_cselect_b32 m0, s39, 160000
    s_nop 0
    buffer_load_dwordx4 v204, s[40:43], s38 offen lds
    v_mfma_f32_16x16x32_bf16 v[32:35], v[52:55], v[60:63], v[32:35]
    v_lshl_add_u32 v13, v3, 5, v13
    ds_read_b64_tr_b16 v[52:53], v236 offset:7296
    ds_read_b64_tr_b16 v[54:55], v236 offset:8576
    s_lshl_b32 s21, s20, 7
    s_waitcnt lgkmcnt(4)
    v_mfma_f32_16x16x32_bf16 v[16:19], v[36:39], v[56:59], v[16:19]
    ds_read_b128 v[60:63], v223 offset:57344
    v_add_u32 v13, s21, v13
    ds_read_b64_tr_b16 v[36:37], v236 offset:12288
    ds_read_b64_tr_b16 v[38:39], v236 offset:13568
    v_mfma_f32_16x16x32_bf16 v[20:23], v[40:43], v[56:59], v[20:23]
    v_lshrrev_b32 v12, 2, v2
    ds_read_b64_tr_b16 v[40:41], v236 offset:12320
    ds_read_b64_tr_b16 v[42:43], v236 offset:13600
    s_movk_i32 s24, 576
    v_mfma_f32_16x16x32_bf16 v[24:27], v[44:47], v[56:59], v[24:27]
    ds_read_b64_tr_b16 v[44:45], v236 offset:12352
    v_mul_u32_u24 v14, s24, v12
    ds_read_b64_tr_b16 v[46:47], v236 offset:13632
    s_waitcnt lgkmcnt(7)
    v_mfma_f32_16x16x32_bf16 v[28:31], v[48:51], v[56:59], v[28:31]
    v_add_u32 v14, v14, v13
    ds_read_b64_tr_b16 v[48:49], v236 offset:12384
    ds_read_b64_tr_b16 v[50:51], v236 offset:13664
    v_mfma_f32_16x16x32_bf16 v[32:35], v[52:55], v[56:59], v[32:35]
    v_add_u32 v217, 16896, v14
    ds_read_b64_tr_b16 v[52:53], v236 offset:12416
    ds_read_b64_tr_b16 v[54:55], v236 offset:13696
    s_movk_i32 s24, 4160
    s_waitcnt lgkmcnt(4)
    v_mfma_f32_16x16x32_bf16 v[16:19], v[36:39], v[60:63], v[16:19]
    s_waitcnt vmcnt(3)
    s_barrier
    ds_read_b128 v[56:59], v233 offset:0
    v_mul_u32_u24 v14, s24, v12
    ds_read_b64_tr_b16 v[36:37], v235 offset:41984
    ds_read_b64_tr_b16 v[38:39], v235 offset:43264
    v_mfma_f32_16x16x32_bf16 v[20:23], v[40:43], v[60:63], v[20:23]
    v_add_u32 v14, v14, v13
    ds_read_b64_tr_b16 v[40:41], v235 offset:42016
    ds_read_b64_tr_b16 v[42:43], v235 offset:43296
    v_add_u32 v218, 92192, v14
    v_mfma_f32_16x16x32_bf16 v[24:27], v[44:47], v[60:63], v[24:27]
    ds_read_b64_tr_b16 v[44:45], v235 offset:42048
    s_lshr_b32 s21, s20, 1
    ds_read_b64_tr_b16 v[46:47], v235 offset:43328
    s_waitcnt lgkmcnt(7)
    v_mfma_f32_16x16x32_bf16 v[28:31], v[48:51], v[60:63], v[28:31]
    s_mul_i32 s21, s21, 8320
    ds_read_b64_tr_b16 v[48:49], v235 offset:42080
    ds_read_b64_tr_b16 v[50:51], v235 offset:43360
    v_mfma_f32_16x16x32_bf16 v[32:35], v[52:55], v[60:63], v[32:35]
    s_add_u32 s21, s21, 92160
    ds_read_b64_tr_b16 v[52:53], v235 offset:42112
    ds_read_b64_tr_b16 v[54:55], v235 offset:43392
    v_lshlrev_b32 v13, 5, v1
    s_waitcnt lgkmcnt(4)
    v_mfma_f32_16x16x32_bf16 v[16:19], v[36:39], v[56:59], v[16:19]
    ds_read_b128 v[60:63], v234 offset:0
    v_add_u32 v219, s21, v13
    ds_read_b64_tr_b16 v[36:37], v235 offset:47104
    ds_read_b64_tr_b16 v[38:39], v235 offset:48384
    v_mfma_f32_16x16x32_bf16 v[20:23], v[40:43], v[56:59], v[20:23]
    s_movk_i32 s26, 1280
    ds_read_b64_tr_b16 v[40:41], v235 offset:47136
    ds_read_b64_tr_b16 v[42:43], v235 offset:48416
    v_mul_u32_u24 v13, s26, v1
    v_mfma_f32_16x16x32_bf16 v[24:27], v[44:47], v[56:59], v[24:27]
    ds_read_b64_tr_b16 v[44:45], v235 offset:47168
    s_lshl_b32 s21, s33, 3
    ds_read_b64_tr_b16 v[46:47], v235 offset:48448
    s_waitcnt lgkmcnt(7)
    v_mfma_f32_16x16x32_bf16 v[28:31], v[48:51], v[56:59], v[28:31]
    v_add_u32 v225, s21, v13
    ds_read_b64_tr_b16 v[48:49], v235 offset:47200
    ds_read_b64_tr_b16 v[50:51], v235 offset:48480
    v_mfma_f32_16x16x32_bf16 v[32:35], v[52:55], v[56:59], v[32:35]
    s_lshl_b32 s21, s20, 11
    ds_read_b64_tr_b16 v[52:53], v235 offset:47232
    ds_read_b64_tr_b16 v[54:55], v235 offset:48512
    s_add_u32 s21, s21, 92224
    s_waitcnt lgkmcnt(4)
    v_mfma_f32_16x16x32_bf16 v[16:19], v[36:39], v[60:63], v[16:19]
    s_waitcnt vmcnt(0)
    s_barrier
    ds_read_b128 v[56:59], v233 offset:8192
    ds_read_b64_tr_b16 v[36:37], v235 offset:52224
    ds_read_b64_tr_b16 v[38:39], v235 offset:53504
    v_mfma_f32_16x16x32_bf16 v[20:23], v[40:43], v[60:63], v[20:23]
    ds_read_b64_tr_b16 v[40:41], v235 offset:52256
    ds_read_b64_tr_b16 v[42:43], v235 offset:53536
    v_mfma_f32_16x16x32_bf16 v[24:27], v[44:47], v[60:63], v[24:27]
    v_lshlrev_b32 v13, 2, v1
    ds_read_b64_tr_b16 v[44:45], v235 offset:52288
    ds_read_b64_tr_b16 v[46:47], v235 offset:53568
    s_waitcnt lgkmcnt(7)
    v_mfma_f32_16x16x32_bf16 v[28:31], v[48:51], v[60:63], v[28:31]
    ds_read_b64_tr_b16 v[48:49], v235 offset:52320
    ds_read_b64_tr_b16 v[50:51], v235 offset:53600
    v_mfma_f32_16x16x32_bf16 v[32:35], v[52:55], v[60:63], v[32:35]
    ds_read_b64_tr_b16 v[52:53], v235 offset:52352
    ds_read_b64_tr_b16 v[54:55], v235 offset:53632
    v_add_u32 v237, s21, v13
    s_waitcnt lgkmcnt(4)
    v_mfma_f32_16x16x32_bf16 v[16:19], v[36:39], v[56:59], v[16:19]
    ds_read_b128 v[60:63], v234 offset:8192
    ds_read_b64_tr_b16 v[36:37], v235 offset:57344
    ds_read_b64_tr_b16 v[38:39], v235 offset:58624
    v_mfma_f32_16x16x32_bf16 v[20:23], v[40:43], v[56:59], v[20:23]
    ds_read_b64_tr_b16 v[40:41], v235 offset:57376
    ds_read_b64_tr_b16 v[42:43], v235 offset:58656
    v_mfma_f32_16x16x32_bf16 v[24:27], v[44:47], v[56:59], v[24:27]
    ds_read_b64_tr_b16 v[44:45], v235 offset:57408
    ds_read_b64_tr_b16 v[46:47], v235 offset:58688
    s_waitcnt lgkmcnt(7)
    v_mfma_f32_16x16x32_bf16 v[28:31], v[48:51], v[56:59], v[28:31]
    ds_read_b64_tr_b16 v[48:49], v235 offset:57440
    ds_read_b64_tr_b16 v[50:51], v235 offset:58720
    v_mfma_f32_16x16x32_bf16 v[32:35], v[52:55], v[56:59], v[32:35]
    ds_read_b64_tr_b16 v[52:53], v235 offset:57472
    ds_read_b64_tr_b16 v[54:55], v235 offset:58752
    s_waitcnt lgkmcnt(4)
    v_mfma_f32_16x16x32_bf16 v[16:19], v[36:39], v[60:63], v[16:19]
    v_mfma_f32_16x16x32_bf16 v[20:23], v[40:43], v[60:63], v[20:23]
    v_mfma_f32_16x16x32_bf16 v[24:27], v[44:47], v[60:63], v[24:27]
    s_waitcnt lgkmcnt(0)
    v_mfma_f32_16x16x32_bf16 v[28:31], v[48:51], v[60:63], v[28:31]
    v_mfma_f32_16x16x32_bf16 v[32:35], v[52:55], v[60:63], v[32:35]
    s_mov_b32 s44, s94
    s_mov_b32 s45, s95
    s_mov_b32 s46, 256
    s_mov_b32 s47, 0x20000
    v_lshlrev_b32 v12, 2, v1
    s_cmp_lg_u32 s20, 0
    s_cbranch_scc1 mg_kv_nl
    buffer_load_dword v248, v12, s[44:47], 0 offen sc1
mg_kv_nl:
    s_barrier
    s_mov_b32 s26, 0x3ea52b5c
    v_mul_f32 v16, s26, v16
    v_mul_f32 v17, s26, v17
    v_mul_f32 v18, s26, v18
    v_mul_f32 v19, s26, v19
    v_cvt_pk_bf16_f32 v36, v16, v17
    v_cvt_pk_bf16_f32 v37, v18, v19
    ds_write_b64 v226, v[36:37]
    v_mul_f32 v20, s26, v20
    v_mul_f32 v21, s26, v21
    v_mul_f32 v22, s26, v22
    v_mul_f32 v23, s26, v23
    v_cvt_pk_bf16_f32 v38, v20, v21
    v_cvt_pk_bf16_f32 v39, v22, v23
    ds_write_b64 v227, v[38:39]
    v_mul_f32 v24, s26, v24
    v_mul_f32 v25, s26, v25
    v_mul_f32 v26, s26, v26
    v_mul_f32 v27, s26, v27
    v_cvt_pk_bf16_f32 v40, v24, v25
    v_cvt_pk_bf16_f32 v41, v26, v27
    ds_write_b64 v228, v[40:41]
    v_mul_f32 v28, s26, v28
    v_mul_f32 v29, s26, v29
    v_mul_f32 v30, s26, v30
    v_mul_f32 v31, s26, v31
    v_cvt_pk_bf16_f32 v42, v28, v29
    v_cvt_pk_bf16_f32 v43, v30, v31
    ds_write_b64 v229, v[42:43]
    v_mul_f32 v32, s26, v32
    v_mul_f32 v33, s26, v33
    v_mul_f32 v34, s26, v34
    v_mul_f32 v35, s26, v35
    v_cvt_pk_bf16_f32 v44, v32, v33
    v_cvt_pk_bf16_f32 v45, v34, v35
    ds_write_b64 v230, v[44:45]
    s_mov_b32 s35, 262144
    s_cmp_lg_u32 s20, 0
    s_cbranch_scc1 mg_kv_d
mg_kv_p:
    s_waitcnt vmcnt(0)
    v_cmp_ne_u32 vcc, 0, v248
    s_sub_u32 s35, s35, 1
    s_cmp_eq_u32 s35, 0
    s_cbranch_scc1 mg_kv_d
    s_cmp_eq_u64 vcc, -1
    s_cbranch_scc1 mg_kv_d
    buffer_load_dword v248, v12, s[44:47], 0 offen sc1
    s_branch mg_kv_p
mg_kv_d:
    s_waitcnt lgkmcnt(0)
    s_barrier
    s_mov_b32 s8, s4
    s_mov_b32 s9, s5
    s_mov_b32 s10, 262144
    s_mov_b32 s11, 0x20000
    s_lshl_b32 s44, s20, 14
    s_lshl_b32 s45, s20, 13
    s_add_u32 s45, s45, 65536
    s_lshl_b32 s46, s20, 15
    s_add_u32 s46, s46, 131072
    s_cmp_ge_u32 s3, 160
    s_cbranch_scc1 mg_btr
    v_mov_b32 v12, 161024
    v_mov_b32 v13, 0
    ds_write_b32 v12, v13
    s_lshl_b32 s35, s20, 1
    s_add_u32 s36, s35, 2
    s_and_b32 s36, s36, 7
    s_mul_i32 s36, s36, 1280
    v_add_u32 v16, s36, v231
    ds_read_b128 v[128:131], v16
    v_mov_b32 v132, 0
    v_mov_b32 v133, 0
    s_add_u32 s36, s35, 3
    s_and_b32 s36, s36, 7
    s_mul_i32 s36, s36, 1280
    v_add_u32 v17, s36, v231
    ds_read_b128 v[134:137], v17
    v_mov_b32 v138, 0
    v_mov_b32 v139, 0
    s_add_u32 s36, s35, 4
    s_and_b32 s36, s36, 7
    s_mul_i32 s36, s36, 1280
    v_add_u32 v18, s36, v231
    ds_read_b128 v[140:143], v18
    v_mov_b32 v144, 0
    v_mov_b32 v145, 0
    s_add_u32 s36, s35, 5
    s_and_b32 s36, s36, 7
    s_mul_i32 s36, s36, 1280
    v_add_u32 v19, s36, v231
    ds_read_b128 v[146:149], v19
    v_mov_b32 v150, 0
    v_mov_b32 v151, 0
    s_add_u32 s36, s35, 6
    s_and_b32 s36, s36, 7
    s_mul_i32 s36, s36, 1280
    v_add_u32 v20, s36, v231
    ds_read_b128 v[152:155], v20
    v_mov_b32 v156, 0
    v_mov_b32 v157, 0
    s_add_u32 s36, s35, 7
    s_and_b32 s36, s36, 7
    s_mul_i32 s36, s36, 1280
    v_add_u32 v21, s36, v231
    ds_read_b128 v[158:161], v21
    v_mov_b32 v162, 0
    v_mov_b32 v163, 0
    s_add_u32 s36, s35, 8
    s_and_b32 s36, s36, 7
    s_mul_i32 s36, s36, 1280
    v_add_u32 v22, s36, v231
    ds_read_b128 v[164:167], v22
    v_mov_b32 v168, 0
    v_mov_b32 v169, 0
    s_add_u32 s36, s35, 9
    s_and_b32 s36, s36, 7
    s_mul_i32 s36, s36, 1280
    v_add_u32 v23, s36, v231
    ds_read_b128 v[170:173], v23
    v_mov_b32 v174, 0
    v_mov_b32 v175, 0
    s_mov_b32 exec_hi, 0
    v_sub_u32 v24, v16, v232
    ds_read_b64 v[132:133], v24 offset:1024
    v_sub_u32 v25, v17, v232
    ds_read_b64 v[138:139], v25 offset:1024
    v_sub_u32 v26, v18, v232
    ds_read_b64 v[144:145], v26 offset:1024
    v_sub_u32 v27, v19, v232
    ds_read_b64 v[150:151], v27 offset:1024
    v_sub_u32 v28, v20, v232
    ds_read_b64 v[156:157], v28 offset:1024
    v_sub_u32 v29, v21, v232
    ds_read_b64 v[162:163], v29 offset:1024
    v_sub_u32 v30, v22, v232
    ds_read_b64 v[168:169], v30 offset:1024
    v_sub_u32 v31, v23, v232
    ds_read_b64 v[174:175], v31 offset:1024
    s_mov_b32 exec_hi, -1
    v_pk_mul_f32 v[180:181], v[176:177], v[120:121] op_sel:[0,0] op_sel_hi:[0,1]
    v_pk_mul_f32 v[182:183], v[178:179], v[122:123] op_sel:[0,0] op_sel_hi:[0,1]
    v_cvt_pk_bf16_f32 v184, v176, -v177
    v_cvt_pk_bf16_f32 v185, v178, -v179
    v_pk_fma_f32 v[176:177], v[176:177], v[120:121], v[180:181] op_sel:[1,1,0] op_sel_hi:[1,0,1] neg_lo:[1,0,0]
    v_pk_fma_f32 v[178:179], v[178:179], v[122:123], v[182:183] op_sel:[1,1,0] op_sel_hi:[1,0,1] neg_lo:[1,0,0]
    ds_write_b64 v196, v[184:185] offset:0
    v_pk_mul_f32 v[180:181], v[176:177], v[120:121] op_sel:[0,0] op_sel_hi:[0,1]
    v_pk_mul_f32 v[182:183], v[178:179], v[122:123] op_sel:[0,0] op_sel_hi:[0,1]
    v_cvt_pk_bf16_f32 v186, v176, -v177
    v_cvt_pk_bf16_f32 v187, v178, -v179
    v_pk_fma_f32 v[176:177], v[176:177], v[120:121], v[180:181] op_sel:[1,1,0] op_sel_hi:[1,0,1] neg_lo:[1,0,0]
    v_pk_fma_f32 v[178:179], v[178:179], v[122:123], v[182:183] op_sel:[1,1,0] op_sel_hi:[1,0,1] neg_lo:[1,0,0]
    ds_write_b64 v196, v[186:187] offset:528
    v_pk_mul_f32 v[180:181], v[176:177], v[120:121] op_sel:[0,0] op_sel_hi:[0,1]
    v_pk_mul_f32 v[182:183], v[178:179], v[122:123] op_sel:[0,0] op_sel_hi:[0,1]
    v_cvt_pk_bf16_f32 v184, v176, -v177
    v_cvt_pk_bf16_f32 v185, v178, -v179
    v_pk_fma_f32 v[176:177], v[176:177], v[120:121], v[180:181] op_sel:[1,1,0] op_sel_hi:[1,0,1] neg_lo:[1,0,0]
    v_pk_fma_f32 v[178:179], v[178:179], v[122:123], v[182:183] op_sel:[1,1,0] op_sel_hi:[1,0,1] neg_lo:[1,0,0]
    ds_write_b64 v196, v[184:185] offset:1056
    v_pk_mul_f32 v[180:181], v[176:177], v[120:121] op_sel:[0,0] op_sel_hi:[0,1]
    v_pk_mul_f32 v[182:183], v[178:179], v[122:123] op_sel:[0,0] op_sel_hi:[0,1]
    v_cvt_pk_bf16_f32 v186, v176, -v177
    v_cvt_pk_bf16_f32 v187, v178, -v179
    v_pk_fma_f32 v[176:177], v[176:177], v[120:121], v[180:181] op_sel:[1,1,0] op_sel_hi:[1,0,1] neg_lo:[1,0,0]
    v_pk_fma_f32 v[178:179], v[178:179], v[122:123], v[182:183] op_sel:[1,1,0] op_sel_hi:[1,0,1] neg_lo:[1,0,0]
    ds_write_b64 v196, v[186:187] offset:1584
    v_pk_mul_f32 v[180:181], v[176:177], v[120:121] op_sel:[0,0] op_sel_hi:[0,1]
    v_pk_mul_f32 v[182:183], v[178:179], v[122:123] op_sel:[0,0] op_sel_hi:[0,1]
    v_cvt_pk_bf16_f32 v184, v176, -v177
    v_cvt_pk_bf16_f32 v185, v178, -v179
    v_pk_fma_f32 v[176:177], v[176:177], v[120:121], v[180:181] op_sel:[1,1,0] op_sel_hi:[1,0,1] neg_lo:[1,0,0]
    v_pk_fma_f32 v[178:179], v[178:179], v[122:123], v[182:183] op_sel:[1,1,0] op_sel_hi:[1,0,1] neg_lo:[1,0,0]
    ds_write_b64 v196, v[184:185] offset:2112
    v_pk_mul_f32 v[180:181], v[176:177], v[120:121] op_sel:[0,0] op_sel_hi:[0,1]
    v_pk_mul_f32 v[182:183], v[178:179], v[122:123] op_sel:[0,0] op_sel_hi:[0,1]
    v_cvt_pk_bf16_f32 v186, v176, -v177
    v_cvt_pk_bf16_f32 v187, v178, -v179
    v_pk_fma_f32 v[176:177], v[176:177], v[120:121], v[180:181] op_sel:[1,1,0] op_sel_hi:[1,0,1] neg_lo:[1,0,0]
    v_pk_fma_f32 v[178:179], v[178:179], v[122:123], v[182:183] op_sel:[1,1,0] op_sel_hi:[1,0,1] neg_lo:[1,0,0]
    ds_write_b64 v196, v[186:187] offset:2640
    v_pk_mul_f32 v[180:181], v[176:177], v[120:121] op_sel:[0,0] op_sel_hi:[0,1]
    v_pk_mul_f32 v[182:183], v[178:179], v[122:123] op_sel:[0,0] op_sel_hi:[0,1]
    v_cvt_pk_bf16_f32 v184, v176, -v177
    v_cvt_pk_bf16_f32 v185, v178, -v179
    v_pk_fma_f32 v[176:177], v[176:177], v[120:121], v[180:181] op_sel:[1,1,0] op_sel_hi:[1,0,1] neg_lo:[1,0,0]
    v_pk_fma_f32 v[178:179], v[178:179], v[122:123], v[182:183] op_sel:[1,1,0] op_sel_hi:[1,0,1] neg_lo:[1,0,0]
    ds_write_b64 v196, v[184:185] offset:3168
    v_pk_mul_f32 v[180:181], v[176:177], v[120:121] op_sel:[0,0] op_sel_hi:[0,1]
    v_pk_mul_f32 v[182:183], v[178:179], v[122:123] op_sel:[0,0] op_sel_hi:[0,1]
    v_cvt_pk_bf16_f32 v186, v176, -v177
    v_cvt_pk_bf16_f32 v187, v178, -v179
    v_pk_fma_f32 v[176:177], v[176:177], v[120:121], v[180:181] op_sel:[1,1,0] op_sel_hi:[1,0,1] neg_lo:[1,0,0]
    v_pk_fma_f32 v[178:179], v[178:179], v[122:123], v[182:183] op_sel:[1,1,0] op_sel_hi:[1,0,1] neg_lo:[1,0,0]
    ds_write_b64 v196, v[186:187] offset:3696
    v_pk_mul_f32 v[180:181], v[176:177], v[120:121] op_sel:[0,0] op_sel_hi:[0,1]
    v_pk_mul_f32 v[182:183], v[178:179], v[122:123] op_sel:[0,0] op_sel_hi:[0,1]
    v_cvt_pk_bf16_f32 v184, v176, -v177
    v_cvt_pk_bf16_f32 v185, v178, -v179
    v_pk_fma_f32 v[176:177], v[176:177], v[120:121], v[180:181] op_sel:[1,1,0] op_sel_hi:[1,0,1] neg_lo:[1,0,0]
    v_pk_fma_f32 v[178:179], v[178:179], v[122:123], v[182:183] op_sel:[1,1,0] op_sel_hi:[1,0,1] neg_lo:[1,0,0]
    ds_write_b64 v196, v[184:185] offset:4224
    v_pk_mul_f32 v[180:181], v[176:177], v[120:121] op_sel:[0,0] op_sel_hi:[0,1]
    v_pk_mul_f32 v[182:183], v[178:179], v[122:123] op_sel:[0,0] op_sel_hi:[0,1]
    v_cvt_pk_bf16_f32 v186, v176, -v177
    v_cvt_pk_bf16_f32 v187, v178, -v179
    v_pk_fma_f32 v[176:177], v[176:177], v[120:121], v[180:181] op_sel:[1,1,0] op_sel_hi:[1,0,1] neg_lo:[1,0,0]
    v_pk_fma_f32 v[178:179], v[178:179], v[122:123], v[182:183] op_sel:[1,1,0] op_sel_hi:[1,0,1] neg_lo:[1,0,0]
    ds_write_b64 v196, v[186:187] offset:4752
    v_pk_mul_f32 v[180:181], v[176:177], v[120:121] op_sel:[0,0] op_sel_hi:[0,1]
    v_pk_mul_f32 v[182:183], v[178:179], v[122:123] op_sel:[0,0] op_sel_hi:[0,1]
    v_cvt_pk_bf16_f32 v184, v176, -v177
    v_cvt_pk_bf16_f32 v185, v178, -v179
    v_pk_fma_f32 v[176:177], v[176:177], v[120:121], v[180:181] op_sel:[1,1,0] op_sel_hi:[1,0,1] neg_lo:[1,0,0]
    v_pk_fma_f32 v[178:179], v[178:179], v[122:123], v[182:183] op_sel:[1,1,0] op_sel_hi:[1,0,1] neg_lo:[1,0,0]
    ds_write_b64 v196, v[184:185] offset:5280
    v_pk_mul_f32 v[180:181], v[176:177], v[120:121] op_sel:[0,0] op_sel_hi:[0,1]
    v_pk_mul_f32 v[182:183], v[178:179], v[122:123] op_sel:[0,0] op_sel_hi:[0,1]
    v_cvt_pk_bf16_f32 v186, v176, -v177
    v_cvt_pk_bf16_f32 v187, v178, -v179
    v_pk_fma_f32 v[176:177], v[176:177], v[120:121], v[180:181] op_sel:[1,1,0] op_sel_hi:[1,0,1] neg_lo:[1,0,0]
    v_pk_fma_f32 v[178:179], v[178:179], v[122:123], v[182:183] op_sel:[1,1,0] op_sel_hi:[1,0,1] neg_lo:[1,0,0]
    ds_write_b64 v196, v[186:187] offset:5808
    v_pk_mul_f32 v[180:181], v[176:177], v[120:121] op_sel:[0,0] op_sel_hi:[0,1]
    v_pk_mul_f32 v[182:183], v[178:179], v[122:123] op_sel:[0,0] op_sel_hi:[0,1]
    v_cvt_pk_bf16_f32 v184, v176, -v177
    v_cvt_pk_bf16_f32 v185, v178, -v179
    v_pk_fma_f32 v[176:177], v[176:177], v[120:121], v[180:181] op_sel:[1,1,0] op_sel_hi:[1,0,1] neg_lo:[1,0,0]
    v_pk_fma_f32 v[178:179], v[178:179], v[122:123], v[182:183] op_sel:[1,1,0] op_sel_hi:[1,0,1] neg_lo:[1,0,0]
    ds_write_b64 v196, v[184:185] offset:6336
    v_pk_mul_f32 v[180:181], v[176:177], v[120:121] op_sel:[0,0] op_sel_hi:[0,1]
    v_pk_mul_f32 v[182:183], v[178:179], v[122:123] op_sel:[0,0] op_sel_hi:[0,1]
    v_cvt_pk_bf16_f32 v186, v176, -v177
    v_cvt_pk_bf16_f32 v187, v178, -v179
    v_pk_fma_f32 v[176:177], v[176:177], v[120:121], v[180:181] op_sel:[1,1,0] op_sel_hi:[1,0,1] neg_lo:[1,0,0]
    v_pk_fma_f32 v[178:179], v[178:179], v[122:123], v[182:183] op_sel:[1,1,0] op_sel_hi:[1,0,1] neg_lo:[1,0,0]
    ds_write_b64 v196, v[186:187] offset:6864
    v_pk_mul_f32 v[180:181], v[176:177], v[120:121] op_sel:[0,0] op_sel_hi:[0,1]
    v_pk_mul_f32 v[182:183], v[178:179], v[122:123] op_sel:[0,0] op_sel_hi:[0,1]
    v_cvt_pk_bf16_f32 v184, v176, -v177
    v_cvt_pk_bf16_f32 v185, v178, -v179
    v_pk_fma_f32 v[176:177], v[176:177], v[120:121], v[180:181] op_sel:[1,1,0] op_sel_hi:[1,0,1] neg_lo:[1,0,0]
    v_pk_fma_f32 v[178:179], v[178:179], v[122:123], v[182:183] op_sel:[1,1,0] op_sel_hi:[1,0,1] neg_lo:[1,0,0]
    ds_write_b64 v196, v[184:185] offset:7392
    v_pk_mul_f32 v[180:181], v[176:177], v[120:121] op_sel:[0,0] op_sel_hi:[0,1]
    v_pk_mul_f32 v[182:183], v[178:179], v[122:123] op_sel:[0,0] op_sel_hi:[0,1]
    v_cvt_pk_bf16_f32 v186, v176, -v177
    v_cvt_pk_bf16_f32 v187, v178, -v179
    v_pk_fma_f32 v[176:177], v[176:177], v[120:121], v[180:181] op_sel:[1,1,0] op_sel_hi:[1,0,1] neg_lo:[1,0,0]
    v_pk_fma_f32 v[178:179], v[178:179], v[122:123], v[182:183] op_sel:[1,1,0] op_sel_hi:[1,0,1] neg_lo:[1,0,0]
    ds_write_b64 v196, v[186:187] offset:7920
    v_pk_mul_f32 v[180:181], v[176:177], v[120:121] op_sel:[0,0] op_sel_hi:[0,1]
    v_pk_mul_f32 v[182:183], v[178:179], v[122:123] op_sel:[0,0] op_sel_hi:[0,1]
    v_cvt_pk_bf16_f32 v184, v176, -v177
    v_cvt_pk_bf16_f32 v185, v178, -v179
    v_pk_fma_f32 v[176:177], v[176:177], v[120:121], v[180:181] op_sel:[1,1,0] op_sel_hi:[1,0,1] neg_lo:[1,0,0]
    v_pk_fma_f32 v[178:179], v[178:179], v[122:123], v[182:183] op_sel:[1,1,0] op_sel_hi:[1,0,1] neg_lo:[1,0,0]
    ds_write_b64 v196, v[184:185] offset:8448
    v_pk_mul_f32 v[180:181], v[176:177], v[120:121] op_sel:[0,0] op_sel_hi:[0,1]
    v_pk_mul_f32 v[182:183], v[178:179], v[122:123] op_sel:[0,0] op_sel_hi:[0,1]
    v_cvt_pk_bf16_f32 v186, v176, -v177
    v_cvt_pk_bf16_f32 v187, v178, -v179
    v_pk_fma_f32 v[176:177], v[176:177], v[120:121], v[180:181] op_sel:[1,1,0] op_sel_hi:[1,0,1] neg_lo:[1,0,0]
    v_pk_fma_f32 v[178:179], v[178:179], v[122:123], v[182:183] op_sel:[1,1,0] op_sel_hi:[1,0,1] neg_lo:[1,0,0]
    ds_write_b64 v196, v[186:187] offset:8976
    v_pk_mul_f32 v[180:181], v[176:177], v[120:121] op_sel:[0,0] op_sel_hi:[0,1]
    v_pk_mul_f32 v[182:183], v[178:179], v[122:123] op_sel:[0,0] op_sel_hi:[0,1]
    v_cvt_pk_bf16_f32 v184, v176, -v177
    v_cvt_pk_bf16_f32 v185, v178, -v179
    v_pk_fma_f32 v[176:177], v[176:177], v[120:121], v[180:181] op_sel:[1,1,0] op_sel_hi:[1,0,1] neg_lo:[1,0,0]
    v_pk_fma_f32 v[178:179], v[178:179], v[122:123], v[182:183] op_sel:[1,1,0] op_sel_hi:[1,0,1] neg_lo:[1,0,0]
    ds_write_b64 v196, v[184:185] offset:9504
    v_pk_mul_f32 v[180:181], v[176:177], v[120:121] op_sel:[0,0] op_sel_hi:[0,1]
    v_pk_mul_f32 v[182:183], v[178:179], v[122:123] op_sel:[0,0] op_sel_hi:[0,1]
    v_cvt_pk_bf16_f32 v186, v176, -v177
    v_cvt_pk_bf16_f32 v187, v178, -v179
    v_pk_fma_f32 v[176:177], v[176:177], v[120:121], v[180:181] op_sel:[1,1,0] op_sel_hi:[1,0,1] neg_lo:[1,0,0]
    v_pk_fma_f32 v[178:179], v[178:179], v[122:123], v[182:183] op_sel:[1,1,0] op_sel_hi:[1,0,1] neg_lo:[1,0,0]
    ds_write_b64 v196, v[186:187] offset:10032
    v_pk_mul_f32 v[180:181], v[176:177], v[120:121] op_sel:[0,0] op_sel_hi:[0,1]
    v_pk_mul_f32 v[182:183], v[178:179], v[122:123] op_sel:[0,0] op_sel_hi:[0,1]
    v_cvt_pk_bf16_f32 v184, v176, -v177
    v_cvt_pk_bf16_f32 v185, v178, -v179
    v_pk_fma_f32 v[176:177], v[176:177], v[120:121], v[180:181] op_sel:[1,1,0] op_sel_hi:[1,0,1] neg_lo:[1,0,0]
    v_pk_fma_f32 v[178:179], v[178:179], v[122:123], v[182:183] op_sel:[1,1,0] op_sel_hi:[1,0,1] neg_lo:[1,0,0]
    ds_write_b64 v196, v[184:185] offset:10560
    v_pk_mul_f32 v[180:181], v[176:177], v[120:121] op_sel:[0,0] op_sel_hi:[0,1]
    v_pk_mul_f32 v[182:183], v[178:179], v[122:123] op_sel:[0,0] op_sel_hi:[0,1]
    v_cvt_pk_bf16_f32 v186, v176, -v177
    v_cvt_pk_bf16_f32 v187, v178, -v179
    v_pk_fma_f32 v[176:177], v[176:177], v[120:121], v[180:181] op_sel:[1,1,0] op_sel_hi:[1,0,1] neg_lo:[1,0,0]
    v_pk_fma_f32 v[178:179], v[178:179], v[122:123], v[182:183] op_sel:[1,1,0] op_sel_hi:[1,0,1] neg_lo:[1,0,0]
    ds_write_b64 v196, v[186:187] offset:11088
    v_pk_mul_f32 v[180:181], v[176:177], v[120:121] op_sel:[0,0] op_sel_hi:[0,1]
    v_pk_mul_f32 v[182:183], v[178:179], v[122:123] op_sel:[0,0] op_sel_hi:[0,1]
    v_cvt_pk_bf16_f32 v184, v176, -v177
    v_cvt_pk_bf16_f32 v185, v178, -v179
    v_pk_fma_f32 v[176:177], v[176:177], v[120:121], v[180:181] op_sel:[1,1,0] op_sel_hi:[1,0,1] neg_lo:[1,0,0]
    v_pk_fma_f32 v[178:179], v[178:179], v[122:123], v[182:183] op_sel:[1,1,0] op_sel_hi:[1,0,1] neg_lo:[1,0,0]
    ds_write_b64 v196, v[184:185] offset:11616
    v_pk_mul_f32 v[180:181], v[176:177], v[120:121] op_sel:[0,0] op_sel_hi:[0,1]
    v_pk_mul_f32 v[182:183], v[178:179], v[122:123] op_sel:[0,0] op_sel_hi:[0,1]
    v_cvt_pk_bf16_f32 v186, v176, -v177
    v_cvt_pk_bf16_f32 v187, v178, -v179
    v_pk_fma_f32 v[176:177], v[176:177], v[120:121], v[180:181] op_sel:[1,1,0] op_sel_hi:[1,0,1] neg_lo:[1,0,0]
    v_pk_fma_f32 v[178:179], v[178:179], v[122:123], v[182:183] op_sel:[1,1,0] op_sel_hi:[1,0,1] neg_lo:[1,0,0]
    ds_write_b64 v196, v[186:187] offset:12144
    v_pk_mul_f32 v[180:181], v[176:177], v[120:121] op_sel:[0,0] op_sel_hi:[0,1]
    v_pk_mul_f32 v[182:183], v[178:179], v[122:123] op_sel:[0,0] op_sel_hi:[0,1]
    v_cvt_pk_bf16_f32 v184, v176, -v177
    v_cvt_pk_bf16_f32 v185, v178, -v179
    v_pk_fma_f32 v[176:177], v[176:177], v[120:121], v[180:181] op_sel:[1,1,0] op_sel_hi:[1,0,1] neg_lo:[1,0,0]
    v_pk_fma_f32 v[178:179], v[178:179], v[122:123], v[182:183] op_sel:[1,1,0] op_sel_hi:[1,0,1] neg_lo:[1,0,0]
    ds_write_b64 v196, v[184:185] offset:12672
    v_pk_mul_f32 v[180:181], v[176:177], v[120:121] op_sel:[0,0] op_sel_hi:[0,1]
    v_pk_mul_f32 v[182:183], v[178:179], v[122:123] op_sel:[0,0] op_sel_hi:[0,1]
    v_cvt_pk_bf16_f32 v186, v176, -v177
    v_cvt_pk_bf16_f32 v187, v178, -v179
    v_pk_fma_f32 v[176:177], v[176:177], v[120:121], v[180:181] op_sel:[1,1,0] op_sel_hi:[1,0,1] neg_lo:[1,0,0]
    v_pk_fma_f32 v[178:179], v[178:179], v[122:123], v[182:183] op_sel:[1,1,0] op_sel_hi:[1,0,1] neg_lo:[1,0,0]
    ds_write_b64 v196, v[186:187] offset:13200
    v_pk_mul_f32 v[180:181], v[176:177], v[120:121] op_sel:[0,0] op_sel_hi:[0,1]
    v_pk_mul_f32 v[182:183], v[178:179], v[122:123] op_sel:[0,0] op_sel_hi:[0,1]
    v_cvt_pk_bf16_f32 v184, v176, -v177
    v_cvt_pk_bf16_f32 v185, v178, -v179
    v_pk_fma_f32 v[176:177], v[176:177], v[120:121], v[180:181] op_sel:[1,1,0] op_sel_hi:[1,0,1] neg_lo:[1,0,0]
    v_pk_fma_f32 v[178:179], v[178:179], v[122:123], v[182:183] op_sel:[1,1,0] op_sel_hi:[1,0,1] neg_lo:[1,0,0]
    ds_write_b64 v196, v[184:185] offset:13728
    v_pk_mul_f32 v[180:181], v[176:177], v[120:121] op_sel:[0,0] op_sel_hi:[0,1]
    v_pk_mul_f32 v[182:183], v[178:179], v[122:123] op_sel:[0,0] op_sel_hi:[0,1]
    v_cvt_pk_bf16_f32 v186, v176, -v177
    v_cvt_pk_bf16_f32 v187, v178, -v179
    v_pk_fma_f32 v[176:177], v[176:177], v[120:121], v[180:181] op_sel:[1,1,0] op_sel_hi:[1,0,1] neg_lo:[1,0,0]
    v_pk_fma_f32 v[178:179], v[178:179], v[122:123], v[182:183] op_sel:[1,1,0] op_sel_hi:[1,0,1] neg_lo:[1,0,0]
    ds_write_b64 v196, v[186:187] offset:14256
    v_pk_mul_f32 v[180:181], v[176:177], v[120:121] op_sel:[0,0] op_sel_hi:[0,1]
    v_pk_mul_f32 v[182:183], v[178:179], v[122:123] op_sel:[0,0] op_sel_hi:[0,1]
    v_cvt_pk_bf16_f32 v184, v176, -v177
    v_cvt_pk_bf16_f32 v185, v178, -v179
    v_pk_fma_f32 v[176:177], v[176:177], v[120:121], v[180:181] op_sel:[1,1,0] op_sel_hi:[1,0,1] neg_lo:[1,0,0]
    v_pk_fma_f32 v[178:179], v[178:179], v[122:123], v[182:183] op_sel:[1,1,0] op_sel_hi:[1,0,1] neg_lo:[1,0,0]
    ds_write_b64 v196, v[184:185] offset:14784
    v_pk_mul_f32 v[180:181], v[176:177], v[120:121] op_sel:[0,0] op_sel_hi:[0,1]
    v_pk_mul_f32 v[182:183], v[178:179], v[122:123] op_sel:[0,0] op_sel_hi:[0,1]
    v_cvt_pk_bf16_f32 v186, v176, -v177
    v_cvt_pk_bf16_f32 v187, v178, -v179
    v_pk_fma_f32 v[176:177], v[176:177], v[120:121], v[180:181] op_sel:[1,1,0] op_sel_hi:[1,0,1] neg_lo:[1,0,0]
    v_pk_fma_f32 v[178:179], v[178:179], v[122:123], v[182:183] op_sel:[1,1,0] op_sel_hi:[1,0,1] neg_lo:[1,0,0]
    ds_write_b64 v196, v[186:187] offset:15312
    v_pk_mul_f32 v[180:181], v[176:177], v[120:121] op_sel:[0,0] op_sel_hi:[0,1]
    v_pk_mul_f32 v[182:183], v[178:179], v[122:123] op_sel:[0,0] op_sel_hi:[0,1]
    v_cvt_pk_bf16_f32 v184, v176, -v177
    v_cvt_pk_bf16_f32 v185, v178, -v179
    v_pk_fma_f32 v[176:177], v[176:177], v[120:121], v[180:181] op_sel:[1,1,0] op_sel_hi:[1,0,1] neg_lo:[1,0,0]
    v_pk_fma_f32 v[178:179], v[178:179], v[122:123], v[182:183] op_sel:[1,1,0] op_sel_hi:[1,0,1] neg_lo:[1,0,0]
    ds_write_b64 v196, v[184:185] offset:15840
    v_pk_mul_f32 v[180:181], v[176:177], v[120:121] op_sel:[0,0] op_sel_hi:[0,1]
    v_pk_mul_f32 v[182:183], v[178:179], v[122:123] op_sel:[0,0] op_sel_hi:[0,1]
    v_cvt_pk_bf16_f32 v186, v176, -v177
    v_cvt_pk_bf16_f32 v187, v178, -v179
    v_pk_fma_f32 v[176:177], v[176:177], v[120:121], v[180:181] op_sel:[1,1,0] op_sel_hi:[1,0,1] neg_lo:[1,0,0]
    v_pk_fma_f32 v[178:179], v[178:179], v[122:123], v[182:183] op_sel:[1,1,0] op_sel_hi:[1,0,1] neg_lo:[1,0,0]
    ds_write_b64 v196, v[186:187] offset:16368
    v_cvt_pk_bf16_f32 v184, v176, -v177
    v_cvt_pk_bf16_f32 v185, v178, -v179
    ds_write_b64 v196, v[184:185] offset:16896
    v_mov_b32 v176, 1.0
    v_mov_b32 v177, 0
    v_mov_b32 v178, 1.0
    v_mov_b32 v179, 0
    v_pk_mul_f32 v[180:181], v[176:177], v[124:125] op_sel:[0,0] op_sel_hi:[0,1]
    v_pk_mul_f32 v[182:183], v[178:179], v[126:127] op_sel:[0,0] op_sel_hi:[0,1]
    v_cvt_pk_bf16_f32 v186, v176, v177
    v_cvt_pk_bf16_f32 v187, v178, v179
    v_pk_fma_f32 v[176:177], v[176:177], v[124:125], v[180:181] op_sel:[1,1,0] op_sel_hi:[1,0,1] neg_lo:[1,0,0]
    v_pk_fma_f32 v[178:179], v[178:179], v[126:127], v[182:183] op_sel:[1,1,0] op_sel_hi:[1,0,1] neg_lo:[1,0,0]
    ds_write_b64 v197, v[186:187] offset:0
    v_pk_mul_f32 v[180:181], v[176:177], v[124:125] op_sel:[0,0] op_sel_hi:[0,1]
    v_pk_mul_f32 v[182:183], v[178:179], v[126:127] op_sel:[0,0] op_sel_hi:[0,1]
    v_cvt_pk_bf16_f32 v184, v176, v177
    v_cvt_pk_bf16_f32 v185, v178, v179
    v_pk_fma_f32 v[176:177], v[176:177], v[124:125], v[180:181] op_sel:[1,1,0] op_sel_hi:[1,0,1] neg_lo:[1,0,0]
    v_pk_fma_f32 v[178:179], v[178:179], v[126:127], v[182:183] op_sel:[1,1,0] op_sel_hi:[1,0,1] neg_lo:[1,0,0]
    ds_write_b64 v197, v[184:185] offset:528
    v_pk_mul_f32 v[180:181], v[176:177], v[124:125] op_sel:[0,0] op_sel_hi:[0,1]
    v_pk_mul_f32 v[182:183], v[178:179], v[126:127] op_sel:[0,0] op_sel_hi:[0,1]
    v_cvt_pk_bf16_f32 v186, v176, v177
    v_cvt_pk_bf16_f32 v187, v178, v179
    v_pk_fma_f32 v[176:177], v[176:177], v[124:125], v[180:181] op_sel:[1,1,0] op_sel_hi:[1,0,1] neg_lo:[1,0,0]
    v_pk_fma_f32 v[178:179], v[178:179], v[126:127], v[182:183] op_sel:[1,1,0] op_sel_hi:[1,0,1] neg_lo:[1,0,0]
    ds_write_b64 v197, v[186:187] offset:1056
    v_pk_mul_f32 v[180:181], v[176:177], v[124:125] op_sel:[0,0] op_sel_hi:[0,1]
    v_pk_mul_f32 v[182:183], v[178:179], v[126:127] op_sel:[0,0] op_sel_hi:[0,1]
    v_cvt_pk_bf16_f32 v184, v176, v177
    v_cvt_pk_bf16_f32 v185, v178, v179
    v_pk_fma_f32 v[176:177], v[176:177], v[124:125], v[180:181] op_sel:[1,1,0] op_sel_hi:[1,0,1] neg_lo:[1,0,0]
    v_pk_fma_f32 v[178:179], v[178:179], v[126:127], v[182:183] op_sel:[1,1,0] op_sel_hi:[1,0,1] neg_lo:[1,0,0]
    ds_write_b64 v197, v[184:185] offset:1584
    ds_read_b128 v[16:19], v112 offset:0
    v_pk_mul_f32 v[180:181], v[176:177], v[124:125] op_sel:[0,0] op_sel_hi:[0,1]
    v_pk_mul_f32 v[182:183], v[178:179], v[126:127] op_sel:[0,0] op_sel_hi:[0,1]
    v_cvt_pk_bf16_f32 v186, v176, v177
    v_cvt_pk_bf16_f32 v187, v178, v179
    v_pk_fma_f32 v[176:177], v[176:177], v[124:125], v[180:181] op_sel:[1,1,0] op_sel_hi:[1,0,1] neg_lo:[1,0,0]
    v_pk_fma_f32 v[178:179], v[178:179], v[126:127], v[182:183] op_sel:[1,1,0] op_sel_hi:[1,0,1] neg_lo:[1,0,0]
    ds_write_b64 v197, v[186:187] offset:2112
    ds_read_b128 v[20:23], v113 offset:0
    v_pk_mul_f32 v[180:181], v[176:177], v[124:125] op_sel:[0,0] op_sel_hi:[0,1]
    v_pk_mul_f32 v[182:183], v[178:179], v[126:127] op_sel:[0,0] op_sel_hi:[0,1]
    v_cvt_pk_bf16_f32 v184, v176, v177
    v_cvt_pk_bf16_f32 v185, v178, v179
    v_pk_fma_f32 v[176:177], v[176:177], v[124:125], v[180:181] op_sel:[1,1,0] op_sel_hi:[1,0,1] neg_lo:[1,0,0]
    v_pk_fma_f32 v[178:179], v[178:179], v[126:127], v[182:183] op_sel:[1,1,0] op_sel_hi:[1,0,1] neg_lo:[1,0,0]
    ds_write_b64 v197, v[184:185] offset:2640
    ds_read_b128 v[24:27], v114 offset:0
    v_pk_mul_f32 v[180:181], v[176:177], v[124:125] op_sel:[0,0] op_sel_hi:[0,1]
    v_pk_mul_f32 v[182:183], v[178:179], v[126:127] op_sel:[0,0] op_sel_hi:[0,1]
    v_cvt_pk_bf16_f32 v186, v176, v177
    v_cvt_pk_bf16_f32 v187, v178, v179
    v_pk_fma_f32 v[176:177], v[176:177], v[124:125], v[180:181] op_sel:[1,1,0] op_sel_hi:[1,0,1] neg_lo:[1,0,0]
    v_pk_fma_f32 v[178:179], v[178:179], v[126:127], v[182:183] op_sel:[1,1,0] op_sel_hi:[1,0,1] neg_lo:[1,0,0]
    ds_write_b64 v197, v[186:187] offset:3168
    ds_read_b128 v[28:31], v115 offset:0
    v_pk_mul_f32 v[180:181], v[176:177], v[124:125] op_sel:[0,0] op_sel_hi:[0,1]
    v_pk_mul_f32 v[182:183], v[178:179], v[126:127] op_sel:[0,0] op_sel_hi:[0,1]
    v_cvt_pk_bf16_f32 v184, v176, v177
    v_cvt_pk_bf16_f32 v185, v178, v179
    v_pk_fma_f32 v[176:177], v[176:177], v[124:125], v[180:181] op_sel:[1,1,0] op_sel_hi:[1,0,1] neg_lo:[1,0,0]
    v_pk_fma_f32 v[178:179], v[178:179], v[126:127], v[182:183] op_sel:[1,1,0] op_sel_hi:[1,0,1] neg_lo:[1,0,0]
    ds_write_b64 v197, v[184:185] offset:3696
    ds_read_b128 v[32:35], v112 offset:64
    v_pk_mul_f32 v[180:181], v[176:177], v[124:125] op_sel:[0,0] op_sel_hi:[0,1]
    v_pk_mul_f32 v[182:183], v[178:179], v[126:127] op_sel:[0,0] op_sel_hi:[0,1]
    v_cvt_pk_bf16_f32 v186, v176, v177
    v_cvt_pk_bf16_f32 v187, v178, v179
    v_pk_fma_f32 v[176:177], v[176:177], v[124:125], v[180:181] op_sel:[1,1,0] op_sel_hi:[1,0,1] neg_lo:[1,0,0]
    v_pk_fma_f32 v[178:179], v[178:179], v[126:127], v[182:183] op_sel:[1,1,0] op_sel_hi:[1,0,1] neg_lo:[1,0,0]
    ds_write_b64 v197, v[186:187] offset:4224
    ds_read_b128 v[36:39], v113 offset:64
    v_pk_mul_f32 v[180:181], v[176:177], v[124:125] op_sel:[0,0] op_sel_hi:[0,1]
    v_pk_mul_f32 v[182:183], v[178:179], v[126:127] op_sel:[0,0] op_sel_hi:[0,1]
    v_cvt_pk_bf16_f32 v184, v176, v177
    v_cvt_pk_bf16_f32 v185, v178, v179
    v_pk_fma_f32 v[176:177], v[176:177], v[124:125], v[180:181] op_sel:[1,1,0] op_sel_hi:[1,0,1] neg_lo:[1,0,0]
    v_pk_fma_f32 v[178:179], v[178:179], v[126:127], v[182:183] op_sel:[1,1,0] op_sel_hi:[1,0,1] neg_lo:[1,0,0]
    ds_write_b64 v197, v[184:185] offset:4752
    ds_read_b128 v[40:43], v114 offset:64
    v_pk_mul_f32 v[180:181], v[176:177], v[124:125] op_sel:[0,0] op_sel_hi:[0,1]
    v_pk_mul_f32 v[182:183], v[178:179], v[126:127] op_sel:[0,0] op_sel_hi:[0,1]
    v_cvt_pk_bf16_f32 v186, v176, v177
    v_cvt_pk_bf16_f32 v187, v178, v179
    v_pk_fma_f32 v[176:177], v[176:177], v[124:125], v[180:181] op_sel:[1,1,0] op_sel_hi:[1,0,1] neg_lo:[1,0,0]
    v_pk_fma_f32 v[178:179], v[178:179], v[126:127], v[182:183] op_sel:[1,1,0] op_sel_hi:[1,0,1] neg_lo:[1,0,0]
    ds_write_b64 v197, v[186:187] offset:5280
    ds_read_b128 v[44:47], v115 offset:64
    v_pk_mul_f32 v[180:181], v[176:177], v[124:125] op_sel:[0,0] op_sel_hi:[0,1]
    v_pk_mul_f32 v[182:183], v[178:179], v[126:127] op_sel:[0,0] op_sel_hi:[0,1]
    v_cvt_pk_bf16_f32 v184, v176, v177
    v_cvt_pk_bf16_f32 v185, v178, v179
    v_pk_fma_f32 v[176:177], v[176:177], v[124:125], v[180:181] op_sel:[1,1,0] op_sel_hi:[1,0,1] neg_lo:[1,0,0]
    v_pk_fma_f32 v[178:179], v[178:179], v[126:127], v[182:183] op_sel:[1,1,0] op_sel_hi:[1,0,1] neg_lo:[1,0,0]
    ds_write_b64 v197, v[184:185] offset:5808
    ds_read_b128 v[48:51], v112 offset:128
    v_pk_mul_f32 v[180:181], v[176:177], v[124:125] op_sel:[0,0] op_sel_hi:[0,1]
    v_pk_mul_f32 v[182:183], v[178:179], v[126:127] op_sel:[0,0] op_sel_hi:[0,1]
    v_cvt_pk_bf16_f32 v186, v176, v177
    v_cvt_pk_bf16_f32 v187, v178, v179
    v_pk_fma_f32 v[176:177], v[176:177], v[124:125], v[180:181] op_sel:[1,1,0] op_sel_hi:[1,0,1] neg_lo:[1,0,0]
    v_pk_fma_f32 v[178:179], v[178:179], v[126:127], v[182:183] op_sel:[1,1,0] op_sel_hi:[1,0,1] neg_lo:[1,0,0]
    ds_write_b64 v197, v[186:187] offset:6336
    ds_read_b128 v[52:55], v113 offset:128
    v_pk_mul_f32 v[180:181], v[176:177], v[124:125] op_sel:[0,0] op_sel_hi:[0,1]
    v_pk_mul_f32 v[182:183], v[178:179], v[126:127] op_sel:[0,0] op_sel_hi:[0,1]
    v_cvt_pk_bf16_f32 v184, v176, v177
    v_cvt_pk_bf16_f32 v185, v178, v179
    v_pk_fma_f32 v[176:177], v[176:177], v[124:125], v[180:181] op_sel:[1,1,0] op_sel_hi:[1,0,1] neg_lo:[1,0,0]
    v_pk_fma_f32 v[178:179], v[178:179], v[126:127], v[182:183] op_sel:[1,1,0] op_sel_hi:[1,0,1] neg_lo:[1,0,0]
    ds_write_b64 v197, v[184:185] offset:6864
    ds_read_b128 v[56:59], v114 offset:128
    v_pk_mul_f32 v[180:181], v[176:177], v[124:125] op_sel:[0,0] op_sel_hi:[0,1]
    v_pk_mul_f32 v[182:183], v[178:179], v[126:127] op_sel:[0,0] op_sel_hi:[0,1]
    v_cvt_pk_bf16_f32 v186, v176, v177
    v_cvt_pk_bf16_f32 v187, v178, v179
    v_pk_fma_f32 v[176:177], v[176:177], v[124:125], v[180:181] op_sel:[1,1,0] op_sel_hi:[1,0,1] neg_lo:[1,0,0]
    v_pk_fma_f32 v[178:179], v[178:179], v[126:127], v[182:183] op_sel:[1,1,0] op_sel_hi:[1,0,1] neg_lo:[1,0,0]
    ds_write_b64 v197, v[186:187] offset:7392
    ds_read_b128 v[60:63], v115 offset:128
    v_pk_mul_f32 v[180:181], v[176:177], v[124:125] op_sel:[0,0] op_sel_hi:[0,1]
    v_pk_mul_f32 v[182:183], v[178:179], v[126:127] op_sel:[0,0] op_sel_hi:[0,1]
    v_cvt_pk_bf16_f32 v184, v176, v177
    v_cvt_pk_bf16_f32 v185, v178, v179
    v_pk_fma_f32 v[176:177], v[176:177], v[124:125], v[180:181] op_sel:[1,1,0] op_sel_hi:[1,0,1] neg_lo:[1,0,0]
    v_pk_fma_f32 v[178:179], v[178:179], v[126:127], v[182:183] op_sel:[1,1,0] op_sel_hi:[1,0,1] neg_lo:[1,0,0]
    ds_write_b64 v197, v[184:185] offset:7920
    ds_read_b128 a[224:227], v111 offset:0
    ds_read_b128 a[228:231], v111 offset:64
    ds_read_b128 a[232:235], v111 offset:128
    ds_read_b128 a[236:239], v111 offset:192
    ds_read_b128 a[240:243], v111 offset:256
    ds_read_b128 a[244:247], v111 offset:320
    ds_read_b128 a[248:251], v111 offset:384
    ds_read_b128 a[252:255], v111 offset:448
    s_add_u32 s27, s44, 0
    buffer_load_dwordx4 a[0:3], v4, s[8:11], s27 offen
    s_add_u32 s28, s45, 0
    buffer_load_dwordx2 a[64:65], v5, s[8:11], s28 offen
    s_add_u32 s29, s46, 0
    buffer_load_dwordx4 a[96:99], v8, s[8:11], s29 offen
    buffer_load_dwordx4 a[100:103], v8, s[8:11], s29 offen offset:1024
    s_waitcnt lgkmcnt(7)
    v_mfma_f32_16x16x32_bf16 v[64:67], v[16:19], a[224:227], 0
    ds_read_b128 v[16:19], v112 offset:192
    v_mfma_f32_16x16x32_bf16 v[68:71], v[20:23], a[224:227], 0
    s_add_u32 s27, s44, 1024
    buffer_load_dwordx4 a[4:7], v4, s[8:11], s27 offen
    ds_read_b128 v[20:23], v113 offset:192
    v_mfma_f32_16x16x32_bf16 v[72:75], v[24:27], a[224:227], 0
    s_add_u32 s28, s45, 512
    buffer_load_dwordx2 a[66:67], v5, s[8:11], s28 offen
    ds_read_b128 v[24:27], v114 offset:192
    v_mfma_f32_16x16x32_bf16 v[76:79], v[28:31], a[224:227], 0
    ds_read_b128 v[28:31], v115 offset:192
    s_add_u32 s29, s46, 2048
    buffer_load_dwordx4 a[104:107], v8, s[8:11], s29 offen
    s_waitcnt lgkmcnt(10)
    v_mfma_f32_16x16x32_bf16 v[64:67], v[32:35], a[228:231], v[64:67]
    ds_read_b128 v[32:35], v112 offset:256
    v_mfma_f32_16x16x32_bf16 v[68:71], v[36:39], a[228:231], v[68:71]
    buffer_load_dwordx4 a[108:111], v8, s[8:11], s29 offen offset:1024
    ds_read_b128 v[36:39], v113 offset:256
    v_mfma_f32_16x16x32_bf16 v[72:75], v[40:43], a[228:231], v[72:75]
    s_add_u32 s27, s44, 2048
    buffer_load_dwordx4 a[8:11], v4, s[8:11], s27 offen
    ds_read_b128 v[40:43], v114 offset:256
    v_mfma_f32_16x16x32_bf16 v[76:79], v[44:47], a[228:231], v[76:79]
    s_add_u32 s28, s45, 1024
    buffer_load_dwordx2 a[68:69], v5, s[8:11], s28 offen
    ds_read_b128 v[44:47], v115 offset:256
    s_waitcnt lgkmcnt(13)
    v_mfma_f32_16x16x32_bf16 v[64:67], v[48:51], a[232:235], v[64:67]
    ds_read_b128 v[48:51], v112 offset:320
    s_add_u32 s29, s46, 4096
    buffer_load_dwordx4 a[112:115], v8, s[8:11], s29 offen
    v_mfma_f32_16x16x32_bf16 v[68:71], v[52:55], a[232:235], v[68:71]
    ds_read_b128 v[52:55], v113 offset:320
    v_mfma_f32_16x16x32_bf16 v[72:75], v[56:59], a[232:235], v[72:75]
    buffer_load_dwordx4 a[116:119], v8, s[8:11], s29 offen offset:1024
    ds_read_b128 v[56:59], v114 offset:320
    v_mfma_f32_16x16x32_bf16 v[76:79], v[60:63], a[232:235], v[76:79]
    s_add_u32 s27, s44, 3072
    buffer_load_dwordx4 a[12:15], v4, s[8:11], s27 offen
    ds_read_b128 v[60:63], v115 offset:320
    s_waitcnt lgkmcnt(11)
    v_mfma_f32_16x16x32_bf16 v[64:67], v[16:19], a[236:239], v[64:67]
    ds_read_b128 v[16:19], v112 offset:384
    s_add_u32 s28, s45, 1536
    buffer_load_dwordx2 a[70:71], v5, s[8:11], s28 offen
    s_waitcnt lgkmcnt(11)
    v_mfma_f32_16x16x32_bf16 v[68:71], v[20:23], a[236:239], v[68:71]
    ds_read_b128 v[20:23], v113 offset:384
    s_add_u32 s29, s46, 6144
    buffer_load_dwordx4 a[120:123], v8, s[8:11], s29 offen
    s_waitcnt lgkmcnt(11)
    v_mfma_f32_16x16x32_bf16 v[72:75], v[24:27], a[236:239], v[72:75]
    ds_read_b128 v[24:27], v114 offset:384
    s_waitcnt lgkmcnt(11)
    v_mfma_f32_16x16x32_bf16 v[76:79], v[28:31], a[236:239], v[76:79]
    buffer_load_dwordx4 a[124:127], v8, s[8:11], s29 offen offset:1024
    ds_read_b128 v[28:31], v115 offset:384
    s_waitcnt lgkmcnt(11)
    v_mfma_f32_16x16x32_bf16 v[64:67], v[32:35], a[240:243], v[64:67]
    s_add_u32 s27, s44, 4096
    buffer_load_dwordx4 a[16:19], v4, s[8:11], s27 offen
    ds_read_b128 v[32:35], v112 offset:448
    s_waitcnt lgkmcnt(11)
    v_mfma_f32_16x16x32_bf16 v[68:71], v[36:39], a[240:243], v[68:71]
    ds_read_b128 v[36:39], v113 offset:448
    s_add_u32 s28, s45, 2048
    buffer_load_dwordx2 a[72:73], v5, s[8:11], s28 offen
    s_waitcnt lgkmcnt(11)
    v_mfma_f32_16x16x32_bf16 v[72:75], v[40:43], a[240:243], v[72:75]
    ds_read_b128 v[40:43], v114 offset:448
    s_waitcnt lgkmcnt(11)
    v_mfma_f32_16x16x32_bf16 v[76:79], v[44:47], a[240:243], v[76:79]
    s_add_u32 s29, s46, 8192
    buffer_load_dwordx4 a[128:131], v8, s[8:11], s29 offen
    ds_read_b128 v[44:47], v115 offset:448
    s_waitcnt lgkmcnt(11)
    v_mfma_f32_16x16x32_bf16 v[64:67], v[48:51], a[244:247], v[64:67]
    buffer_load_dwordx4 a[132:135], v8, s[8:11], s29 offen offset:1024
    s_waitcnt lgkmcnt(10)
    v_mfma_f32_16x16x32_bf16 v[68:71], v[52:55], a[244:247], v[68:71]
    s_waitcnt lgkmcnt(9)
    v_mfma_f32_16x16x32_bf16 v[72:75], v[56:59], a[244:247], v[72:75]
    s_add_u32 s27, s44, 5120
    buffer_load_dwordx4 a[20:23], v4, s[8:11], s27 offen
    s_waitcnt lgkmcnt(8)
    v_mfma_f32_16x16x32_bf16 v[76:79], v[60:63], a[244:247], v[76:79]
    s_waitcnt lgkmcnt(7)
    v_mfma_f32_16x16x32_bf16 v[64:67], v[16:19], a[248:251], v[64:67]
    s_add_u32 s28, s45, 2560
    buffer_load_dwordx2 a[74:75], v5, s[8:11], s28 offen
    s_waitcnt lgkmcnt(6)
    v_mfma_f32_16x16x32_bf16 v[68:71], v[20:23], a[248:251], v[68:71]
    s_waitcnt lgkmcnt(5)
    v_mfma_f32_16x16x32_bf16 v[72:75], v[24:27], a[248:251], v[72:75]
    s_add_u32 s29, s46, 10240
    buffer_load_dwordx4 a[136:139], v8, s[8:11], s29 offen
    s_waitcnt lgkmcnt(4)
    v_mfma_f32_16x16x32_bf16 v[76:79], v[28:31], a[248:251], v[76:79]
    s_waitcnt lgkmcnt(3)
    v_mfma_f32_16x16x32_bf16 v[64:67], v[32:35], a[252:255], v[64:67]
    buffer_load_dwordx4 a[140:143], v8, s[8:11], s29 offen offset:1024
    s_waitcnt lgkmcnt(2)
    v_mfma_f32_16x16x32_bf16 v[68:71], v[36:39], a[252:255], v[68:71]
    s_waitcnt lgkmcnt(1)
    v_mfma_f32_16x16x32_bf16 v[72:75], v[40:43], a[252:255], v[72:75]
    s_add_u32 s27, s44, 6144
    buffer_load_dwordx4 a[24:27], v4, s[8:11], s27 offen
    s_waitcnt lgkmcnt(0)
    v_mfma_f32_16x16x32_bf16 v[76:79], v[44:47], a[252:255], v[76:79]
    s_add_u32 s28, s45, 3072
    buffer_load_dwordx2 a[76:77], v5, s[8:11], s28 offen
    v_pk_mul_f32 v[180:181], v[176:177], v[124:125] op_sel:[0,0] op_sel_hi:[0,1]
    v_pk_mul_f32 v[182:183], v[178:179], v[126:127] op_sel:[0,0] op_sel_hi:[0,1]
    v_cvt_pk_bf16_f32 v186, v176, v177
    v_cvt_pk_bf16_f32 v187, v178, v179
    v_pk_fma_f32 v[176:177], v[176:177], v[124:125], v[180:181] op_sel:[1,1,0] op_sel_hi:[1,0,1] neg_lo:[1,0,0]
    v_pk_fma_f32 v[178:179], v[178:179], v[126:127], v[182:183] op_sel:[1,1,0] op_sel_hi:[1,0,1] neg_lo:[1,0,0]
    ds_write_b64 v197, v[186:187] offset:0
    v_pk_mul_f32 v[180:181], v[176:177], v[124:125] op_sel:[0,0] op_sel_hi:[0,1]
    v_pk_mul_f32 v[182:183], v[178:179], v[126:127] op_sel:[0,0] op_sel_hi:[0,1]
    v_cvt_pk_bf16_f32 v184, v176, v177
    v_cvt_pk_bf16_f32 v185, v178, v179
    v_pk_fma_f32 v[176:177], v[176:177], v[124:125], v[180:181] op_sel:[1,1,0] op_sel_hi:[1,0,1] neg_lo:[1,0,0]
    v_pk_fma_f32 v[178:179], v[178:179], v[126:127], v[182:183] op_sel:[1,1,0] op_sel_hi:[1,0,1] neg_lo:[1,0,0]
    ds_write_b64 v197, v[184:185] offset:528
    v_pk_mul_f32 v[180:181], v[176:177], v[124:125] op_sel:[0,0] op_sel_hi:[0,1]
    v_pk_mul_f32 v[182:183], v[178:179], v[126:127] op_sel:[0,0] op_sel_hi:[0,1]
    v_cvt_pk_bf16_f32 v186, v176, v177
    v_cvt_pk_bf16_f32 v187, v178, v179
    v_pk_fma_f32 v[176:177], v[176:177], v[124:125], v[180:181] op_sel:[1,1,0] op_sel_hi:[1,0,1] neg_lo:[1,0,0]
    v_pk_fma_f32 v[178:179], v[178:179], v[126:127], v[182:183] op_sel:[1,1,0] op_sel_hi:[1,0,1] neg_lo:[1,0,0]
    ds_write_b64 v197, v[186:187] offset:1056
    v_pk_mul_f32 v[180:181], v[176:177], v[124:125] op_sel:[0,0] op_sel_hi:[0,1]
    v_pk_mul_f32 v[182:183], v[178:179], v[126:127] op_sel:[0,0] op_sel_hi:[0,1]
    v_cvt_pk_bf16_f32 v184, v176, v177
    v_cvt_pk_bf16_f32 v185, v178, v179
    v_pk_fma_f32 v[176:177], v[176:177], v[124:125], v[180:181] op_sel:[1,1,0] op_sel_hi:[1,0,1] neg_lo:[1,0,0]
    v_pk_fma_f32 v[178:179], v[178:179], v[126:127], v[182:183] op_sel:[1,1,0] op_sel_hi:[1,0,1] neg_lo:[1,0,0]
    ds_write_b64 v197, v[184:185] offset:1584
    ds_read_b128 v[16:19], v116 offset:0
    v_pk_mul_f32 v[180:181], v[176:177], v[124:125] op_sel:[0,0] op_sel_hi:[0,1]
    v_pk_mul_f32 v[182:183], v[178:179], v[126:127] op_sel:[0,0] op_sel_hi:[0,1]
    v_cvt_pk_bf16_f32 v186, v176, v177
    v_cvt_pk_bf16_f32 v187, v178, v179
    v_pk_fma_f32 v[176:177], v[176:177], v[124:125], v[180:181] op_sel:[1,1,0] op_sel_hi:[1,0,1] neg_lo:[1,0,0]
    v_pk_fma_f32 v[178:179], v[178:179], v[126:127], v[182:183] op_sel:[1,1,0] op_sel_hi:[1,0,1] neg_lo:[1,0,0]
    ds_write_b64 v197, v[186:187] offset:2112
    ds_read_b128 v[20:23], v117 offset:0
    v_pk_mul_f32 v[180:181], v[176:177], v[124:125] op_sel:[0,0] op_sel_hi:[0,1]
    v_pk_mul_f32 v[182:183], v[178:179], v[126:127] op_sel:[0,0] op_sel_hi:[0,1]
    v_cvt_pk_bf16_f32 v184, v176, v177
    v_cvt_pk_bf16_f32 v185, v178, v179
    v_pk_fma_f32 v[176:177], v[176:177], v[124:125], v[180:181] op_sel:[1,1,0] op_sel_hi:[1,0,1] neg_lo:[1,0,0]
    v_pk_fma_f32 v[178:179], v[178:179], v[126:127], v[182:183] op_sel:[1,1,0] op_sel_hi:[1,0,1] neg_lo:[1,0,0]
    ds_write_b64 v197, v[184:185] offset:2640
    ds_read_b128 v[24:27], v116 offset:64
    v_pk_mul_f32 v[180:181], v[176:177], v[124:125] op_sel:[0,0] op_sel_hi:[0,1]
    v_pk_mul_f32 v[182:183], v[178:179], v[126:127] op_sel:[0,0] op_sel_hi:[0,1]
    v_cvt_pk_bf16_f32 v186, v176, v177
    v_cvt_pk_bf16_f32 v187, v178, v179
    v_pk_fma_f32 v[176:177], v[176:177], v[124:125], v[180:181] op_sel:[1,1,0] op_sel_hi:[1,0,1] neg_lo:[1,0,0]
    v_pk_fma_f32 v[178:179], v[178:179], v[126:127], v[182:183] op_sel:[1,1,0] op_sel_hi:[1,0,1] neg_lo:[1,0,0]
    ds_write_b64 v197, v[186:187] offset:3168
    ds_read_b128 v[28:31], v117 offset:64
    v_pk_mul_f32 v[180:181], v[176:177], v[124:125] op_sel:[0,0] op_sel_hi:[0,1]
    v_pk_mul_f32 v[182:183], v[178:179], v[126:127] op_sel:[0,0] op_sel_hi:[0,1]
    v_cvt_pk_bf16_f32 v184, v176, v177
    v_cvt_pk_bf16_f32 v185, v178, v179
    v_pk_fma_f32 v[176:177], v[176:177], v[124:125], v[180:181] op_sel:[1,1,0] op_sel_hi:[1,0,1] neg_lo:[1,0,0]
    v_pk_fma_f32 v[178:179], v[178:179], v[126:127], v[182:183] op_sel:[1,1,0] op_sel_hi:[1,0,1] neg_lo:[1,0,0]
    ds_write_b64 v197, v[184:185] offset:3696
    ds_read_b128 v[32:35], v116 offset:128
    v_pk_mul_f32 v[180:181], v[176:177], v[124:125] op_sel:[0,0] op_sel_hi:[0,1]
    v_pk_mul_f32 v[182:183], v[178:179], v[126:127] op_sel:[0,0] op_sel_hi:[0,1]
    v_cvt_pk_bf16_f32 v186, v176, v177
    v_cvt_pk_bf16_f32 v187, v178, v179
    v_pk_fma_f32 v[176:177], v[176:177], v[124:125], v[180:181] op_sel:[1,1,0] op_sel_hi:[1,0,1] neg_lo:[1,0,0]
    v_pk_fma_f32 v[178:179], v[178:179], v[126:127], v[182:183] op_sel:[1,1,0] op_sel_hi:[1,0,1] neg_lo:[1,0,0]
    ds_write_b64 v197, v[186:187] offset:4224
    ds_read_b128 v[36:39], v117 offset:128
    v_pk_mul_f32 v[180:181], v[176:177], v[124:125] op_sel:[0,0] op_sel_hi:[0,1]
    v_pk_mul_f32 v[182:183], v[178:179], v[126:127] op_sel:[0,0] op_sel_hi:[0,1]
    v_cvt_pk_bf16_f32 v184, v176, v177
    v_cvt_pk_bf16_f32 v185, v178, v179
    v_pk_fma_f32 v[176:177], v[176:177], v[124:125], v[180:181] op_sel:[1,1,0] op_sel_hi:[1,0,1] neg_lo:[1,0,0]
    v_pk_fma_f32 v[178:179], v[178:179], v[126:127], v[182:183] op_sel:[1,1,0] op_sel_hi:[1,0,1] neg_lo:[1,0,0]
    ds_write_b64 v197, v[184:185] offset:4752
    ds_read_b128 v[40:43], v116 offset:192
    v_pk_mul_f32 v[180:181], v[176:177], v[124:125] op_sel:[0,0] op_sel_hi:[0,1]
    v_pk_mul_f32 v[182:183], v[178:179], v[126:127] op_sel:[0,0] op_sel_hi:[0,1]
    v_cvt_pk_bf16_f32 v186, v176, v177
    v_cvt_pk_bf16_f32 v187, v178, v179
    v_pk_fma_f32 v[176:177], v[176:177], v[124:125], v[180:181] op_sel:[1,1,0] op_sel_hi:[1,0,1] neg_lo:[1,0,0]
    v_pk_fma_f32 v[178:179], v[178:179], v[126:127], v[182:183] op_sel:[1,1,0] op_sel_hi:[1,0,1] neg_lo:[1,0,0]
    ds_write_b64 v197, v[186:187] offset:5280
    ds_read_b128 v[44:47], v117 offset:192
    v_pk_mul_f32 v[180:181], v[176:177], v[124:125] op_sel:[0,0] op_sel_hi:[0,1]
    v_pk_mul_f32 v[182:183], v[178:179], v[126:127] op_sel:[0,0] op_sel_hi:[0,1]
    v_cvt_pk_bf16_f32 v184, v176, v177
    v_cvt_pk_bf16_f32 v185, v178, v179
    v_pk_fma_f32 v[176:177], v[176:177], v[124:125], v[180:181] op_sel:[1,1,0] op_sel_hi:[1,0,1] neg_lo:[1,0,0]
    v_pk_fma_f32 v[178:179], v[178:179], v[126:127], v[182:183] op_sel:[1,1,0] op_sel_hi:[1,0,1] neg_lo:[1,0,0]
    ds_write_b64 v197, v[184:185] offset:5808
    ds_read_b128 v[48:51], v116 offset:256
    v_pk_mul_f32 v[180:181], v[176:177], v[124:125] op_sel:[0,0] op_sel_hi:[0,1]
    v_pk_mul_f32 v[182:183], v[178:179], v[126:127] op_sel:[0,0] op_sel_hi:[0,1]
    v_cvt_pk_bf16_f32 v186, v176, v177
    v_cvt_pk_bf16_f32 v187, v178, v179
    v_pk_fma_f32 v[176:177], v[176:177], v[124:125], v[180:181] op_sel:[1,1,0] op_sel_hi:[1,0,1] neg_lo:[1,0,0]
    v_pk_fma_f32 v[178:179], v[178:179], v[126:127], v[182:183] op_sel:[1,1,0] op_sel_hi:[1,0,1] neg_lo:[1,0,0]
    ds_write_b64 v197, v[186:187] offset:6336
    ds_read_b128 v[52:55], v117 offset:256
    v_pk_mul_f32 v[180:181], v[176:177], v[124:125] op_sel:[0,0] op_sel_hi:[0,1]
    v_pk_mul_f32 v[182:183], v[178:179], v[126:127] op_sel:[0,0] op_sel_hi:[0,1]
    v_cvt_pk_bf16_f32 v184, v176, v177
    v_cvt_pk_bf16_f32 v185, v178, v179
    v_pk_fma_f32 v[176:177], v[176:177], v[124:125], v[180:181] op_sel:[1,1,0] op_sel_hi:[1,0,1] neg_lo:[1,0,0]
    v_pk_fma_f32 v[178:179], v[178:179], v[126:127], v[182:183] op_sel:[1,1,0] op_sel_hi:[1,0,1] neg_lo:[1,0,0]
    ds_write_b64 v197, v[184:185] offset:6864
    ds_read_b128 v[56:59], v116 offset:320
    v_pk_mul_f32 v[180:181], v[176:177], v[124:125] op_sel:[0,0] op_sel_hi:[0,1]
    v_pk_mul_f32 v[182:183], v[178:179], v[126:127] op_sel:[0,0] op_sel_hi:[0,1]
    v_cvt_pk_bf16_f32 v186, v176, v177
    v_cvt_pk_bf16_f32 v187, v178, v179
    v_pk_fma_f32 v[176:177], v[176:177], v[124:125], v[180:181] op_sel:[1,1,0] op_sel_hi:[1,0,1] neg_lo:[1,0,0]
    v_pk_fma_f32 v[178:179], v[178:179], v[126:127], v[182:183] op_sel:[1,1,0] op_sel_hi:[1,0,1] neg_lo:[1,0,0]
    ds_write_b64 v197, v[186:187] offset:7392
    ds_read_b128 v[60:63], v117 offset:320
    v_pk_mul_f32 v[180:181], v[176:177], v[124:125] op_sel:[0,0] op_sel_hi:[0,1]
    v_pk_mul_f32 v[182:183], v[178:179], v[126:127] op_sel:[0,0] op_sel_hi:[0,1]
    v_cvt_pk_bf16_f32 v184, v176, v177
    v_cvt_pk_bf16_f32 v185, v178, v179
    v_pk_fma_f32 v[176:177], v[176:177], v[124:125], v[180:181] op_sel:[1,1,0] op_sel_hi:[1,0,1] neg_lo:[1,0,0]
    v_pk_fma_f32 v[178:179], v[178:179], v[126:127], v[182:183] op_sel:[1,1,0] op_sel_hi:[1,0,1] neg_lo:[1,0,0]
    ds_write_b64 v197, v[184:185] offset:7920
    ds_read_b128 a[224:227], v111 offset:0
    ds_read_b128 a[228:231], v111 offset:64
    ds_read_b128 a[232:235], v111 offset:128
    ds_read_b128 a[236:239], v111 offset:192
    ds_read_b128 a[240:243], v111 offset:256
    ds_read_b128 a[244:247], v111 offset:320
    ds_read_b128 a[248:251], v111 offset:384
    ds_read_b128 a[252:255], v111 offset:448
    s_add_u32 s29, s46, 12288
    buffer_load_dwordx4 a[144:147], v8, s[8:11], s29 offen
    buffer_load_dwordx4 a[148:151], v8, s[8:11], s29 offen offset:1024
    s_add_u32 s27, s44, 7168
    buffer_load_dwordx4 a[28:31], v4, s[8:11], s27 offen
    s_add_u32 s28, s45, 3584
    buffer_load_dwordx2 a[78:79], v5, s[8:11], s28 offen
    s_waitcnt lgkmcnt(7)
    v_mfma_f32_16x16x32_bf16 v[80:83], v[16:19], a[224:227], 0
    ds_read_b128 v[16:19], v116 offset:384
    v_mfma_f32_16x16x32_bf16 v[84:87], v[20:23], a[224:227], 0
    s_add_u32 s29, s46, 14336
    buffer_load_dwordx4 a[152:155], v8, s[8:11], s29 offen
    ds_read_b128 v[20:23], v117 offset:384
    s_waitcnt lgkmcnt(8)
    v_mfma_f32_16x16x32_bf16 v[80:83], v[24:27], a[228:231], v[80:83]
    buffer_load_dwordx4 a[156:159], v8, s[8:11], s29 offen offset:1024
    ds_read_b128 v[24:27], v116 offset:448
    v_mfma_f32_16x16x32_bf16 v[84:87], v[28:31], a[228:231], v[84:87]
    s_add_u32 s27, s44, 8192
    buffer_load_dwordx4 a[32:35], v4, s[8:11], s27 offen
    ds_read_b128 v[28:31], v117 offset:448
    s_waitcnt lgkmcnt(9)
    v_mfma_f32_16x16x32_bf16 v[80:83], v[32:35], a[232:235], v[80:83]
    v_mfma_f32_16x16x32_bf16 v[84:87], v[36:39], a[232:235], v[84:87]
    s_add_u32 s28, s45, 4096
    buffer_load_dwordx2 a[80:81], v5, s[8:11], s28 offen
    s_waitcnt lgkmcnt(8)
    v_mfma_f32_16x16x32_bf16 v[80:83], v[40:43], a[236:239], v[80:83]
    s_add_u32 s29, s46, 16384
    buffer_load_dwordx4 a[160:163], v8, s[8:11], s29 offen
    v_mfma_f32_16x16x32_bf16 v[84:87], v[44:47], a[236:239], v[84:87]
    s_waitcnt lgkmcnt(7)
    v_mfma_f32_16x16x32_bf16 v[80:83], v[48:51], a[240:243], v[80:83]
    buffer_load_dwordx4 a[164:167], v8, s[8:11], s29 offen offset:1024
    v_mfma_f32_16x16x32_bf16 v[84:87], v[52:55], a[240:243], v[84:87]
    s_waitcnt lgkmcnt(6)
    v_mfma_f32_16x16x32_bf16 v[80:83], v[56:59], a[244:247], v[80:83]
    s_add_u32 s27, s44, 9216
    buffer_load_dwordx4 a[36:39], v4, s[8:11], s27 offen
    v_mfma_f32_16x16x32_bf16 v[84:87], v[60:63], a[244:247], v[84:87]
    s_waitcnt lgkmcnt(3)
    v_mfma_f32_16x16x32_bf16 v[80:83], v[16:19], a[248:251], v[80:83]
    s_add_u32 s28, s45, 4608
    buffer_load_dwordx2 a[82:83], v5, s[8:11], s28 offen
    s_waitcnt lgkmcnt(2)
    v_mfma_f32_16x16x32_bf16 v[84:87], v[20:23], a[248:251], v[84:87]
    s_waitcnt lgkmcnt(1)
    v_mfma_f32_16x16x32_bf16 v[80:83], v[24:27], a[252:255], v[80:83]
    s_add_u32 s29, s46, 18432
    buffer_load_dwordx4 a[168:171], v8, s[8:11], s29 offen
    s_waitcnt lgkmcnt(0)
    v_mfma_f32_16x16x32_bf16 v[84:87], v[28:31], a[252:255], v[84:87]
    buffer_load_dwordx4 a[172:175], v8, s[8:11], s29 offen offset:1024
    v_pk_mul_f32 v[180:181], v[176:177], v[124:125] op_sel:[0,0] op_sel_hi:[0,1]
    v_pk_mul_f32 v[182:183], v[178:179], v[126:127] op_sel:[0,0] op_sel_hi:[0,1]
    v_cvt_pk_bf16_f32 v186, v176, v177
    v_cvt_pk_bf16_f32 v187, v178, v179
    v_pk_fma_f32 v[176:177], v[176:177], v[124:125], v[180:181] op_sel:[1,1,0] op_sel_hi:[1,0,1] neg_lo:[1,0,0]
    v_pk_fma_f32 v[178:179], v[178:179], v[126:127], v[182:183] op_sel:[1,1,0] op_sel_hi:[1,0,1] neg_lo:[1,0,0]
    ds_write_b64 v197, v[186:187] offset:0
    v_pk_mul_f32 v[180:181], v[176:177], v[124:125] op_sel:[0,0] op_sel_hi:[0,1]
    v_pk_mul_f32 v[182:183], v[178:179], v[126:127] op_sel:[0,0] op_sel_hi:[0,1]
    v_cvt_pk_bf16_f32 v184, v176, v177
    v_cvt_pk_bf16_f32 v185, v178, v179
    v_pk_fma_f32 v[176:177], v[176:177], v[124:125], v[180:181] op_sel:[1,1,0] op_sel_hi:[1,0,1] neg_lo:[1,0,0]
    v_pk_fma_f32 v[178:179], v[178:179], v[126:127], v[182:183] op_sel:[1,1,0] op_sel_hi:[1,0,1] neg_lo:[1,0,0]
    ds_write_b64 v197, v[184:185] offset:528
    v_pk_mul_f32 v[180:181], v[176:177], v[124:125] op_sel:[0,0] op_sel_hi:[0,1]
    v_pk_mul_f32 v[182:183], v[178:179], v[126:127] op_sel:[0,0] op_sel_hi:[0,1]
    v_cvt_pk_bf16_f32 v186, v176, v177
    v_cvt_pk_bf16_f32 v187, v178, v179
    v_pk_fma_f32 v[176:177], v[176:177], v[124:125], v[180:181] op_sel:[1,1,0] op_sel_hi:[1,0,1] neg_lo:[1,0,0]
    v_pk_fma_f32 v[178:179], v[178:179], v[126:127], v[182:183] op_sel:[1,1,0] op_sel_hi:[1,0,1] neg_lo:[1,0,0]
    ds_write_b64 v197, v[186:187] offset:1056
    v_pk_mul_f32 v[180:181], v[176:177], v[124:125] op_sel:[0,0] op_sel_hi:[0,1]
    v_pk_mul_f32 v[182:183], v[178:179], v[126:127] op_sel:[0,0] op_sel_hi:[0,1]
    v_cvt_pk_bf16_f32 v184, v176, v177
    v_cvt_pk_bf16_f32 v185, v178, v179
    v_pk_fma_f32 v[176:177], v[176:177], v[124:125], v[180:181] op_sel:[1,1,0] op_sel_hi:[1,0,1] neg_lo:[1,0,0]
    v_pk_fma_f32 v[178:179], v[178:179], v[126:127], v[182:183] op_sel:[1,1,0] op_sel_hi:[1,0,1] neg_lo:[1,0,0]
    ds_write_b64 v197, v[184:185] offset:1584
    ds_read_b128 v[16:19], v118 offset:0
    v_pk_mul_f32 v[180:181], v[176:177], v[124:125] op_sel:[0,0] op_sel_hi:[0,1]
    v_pk_mul_f32 v[182:183], v[178:179], v[126:127] op_sel:[0,0] op_sel_hi:[0,1]
    v_cvt_pk_bf16_f32 v186, v176, v177
    v_cvt_pk_bf16_f32 v187, v178, v179
    v_pk_fma_f32 v[176:177], v[176:177], v[124:125], v[180:181] op_sel:[1,1,0] op_sel_hi:[1,0,1] neg_lo:[1,0,0]
    v_pk_fma_f32 v[178:179], v[178:179], v[126:127], v[182:183] op_sel:[1,1,0] op_sel_hi:[1,0,1] neg_lo:[1,0,0]
    ds_write_b64 v197, v[186:187] offset:2112
    ds_read_b128 v[20:23], v119 offset:0
    v_pk_mul_f32 v[180:181], v[176:177], v[124:125] op_sel:[0,0] op_sel_hi:[0,1]
    v_pk_mul_f32 v[182:183], v[178:179], v[126:127] op_sel:[0,0] op_sel_hi:[0,1]
    v_cvt_pk_bf16_f32 v184, v176, v177
    v_cvt_pk_bf16_f32 v185, v178, v179
    v_pk_fma_f32 v[176:177], v[176:177], v[124:125], v[180:181] op_sel:[1,1,0] op_sel_hi:[1,0,1] neg_lo:[1,0,0]
    v_pk_fma_f32 v[178:179], v[178:179], v[126:127], v[182:183] op_sel:[1,1,0] op_sel_hi:[1,0,1] neg_lo:[1,0,0]
    ds_write_b64 v197, v[184:185] offset:2640
    ds_read_b128 v[24:27], v118 offset:64
    v_pk_mul_f32 v[180:181], v[176:177], v[124:125] op_sel:[0,0] op_sel_hi:[0,1]
    v_pk_mul_f32 v[182:183], v[178:179], v[126:127] op_sel:[0,0] op_sel_hi:[0,1]
    v_cvt_pk_bf16_f32 v186, v176, v177
    v_cvt_pk_bf16_f32 v187, v178, v179
    v_pk_fma_f32 v[176:177], v[176:177], v[124:125], v[180:181] op_sel:[1,1,0] op_sel_hi:[1,0,1] neg_lo:[1,0,0]
    v_pk_fma_f32 v[178:179], v[178:179], v[126:127], v[182:183] op_sel:[1,1,0] op_sel_hi:[1,0,1] neg_lo:[1,0,0]
    ds_write_b64 v197, v[186:187] offset:3168
    ds_read_b128 v[28:31], v119 offset:64
    v_pk_mul_f32 v[180:181], v[176:177], v[124:125] op_sel:[0,0] op_sel_hi:[0,1]
    v_pk_mul_f32 v[182:183], v[178:179], v[126:127] op_sel:[0,0] op_sel_hi:[0,1]
    v_cvt_pk_bf16_f32 v184, v176, v177
    v_cvt_pk_bf16_f32 v185, v178, v179
    v_pk_fma_f32 v[176:177], v[176:177], v[124:125], v[180:181] op_sel:[1,1,0] op_sel_hi:[1,0,1] neg_lo:[1,0,0]
    v_pk_fma_f32 v[178:179], v[178:179], v[126:127], v[182:183] op_sel:[1,1,0] op_sel_hi:[1,0,1] neg_lo:[1,0,0]
    ds_write_b64 v197, v[184:185] offset:3696
    ds_read_b128 v[32:35], v118 offset:128
    v_pk_mul_f32 v[180:181], v[176:177], v[124:125] op_sel:[0,0] op_sel_hi:[0,1]
    v_pk_mul_f32 v[182:183], v[178:179], v[126:127] op_sel:[0,0] op_sel_hi:[0,1]
    v_cvt_pk_bf16_f32 v186, v176, v177
    v_cvt_pk_bf16_f32 v187, v178, v179
    v_pk_fma_f32 v[176:177], v[176:177], v[124:125], v[180:181] op_sel:[1,1,0] op_sel_hi:[1,0,1] neg_lo:[1,0,0]
    v_pk_fma_f32 v[178:179], v[178:179], v[126:127], v[182:183] op_sel:[1,1,0] op_sel_hi:[1,0,1] neg_lo:[1,0,0]
    ds_write_b64 v197, v[186:187] offset:4224
    ds_read_b128 v[36:39], v119 offset:128
    v_pk_mul_f32 v[180:181], v[176:177], v[124:125] op_sel:[0,0] op_sel_hi:[0,1]
    v_pk_mul_f32 v[182:183], v[178:179], v[126:127] op_sel:[0,0] op_sel_hi:[0,1]
    v_cvt_pk_bf16_f32 v184, v176, v177
    v_cvt_pk_bf16_f32 v185, v178, v179
    v_pk_fma_f32 v[176:177], v[176:177], v[124:125], v[180:181] op_sel:[1,1,0] op_sel_hi:[1,0,1] neg_lo:[1,0,0]
    v_pk_fma_f32 v[178:179], v[178:179], v[126:127], v[182:183] op_sel:[1,1,0] op_sel_hi:[1,0,1] neg_lo:[1,0,0]
    ds_write_b64 v197, v[184:185] offset:4752
    ds_read_b128 v[40:43], v118 offset:192
    v_pk_mul_f32 v[180:181], v[176:177], v[124:125] op_sel:[0,0] op_sel_hi:[0,1]
    v_pk_mul_f32 v[182:183], v[178:179], v[126:127] op_sel:[0,0] op_sel_hi:[0,1]
    v_cvt_pk_bf16_f32 v186, v176, v177
    v_cvt_pk_bf16_f32 v187, v178, v179
    v_pk_fma_f32 v[176:177], v[176:177], v[124:125], v[180:181] op_sel:[1,1,0] op_sel_hi:[1,0,1] neg_lo:[1,0,0]
    v_pk_fma_f32 v[178:179], v[178:179], v[126:127], v[182:183] op_sel:[1,1,0] op_sel_hi:[1,0,1] neg_lo:[1,0,0]
    ds_write_b64 v197, v[186:187] offset:5280
    ds_read_b128 v[44:47], v119 offset:192
    v_pk_mul_f32 v[180:181], v[176:177], v[124:125] op_sel:[0,0] op_sel_hi:[0,1]
    v_pk_mul_f32 v[182:183], v[178:179], v[126:127] op_sel:[0,0] op_sel_hi:[0,1]
    v_cvt_pk_bf16_f32 v184, v176, v177
    v_cvt_pk_bf16_f32 v185, v178, v179
    v_pk_fma_f32 v[176:177], v[176:177], v[124:125], v[180:181] op_sel:[1,1,0] op_sel_hi:[1,0,1] neg_lo:[1,0,0]
    v_pk_fma_f32 v[178:179], v[178:179], v[126:127], v[182:183] op_sel:[1,1,0] op_sel_hi:[1,0,1] neg_lo:[1,0,0]
    ds_write_b64 v197, v[184:185] offset:5808
    ds_read_b128 v[48:51], v118 offset:256
    v_pk_mul_f32 v[180:181], v[176:177], v[124:125] op_sel:[0,0] op_sel_hi:[0,1]
    v_pk_mul_f32 v[182:183], v[178:179], v[126:127] op_sel:[0,0] op_sel_hi:[0,1]
    v_cvt_pk_bf16_f32 v186, v176, v177
    v_cvt_pk_bf16_f32 v187, v178, v179
    v_pk_fma_f32 v[176:177], v[176:177], v[124:125], v[180:181] op_sel:[1,1,0] op_sel_hi:[1,0,1] neg_lo:[1,0,0]
    v_pk_fma_f32 v[178:179], v[178:179], v[126:127], v[182:183] op_sel:[1,1,0] op_sel_hi:[1,0,1] neg_lo:[1,0,0]
    ds_write_b64 v197, v[186:187] offset:6336
    ds_read_b128 v[52:55], v119 offset:256
    v_pk_mul_f32 v[180:181], v[176:177], v[124:125] op_sel:[0,0] op_sel_hi:[0,1]
    v_pk_mul_f32 v[182:183], v[178:179], v[126:127] op_sel:[0,0] op_sel_hi:[0,1]
    v_cvt_pk_bf16_f32 v184, v176, v177
    v_cvt_pk_bf16_f32 v185, v178, v179
    v_pk_fma_f32 v[176:177], v[176:177], v[124:125], v[180:181] op_sel:[1,1,0] op_sel_hi:[1,0,1] neg_lo:[1,0,0]
    v_pk_fma_f32 v[178:179], v[178:179], v[126:127], v[182:183] op_sel:[1,1,0] op_sel_hi:[1,0,1] neg_lo:[1,0,0]
    ds_write_b64 v197, v[184:185] offset:6864
    ds_read_b128 v[56:59], v118 offset:320
    v_pk_mul_f32 v[180:181], v[176:177], v[124:125] op_sel:[0,0] op_sel_hi:[0,1]
    v_pk_mul_f32 v[182:183], v[178:179], v[126:127] op_sel:[0,0] op_sel_hi:[0,1]
    v_cvt_pk_bf16_f32 v186, v176, v177
    v_cvt_pk_bf16_f32 v187, v178, v179
    v_pk_fma_f32 v[176:177], v[176:177], v[124:125], v[180:181] op_sel:[1,1,0] op_sel_hi:[1,0,1] neg_lo:[1,0,0]
    v_pk_fma_f32 v[178:179], v[178:179], v[126:127], v[182:183] op_sel:[1,1,0] op_sel_hi:[1,0,1] neg_lo:[1,0,0]
    ds_write_b64 v197, v[186:187] offset:7392
    ds_read_b128 v[60:63], v119 offset:320
    v_pk_mul_f32 v[180:181], v[176:177], v[124:125] op_sel:[0,0] op_sel_hi:[0,1]
    v_pk_mul_f32 v[182:183], v[178:179], v[126:127] op_sel:[0,0] op_sel_hi:[0,1]
    v_cvt_pk_bf16_f32 v184, v176, v177
    v_cvt_pk_bf16_f32 v185, v178, v179
    v_pk_fma_f32 v[176:177], v[176:177], v[124:125], v[180:181] op_sel:[1,1,0] op_sel_hi:[1,0,1] neg_lo:[1,0,0]
    v_pk_fma_f32 v[178:179], v[178:179], v[126:127], v[182:183] op_sel:[1,1,0] op_sel_hi:[1,0,1] neg_lo:[1,0,0]
    ds_write_b64 v197, v[184:185] offset:7920
    ds_read_b128 a[224:227], v111 offset:0
    ds_read_b128 a[228:231], v111 offset:64
    ds_read_b128 a[232:235], v111 offset:128
    ds_read_b128 a[236:239], v111 offset:192
    ds_read_b128 a[240:243], v111 offset:256
    ds_read_b128 a[244:247], v111 offset:320
    ds_read_b128 a[248:251], v111 offset:384
    ds_read_b128 a[252:255], v111 offset:448
    s_waitcnt vmcnt(30)
    s_add_u32 s27, s44, 10240
    buffer_load_dwordx4 a[40:43], v4, s[8:11], s27 offen
    s_add_u32 s28, s45, 5120
    buffer_load_dwordx2 a[84:85], v5, s[8:11], s28 offen
    s_add_u32 s29, s46, 20480
    buffer_load_dwordx4 a[176:179], v8, s[8:11], s29 offen
    buffer_load_dwordx4 a[180:183], v8, s[8:11], s29 offen offset:1024
    s_waitcnt lgkmcnt(7)
    v_mfma_f32_16x16x32_bf16 v[88:91], v[16:19], a[224:227], 0
    ds_read_b128 v[16:19], v118 offset:384
    v_mfma_f32_16x16x32_bf16 v[92:95], v[20:23], a[224:227], 0
    s_add_u32 s27, s44, 11264
    buffer_load_dwordx4 a[44:47], v4, s[8:11], s27 offen
    ds_read_b128 v[20:23], v119 offset:384
    s_waitcnt lgkmcnt(8)
    v_mfma_f32_16x16x32_bf16 v[88:91], v[24:27], a[228:231], v[88:91]
    s_add_u32 s28, s45, 5632
    buffer_load_dwordx2 a[86:87], v5, s[8:11], s28 offen
    ds_read_b128 v[24:27], v118 offset:448
    v_mfma_f32_16x16x32_bf16 v[92:95], v[28:31], a[228:231], v[92:95]
    s_add_u32 s29, s46, 22528
    buffer_load_dwordx4 a[184:187], v8, s[8:11], s29 offen
    ds_read_b128 v[28:31], v119 offset:448
    s_waitcnt lgkmcnt(9)
    v_mfma_f32_16x16x32_bf16 v[88:91], v[32:35], a[232:235], v[88:91]
    v_mfma_f32_16x16x32_bf16 v[92:95], v[36:39], a[232:235], v[92:95]
    buffer_load_dwordx4 a[188:191], v8, s[8:11], s29 offen offset:1024
    s_waitcnt lgkmcnt(8)
    v_mfma_f32_16x16x32_bf16 v[88:91], v[40:43], a[236:239], v[88:91]
    s_add_u32 s27, s44, 12288
    buffer_load_dwordx4 a[48:51], v4, s[8:11], s27 offen
    v_mfma_f32_16x16x32_bf16 v[92:95], v[44:47], a[236:239], v[92:95]
    s_waitcnt lgkmcnt(7)
    v_mfma_f32_16x16x32_bf16 v[88:91], v[48:51], a[240:243], v[88:91]
    s_add_u32 s28, s45, 6144
    buffer_load_dwordx2 a[88:89], v5, s[8:11], s28 offen
    v_mfma_f32_16x16x32_bf16 v[92:95], v[52:55], a[240:243], v[92:95]
    s_waitcnt lgkmcnt(6)
    v_mfma_f32_16x16x32_bf16 v[88:91], v[56:59], a[244:247], v[88:91]
    s_add_u32 s29, s46, 24576
    buffer_load_dwordx4 a[192:195], v8, s[8:11], s29 offen
    v_mfma_f32_16x16x32_bf16 v[92:95], v[60:63], a[244:247], v[92:95]
    s_waitcnt lgkmcnt(3)
    v_mfma_f32_16x16x32_bf16 v[88:91], v[16:19], a[248:251], v[88:91]
    buffer_load_dwordx4 a[196:199], v8, s[8:11], s29 offen offset:1024
    s_waitcnt lgkmcnt(2)
    v_mfma_f32_16x16x32_bf16 v[92:95], v[20:23], a[248:251], v[92:95]
    s_waitcnt lgkmcnt(1)
    v_mfma_f32_16x16x32_bf16 v[88:91], v[24:27], a[252:255], v[88:91]
    s_add_u32 s27, s44, 13312
    buffer_load_dwordx4 a[52:55], v4, s[8:11], s27 offen
    s_waitcnt lgkmcnt(0)
    v_mfma_f32_16x16x32_bf16 v[92:95], v[28:31], a[252:255], v[92:95]
    s_add_u32 s28, s45, 6656
    buffer_load_dwordx2 a[90:91], v5, s[8:11], s28 offen
    v_pk_mul_f32 v[180:181], v[176:177], v[124:125] op_sel:[0,0] op_sel_hi:[0,1]
    v_pk_mul_f32 v[182:183], v[178:179], v[126:127] op_sel:[0,0] op_sel_hi:[0,1]
    v_cvt_pk_bf16_f32 v186, v176, v177
    v_cvt_pk_bf16_f32 v187, v178, v179
    v_pk_fma_f32 v[176:177], v[176:177], v[124:125], v[180:181] op_sel:[1,1,0] op_sel_hi:[1,0,1] neg_lo:[1,0,0]
    v_pk_fma_f32 v[178:179], v[178:179], v[126:127], v[182:183] op_sel:[1,1,0] op_sel_hi:[1,0,1] neg_lo:[1,0,0]
    ds_write_b64 v197, v[186:187] offset:0
    v_pk_mul_f32 v[180:181], v[176:177], v[124:125] op_sel:[0,0] op_sel_hi:[0,1]
    v_pk_mul_f32 v[182:183], v[178:179], v[126:127] op_sel:[0,0] op_sel_hi:[0,1]
    v_cvt_pk_bf16_f32 v184, v176, v177
    v_cvt_pk_bf16_f32 v185, v178, v179
    v_pk_fma_f32 v[176:177], v[176:177], v[124:125], v[180:181] op_sel:[1,1,0] op_sel_hi:[1,0,1] neg_lo:[1,0,0]
    v_pk_fma_f32 v[178:179], v[178:179], v[126:127], v[182:183] op_sel:[1,1,0] op_sel_hi:[1,0,1] neg_lo:[1,0,0]
    ds_write_b64 v197, v[184:185] offset:528
    v_pk_mul_f32 v[180:181], v[176:177], v[124:125] op_sel:[0,0] op_sel_hi:[0,1]
    v_pk_mul_f32 v[182:183], v[178:179], v[126:127] op_sel:[0,0] op_sel_hi:[0,1]
    v_cvt_pk_bf16_f32 v186, v176, v177
    v_cvt_pk_bf16_f32 v187, v178, v179
    v_pk_fma_f32 v[176:177], v[176:177], v[124:125], v[180:181] op_sel:[1,1,0] op_sel_hi:[1,0,1] neg_lo:[1,0,0]
    v_pk_fma_f32 v[178:179], v[178:179], v[126:127], v[182:183] op_sel:[1,1,0] op_sel_hi:[1,0,1] neg_lo:[1,0,0]
    ds_write_b64 v197, v[186:187] offset:1056
    v_pk_mul_f32 v[180:181], v[176:177], v[124:125] op_sel:[0,0] op_sel_hi:[0,1]
    v_pk_mul_f32 v[182:183], v[178:179], v[126:127] op_sel:[0,0] op_sel_hi:[0,1]
    v_cvt_pk_bf16_f32 v184, v176, v177
    v_cvt_pk_bf16_f32 v185, v178, v179
    v_pk_fma_f32 v[176:177], v[176:177], v[124:125], v[180:181] op_sel:[1,1,0] op_sel_hi:[1,0,1] neg_lo:[1,0,0]
    v_pk_fma_f32 v[178:179], v[178:179], v[126:127], v[182:183] op_sel:[1,1,0] op_sel_hi:[1,0,1] neg_lo:[1,0,0]
    ds_write_b64 v197, v[184:185] offset:1584
    ds_read_b128 v[16:19], v118 offset:0
    v_pk_mul_f32 v[180:181], v[176:177], v[124:125] op_sel:[0,0] op_sel_hi:[0,1]
    v_pk_mul_f32 v[182:183], v[178:179], v[126:127] op_sel:[0,0] op_sel_hi:[0,1]
    v_cvt_pk_bf16_f32 v186, v176, v177
    v_cvt_pk_bf16_f32 v187, v178, v179
    v_pk_fma_f32 v[176:177], v[176:177], v[124:125], v[180:181] op_sel:[1,1,0] op_sel_hi:[1,0,1] neg_lo:[1,0,0]
    v_pk_fma_f32 v[178:179], v[178:179], v[126:127], v[182:183] op_sel:[1,1,0] op_sel_hi:[1,0,1] neg_lo:[1,0,0]
    ds_write_b64 v197, v[186:187] offset:2112
    ds_read_b128 v[20:23], v119 offset:0
    v_pk_mul_f32 v[180:181], v[176:177], v[124:125] op_sel:[0,0] op_sel_hi:[0,1]
    v_pk_mul_f32 v[182:183], v[178:179], v[126:127] op_sel:[0,0] op_sel_hi:[0,1]
    v_cvt_pk_bf16_f32 v184, v176, v177
    v_cvt_pk_bf16_f32 v185, v178, v179
    v_pk_fma_f32 v[176:177], v[176:177], v[124:125], v[180:181] op_sel:[1,1,0] op_sel_hi:[1,0,1] neg_lo:[1,0,0]
    v_pk_fma_f32 v[178:179], v[178:179], v[126:127], v[182:183] op_sel:[1,1,0] op_sel_hi:[1,0,1] neg_lo:[1,0,0]
    ds_write_b64 v197, v[184:185] offset:2640
    ds_read_b128 v[24:27], v118 offset:64
    v_pk_mul_f32 v[180:181], v[176:177], v[124:125] op_sel:[0,0] op_sel_hi:[0,1]
    v_pk_mul_f32 v[182:183], v[178:179], v[126:127] op_sel:[0,0] op_sel_hi:[0,1]
    v_cvt_pk_bf16_f32 v186, v176, v177
    v_cvt_pk_bf16_f32 v187, v178, v179
    v_pk_fma_f32 v[176:177], v[176:177], v[124:125], v[180:181] op_sel:[1,1,0] op_sel_hi:[1,0,1] neg_lo:[1,0,0]
    v_pk_fma_f32 v[178:179], v[178:179], v[126:127], v[182:183] op_sel:[1,1,0] op_sel_hi:[1,0,1] neg_lo:[1,0,0]
    ds_write_b64 v197, v[186:187] offset:3168
    ds_read_b128 v[28:31], v119 offset:64
    v_pk_mul_f32 v[180:181], v[176:177], v[124:125] op_sel:[0,0] op_sel_hi:[0,1]
    v_pk_mul_f32 v[182:183], v[178:179], v[126:127] op_sel:[0,0] op_sel_hi:[0,1]
    v_cvt_pk_bf16_f32 v184, v176, v177
    v_cvt_pk_bf16_f32 v185, v178, v179
    v_pk_fma_f32 v[176:177], v[176:177], v[124:125], v[180:181] op_sel:[1,1,0] op_sel_hi:[1,0,1] neg_lo:[1,0,0]
    v_pk_fma_f32 v[178:179], v[178:179], v[126:127], v[182:183] op_sel:[1,1,0] op_sel_hi:[1,0,1] neg_lo:[1,0,0]
    ds_write_b64 v197, v[184:185] offset:3696
    ds_read_b128 v[32:35], v118 offset:128
    v_pk_mul_f32 v[180:181], v[176:177], v[124:125] op_sel:[0,0] op_sel_hi:[0,1]
    v_pk_mul_f32 v[182:183], v[178:179], v[126:127] op_sel:[0,0] op_sel_hi:[0,1]
    v_cvt_pk_bf16_f32 v186, v176, v177
    v_cvt_pk_bf16_f32 v187, v178, v179
    v_pk_fma_f32 v[176:177], v[176:177], v[124:125], v[180:181] op_sel:[1,1,0] op_sel_hi:[1,0,1] neg_lo:[1,0,0]
    v_pk_fma_f32 v[178:179], v[178:179], v[126:127], v[182:183] op_sel:[1,1,0] op_sel_hi:[1,0,1] neg_lo:[1,0,0]
    ds_write_b64 v197, v[186:187] offset:4224
    ds_read_b128 v[36:39], v119 offset:128
    v_pk_mul_f32 v[180:181], v[176:177], v[124:125] op_sel:[0,0] op_sel_hi:[0,1]
    v_pk_mul_f32 v[182:183], v[178:179], v[126:127] op_sel:[0,0] op_sel_hi:[0,1]
    v_cvt_pk_bf16_f32 v184, v176, v177
    v_cvt_pk_bf16_f32 v185, v178, v179
    v_pk_fma_f32 v[176:177], v[176:177], v[124:125], v[180:181] op_sel:[1,1,0] op_sel_hi:[1,0,1] neg_lo:[1,0,0]
    v_pk_fma_f32 v[178:179], v[178:179], v[126:127], v[182:183] op_sel:[1,1,0] op_sel_hi:[1,0,1] neg_lo:[1,0,0]
    ds_write_b64 v197, v[184:185] offset:4752
    ds_read_b128 v[40:43], v118 offset:192
    v_pk_mul_f32 v[180:181], v[176:177], v[124:125] op_sel:[0,0] op_sel_hi:[0,1]
    v_pk_mul_f32 v[182:183], v[178:179], v[126:127] op_sel:[0,0] op_sel_hi:[0,1]
    v_cvt_pk_bf16_f32 v186, v176, v177
    v_cvt_pk_bf16_f32 v187, v178, v179
    v_pk_fma_f32 v[176:177], v[176:177], v[124:125], v[180:181] op_sel:[1,1,0] op_sel_hi:[1,0,1] neg_lo:[1,0,0]
    v_pk_fma_f32 v[178:179], v[178:179], v[126:127], v[182:183] op_sel:[1,1,0] op_sel_hi:[1,0,1] neg_lo:[1,0,0]
    ds_write_b64 v197, v[186:187] offset:5280
    ds_read_b128 v[44:47], v119 offset:192
    v_pk_mul_f32 v[180:181], v[176:177], v[124:125] op_sel:[0,0] op_sel_hi:[0,1]
    v_pk_mul_f32 v[182:183], v[178:179], v[126:127] op_sel:[0,0] op_sel_hi:[0,1]
    v_cvt_pk_bf16_f32 v184, v176, v177
    v_cvt_pk_bf16_f32 v185, v178, v179
    v_pk_fma_f32 v[176:177], v[176:177], v[124:125], v[180:181] op_sel:[1,1,0] op_sel_hi:[1,0,1] neg_lo:[1,0,0]
    v_pk_fma_f32 v[178:179], v[178:179], v[126:127], v[182:183] op_sel:[1,1,0] op_sel_hi:[1,0,1] neg_lo:[1,0,0]
    ds_write_b64 v197, v[184:185] offset:5808
    ds_read_b128 v[48:51], v118 offset:256
    v_pk_mul_f32 v[180:181], v[176:177], v[124:125] op_sel:[0,0] op_sel_hi:[0,1]
    v_pk_mul_f32 v[182:183], v[178:179], v[126:127] op_sel:[0,0] op_sel_hi:[0,1]
    v_cvt_pk_bf16_f32 v186, v176, v177
    v_cvt_pk_bf16_f32 v187, v178, v179
    v_pk_fma_f32 v[176:177], v[176:177], v[124:125], v[180:181] op_sel:[1,1,0] op_sel_hi:[1,0,1] neg_lo:[1,0,0]
    v_pk_fma_f32 v[178:179], v[178:179], v[126:127], v[182:183] op_sel:[1,1,0] op_sel_hi:[1,0,1] neg_lo:[1,0,0]
    ds_write_b64 v197, v[186:187] offset:6336
    ds_read_b128 v[52:55], v119 offset:256
    v_pk_mul_f32 v[180:181], v[176:177], v[124:125] op_sel:[0,0] op_sel_hi:[0,1]
    v_pk_mul_f32 v[182:183], v[178:179], v[126:127] op_sel:[0,0] op_sel_hi:[0,1]
    v_cvt_pk_bf16_f32 v184, v176, v177
    v_cvt_pk_bf16_f32 v185, v178, v179
    v_pk_fma_f32 v[176:177], v[176:177], v[124:125], v[180:181] op_sel:[1,1,0] op_sel_hi:[1,0,1] neg_lo:[1,0,0]
    v_pk_fma_f32 v[178:179], v[178:179], v[126:127], v[182:183] op_sel:[1,1,0] op_sel_hi:[1,0,1] neg_lo:[1,0,0]
    ds_write_b64 v197, v[184:185] offset:6864
    ds_read_b128 v[56:59], v118 offset:320
    v_pk_mul_f32 v[180:181], v[176:177], v[124:125] op_sel:[0,0] op_sel_hi:[0,1]
    v_pk_mul_f32 v[182:183], v[178:179], v[126:127] op_sel:[0,0] op_sel_hi:[0,1]
    v_cvt_pk_bf16_f32 v186, v176, v177
    v_cvt_pk_bf16_f32 v187, v178, v179
    v_pk_fma_f32 v[176:177], v[176:177], v[124:125], v[180:181] op_sel:[1,1,0] op_sel_hi:[1,0,1] neg_lo:[1,0,0]
    v_pk_fma_f32 v[178:179], v[178:179], v[126:127], v[182:183] op_sel:[1,1,0] op_sel_hi:[1,0,1] neg_lo:[1,0,0]
    ds_write_b64 v197, v[186:187] offset:7392
    ds_read_b128 v[60:63], v119 offset:320
    v_cvt_pk_bf16_f32 v184, v176, v177
    v_cvt_pk_bf16_f32 v185, v178, v179
    ds_write_b64 v197, v[184:185] offset:7920
    ds_read_b128 a[224:227], v111 offset:0
    ds_read_b128 a[228:231], v111 offset:64
    ds_read_b128 a[232:235], v111 offset:128
    ds_read_b128 a[236:239], v111 offset:192
    ds_read_b128 a[240:243], v111 offset:256
    ds_read_b128 a[244:247], v111 offset:320
    ds_read_b128 a[248:251], v111 offset:384
    ds_read_b128 a[252:255], v111 offset:448
    s_add_u32 s29, s46, 26624
    buffer_load_dwordx4 a[200:203], v8, s[8:11], s29 offen
    buffer_load_dwordx4 a[204:207], v8, s[8:11], s29 offen offset:1024
    s_add_u32 s27, s44, 14336
    buffer_load_dwordx4 a[56:59], v4, s[8:11], s27 offen
    s_add_u32 s28, s45, 7168
    buffer_load_dwordx2 a[92:93], v5, s[8:11], s28 offen
    s_waitcnt lgkmcnt(7)
    v_mfma_f32_16x16x32_bf16 v[96:99], v[16:19], a[224:227], 0
    ds_read_b128 v[16:19], v118 offset:384
    v_mfma_f32_16x16x32_bf16 v[100:103], v[20:23], a[224:227], 0
    ds_read_b128 v[20:23], v119 offset:384
    s_add_u32 s29, s46, 28672
    buffer_load_dwordx4 a[208:211], v8, s[8:11], s29 offen
    s_waitcnt lgkmcnt(8)
    v_mfma_f32_16x16x32_bf16 v[96:99], v[24:27], a[228:231], v[96:99]
    ds_read_b128 v[24:27], v118 offset:448
    v_mfma_f32_16x16x32_bf16 v[100:103], v[28:31], a[228:231], v[100:103]
    ds_read_b128 v[28:31], v119 offset:448
    buffer_load_dwordx4 a[212:215], v8, s[8:11], s29 offen offset:1024
    s_waitcnt lgkmcnt(9)
    v_mfma_f32_16x16x32_bf16 v[96:99], v[32:35], a[232:235], v[96:99]
    v_mfma_f32_16x16x32_bf16 v[100:103], v[36:39], a[232:235], v[100:103]
    s_waitcnt lgkmcnt(8)
    v_mfma_f32_16x16x32_bf16 v[96:99], v[40:43], a[236:239], v[96:99]
    s_add_u32 s27, s44, 15360
    buffer_load_dwordx4 a[60:63], v4, s[8:11], s27 offen
    v_mfma_f32_16x16x32_bf16 v[100:103], v[44:47], a[236:239], v[100:103]
    s_waitcnt lgkmcnt(7)
    v_mfma_f32_16x16x32_bf16 v[96:99], v[48:51], a[240:243], v[96:99]
    v_mfma_f32_16x16x32_bf16 v[100:103], v[52:55], a[240:243], v[100:103]
    s_add_u32 s28, s45, 7680
    buffer_load_dwordx2 a[94:95], v5, s[8:11], s28 offen
    s_waitcnt lgkmcnt(6)
    v_mfma_f32_16x16x32_bf16 v[96:99], v[56:59], a[244:247], v[96:99]
    v_mfma_f32_16x16x32_bf16 v[100:103], v[60:63], a[244:247], v[100:103]
    s_waitcnt lgkmcnt(3)
    v_mfma_f32_16x16x32_bf16 v[96:99], v[16:19], a[248:251], v[96:99]
    s_add_u32 s29, s46, 30720
    buffer_load_dwordx4 a[216:219], v8, s[8:11], s29 offen
    s_waitcnt lgkmcnt(2)
    v_mfma_f32_16x16x32_bf16 v[100:103], v[20:23], a[248:251], v[100:103]
    s_waitcnt lgkmcnt(1)
    v_mfma_f32_16x16x32_bf16 v[96:99], v[24:27], a[252:255], v[96:99]
    s_waitcnt lgkmcnt(0)
    v_mfma_f32_16x16x32_bf16 v[100:103], v[28:31], a[252:255], v[100:103]
    buffer_load_dwordx4 a[220:223], v8, s[8:11], s29 offen offset:1024
    s_nop 7
    v_lshlrev_b32 v198, 16, v198
    v_cmp_eq_u32 vcc, 0, v1
    s_nop 1
    v_cndmask_b32 v198, 0, v198, vcc
    v_add_f32 v64, v64, v198
    v_cmp_gt_u32 vcc, 8, v2
    s_nop 1
    v_cndmask_b32 v64, v72, v64, vcc
    v_cndmask_b32 v65, v73, v65, vcc
    v_cndmask_b32 v66, v74, v66, vcc
    v_cndmask_b32 v67, v75, v67, vcc
    v_cndmask_b32 v68, v76, v68, vcc
    v_cndmask_b32 v69, v77, v69, vcc
    v_cndmask_b32 v70, v78, v70, vcc
    v_cndmask_b32 v71, v79, v71, vcc
    v_cvt_pk_bf16_f32 v176, v67, v66
    v_cvt_pk_bf16_f32 v177, v65, v64
    v_cvt_pk_bf16_f32 v178, v71, v70
    v_cvt_pk_bf16_f32 v179, v69, v68
    v_cvt_pk_bf16_f32 v180, v83, v82
    v_cvt_pk_bf16_f32 v181, v81, v80
    v_cvt_pk_bf16_f32 v182, v87, v86
    v_cvt_pk_bf16_f32 v183, v85, v84
    v_cvt_pk_bf16_f32 v184, v91, v90
    v_cvt_pk_bf16_f32 v185, v89, v88
    v_cvt_pk_bf16_f32 v186, v95, v94
    v_cvt_pk_bf16_f32 v187, v93, v92
    v_cvt_pk_bf16_f32 v188, v99, v98
    v_cvt_pk_bf16_f32 v189, v97, v96
    v_cvt_pk_bf16_f32 v190, v103, v102
    v_cvt_pk_bf16_f32 v191, v101, v100
    s_barrier
    s_mul_i32 s21, s20, 4608
    s_add_u32 s21, s21, 73728
    v_lshlrev_b32 v15, 5, v2
    v_lshl_add_u32 v15, v3, 2, v15
    v_sub_u32 v15, 2044, v15
    v_lshlrev_b32 v15, 1, v15
    v_add_u32 v15, s21, v15
    v_subrev_u32 v15, 3104, v15
    ds_write_b64 v15, v[176:177] offset:3104
    ds_write_b64 v15, v[178:179] offset:3072
    ds_write_b64 v15, v[180:181] offset:2080
    ds_write_b64 v15, v[182:183] offset:2048
    ds_write_b64 v15, v[184:185] offset:1056
    ds_write_b64 v15, v[186:187] offset:1024
    ds_write_b64 v15, v[188:189] offset:32
    ds_write_b64 v15, v[190:191] offset:0
    v_mov_b32 v192, 0
    v_mov_b32 v193, 0
    v_lshlrev_b32 v12, 3, v1
    s_add_u32 s21, s21, 4096
    v_add_u32 v12, s21, v12
    ds_write_b64 v12, v[192:193]
    s_mul_i32 s21, s23, 160
    s_add_u32 s40, s90, s21
    s_addc_u32 s41, s91, 0
    s_mov_b32 s42, 0
    s_mov_b32 s43, 0x20000
    s_sub_u32 s42, 819200, s21
    s_mov_b32 s48, s64
    s_mov_b32 s49, s65
    s_mov_b32 s50, 2621440
    s_mov_b32 s51, 0x20000
    v_mov_b32 v192, 0
    s_and_b32 s21, s20, 1
    s_mul_i32 s21, s21, 8320
    s_add_u32 s21, s21, 92160
    v_and_b32 v12, 15, v1
    v_lshlrev_b32 v12, 2, v12
    v_lshrrev_b32 v13, 4, v1
    v_and_b32 v13, 1, v13
    v_mul_u32_u24 v13, 0x2040, v13
    v_add3_u32 v12, v12, v13, s21
    ds_write_b32 v12, v192
    s_waitcnt vmcnt(0)
    v_mfma_f32_32x32x16_bf16 v[16:31], a[0:3], v[128:131], 0
    v_mfma_f32_32x32x8_bf16 v[16:31], a[64:65], v[132:133], v[16:31]
    s_nop 7
    s_nop 3
    v_exp_f32 v16, v16
    v_mfma_f32_32x32x16_bf16 v[32:47], a[4:7], v[128:131], 0
    v_exp_f32 v17, v17
    v_exp_f32 v18, v18
    v_cvt_pk_bf16_f32 v48, v16, v17
    v_exp_f32 v19, v19
    v_exp_f32 v20, v20
    v_cvt_pk_bf16_f32 v49, v18, v19
    v_exp_f32 v21, v21
    v_exp_f32 v22, v22
    v_cvt_pk_bf16_f32 v50, v20, v21
    v_exp_f32 v23, v23
    v_mfma_f32_32x32x8_bf16 v[32:47], a[66:67], v[132:133], v[32:47]
    v_exp_f32 v24, v24
    v_cvt_pk_bf16_f32 v51, v22, v23
    v_exp_f32 v25, v25
    v_exp_f32 v26, v26
    v_cvt_pk_bf16_f32 v52, v24, v25
    v_exp_f32 v27, v27
    v_exp_f32 v28, v28
    v_cvt_pk_bf16_f32 v53, v26, v27
    v_exp_f32 v29, v29
    v_exp_f32 v30, v30
    v_exp_f32 v31, v31
    v_cvt_pk_bf16_f32 v54, v28, v29
    v_cvt_pk_bf16_f32 v55, v30, v31
    v_exp_f32 v32, v32
    v_mfma_f32_32x32x16_bf16 v[16:31], a[8:11], v[128:131], 0
    v_exp_f32 v33, v33
    v_exp_f32 v34, v34
    v_cvt_pk_bf16_f32 v56, v32, v33
    v_exp_f32 v35, v35
    v_exp_f32 v36, v36
    v_mfma_f32_32x32x16_bf16 v[80:95], a[96:99], v[48:51], 0
    v_cvt_pk_bf16_f32 v57, v34, v35
    v_exp_f32 v37, v37
    v_exp_f32 v38, v38
    v_cvt_pk_bf16_f32 v58, v36, v37
    v_exp_f32 v39, v39
    v_mfma_f32_32x32x8_bf16 v[16:31], a[68:69], v[132:133], v[16:31]
    v_exp_f32 v40, v40
    v_cvt_pk_bf16_f32 v59, v38, v39
    v_exp_f32 v41, v41
    v_exp_f32 v42, v42
    v_cvt_pk_bf16_f32 v60, v40, v41
    v_exp_f32 v43, v43
    v_mfma_f32_32x32x16_bf16 v[80:95], a[100:103], v[52:55], v[80:95]
    v_exp_f32 v44, v44
    v_cvt_pk_bf16_f32 v61, v42, v43
    v_exp_f32 v45, v45
    v_exp_f32 v46, v46
    v_exp_f32 v47, v47
    v_cvt_pk_bf16_f32 v62, v44, v45
    v_cvt_pk_bf16_f32 v63, v46, v47
    v_exp_f32 v16, v16
    v_mfma_f32_32x32x16_bf16 v[32:47], a[12:15], v[128:131], 0
    v_exp_f32 v17, v17
    v_exp_f32 v18, v18
    v_cvt_pk_bf16_f32 v48, v16, v17
    v_exp_f32 v19, v19
    v_exp_f32 v20, v20
    v_mfma_f32_32x32x16_bf16 v[80:95], a[104:107], v[56:59], v[80:95]
    v_cvt_pk_bf16_f32 v49, v18, v19
    v_exp_f32 v21, v21
    v_exp_f32 v22, v22
    v_cvt_pk_bf16_f32 v50, v20, v21
    v_exp_f32 v23, v23
    v_mfma_f32_32x32x8_bf16 v[32:47], a[70:71], v[132:133], v[32:47]
    v_exp_f32 v24, v24
    v_cvt_pk_bf16_f32 v51, v22, v23
    v_exp_f32 v25, v25
    v_exp_f32 v26, v26
    v_cvt_pk_bf16_f32 v52, v24, v25
    v_exp_f32 v27, v27
    v_mfma_f32_32x32x16_bf16 v[80:95], a[108:111], v[60:63], v[80:95]
    v_exp_f32 v28, v28
    v_cvt_pk_bf16_f32 v53, v26, v27
    v_exp_f32 v29, v29
    v_exp_f32 v30, v30
    v_exp_f32 v31, v31
    v_cvt_pk_bf16_f32 v54, v28, v29
    v_cvt_pk_bf16_f32 v55, v30, v31
    v_exp_f32 v32, v32
    v_mfma_f32_32x32x16_bf16 v[16:31], a[16:19], v[128:131], 0
    v_exp_f32 v33, v33
    v_exp_f32 v34, v34
    v_cvt_pk_bf16_f32 v56, v32, v33
    v_exp_f32 v35, v35
    v_exp_f32 v36, v36
    v_mfma_f32_32x32x16_bf16 v[80:95], a[112:115], v[48:51], v[80:95]
    v_cvt_pk_bf16_f32 v57, v34, v35
    v_exp_f32 v37, v37
    v_exp_f32 v38, v38
    v_cvt_pk_bf16_f32 v58, v36, v37
    v_exp_f32 v39, v39
    v_mfma_f32_32x32x8_bf16 v[16:31], a[72:73], v[132:133], v[16:31]
    v_exp_f32 v40, v40
    v_cvt_pk_bf16_f32 v59, v38, v39
    v_exp_f32 v41, v41
    v_exp_f32 v42, v42
    v_cvt_pk_bf16_f32 v60, v40, v41
    v_exp_f32 v43, v43
    v_mfma_f32_32x32x16_bf16 v[80:95], a[116:119], v[52:55], v[80:95]
    v_exp_f32 v44, v44
    v_cvt_pk_bf16_f32 v61, v42, v43
    v_exp_f32 v45, v45
    v_exp_f32 v46, v46
    v_exp_f32 v47, v47
    v_cvt_pk_bf16_f32 v62, v44, v45
    v_cvt_pk_bf16_f32 v63, v46, v47
    v_exp_f32 v16, v16
    v_mfma_f32_32x32x16_bf16 v[32:47], a[20:23], v[128:131], 0
    v_exp_f32 v17, v17
    v_exp_f32 v18, v18
    v_cvt_pk_bf16_f32 v48, v16, v17
    v_exp_f32 v19, v19
    v_exp_f32 v20, v20
    v_mfma_f32_32x32x16_bf16 v[80:95], a[120:123], v[56:59], v[80:95]
    v_cvt_pk_bf16_f32 v49, v18, v19
    v_exp_f32 v21, v21
    v_exp_f32 v22, v22
    v_cvt_pk_bf16_f32 v50, v20, v21
    v_exp_f32 v23, v23
    v_mfma_f32_32x32x8_bf16 v[32:47], a[74:75], v[132:133], v[32:47]
    v_exp_f32 v24, v24
    v_cvt_pk_bf16_f32 v51, v22, v23
    v_exp_f32 v25, v25
    v_exp_f32 v26, v26
    v_cvt_pk_bf16_f32 v52, v24, v25
    v_exp_f32 v27, v27
    v_mfma_f32_32x32x16_bf16 v[80:95], a[124:127], v[60:63], v[80:95]
    v_exp_f32 v28, v28
    v_cvt_pk_bf16_f32 v53, v26, v27
    v_exp_f32 v29, v29
    v_exp_f32 v30, v30
    v_exp_f32 v31, v31
    v_cvt_pk_bf16_f32 v54, v28, v29
    v_cvt_pk_bf16_f32 v55, v30, v31
    v_exp_f32 v32, v32
    v_mfma_f32_32x32x16_bf16 v[16:31], a[24:27], v[128:131], 0
    v_exp_f32 v33, v33
    v_exp_f32 v34, v34
    v_cvt_pk_bf16_f32 v56, v32, v33
    v_exp_f32 v35, v35
    v_exp_f32 v36, v36
    v_mfma_f32_32x32x16_bf16 v[80:95], a[128:131], v[48:51], v[80:95]
    v_cvt_pk_bf16_f32 v57, v34, v35
    v_exp_f32 v37, v37
    v_exp_f32 v38, v38
    v_cvt_pk_bf16_f32 v58, v36, v37
    v_exp_f32 v39, v39
    v_mfma_f32_32x32x8_bf16 v[16:31], a[76:77], v[132:133], v[16:31]
    v_exp_f32 v40, v40
    v_cvt_pk_bf16_f32 v59, v38, v39
    v_exp_f32 v41, v41
    v_exp_f32 v42, v42
    v_cvt_pk_bf16_f32 v60, v40, v41
    v_exp_f32 v43, v43
    v_mfma_f32_32x32x16_bf16 v[80:95], a[132:135], v[52:55], v[80:95]
    v_exp_f32 v44, v44
    v_cvt_pk_bf16_f32 v61, v42, v43
    v_exp_f32 v45, v45
    v_exp_f32 v46, v46
    v_exp_f32 v47, v47
    v_cvt_pk_bf16_f32 v62, v44, v45
    v_cvt_pk_bf16_f32 v63, v46, v47
    v_exp_f32 v16, v16
    v_mfma_f32_32x32x16_bf16 v[32:47], a[28:31], v[128:131], 0
    v_exp_f32 v17, v17
    v_exp_f32 v18, v18
    v_cvt_pk_bf16_f32 v48, v16, v17
    v_exp_f32 v19, v19
    v_exp_f32 v20, v20
    v_mfma_f32_32x32x16_bf16 v[80:95], a[136:139], v[56:59], v[80:95]
    v_cvt_pk_bf16_f32 v49, v18, v19
    v_exp_f32 v21, v21
    v_exp_f32 v22, v22
    v_cvt_pk_bf16_f32 v50, v20, v21
    v_exp_f32 v23, v23
    v_mfma_f32_32x32x8_bf16 v[32:47], a[78:79], v[132:133], v[32:47]
    v_exp_f32 v24, v24
    v_cvt_pk_bf16_f32 v51, v22, v23
    v_exp_f32 v25, v25
    v_exp_f32 v26, v26
    v_cvt_pk_bf16_f32 v52, v24, v25
    v_exp_f32 v27, v27
    v_mfma_f32_32x32x16_bf16 v[80:95], a[140:143], v[60:63], v[80:95]
    v_exp_f32 v28, v28
    v_cvt_pk_bf16_f32 v53, v26, v27
    v_exp_f32 v29, v29
    v_exp_f32 v30, v30
    v_exp_f32 v31, v31
    v_cvt_pk_bf16_f32 v54, v28, v29
    v_cvt_pk_bf16_f32 v55, v30, v31
    v_exp_f32 v32, v32
    v_mfma_f32_32x32x16_bf16 v[16:31], a[32:35], v[128:131], 0
    v_exp_f32 v33, v33
    v_exp_f32 v34, v34
    v_cvt_pk_bf16_f32 v56, v32, v33
    v_exp_f32 v35, v35
    v_exp_f32 v36, v36
    v_mfma_f32_32x32x16_bf16 v[80:95], a[144:147], v[48:51], v[80:95]
    v_cvt_pk_bf16_f32 v57, v34, v35
    v_exp_f32 v37, v37
    v_exp_f32 v38, v38
    v_cvt_pk_bf16_f32 v58, v36, v37
    v_exp_f32 v39, v39
    v_mfma_f32_32x32x8_bf16 v[16:31], a[80:81], v[132:133], v[16:31]
    v_exp_f32 v40, v40
    v_cvt_pk_bf16_f32 v59, v38, v39
    v_exp_f32 v41, v41
    v_exp_f32 v42, v42
    v_cvt_pk_bf16_f32 v60, v40, v41
    v_exp_f32 v43, v43
    v_mfma_f32_32x32x16_bf16 v[80:95], a[148:151], v[52:55], v[80:95]
    v_exp_f32 v44, v44
    v_cvt_pk_bf16_f32 v61, v42, v43
    v_exp_f32 v45, v45
    v_exp_f32 v46, v46
    v_exp_f32 v47, v47
    v_cvt_pk_bf16_f32 v62, v44, v45
    v_cvt_pk_bf16_f32 v63, v46, v47
    v_exp_f32 v16, v16
    v_mfma_f32_32x32x16_bf16 v[32:47], a[36:39], v[128:131], 0
    v_exp_f32 v17, v17
    v_exp_f32 v18, v18
    v_cvt_pk_bf16_f32 v48, v16, v17
    v_exp_f32 v19, v19
    v_exp_f32 v20, v20
    v_mfma_f32_32x32x16_bf16 v[80:95], a[152:155], v[56:59], v[80:95]
    v_cvt_pk_bf16_f32 v49, v18, v19
    v_exp_f32 v21, v21
    v_exp_f32 v22, v22
    v_cvt_pk_bf16_f32 v50, v20, v21
    v_exp_f32 v23, v23
    v_mfma_f32_32x32x8_bf16 v[32:47], a[82:83], v[132:133], v[32:47]
    v_exp_f32 v24, v24
    v_cvt_pk_bf16_f32 v51, v22, v23
    v_exp_f32 v25, v25
    v_exp_f32 v26, v26
    v_cvt_pk_bf16_f32 v52, v24, v25
    v_exp_f32 v27, v27
    v_mfma_f32_32x32x16_bf16 v[80:95], a[156:159], v[60:63], v[80:95]
    v_exp_f32 v28, v28
    v_cvt_pk_bf16_f32 v53, v26, v27
    v_exp_f32 v29, v29
    v_exp_f32 v30, v30
    v_exp_f32 v31, v31
    v_cvt_pk_bf16_f32 v54, v28, v29
    v_cvt_pk_bf16_f32 v55, v30, v31
    v_exp_f32 v32, v32
    v_mfma_f32_32x32x16_bf16 v[16:31], a[40:43], v[128:131], 0
    v_exp_f32 v33, v33
    v_exp_f32 v34, v34
    v_cvt_pk_bf16_f32 v56, v32, v33
    v_exp_f32 v35, v35
    v_exp_f32 v36, v36
    v_mfma_f32_32x32x16_bf16 v[80:95], a[160:163], v[48:51], v[80:95]
    v_cvt_pk_bf16_f32 v57, v34, v35
    v_exp_f32 v37, v37
    v_exp_f32 v38, v38
    v_cvt_pk_bf16_f32 v58, v36, v37
    v_exp_f32 v39, v39
    v_mfma_f32_32x32x8_bf16 v[16:31], a[84:85], v[132:133], v[16:31]
    v_exp_f32 v40, v40
    v_cvt_pk_bf16_f32 v59, v38, v39
    v_exp_f32 v41, v41
    v_exp_f32 v42, v42
    v_cvt_pk_bf16_f32 v60, v40, v41
    v_exp_f32 v43, v43
    v_mfma_f32_32x32x16_bf16 v[80:95], a[164:167], v[52:55], v[80:95]
    v_exp_f32 v44, v44
    v_cvt_pk_bf16_f32 v61, v42, v43
    v_exp_f32 v45, v45
    v_exp_f32 v46, v46
    v_exp_f32 v47, v47
    v_cvt_pk_bf16_f32 v62, v44, v45
    v_cvt_pk_bf16_f32 v63, v46, v47
    v_exp_f32 v16, v16
    v_mfma_f32_32x32x16_bf16 v[32:47], a[44:47], v[128:131], 0
    v_exp_f32 v17, v17
    v_exp_f32 v18, v18
    v_cvt_pk_bf16_f32 v48, v16, v17
    v_exp_f32 v19, v19
    v_exp_f32 v20, v20
    v_mfma_f32_32x32x16_bf16 v[80:95], a[168:171], v[56:59], v[80:95]
    v_cvt_pk_bf16_f32 v49, v18, v19
    v_exp_f32 v21, v21
    v_exp_f32 v22, v22
    v_cvt_pk_bf16_f32 v50, v20, v21
    v_exp_f32 v23, v23
    v_mfma_f32_32x32x8_bf16 v[32:47], a[86:87], v[132:133], v[32:47]
    v_exp_f32 v24, v24
    v_cvt_pk_bf16_f32 v51, v22, v23
    v_exp_f32 v25, v25
    v_exp_f32 v26, v26
    v_cvt_pk_bf16_f32 v52, v24, v25
    v_exp_f32 v27, v27
    v_mfma_f32_32x32x16_bf16 v[80:95], a[172:175], v[60:63], v[80:95]
    v_exp_f32 v28, v28
    v_cvt_pk_bf16_f32 v53, v26, v27
    v_exp_f32 v29, v29
    v_exp_f32 v30, v30
    v_exp_f32 v31, v31
    v_cvt_pk_bf16_f32 v54, v28, v29
    v_cvt_pk_bf16_f32 v55, v30, v31
    v_exp_f32 v32, v32
    v_mfma_f32_32x32x16_bf16 v[16:31], a[48:51], v[128:131], 0
    v_exp_f32 v33, v33
    v_exp_f32 v34, v34
    v_cvt_pk_bf16_f32 v56, v32, v33
    v_exp_f32 v35, v35
    v_exp_f32 v36, v36
    v_mfma_f32_32x32x16_bf16 v[80:95], a[176:179], v[48:51], v[80:95]
    v_cvt_pk_bf16_f32 v57, v34, v35
    v_exp_f32 v37, v37
    v_exp_f32 v38, v38
    v_cvt_pk_bf16_f32 v58, v36, v37
    v_exp_f32 v39, v39
    v_mfma_f32_32x32x8_bf16 v[16:31], a[88:89], v[132:133], v[16:31]
    v_exp_f32 v40, v40
    v_cvt_pk_bf16_f32 v59, v38, v39
    v_exp_f32 v41, v41
    v_exp_f32 v42, v42
    v_cvt_pk_bf16_f32 v60, v40, v41
    v_exp_f32 v43, v43
    v_mfma_f32_32x32x16_bf16 v[80:95], a[180:183], v[52:55], v[80:95]
    v_exp_f32 v44, v44
    v_cvt_pk_bf16_f32 v61, v42, v43
    v_exp_f32 v45, v45
    v_exp_f32 v46, v46
    v_exp_f32 v47, v47
    v_cvt_pk_bf16_f32 v62, v44, v45
    v_cvt_pk_bf16_f32 v63, v46, v47
    v_exp_f32 v16, v16
    v_mfma_f32_32x32x16_bf16 v[32:47], a[52:55], v[128:131], 0
    v_exp_f32 v17, v17
    v_exp_f32 v18, v18
    v_cvt_pk_bf16_f32 v48, v16, v17
    v_exp_f32 v19, v19
    v_exp_f32 v20, v20
    v_mfma_f32_32x32x16_bf16 v[80:95], a[184:187], v[56:59], v[80:95]
    v_cvt_pk_bf16_f32 v49, v18, v19
    v_exp_f32 v21, v21
    v_exp_f32 v22, v22
    v_cvt_pk_bf16_f32 v50, v20, v21
    v_exp_f32 v23, v23
    v_mfma_f32_32x32x8_bf16 v[32:47], a[90:91], v[132:133], v[32:47]
    v_exp_f32 v24, v24
    v_cvt_pk_bf16_f32 v51, v22, v23
    v_exp_f32 v25, v25
    v_exp_f32 v26, v26
    v_cvt_pk_bf16_f32 v52, v24, v25
    v_exp_f32 v27, v27
    v_mfma_f32_32x32x16_bf16 v[80:95], a[188:191], v[60:63], v[80:95]
    v_exp_f32 v28, v28
    v_cvt_pk_bf16_f32 v53, v26, v27
    v_exp_f32 v29, v29
    v_exp_f32 v30, v30
    v_exp_f32 v31, v31
    v_cvt_pk_bf16_f32 v54, v28, v29
    v_cvt_pk_bf16_f32 v55, v30, v31
    v_exp_f32 v32, v32
    v_mfma_f32_32x32x16_bf16 v[16:31], a[56:59], v[128:131], 0
    v_exp_f32 v33, v33
    v_exp_f32 v34, v34
    v_cvt_pk_bf16_f32 v56, v32, v33
    v_exp_f32 v35, v35
    v_exp_f32 v36, v36
    v_mfma_f32_32x32x16_bf16 v[80:95], a[192:195], v[48:51], v[80:95]
    v_cvt_pk_bf16_f32 v57, v34, v35
    v_exp_f32 v37, v37
    v_exp_f32 v38, v38
    v_cvt_pk_bf16_f32 v58, v36, v37
    v_exp_f32 v39, v39
    v_mfma_f32_32x32x8_bf16 v[16:31], a[92:93], v[132:133], v[16:31]
    v_exp_f32 v40, v40
    v_cvt_pk_bf16_f32 v59, v38, v39
    v_exp_f32 v41, v41
    v_exp_f32 v42, v42
    v_cvt_pk_bf16_f32 v60, v40, v41
    v_exp_f32 v43, v43
    v_mfma_f32_32x32x16_bf16 v[80:95], a[196:199], v[52:55], v[80:95]
    v_exp_f32 v44, v44
    v_cvt_pk_bf16_f32 v61, v42, v43
    v_exp_f32 v45, v45
    v_exp_f32 v46, v46
    v_exp_f32 v47, v47
    v_cvt_pk_bf16_f32 v62, v44, v45
    v_cvt_pk_bf16_f32 v63, v46, v47
    v_exp_f32 v16, v16
    v_mfma_f32_32x32x16_bf16 v[32:47], a[60:63], v[128:131], 0
    v_exp_f32 v17, v17
    v_exp_f32 v18, v18
    v_cvt_pk_bf16_f32 v48, v16, v17
    v_exp_f32 v19, v19
    v_exp_f32 v20, v20
    v_mfma_f32_32x32x16_bf16 v[80:95], a[200:203], v[56:59], v[80:95]
    v_cvt_pk_bf16_f32 v49, v18, v19
    v_exp_f32 v21, v21
    v_exp_f32 v22, v22
    v_cvt_pk_bf16_f32 v50, v20, v21
    v_exp_f32 v23, v23
    v_mfma_f32_32x32x8_bf16 v[32:47], a[94:95], v[132:133], v[32:47]
    v_exp_f32 v24, v24
    v_cvt_pk_bf16_f32 v51, v22, v23
    v_exp_f32 v25, v25
    v_exp_f32 v26, v26
    v_cvt_pk_bf16_f32 v52, v24, v25
    v_exp_f32 v27, v27
    v_mfma_f32_32x32x16_bf16 v[80:95], a[204:207], v[60:63], v[80:95]
    v_exp_f32 v28, v28
    v_cvt_pk_bf16_f32 v53, v26, v27
    v_exp_f32 v29, v29
    v_exp_f32 v30, v30
    v_exp_f32 v31, v31
    v_cvt_pk_bf16_f32 v54, v28, v29
    v_cvt_pk_bf16_f32 v55, v30, v31
    v_exp_f32 v32, v32
    v_mfma_f32_32x32x16_bf16 v[16:31], a[0:3], v[134:137], 0
    v_exp_f32 v33, v33
    v_exp_f32 v34, v34
    v_cvt_pk_bf16_f32 v56, v32, v33
    v_exp_f32 v35, v35
    v_exp_f32 v36, v36
    v_mfma_f32_32x32x16_bf16 v[80:95], a[208:211], v[48:51], v[80:95]
    v_cvt_pk_bf16_f32 v57, v34, v35
    v_exp_f32 v37, v37
    v_exp_f32 v38, v38
    v_cvt_pk_bf16_f32 v58, v36, v37
    v_exp_f32 v39, v39
    v_mfma_f32_32x32x8_bf16 v[16:31], a[64:65], v[138:139], v[16:31]
    v_exp_f32 v40, v40
    v_cvt_pk_bf16_f32 v59, v38, v39
    v_exp_f32 v41, v41
    v_exp_f32 v42, v42
    v_cvt_pk_bf16_f32 v60, v40, v41
    v_exp_f32 v43, v43
    v_mfma_f32_32x32x16_bf16 v[80:95], a[212:215], v[52:55], v[80:95]
    v_exp_f32 v44, v44
    v_cvt_pk_bf16_f32 v61, v42, v43
    v_exp_f32 v45, v45
    v_exp_f32 v46, v46
    v_exp_f32 v47, v47
    v_cvt_pk_bf16_f32 v62, v44, v45
    v_cvt_pk_bf16_f32 v63, v46, v47
    s_mul_i32 s61, s20, 655360
    v_exp_f32 v16, v16
    v_mfma_f32_32x32x16_bf16 v[32:47], a[4:7], v[134:137], 0
    v_exp_f32 v17, v17
    v_exp_f32 v18, v18
    v_cvt_pk_bf16_f32 v48, v16, v17
    v_exp_f32 v19, v19
    v_exp_f32 v20, v20
    v_mfma_f32_32x32x16_bf16 v[80:95], a[216:219], v[56:59], v[80:95]
    v_cvt_pk_bf16_f32 v49, v18, v19
    v_exp_f32 v21, v21
    v_exp_f32 v22, v22
    v_cvt_pk_bf16_f32 v50, v20, v21
    v_exp_f32 v23, v23
    v_mfma_f32_32x32x8_bf16 v[32:47], a[66:67], v[138:139], v[32:47]
    v_exp_f32 v24, v24
    v_cvt_pk_bf16_f32 v51, v22, v23
    v_exp_f32 v25, v25
    v_exp_f32 v26, v26
    v_cvt_pk_bf16_f32 v52, v24, v25
    v_exp_f32 v27, v27
    v_mfma_f32_32x32x16_bf16 v[80:95], a[220:223], v[60:63], v[80:95]
    v_exp_f32 v28, v28
    v_cvt_pk_bf16_f32 v53, v26, v27
    v_exp_f32 v29, v29
    v_exp_f32 v30, v30
    v_exp_f32 v31, v31
    v_cvt_pk_bf16_f32 v54, v28, v29
    v_cvt_pk_bf16_f32 v55, v30, v31
    v_exp_f32 v32, v32
    v_mfma_f32_32x32x16_bf16 v[16:31], a[8:11], v[134:137], 0
    v_exp_f32 v33, v33
    v_exp_f32 v34, v34
    v_cvt_pk_bf16_f32 v56, v32, v33
    v_exp_f32 v35, v35
    v_exp_f32 v36, v36
    v_mfma_f32_32x32x16_bf16 v[96:111], a[96:99], v[48:51], 0
    v_cvt_pk_bf16_f32 v57, v34, v35
    v_exp_f32 v37, v37
    v_exp_f32 v38, v38
    v_cvt_pk_bf16_f32 v58, v36, v37
    v_exp_f32 v39, v39
    v_mfma_f32_32x32x8_bf16 v[16:31], a[68:69], v[138:139], v[16:31]
    v_exp_f32 v40, v40
    v_cvt_pk_bf16_f32 v59, v38, v39
    v_exp_f32 v41, v41
    v_exp_f32 v42, v42
    v_cvt_pk_bf16_f32 v60, v40, v41
    v_exp_f32 v43, v43
    v_mfma_f32_32x32x16_bf16 v[96:111], a[100:103], v[52:55], v[96:111]
    v_exp_f32 v44, v44
    v_cvt_pk_bf16_f32 v61, v42, v43
    v_exp_f32 v45, v45
    v_exp_f32 v46, v46
    v_exp_f32 v47, v47
    v_cvt_pk_bf16_f32 v62, v44, v45
    v_cvt_pk_bf16_f32 v63, v46, v47
    v_exp_f32 v16, v16
    v_mfma_f32_32x32x16_bf16 v[32:47], a[12:15], v[134:137], 0
    v_exp_f32 v17, v17
    v_exp_f32 v18, v18
    v_cvt_pk_bf16_f32 v48, v16, v17
    v_exp_f32 v19, v19
    v_exp_f32 v20, v20
    v_mfma_f32_32x32x16_bf16 v[96:111], a[104:107], v[56:59], v[96:111]
    v_cvt_pk_bf16_f32 v49, v18, v19
    v_exp_f32 v21, v21
    v_exp_f32 v22, v22
    v_cvt_pk_bf16_f32 v50, v20, v21
    v_exp_f32 v23, v23
    v_mfma_f32_32x32x8_bf16 v[32:47], a[70:71], v[138:139], v[32:47]
    v_exp_f32 v24, v24
    v_cvt_pk_bf16_f32 v51, v22, v23
    v_exp_f32 v25, v25
    v_exp_f32 v26, v26
    v_cvt_pk_bf16_f32 v52, v24, v25
    v_exp_f32 v27, v27
    v_mfma_f32_32x32x16_bf16 v[96:111], a[108:111], v[60:63], v[96:111]
    v_exp_f32 v28, v28
    v_cvt_pk_bf16_f32 v53, v26, v27
    v_exp_f32 v29, v29
    v_exp_f32 v30, v30
    v_exp_f32 v31, v31
    v_cvt_pk_bf16_f32 v54, v28, v29
    v_cvt_pk_bf16_f32 v55, v30, v31
    v_exp_f32 v32, v32
    ds_write_b128 v238, v[80:83] offset:0
    v_mfma_f32_32x32x16_bf16 v[16:31], a[16:19], v[134:137], 0
    v_exp_f32 v33, v33
    v_exp_f32 v34, v34
    v_cvt_pk_bf16_f32 v56, v32, v33
    v_exp_f32 v35, v35
    v_exp_f32 v36, v36
    v_mfma_f32_32x32x16_bf16 v[96:111], a[112:115], v[48:51], v[96:111]
    v_cvt_pk_bf16_f32 v57, v34, v35
    v_exp_f32 v37, v37
    v_exp_f32 v38, v38
    v_cvt_pk_bf16_f32 v58, v36, v37
    v_exp_f32 v39, v39
    v_mfma_f32_32x32x8_bf16 v[16:31], a[72:73], v[138:139], v[16:31]
    v_exp_f32 v40, v40
    v_cvt_pk_bf16_f32 v59, v38, v39
    v_exp_f32 v41, v41
    v_exp_f32 v42, v42
    v_cvt_pk_bf16_f32 v60, v40, v41
    v_exp_f32 v43, v43
    v_mfma_f32_32x32x16_bf16 v[96:111], a[116:119], v[52:55], v[96:111]
    v_exp_f32 v44, v44
    v_cvt_pk_bf16_f32 v61, v42, v43
    v_exp_f32 v45, v45
    v_exp_f32 v46, v46
    v_exp_f32 v47, v47
    v_cvt_pk_bf16_f32 v62, v44, v45
    v_cvt_pk_bf16_f32 v63, v46, v47
    v_exp_f32 v16, v16
    ds_write_b128 v238, v[84:87] offset:1024
    v_mfma_f32_32x32x16_bf16 v[32:47], a[20:23], v[134:137], 0
    v_exp_f32 v17, v17
    v_exp_f32 v18, v18
    v_cvt_pk_bf16_f32 v48, v16, v17
    v_exp_f32 v19, v19
    v_exp_f32 v20, v20
    v_mfma_f32_32x32x16_bf16 v[96:111], a[120:123], v[56:59], v[96:111]
    v_cvt_pk_bf16_f32 v49, v18, v19
    v_exp_f32 v21, v21
    v_exp_f32 v22, v22
    v_cvt_pk_bf16_f32 v50, v20, v21
    v_exp_f32 v23, v23
    v_mfma_f32_32x32x8_bf16 v[32:47], a[74:75], v[138:139], v[32:47]
    v_exp_f32 v24, v24
    v_cvt_pk_bf16_f32 v51, v22, v23
    v_exp_f32 v25, v25
    v_exp_f32 v26, v26
    v_cvt_pk_bf16_f32 v52, v24, v25
    v_exp_f32 v27, v27
    v_mfma_f32_32x32x16_bf16 v[96:111], a[124:127], v[60:63], v[96:111]
    v_exp_f32 v28, v28
    v_cvt_pk_bf16_f32 v53, v26, v27
    v_exp_f32 v29, v29
    v_exp_f32 v30, v30
    v_exp_f32 v31, v31
    v_cvt_pk_bf16_f32 v54, v28, v29
    v_cvt_pk_bf16_f32 v55, v30, v31
    v_exp_f32 v32, v32
    s_add_u32 s63, s61, 0
    v_mfma_f32_32x32x16_bf16 v[16:31], a[24:27], v[134:137], 0
    v_exp_f32 v33, v33
    v_exp_f32 v34, v34
    v_cvt_pk_bf16_f32 v56, v32, v33
    v_exp_f32 v35, v35
    v_exp_f32 v36, v36
    v_mfma_f32_32x32x16_bf16 v[96:111], a[128:131], v[48:51], v[96:111]
    v_cvt_pk_bf16_f32 v57, v34, v35
    v_exp_f32 v37, v37
    v_exp_f32 v38, v38
    v_cvt_pk_bf16_f32 v58, v36, v37
    v_exp_f32 v39, v39
    v_mfma_f32_32x32x8_bf16 v[16:31], a[76:77], v[138:139], v[16:31]
    v_exp_f32 v40, v40
    buffer_load_dwordx2 v[176:177], v225, s[48:51], s63 offen
    v_cvt_pk_bf16_f32 v59, v38, v39
    v_exp_f32 v41, v41
    v_exp_f32 v42, v42
    v_cvt_pk_bf16_f32 v60, v40, v41
    v_exp_f32 v43, v43
    v_mfma_f32_32x32x16_bf16 v[96:111], a[132:135], v[52:55], v[96:111]
    v_exp_f32 v44, v44
    v_cvt_pk_bf16_f32 v61, v42, v43
    v_exp_f32 v45, v45
    v_exp_f32 v46, v46
    v_exp_f32 v47, v47
    v_cvt_pk_bf16_f32 v62, v44, v45
    v_cvt_pk_bf16_f32 v63, v46, v47
    v_exp_f32 v16, v16
    ds_write_b128 v238, v[88:91] offset:2048
    v_mfma_f32_32x32x16_bf16 v[32:47], a[28:31], v[134:137], 0
    v_exp_f32 v17, v17
    v_exp_f32 v18, v18
    v_cvt_pk_bf16_f32 v48, v16, v17
    v_exp_f32 v19, v19
    v_exp_f32 v20, v20
    v_mfma_f32_32x32x16_bf16 v[96:111], a[136:139], v[56:59], v[96:111]
    v_cvt_pk_bf16_f32 v49, v18, v19
    v_exp_f32 v21, v21
    v_exp_f32 v22, v22
    v_cvt_pk_bf16_f32 v50, v20, v21
    v_exp_f32 v23, v23
    v_mfma_f32_32x32x8_bf16 v[32:47], a[78:79], v[138:139], v[32:47]
    v_exp_f32 v24, v24
    v_cvt_pk_bf16_f32 v51, v22, v23
    v_exp_f32 v25, v25
    v_exp_f32 v26, v26
    v_cvt_pk_bf16_f32 v52, v24, v25
    v_exp_f32 v27, v27
    v_mfma_f32_32x32x16_bf16 v[96:111], a[140:143], v[60:63], v[96:111]
    v_exp_f32 v28, v28
    v_cvt_pk_bf16_f32 v53, v26, v27
    v_exp_f32 v29, v29
    v_exp_f32 v30, v30
    v_exp_f32 v31, v31
    v_cvt_pk_bf16_f32 v54, v28, v29
    v_cvt_pk_bf16_f32 v55, v30, v31
    v_exp_f32 v32, v32
    v_mfma_f32_32x32x16_bf16 v[16:31], a[32:35], v[134:137], 0
    v_exp_f32 v33, v33
    v_exp_f32 v34, v34
    v_cvt_pk_bf16_f32 v56, v32, v33
    v_exp_f32 v35, v35
    v_exp_f32 v36, v36
    v_mfma_f32_32x32x16_bf16 v[96:111], a[144:147], v[48:51], v[96:111]
    v_cvt_pk_bf16_f32 v57, v34, v35
    v_exp_f32 v37, v37
    v_exp_f32 v38, v38
    v_cvt_pk_bf16_f32 v58, v36, v37
    v_exp_f32 v39, v39
    v_mfma_f32_32x32x8_bf16 v[16:31], a[80:81], v[138:139], v[16:31]
    v_exp_f32 v40, v40
    v_cvt_pk_bf16_f32 v59, v38, v39
    v_exp_f32 v41, v41
    v_exp_f32 v42, v42
    v_cvt_pk_bf16_f32 v60, v40, v41
    v_exp_f32 v43, v43
    v_mfma_f32_32x32x16_bf16 v[96:111], a[148:151], v[52:55], v[96:111]
    v_exp_f32 v44, v44
    v_cvt_pk_bf16_f32 v61, v42, v43
    v_exp_f32 v45, v45
    v_exp_f32 v46, v46
    v_exp_f32 v47, v47
    v_cvt_pk_bf16_f32 v62, v44, v45
    v_cvt_pk_bf16_f32 v63, v46, v47
    v_exp_f32 v16, v16
    s_add_u32 s63, s61, 81920
    v_mfma_f32_32x32x16_bf16 v[32:47], a[36:39], v[134:137], 0
    v_exp_f32 v17, v17
    v_exp_f32 v18, v18
    v_cvt_pk_bf16_f32 v48, v16, v17
    v_exp_f32 v19, v19
    v_exp_f32 v20, v20
    v_mfma_f32_32x32x16_bf16 v[96:111], a[152:155], v[56:59], v[96:111]
    v_cvt_pk_bf16_f32 v49, v18, v19
    v_exp_f32 v21, v21
    v_exp_f32 v22, v22
    v_cvt_pk_bf16_f32 v50, v20, v21
    v_exp_f32 v23, v23
    v_mfma_f32_32x32x8_bf16 v[32:47], a[82:83], v[138:139], v[32:47]
    v_exp_f32 v24, v24
    buffer_load_dwordx2 v[178:179], v225, s[48:51], s63 offen
    v_cvt_pk_bf16_f32 v51, v22, v23
    v_exp_f32 v25, v25
    v_exp_f32 v26, v26
    v_cvt_pk_bf16_f32 v52, v24, v25
    v_exp_f32 v27, v27
    v_mfma_f32_32x32x16_bf16 v[96:111], a[156:159], v[60:63], v[96:111]
    v_exp_f32 v28, v28
    v_cvt_pk_bf16_f32 v53, v26, v27
    v_exp_f32 v29, v29
    v_exp_f32 v30, v30
    v_exp_f32 v31, v31
    v_cvt_pk_bf16_f32 v54, v28, v29
    v_cvt_pk_bf16_f32 v55, v30, v31
    v_exp_f32 v32, v32
    v_mfma_f32_32x32x16_bf16 v[16:31], a[40:43], v[134:137], 0
    v_exp_f32 v33, v33
    v_exp_f32 v34, v34
    v_cvt_pk_bf16_f32 v56, v32, v33
    v_exp_f32 v35, v35
    v_exp_f32 v36, v36
    v_mfma_f32_32x32x16_bf16 v[96:111], a[160:163], v[48:51], v[96:111]
    v_cvt_pk_bf16_f32 v57, v34, v35
    v_exp_f32 v37, v37
    v_exp_f32 v38, v38
    v_cvt_pk_bf16_f32 v58, v36, v37
    v_exp_f32 v39, v39
    v_mfma_f32_32x32x8_bf16 v[16:31], a[84:85], v[138:139], v[16:31]
    v_exp_f32 v40, v40
    v_cvt_pk_bf16_f32 v59, v38, v39
    v_exp_f32 v41, v41
    v_exp_f32 v42, v42
    v_cvt_pk_bf16_f32 v60, v40, v41
    v_exp_f32 v43, v43
    v_mfma_f32_32x32x16_bf16 v[96:111], a[164:167], v[52:55], v[96:111]
    v_exp_f32 v44, v44
    v_cvt_pk_bf16_f32 v61, v42, v43
    v_exp_f32 v45, v45
    v_exp_f32 v46, v46
    v_exp_f32 v47, v47
    v_cvt_pk_bf16_f32 v62, v44, v45
    v_cvt_pk_bf16_f32 v63, v46, v47
    v_exp_f32 v16, v16
    v_mfma_f32_32x32x16_bf16 v[32:47], a[44:47], v[134:137], 0
    v_exp_f32 v17, v17
    v_exp_f32 v18, v18
    v_cvt_pk_bf16_f32 v48, v16, v17
    v_exp_f32 v19, v19
    v_exp_f32 v20, v20
    v_mfma_f32_32x32x16_bf16 v[96:111], a[168:171], v[56:59], v[96:111]
    v_cvt_pk_bf16_f32 v49, v18, v19
    v_exp_f32 v21, v21
    v_exp_f32 v22, v22
    v_cvt_pk_bf16_f32 v50, v20, v21
    v_exp_f32 v23, v23
    v_mfma_f32_32x32x8_bf16 v[32:47], a[86:87], v[138:139], v[32:47]
    v_exp_f32 v24, v24
    v_cvt_pk_bf16_f32 v51, v22, v23
    v_exp_f32 v25, v25
    v_exp_f32 v26, v26
    v_cvt_pk_bf16_f32 v52, v24, v25
    v_exp_f32 v27, v27
    v_mfma_f32_32x32x16_bf16 v[96:111], a[172:175], v[60:63], v[96:111]
    v_exp_f32 v28, v28
    v_cvt_pk_bf16_f32 v53, v26, v27
    v_exp_f32 v29, v29
    v_exp_f32 v30, v30
    v_exp_f32 v31, v31
    v_cvt_pk_bf16_f32 v54, v28, v29
    v_cvt_pk_bf16_f32 v55, v30, v31
    v_exp_f32 v32, v32
    s_add_u32 s63, s61, 163840
    v_mfma_f32_32x32x16_bf16 v[16:31], a[48:51], v[134:137], 0
    v_exp_f32 v33, v33
    v_exp_f32 v34, v34
    v_cvt_pk_bf16_f32 v56, v32, v33
    v_exp_f32 v35, v35
    v_exp_f32 v36, v36
    v_mfma_f32_32x32x16_bf16 v[96:111], a[176:179], v[48:51], v[96:111]
    v_cvt_pk_bf16_f32 v57, v34, v35
    v_exp_f32 v37, v37
    v_exp_f32 v38, v38
    v_cvt_pk_bf16_f32 v58, v36, v37
    v_exp_f32 v39, v39
    v_mfma_f32_32x32x8_bf16 v[16:31], a[88:89], v[138:139], v[16:31]
    v_exp_f32 v40, v40
    buffer_load_dwordx2 v[180:181], v225, s[48:51], s63 offen
    v_cvt_pk_bf16_f32 v59, v38, v39
    v_exp_f32 v41, v41
    v_exp_f32 v42, v42
    v_cvt_pk_bf16_f32 v60, v40, v41
    v_exp_f32 v43, v43
    v_mfma_f32_32x32x16_bf16 v[96:111], a[180:183], v[52:55], v[96:111]
    v_exp_f32 v44, v44
    v_cvt_pk_bf16_f32 v61, v42, v43
    v_exp_f32 v45, v45
    v_exp_f32 v46, v46
    v_exp_f32 v47, v47
    v_cvt_pk_bf16_f32 v62, v44, v45
    v_cvt_pk_bf16_f32 v63, v46, v47
    v_exp_f32 v16, v16
    v_mfma_f32_32x32x16_bf16 v[32:47], a[52:55], v[134:137], 0
    v_exp_f32 v17, v17
    v_exp_f32 v18, v18
    v_cvt_pk_bf16_f32 v48, v16, v17
    v_exp_f32 v19, v19
    v_exp_f32 v20, v20
    v_mfma_f32_32x32x16_bf16 v[96:111], a[184:187], v[56:59], v[96:111]
    v_cvt_pk_bf16_f32 v49, v18, v19
    v_exp_f32 v21, v21
    v_exp_f32 v22, v22
    v_cvt_pk_bf16_f32 v50, v20, v21
    v_exp_f32 v23, v23
    v_mfma_f32_32x32x8_bf16 v[32:47], a[90:91], v[138:139], v[32:47]
    v_exp_f32 v24, v24
    v_cvt_pk_bf16_f32 v51, v22, v23
    v_exp_f32 v25, v25
    v_exp_f32 v26, v26
    v_cvt_pk_bf16_f32 v52, v24, v25
    v_exp_f32 v27, v27
    v_mfma_f32_32x32x16_bf16 v[96:111], a[188:191], v[60:63], v[96:111]
    v_exp_f32 v28, v28
    v_cvt_pk_bf16_f32 v53, v26, v27
    v_exp_f32 v29, v29
    v_exp_f32 v30, v30
    v_exp_f32 v31, v31
    v_cvt_pk_bf16_f32 v54, v28, v29
    v_cvt_pk_bf16_f32 v55, v30, v31
    v_exp_f32 v32, v32
    v_mfma_f32_32x32x16_bf16 v[16:31], a[56:59], v[134:137], 0
    v_exp_f32 v33, v33
    v_exp_f32 v34, v34
    v_cvt_pk_bf16_f32 v56, v32, v33
    v_exp_f32 v35, v35
    v_exp_f32 v36, v36
    v_mfma_f32_32x32x16_bf16 v[96:111], a[192:195], v[48:51], v[96:111]
    v_cvt_pk_bf16_f32 v57, v34, v35
    v_exp_f32 v37, v37
    v_exp_f32 v38, v38
    v_cvt_pk_bf16_f32 v58, v36, v37
    v_exp_f32 v39, v39
    v_mfma_f32_32x32x8_bf16 v[16:31], a[92:93], v[138:139], v[16:31]
    v_exp_f32 v40, v40
    v_cvt_pk_bf16_f32 v59, v38, v39
    v_exp_f32 v41, v41
    v_exp_f32 v42, v42
    v_cvt_pk_bf16_f32 v60, v40, v41
    v_exp_f32 v43, v43
    v_mfma_f32_32x32x16_bf16 v[96:111], a[196:199], v[52:55], v[96:111]
    v_exp_f32 v44, v44
    v_cvt_pk_bf16_f32 v61, v42, v43
    v_exp_f32 v45, v45
    v_exp_f32 v46, v46
    v_exp_f32 v47, v47
    v_cvt_pk_bf16_f32 v62, v44, v45
    v_cvt_pk_bf16_f32 v63, v46, v47
    v_exp_f32 v16, v16
    s_add_u32 s63, s61, 245760
    v_mfma_f32_32x32x16_bf16 v[32:47], a[60:63], v[134:137], 0
    v_exp_f32 v17, v17
    v_exp_f32 v18, v18
    v_cvt_pk_bf16_f32 v48, v16, v17
    v_exp_f32 v19, v19
    v_exp_f32 v20, v20
    v_mfma_f32_32x32x16_bf16 v[96:111], a[200:203], v[56:59], v[96:111]
    v_cvt_pk_bf16_f32 v49, v18, v19
    v_exp_f32 v21, v21
    v_exp_f32 v22, v22
    v_cvt_pk_bf16_f32 v50, v20, v21
    v_exp_f32 v23, v23
    v_mfma_f32_32x32x8_bf16 v[32:47], a[94:95], v[138:139], v[32:47]
    v_exp_f32 v24, v24
    buffer_load_dwordx2 v[182:183], v225, s[48:51], s63 offen
    v_cvt_pk_bf16_f32 v51, v22, v23
    v_exp_f32 v25, v25
    v_exp_f32 v26, v26
    v_cvt_pk_bf16_f32 v52, v24, v25
    v_exp_f32 v27, v27
    v_mfma_f32_32x32x16_bf16 v[96:111], a[204:207], v[60:63], v[96:111]
    v_exp_f32 v28, v28
    v_cvt_pk_bf16_f32 v53, v26, v27
    v_exp_f32 v29, v29
    v_exp_f32 v30, v30
    v_exp_f32 v31, v31
    v_cvt_pk_bf16_f32 v54, v28, v29
    v_cvt_pk_bf16_f32 v55, v30, v31
    v_exp_f32 v32, v32
    v_mfma_f32_32x32x16_bf16 v[16:31], a[0:3], v[140:143], 0
    v_exp_f32 v33, v33
    v_exp_f32 v34, v34
    v_cvt_pk_bf16_f32 v56, v32, v33
    v_exp_f32 v35, v35
    v_exp_f32 v36, v36
    v_mfma_f32_32x32x16_bf16 v[96:111], a[208:211], v[48:51], v[96:111]
    v_cvt_pk_bf16_f32 v57, v34, v35
    v_exp_f32 v37, v37
    v_exp_f32 v38, v38
    v_cvt_pk_bf16_f32 v58, v36, v37
    v_exp_f32 v39, v39
    v_mfma_f32_32x32x8_bf16 v[16:31], a[64:65], v[144:145], v[16:31]
    v_exp_f32 v40, v40
    v_cvt_pk_bf16_f32 v59, v38, v39
    v_exp_f32 v41, v41
    v_exp_f32 v42, v42
    v_cvt_pk_bf16_f32 v60, v40, v41
    v_exp_f32 v43, v43
    v_mfma_f32_32x32x16_bf16 v[96:111], a[212:215], v[52:55], v[96:111]
    v_exp_f32 v44, v44
    v_cvt_pk_bf16_f32 v61, v42, v43
    v_exp_f32 v45, v45
    v_exp_f32 v46, v46
    v_exp_f32 v47, v47
    v_cvt_pk_bf16_f32 v62, v44, v45
    v_cvt_pk_bf16_f32 v63, v46, v47
    v_exp_f32 v16, v16
    v_mfma_f32_32x32x16_bf16 v[32:47], a[4:7], v[140:143], 0
    v_exp_f32 v17, v17
    v_exp_f32 v18, v18
    v_cvt_pk_bf16_f32 v48, v16, v17
    v_exp_f32 v19, v19
    v_exp_f32 v20, v20
    v_mfma_f32_32x32x16_bf16 v[96:111], a[216:219], v[56:59], v[96:111]
    v_cvt_pk_bf16_f32 v49, v18, v19
    v_exp_f32 v21, v21
    v_exp_f32 v22, v22
    v_cvt_pk_bf16_f32 v50, v20, v21
    v_exp_f32 v23, v23
    v_mfma_f32_32x32x8_bf16 v[32:47], a[66:67], v[144:145], v[32:47]
    v_exp_f32 v24, v24
    v_cvt_pk_bf16_f32 v51, v22, v23
    v_exp_f32 v25, v25
    v_exp_f32 v26, v26
    v_cvt_pk_bf16_f32 v52, v24, v25
    v_exp_f32 v27, v27
    v_mfma_f32_32x32x16_bf16 v[96:111], a[220:223], v[60:63], v[96:111]
    v_exp_f32 v28, v28
    v_cvt_pk_bf16_f32 v53, v26, v27
    v_exp_f32 v29, v29
    v_exp_f32 v30, v30
    v_exp_f32 v31, v31
    v_cvt_pk_bf16_f32 v54, v28, v29
    v_cvt_pk_bf16_f32 v55, v30, v31
    v_exp_f32 v32, v32
    v_mfma_f32_32x32x16_bf16 v[16:31], a[8:11], v[140:143], 0
    v_exp_f32 v33, v33
    v_exp_f32 v34, v34
    v_cvt_pk_bf16_f32 v56, v32, v33
    v_exp_f32 v35, v35
    v_exp_f32 v36, v36
    v_mfma_f32_32x32x16_bf16 v[80:95], a[96:99], v[48:51], 0
    v_cvt_pk_bf16_f32 v57, v34, v35
    v_exp_f32 v37, v37
    v_exp_f32 v38, v38
    v_cvt_pk_bf16_f32 v58, v36, v37
    v_exp_f32 v39, v39
    v_mfma_f32_32x32x8_bf16 v[16:31], a[68:69], v[144:145], v[16:31]
    v_exp_f32 v40, v40
    v_cvt_pk_bf16_f32 v59, v38, v39
    v_exp_f32 v41, v41
    v_exp_f32 v42, v42
    v_cvt_pk_bf16_f32 v60, v40, v41
    v_exp_f32 v43, v43
    v_mfma_f32_32x32x16_bf16 v[80:95], a[100:103], v[52:55], v[80:95]
    v_exp_f32 v44, v44
    v_cvt_pk_bf16_f32 v61, v42, v43
    v_exp_f32 v45, v45
    v_exp_f32 v46, v46
    v_exp_f32 v47, v47
    v_cvt_pk_bf16_f32 v62, v44, v45
    v_cvt_pk_bf16_f32 v63, v46, v47
    v_exp_f32 v16, v16
    v_mfma_f32_32x32x16_bf16 v[32:47], a[12:15], v[140:143], 0
    v_exp_f32 v17, v17
    v_exp_f32 v18, v18
    v_cvt_pk_bf16_f32 v48, v16, v17
    v_exp_f32 v19, v19
    v_exp_f32 v20, v20
    v_mfma_f32_32x32x16_bf16 v[80:95], a[104:107], v[56:59], v[80:95]
    v_cvt_pk_bf16_f32 v49, v18, v19
    v_exp_f32 v21, v21
    v_exp_f32 v22, v22
    v_cvt_pk_bf16_f32 v50, v20, v21
    v_exp_f32 v23, v23
    v_mfma_f32_32x32x8_bf16 v[32:47], a[70:71], v[144:145], v[32:47]
    v_exp_f32 v24, v24
    v_cvt_pk_bf16_f32 v51, v22, v23
    v_exp_f32 v25, v25
    v_exp_f32 v26, v26
    v_cvt_pk_bf16_f32 v52, v24, v25
    v_exp_f32 v27, v27
    v_mfma_f32_32x32x16_bf16 v[80:95], a[108:111], v[60:63], v[80:95]
    v_exp_f32 v28, v28
    v_cvt_pk_bf16_f32 v53, v26, v27
    v_exp_f32 v29, v29
    v_exp_f32 v30, v30
    v_exp_f32 v31, v31
    v_cvt_pk_bf16_f32 v54, v28, v29
    v_cvt_pk_bf16_f32 v55, v30, v31
    v_exp_f32 v32, v32
    ds_write_b128 v239, v[96:99] offset:0
    v_mfma_f32_32x32x16_bf16 v[16:31], a[16:19], v[140:143], 0
    v_exp_f32 v33, v33
    v_exp_f32 v34, v34
    v_cvt_pk_bf16_f32 v56, v32, v33
    v_exp_f32 v35, v35
    v_exp_f32 v36, v36
    v_mfma_f32_32x32x16_bf16 v[80:95], a[112:115], v[48:51], v[80:95]
    v_cvt_pk_bf16_f32 v57, v34, v35
    v_exp_f32 v37, v37
    v_exp_f32 v38, v38
    v_cvt_pk_bf16_f32 v58, v36, v37
    v_exp_f32 v39, v39
    v_mfma_f32_32x32x8_bf16 v[16:31], a[72:73], v[144:145], v[16:31]
    v_exp_f32 v40, v40
    v_cvt_pk_bf16_f32 v59, v38, v39
    v_exp_f32 v41, v41
    v_exp_f32 v42, v42
    v_cvt_pk_bf16_f32 v60, v40, v41
    v_exp_f32 v43, v43
    v_mfma_f32_32x32x16_bf16 v[80:95], a[116:119], v[52:55], v[80:95]
    v_exp_f32 v44, v44
    v_cvt_pk_bf16_f32 v61, v42, v43
    v_exp_f32 v45, v45
    v_exp_f32 v46, v46
    v_exp_f32 v47, v47
    v_cvt_pk_bf16_f32 v62, v44, v45
    v_cvt_pk_bf16_f32 v63, v46, v47
    v_exp_f32 v16, v16
    ds_write_b128 v239, v[100:103] offset:1024
    v_mfma_f32_32x32x16_bf16 v[32:47], a[20:23], v[140:143], 0
    v_exp_f32 v17, v17
    v_exp_f32 v18, v18
    v_cvt_pk_bf16_f32 v48, v16, v17
    v_exp_f32 v19, v19
    v_exp_f32 v20, v20
    v_mfma_f32_32x32x16_bf16 v[80:95], a[120:123], v[56:59], v[80:95]
    v_cvt_pk_bf16_f32 v49, v18, v19
    v_exp_f32 v21, v21
    v_exp_f32 v22, v22
    v_cvt_pk_bf16_f32 v50, v20, v21
    v_exp_f32 v23, v23
    v_mfma_f32_32x32x8_bf16 v[32:47], a[74:75], v[144:145], v[32:47]
    v_exp_f32 v24, v24
    v_cvt_pk_bf16_f32 v51, v22, v23
    v_exp_f32 v25, v25
    v_exp_f32 v26, v26
    v_cvt_pk_bf16_f32 v52, v24, v25
    v_exp_f32 v27, v27
    v_mfma_f32_32x32x16_bf16 v[80:95], a[124:127], v[60:63], v[80:95]
    v_exp_f32 v28, v28
    v_cvt_pk_bf16_f32 v53, v26, v27
    v_exp_f32 v29, v29
    v_exp_f32 v30, v30
    v_exp_f32 v31, v31
    v_cvt_pk_bf16_f32 v54, v28, v29
    v_cvt_pk_bf16_f32 v55, v30, v31
    v_exp_f32 v32, v32
    s_add_u32 s63, s61, 327680
    v_mfma_f32_32x32x16_bf16 v[16:31], a[24:27], v[140:143], 0
    v_exp_f32 v33, v33
    v_exp_f32 v34, v34
    v_cvt_pk_bf16_f32 v56, v32, v33
    v_exp_f32 v35, v35
    v_exp_f32 v36, v36
    v_mfma_f32_32x32x16_bf16 v[80:95], a[128:131], v[48:51], v[80:95]
    v_cvt_pk_bf16_f32 v57, v34, v35
    v_exp_f32 v37, v37
    v_exp_f32 v38, v38
    v_cvt_pk_bf16_f32 v58, v36, v37
    v_exp_f32 v39, v39
    v_mfma_f32_32x32x8_bf16 v[16:31], a[76:77], v[144:145], v[16:31]
    v_exp_f32 v40, v40
    buffer_load_dwordx2 v[184:185], v225, s[48:51], s63 offen
    v_cvt_pk_bf16_f32 v59, v38, v39
    v_exp_f32 v41, v41
    v_exp_f32 v42, v42
    v_cvt_pk_bf16_f32 v60, v40, v41
    v_exp_f32 v43, v43
    v_mfma_f32_32x32x16_bf16 v[80:95], a[132:135], v[52:55], v[80:95]
    v_exp_f32 v44, v44
    v_cvt_pk_bf16_f32 v61, v42, v43
    v_exp_f32 v45, v45
    v_exp_f32 v46, v46
    v_exp_f32 v47, v47
    v_cvt_pk_bf16_f32 v62, v44, v45
    v_cvt_pk_bf16_f32 v63, v46, v47
    v_exp_f32 v16, v16
    ds_write_b128 v239, v[104:107] offset:2048
    v_mfma_f32_32x32x16_bf16 v[32:47], a[28:31], v[140:143], 0
    v_exp_f32 v17, v17
    v_exp_f32 v18, v18
    v_cvt_pk_bf16_f32 v48, v16, v17
    v_exp_f32 v19, v19
    v_exp_f32 v20, v20
    v_mfma_f32_32x32x16_bf16 v[80:95], a[136:139], v[56:59], v[80:95]
    v_cvt_pk_bf16_f32 v49, v18, v19
    v_exp_f32 v21, v21
    v_exp_f32 v22, v22
    v_cvt_pk_bf16_f32 v50, v20, v21
    v_exp_f32 v23, v23
    v_mfma_f32_32x32x8_bf16 v[32:47], a[78:79], v[144:145], v[32:47]
    v_exp_f32 v24, v24
    v_cvt_pk_bf16_f32 v51, v22, v23
    v_exp_f32 v25, v25
    v_exp_f32 v26, v26
    v_cvt_pk_bf16_f32 v52, v24, v25
    v_exp_f32 v27, v27
    v_mfma_f32_32x32x16_bf16 v[80:95], a[140:143], v[60:63], v[80:95]
    v_exp_f32 v28, v28
    v_cvt_pk_bf16_f32 v53, v26, v27
    v_exp_f32 v29, v29
    v_exp_f32 v30, v30
    v_exp_f32 v31, v31
    v_cvt_pk_bf16_f32 v54, v28, v29
    v_cvt_pk_bf16_f32 v55, v30, v31
    v_exp_f32 v32, v32
    v_mfma_f32_32x32x16_bf16 v[16:31], a[32:35], v[140:143], 0
    v_exp_f32 v33, v33
    v_exp_f32 v34, v34
    v_cvt_pk_bf16_f32 v56, v32, v33
    v_exp_f32 v35, v35
    v_exp_f32 v36, v36
    v_mfma_f32_32x32x16_bf16 v[80:95], a[144:147], v[48:51], v[80:95]
    v_cvt_pk_bf16_f32 v57, v34, v35
    v_exp_f32 v37, v37
    v_exp_f32 v38, v38
    v_cvt_pk_bf16_f32 v58, v36, v37
    v_exp_f32 v39, v39
    v_mfma_f32_32x32x8_bf16 v[16:31], a[80:81], v[144:145], v[16:31]
    v_exp_f32 v40, v40
    v_cvt_pk_bf16_f32 v59, v38, v39
    v_exp_f32 v41, v41
    v_exp_f32 v42, v42
    v_cvt_pk_bf16_f32 v60, v40, v41
    v_exp_f32 v43, v43
    v_mfma_f32_32x32x16_bf16 v[80:95], a[148:151], v[52:55], v[80:95]
    v_exp_f32 v44, v44
    v_cvt_pk_bf16_f32 v61, v42, v43
    v_exp_f32 v45, v45
    v_exp_f32 v46, v46
    v_exp_f32 v47, v47
    v_cvt_pk_bf16_f32 v62, v44, v45
    v_cvt_pk_bf16_f32 v63, v46, v47
    v_exp_f32 v16, v16
    s_add_u32 s63, s61, 409600
    v_mfma_f32_32x32x16_bf16 v[32:47], a[36:39], v[140:143], 0
    v_exp_f32 v17, v17
    v_exp_f32 v18, v18
    v_cvt_pk_bf16_f32 v48, v16, v17
    v_exp_f32 v19, v19
    v_exp_f32 v20, v20
    v_mfma_f32_32x32x16_bf16 v[80:95], a[152:155], v[56:59], v[80:95]
    v_cvt_pk_bf16_f32 v49, v18, v19
    v_exp_f32 v21, v21
    v_exp_f32 v22, v22
    v_cvt_pk_bf16_f32 v50, v20, v21
    v_exp_f32 v23, v23
    v_mfma_f32_32x32x8_bf16 v[32:47], a[82:83], v[144:145], v[32:47]
    v_exp_f32 v24, v24
    buffer_load_dwordx2 v[186:187], v225, s[48:51], s63 offen
    v_cvt_pk_bf16_f32 v51, v22, v23
    v_exp_f32 v25, v25
    v_exp_f32 v26, v26
    v_cvt_pk_bf16_f32 v52, v24, v25
    v_exp_f32 v27, v27
    v_mfma_f32_32x32x16_bf16 v[80:95], a[156:159], v[60:63], v[80:95]
    v_exp_f32 v28, v28
    v_cvt_pk_bf16_f32 v53, v26, v27
    v_exp_f32 v29, v29
    v_exp_f32 v30, v30
    v_exp_f32 v31, v31
    v_cvt_pk_bf16_f32 v54, v28, v29
    v_cvt_pk_bf16_f32 v55, v30, v31
    v_exp_f32 v32, v32
    v_mfma_f32_32x32x16_bf16 v[16:31], a[40:43], v[140:143], 0
    v_exp_f32 v33, v33
    v_exp_f32 v34, v34
    v_cvt_pk_bf16_f32 v56, v32, v33
    v_exp_f32 v35, v35
    v_exp_f32 v36, v36
    v_mfma_f32_32x32x16_bf16 v[80:95], a[160:163], v[48:51], v[80:95]
    v_cvt_pk_bf16_f32 v57, v34, v35
    v_exp_f32 v37, v37
    v_exp_f32 v38, v38
    v_cvt_pk_bf16_f32 v58, v36, v37
    v_exp_f32 v39, v39
    v_mfma_f32_32x32x8_bf16 v[16:31], a[84:85], v[144:145], v[16:31]
    v_exp_f32 v40, v40
    v_cvt_pk_bf16_f32 v59, v38, v39
    v_exp_f32 v41, v41
    v_exp_f32 v42, v42
    v_cvt_pk_bf16_f32 v60, v40, v41
    v_exp_f32 v43, v43
    v_mfma_f32_32x32x16_bf16 v[80:95], a[164:167], v[52:55], v[80:95]
    v_exp_f32 v44, v44
    v_cvt_pk_bf16_f32 v61, v42, v43
    v_exp_f32 v45, v45
    v_exp_f32 v46, v46
    v_exp_f32 v47, v47
    v_cvt_pk_bf16_f32 v62, v44, v45
    v_cvt_pk_bf16_f32 v63, v46, v47
    v_exp_f32 v16, v16
    v_mfma_f32_32x32x16_bf16 v[32:47], a[44:47], v[140:143], 0
    v_exp_f32 v17, v17
    v_exp_f32 v18, v18
    v_cvt_pk_bf16_f32 v48, v16, v17
    v_exp_f32 v19, v19
    v_exp_f32 v20, v20
    v_mfma_f32_32x32x16_bf16 v[80:95], a[168:171], v[56:59], v[80:95]
    v_cvt_pk_bf16_f32 v49, v18, v19
    v_exp_f32 v21, v21
    v_exp_f32 v22, v22
    v_cvt_pk_bf16_f32 v50, v20, v21
    v_exp_f32 v23, v23
    v_mfma_f32_32x32x8_bf16 v[32:47], a[86:87], v[144:145], v[32:47]
    v_exp_f32 v24, v24
    v_cvt_pk_bf16_f32 v51, v22, v23
    v_exp_f32 v25, v25
    v_exp_f32 v26, v26
    v_cvt_pk_bf16_f32 v52, v24, v25
    v_exp_f32 v27, v27
    v_mfma_f32_32x32x16_bf16 v[80:95], a[172:175], v[60:63], v[80:95]
    v_exp_f32 v28, v28
    v_cvt_pk_bf16_f32 v53, v26, v27
    v_exp_f32 v29, v29
    v_exp_f32 v30, v30
    v_exp_f32 v31, v31
    v_cvt_pk_bf16_f32 v54, v28, v29
    v_cvt_pk_bf16_f32 v55, v30, v31
    v_exp_f32 v32, v32
    s_add_u32 s63, s61, 491520
    v_mfma_f32_32x32x16_bf16 v[16:31], a[48:51], v[140:143], 0
    v_exp_f32 v33, v33
    v_exp_f32 v34, v34
    v_cvt_pk_bf16_f32 v56, v32, v33
    v_exp_f32 v35, v35
    v_exp_f32 v36, v36
    v_mfma_f32_32x32x16_bf16 v[80:95], a[176:179], v[48:51], v[80:95]
    v_cvt_pk_bf16_f32 v57, v34, v35
    v_exp_f32 v37, v37
    v_exp_f32 v38, v38
    v_cvt_pk_bf16_f32 v58, v36, v37
    v_exp_f32 v39, v39
    v_mfma_f32_32x32x8_bf16 v[16:31], a[88:89], v[144:145], v[16:31]
    v_exp_f32 v40, v40
    buffer_load_dwordx2 v[188:189], v225, s[48:51], s63 offen
    v_cvt_pk_bf16_f32 v59, v38, v39
    v_exp_f32 v41, v41
    v_exp_f32 v42, v42
    v_cvt_pk_bf16_f32 v60, v40, v41
    v_exp_f32 v43, v43
    v_mfma_f32_32x32x16_bf16 v[80:95], a[180:183], v[52:55], v[80:95]
    v_exp_f32 v44, v44
    v_cvt_pk_bf16_f32 v61, v42, v43
    v_exp_f32 v45, v45
    v_exp_f32 v46, v46
    v_exp_f32 v47, v47
    v_cvt_pk_bf16_f32 v62, v44, v45
    v_cvt_pk_bf16_f32 v63, v46, v47
    v_exp_f32 v16, v16
    v_mfma_f32_32x32x16_bf16 v[32:47], a[52:55], v[140:143], 0
    v_exp_f32 v17, v17
    v_exp_f32 v18, v18
    v_cvt_pk_bf16_f32 v48, v16, v17
    v_exp_f32 v19, v19
    v_exp_f32 v20, v20
    v_mfma_f32_32x32x16_bf16 v[80:95], a[184:187], v[56:59], v[80:95]
    v_cvt_pk_bf16_f32 v49, v18, v19
    v_exp_f32 v21, v21
    v_exp_f32 v22, v22
    v_cvt_pk_bf16_f32 v50, v20, v21
    v_exp_f32 v23, v23
    v_mfma_f32_32x32x8_bf16 v[32:47], a[90:91], v[144:145], v[32:47]
    v_exp_f32 v24, v24
    v_cvt_pk_bf16_f32 v51, v22, v23
    v_exp_f32 v25, v25
    v_exp_f32 v26, v26
    v_cvt_pk_bf16_f32 v52, v24, v25
    v_exp_f32 v27, v27
    v_mfma_f32_32x32x16_bf16 v[80:95], a[188:191], v[60:63], v[80:95]
    v_exp_f32 v28, v28
    v_cvt_pk_bf16_f32 v53, v26, v27
    v_exp_f32 v29, v29
    v_exp_f32 v30, v30
    v_exp_f32 v31, v31
    v_cvt_pk_bf16_f32 v54, v28, v29
    v_cvt_pk_bf16_f32 v55, v30, v31
    v_exp_f32 v32, v32
    v_mfma_f32_32x32x16_bf16 v[16:31], a[56:59], v[140:143], 0
    v_exp_f32 v33, v33
    v_exp_f32 v34, v34
    v_cvt_pk_bf16_f32 v56, v32, v33
    v_exp_f32 v35, v35
    v_exp_f32 v36, v36
    v_mfma_f32_32x32x16_bf16 v[80:95], a[192:195], v[48:51], v[80:95]
    v_cvt_pk_bf16_f32 v57, v34, v35
    v_exp_f32 v37, v37
    v_exp_f32 v38, v38
    v_cvt_pk_bf16_f32 v58, v36, v37
    v_exp_f32 v39, v39
    v_mfma_f32_32x32x8_bf16 v[16:31], a[92:93], v[144:145], v[16:31]
    v_exp_f32 v40, v40
    v_cvt_pk_bf16_f32 v59, v38, v39
    v_exp_f32 v41, v41
    v_exp_f32 v42, v42
    v_cvt_pk_bf16_f32 v60, v40, v41
    v_exp_f32 v43, v43
    v_mfma_f32_32x32x16_bf16 v[80:95], a[196:199], v[52:55], v[80:95]
    v_exp_f32 v44, v44
    v_cvt_pk_bf16_f32 v61, v42, v43
    v_exp_f32 v45, v45
    v_exp_f32 v46, v46
    v_exp_f32 v47, v47
    v_cvt_pk_bf16_f32 v62, v44, v45
    v_cvt_pk_bf16_f32 v63, v46, v47
    v_exp_f32 v16, v16
    s_add_u32 s63, s61, 573440
    v_mfma_f32_32x32x16_bf16 v[32:47], a[60:63], v[140:143], 0
    v_exp_f32 v17, v17
    v_exp_f32 v18, v18
    v_cvt_pk_bf16_f32 v48, v16, v17
    v_exp_f32 v19, v19
    v_exp_f32 v20, v20
    v_mfma_f32_32x32x16_bf16 v[80:95], a[200:203], v[56:59], v[80:95]
    v_cvt_pk_bf16_f32 v49, v18, v19
    v_exp_f32 v21, v21
    v_exp_f32 v22, v22
    v_cvt_pk_bf16_f32 v50, v20, v21
    v_exp_f32 v23, v23
    v_mfma_f32_32x32x8_bf16 v[32:47], a[94:95], v[144:145], v[32:47]
    v_exp_f32 v24, v24
    buffer_load_dwordx2 v[190:191], v225, s[48:51], s63 offen
    v_cvt_pk_bf16_f32 v51, v22, v23
    v_exp_f32 v25, v25
    v_exp_f32 v26, v26
    v_cvt_pk_bf16_f32 v52, v24, v25
    v_exp_f32 v27, v27
    v_mfma_f32_32x32x16_bf16 v[80:95], a[204:207], v[60:63], v[80:95]
    v_exp_f32 v28, v28
    v_cvt_pk_bf16_f32 v53, v26, v27
    v_exp_f32 v29, v29
    v_exp_f32 v30, v30
    v_exp_f32 v31, v31
    v_cvt_pk_bf16_f32 v54, v28, v29
    v_cvt_pk_bf16_f32 v55, v30, v31
    v_exp_f32 v32, v32
    v_mfma_f32_32x32x16_bf16 v[16:31], a[0:3], v[146:149], 0
    v_exp_f32 v33, v33
    v_exp_f32 v34, v34
    v_cvt_pk_bf16_f32 v56, v32, v33
    v_exp_f32 v35, v35
    v_exp_f32 v36, v36
    v_mfma_f32_32x32x16_bf16 v[80:95], a[208:211], v[48:51], v[80:95]
    v_cvt_pk_bf16_f32 v57, v34, v35
    v_exp_f32 v37, v37
    v_exp_f32 v38, v38
    v_cvt_pk_bf16_f32 v58, v36, v37
    v_exp_f32 v39, v39
    v_mfma_f32_32x32x8_bf16 v[16:31], a[64:65], v[150:151], v[16:31]
    v_exp_f32 v40, v40
    v_cvt_pk_bf16_f32 v59, v38, v39
    v_exp_f32 v41, v41
    v_exp_f32 v42, v42
    v_cvt_pk_bf16_f32 v60, v40, v41
    v_exp_f32 v43, v43
    v_mfma_f32_32x32x16_bf16 v[80:95], a[212:215], v[52:55], v[80:95]
    v_exp_f32 v44, v44
    v_cvt_pk_bf16_f32 v61, v42, v43
    v_exp_f32 v45, v45
    v_exp_f32 v46, v46
    v_exp_f32 v47, v47
    v_cvt_pk_bf16_f32 v62, v44, v45
    v_cvt_pk_bf16_f32 v63, v46, v47
    v_exp_f32 v16, v16
    v_mfma_f32_32x32x16_bf16 v[32:47], a[4:7], v[146:149], 0
    v_exp_f32 v17, v17
    v_exp_f32 v18, v18
    v_cvt_pk_bf16_f32 v48, v16, v17
    v_exp_f32 v19, v19
    v_exp_f32 v20, v20
    v_mfma_f32_32x32x16_bf16 v[80:95], a[216:219], v[56:59], v[80:95]
    v_cvt_pk_bf16_f32 v49, v18, v19
    v_exp_f32 v21, v21
    v_exp_f32 v22, v22
    v_cvt_pk_bf16_f32 v50, v20, v21
    v_exp_f32 v23, v23
    v_mfma_f32_32x32x8_bf16 v[32:47], a[66:67], v[150:151], v[32:47]
    v_exp_f32 v24, v24
    v_cvt_pk_bf16_f32 v51, v22, v23
    v_exp_f32 v25, v25
    v_exp_f32 v26, v26
    v_cvt_pk_bf16_f32 v52, v24, v25
    v_exp_f32 v27, v27
    v_mfma_f32_32x32x16_bf16 v[80:95], a[220:223], v[60:63], v[80:95]
    v_exp_f32 v28, v28
    v_cvt_pk_bf16_f32 v53, v26, v27
    v_exp_f32 v29, v29
    v_exp_f32 v30, v30
    v_exp_f32 v31, v31
    v_cvt_pk_bf16_f32 v54, v28, v29
    v_cvt_pk_bf16_f32 v55, v30, v31
    v_exp_f32 v32, v32
    v_mfma_f32_32x32x16_bf16 v[16:31], a[8:11], v[146:149], 0
    v_exp_f32 v33, v33
    v_exp_f32 v34, v34
    v_cvt_pk_bf16_f32 v56, v32, v33
    v_exp_f32 v35, v35
    v_exp_f32 v36, v36
    v_mfma_f32_32x32x16_bf16 v[96:111], a[96:99], v[48:51], 0
    v_cvt_pk_bf16_f32 v57, v34, v35
    v_exp_f32 v37, v37
    v_exp_f32 v38, v38
    v_cvt_pk_bf16_f32 v58, v36, v37
    v_exp_f32 v39, v39
    v_mfma_f32_32x32x8_bf16 v[16:31], a[68:69], v[150:151], v[16:31]
    v_exp_f32 v40, v40
    v_cvt_pk_bf16_f32 v59, v38, v39
    v_exp_f32 v41, v41
    v_exp_f32 v42, v42
    v_cvt_pk_bf16_f32 v60, v40, v41
    v_exp_f32 v43, v43
    v_mfma_f32_32x32x16_bf16 v[96:111], a[100:103], v[52:55], v[96:111]
    v_exp_f32 v44, v44
    v_cvt_pk_bf16_f32 v61, v42, v43
    v_exp_f32 v45, v45
    v_exp_f32 v46, v46
    v_exp_f32 v47, v47
    v_cvt_pk_bf16_f32 v62, v44, v45
    v_cvt_pk_bf16_f32 v63, v46, v47
    v_exp_f32 v16, v16
    v_mfma_f32_32x32x16_bf16 v[32:47], a[12:15], v[146:149], 0
    v_exp_f32 v17, v17
    v_exp_f32 v18, v18
    v_cvt_pk_bf16_f32 v48, v16, v17
    v_exp_f32 v19, v19
    v_exp_f32 v20, v20
    v_mfma_f32_32x32x16_bf16 v[96:111], a[104:107], v[56:59], v[96:111]
    v_cvt_pk_bf16_f32 v49, v18, v19
    v_exp_f32 v21, v21
    v_exp_f32 v22, v22
    v_cvt_pk_bf16_f32 v50, v20, v21
    v_exp_f32 v23, v23
    v_mfma_f32_32x32x8_bf16 v[32:47], a[70:71], v[150:151], v[32:47]
    v_exp_f32 v24, v24
    v_cvt_pk_bf16_f32 v51, v22, v23
    v_exp_f32 v25, v25
    v_exp_f32 v26, v26
    v_cvt_pk_bf16_f32 v52, v24, v25
    v_exp_f32 v27, v27
    v_mfma_f32_32x32x16_bf16 v[96:111], a[108:111], v[60:63], v[96:111]
    v_exp_f32 v28, v28
    v_cvt_pk_bf16_f32 v53, v26, v27
    v_exp_f32 v29, v29
    v_exp_f32 v30, v30
    v_exp_f32 v31, v31
    v_cvt_pk_bf16_f32 v54, v28, v29
    v_cvt_pk_bf16_f32 v55, v30, v31
    v_exp_f32 v32, v32
    ds_write_b128 v240, v[80:83] offset:0
    v_mfma_f32_32x32x16_bf16 v[16:31], a[16:19], v[146:149], 0
    v_exp_f32 v33, v33
    v_exp_f32 v34, v34
    v_cvt_pk_bf16_f32 v56, v32, v33
    v_exp_f32 v35, v35
    v_exp_f32 v36, v36
    v_mfma_f32_32x32x16_bf16 v[96:111], a[112:115], v[48:51], v[96:111]
    v_cvt_pk_bf16_f32 v57, v34, v35
    v_exp_f32 v37, v37
    v_exp_f32 v38, v38
    v_cvt_pk_bf16_f32 v58, v36, v37
    v_exp_f32 v39, v39
    v_mfma_f32_32x32x8_bf16 v[16:31], a[72:73], v[150:151], v[16:31]
    v_exp_f32 v40, v40
    v_cvt_pk_bf16_f32 v59, v38, v39
    v_exp_f32 v41, v41
    v_exp_f32 v42, v42
    v_cvt_pk_bf16_f32 v60, v40, v41
    v_exp_f32 v43, v43
    v_mfma_f32_32x32x16_bf16 v[96:111], a[116:119], v[52:55], v[96:111]
    v_exp_f32 v44, v44
    v_cvt_pk_bf16_f32 v61, v42, v43
    v_exp_f32 v45, v45
    v_exp_f32 v46, v46
    v_exp_f32 v47, v47
    v_cvt_pk_bf16_f32 v62, v44, v45
    v_cvt_pk_bf16_f32 v63, v46, v47
    v_exp_f32 v16, v16
    ds_write_b128 v240, v[84:87] offset:1024
    v_mfma_f32_32x32x16_bf16 v[32:47], a[20:23], v[146:149], 0
    v_exp_f32 v17, v17
    v_exp_f32 v18, v18
    v_cvt_pk_bf16_f32 v48, v16, v17
    v_exp_f32 v19, v19
    v_exp_f32 v20, v20
    v_mfma_f32_32x32x16_bf16 v[96:111], a[120:123], v[56:59], v[96:111]
    v_cvt_pk_bf16_f32 v49, v18, v19
    v_exp_f32 v21, v21
    v_exp_f32 v22, v22
    v_cvt_pk_bf16_f32 v50, v20, v21
    v_exp_f32 v23, v23
    v_mfma_f32_32x32x8_bf16 v[32:47], a[74:75], v[150:151], v[32:47]
    v_exp_f32 v24, v24
    v_cvt_pk_bf16_f32 v51, v22, v23
    v_exp_f32 v25, v25
    v_exp_f32 v26, v26
    v_cvt_pk_bf16_f32 v52, v24, v25
    v_exp_f32 v27, v27
    v_mfma_f32_32x32x16_bf16 v[96:111], a[124:127], v[60:63], v[96:111]
    v_exp_f32 v28, v28
    v_cvt_pk_bf16_f32 v53, v26, v27
    v_exp_f32 v29, v29
    v_exp_f32 v30, v30
    v_exp_f32 v31, v31
    v_cvt_pk_bf16_f32 v54, v28, v29
    v_cvt_pk_bf16_f32 v55, v30, v31
    v_exp_f32 v32, v32
    v_mfma_f32_32x32x16_bf16 v[16:31], a[24:27], v[146:149], 0
    v_exp_f32 v33, v33
    v_exp_f32 v34, v34
    v_cvt_pk_bf16_f32 v56, v32, v33
    v_exp_f32 v35, v35
    v_exp_f32 v36, v36
    v_mfma_f32_32x32x16_bf16 v[96:111], a[128:131], v[48:51], v[96:111]
    v_cvt_pk_bf16_f32 v57, v34, v35
    v_exp_f32 v37, v37
    v_exp_f32 v38, v38
    v_cvt_pk_bf16_f32 v58, v36, v37
    v_exp_f32 v39, v39
    v_mfma_f32_32x32x8_bf16 v[16:31], a[76:77], v[150:151], v[16:31]
    v_exp_f32 v40, v40
    v_cvt_pk_bf16_f32 v59, v38, v39
    v_exp_f32 v41, v41
    v_exp_f32 v42, v42
    v_cvt_pk_bf16_f32 v60, v40, v41
    v_exp_f32 v43, v43
    v_mfma_f32_32x32x16_bf16 v[96:111], a[132:135], v[52:55], v[96:111]
    v_exp_f32 v44, v44
    v_cvt_pk_bf16_f32 v61, v42, v43
    v_exp_f32 v45, v45
    v_exp_f32 v46, v46
    v_exp_f32 v47, v47
    v_cvt_pk_bf16_f32 v62, v44, v45
    v_cvt_pk_bf16_f32 v63, v46, v47
    v_exp_f32 v16, v16
    ds_write_b128 v240, v[88:91] offset:2048
    v_mfma_f32_32x32x16_bf16 v[32:47], a[28:31], v[146:149], 0
    v_exp_f32 v17, v17
    v_exp_f32 v18, v18
    v_cvt_pk_bf16_f32 v48, v16, v17
    v_exp_f32 v19, v19
    v_exp_f32 v20, v20
    v_mfma_f32_32x32x16_bf16 v[96:111], a[136:139], v[56:59], v[96:111]
    v_cvt_pk_bf16_f32 v49, v18, v19
    v_exp_f32 v21, v21
    v_exp_f32 v22, v22
    v_cvt_pk_bf16_f32 v50, v20, v21
    v_exp_f32 v23, v23
    v_mfma_f32_32x32x8_bf16 v[32:47], a[78:79], v[150:151], v[32:47]
    v_exp_f32 v24, v24
    v_cvt_pk_bf16_f32 v51, v22, v23
    v_exp_f32 v25, v25
    v_exp_f32 v26, v26
    v_cvt_pk_bf16_f32 v52, v24, v25
    v_exp_f32 v27, v27
    v_mfma_f32_32x32x16_bf16 v[96:111], a[140:143], v[60:63], v[96:111]
    v_exp_f32 v28, v28
    v_cvt_pk_bf16_f32 v53, v26, v27
    v_exp_f32 v29, v29
    v_exp_f32 v30, v30
    v_exp_f32 v31, v31
    v_cvt_pk_bf16_f32 v54, v28, v29
    v_cvt_pk_bf16_f32 v55, v30, v31
    v_exp_f32 v32, v32
    v_mfma_f32_32x32x16_bf16 v[16:31], a[32:35], v[146:149], 0
    v_exp_f32 v33, v33
    v_exp_f32 v34, v34
    v_cvt_pk_bf16_f32 v56, v32, v33
    v_exp_f32 v35, v35
    v_exp_f32 v36, v36
    v_mfma_f32_32x32x16_bf16 v[96:111], a[144:147], v[48:51], v[96:111]
    v_cvt_pk_bf16_f32 v57, v34, v35
    v_exp_f32 v37, v37
    v_exp_f32 v38, v38
    v_cvt_pk_bf16_f32 v58, v36, v37
    v_exp_f32 v39, v39
    v_mfma_f32_32x32x8_bf16 v[16:31], a[80:81], v[150:151], v[16:31]
    v_exp_f32 v40, v40
    v_cvt_pk_bf16_f32 v59, v38, v39
    v_exp_f32 v41, v41
    v_exp_f32 v42, v42
    v_cvt_pk_bf16_f32 v60, v40, v41
    v_exp_f32 v43, v43
    v_mfma_f32_32x32x16_bf16 v[96:111], a[148:151], v[52:55], v[96:111]
    v_exp_f32 v44, v44
    v_cvt_pk_bf16_f32 v61, v42, v43
    v_exp_f32 v45, v45
    v_exp_f32 v46, v46
    v_exp_f32 v47, v47
    v_cvt_pk_bf16_f32 v62, v44, v45
    v_cvt_pk_bf16_f32 v63, v46, v47
    v_exp_f32 v16, v16
    v_mfma_f32_32x32x16_bf16 v[32:47], a[36:39], v[146:149], 0
    v_exp_f32 v17, v17
    v_exp_f32 v18, v18
    v_cvt_pk_bf16_f32 v48, v16, v17
    v_exp_f32 v19, v19
    v_exp_f32 v20, v20
    v_mfma_f32_32x32x16_bf16 v[96:111], a[152:155], v[56:59], v[96:111]
    v_cvt_pk_bf16_f32 v49, v18, v19
    v_exp_f32 v21, v21
    v_exp_f32 v22, v22
    v_cvt_pk_bf16_f32 v50, v20, v21
    v_exp_f32 v23, v23
    v_mfma_f32_32x32x8_bf16 v[32:47], a[82:83], v[150:151], v[32:47]
    v_exp_f32 v24, v24
    v_cvt_pk_bf16_f32 v51, v22, v23
    v_exp_f32 v25, v25
    v_exp_f32 v26, v26
    v_cvt_pk_bf16_f32 v52, v24, v25
    v_exp_f32 v27, v27
    v_mfma_f32_32x32x16_bf16 v[96:111], a[156:159], v[60:63], v[96:111]
    v_exp_f32 v28, v28
    v_cvt_pk_bf16_f32 v53, v26, v27
    v_exp_f32 v29, v29
    v_exp_f32 v30, v30
    v_exp_f32 v31, v31
    v_cvt_pk_bf16_f32 v54, v28, v29
    v_cvt_pk_bf16_f32 v55, v30, v31
    v_exp_f32 v32, v32
    v_mfma_f32_32x32x16_bf16 v[16:31], a[40:43], v[146:149], 0
    v_exp_f32 v33, v33
    v_exp_f32 v34, v34
    v_cvt_pk_bf16_f32 v56, v32, v33
    v_exp_f32 v35, v35
    v_exp_f32 v36, v36
    v_mfma_f32_32x32x16_bf16 v[96:111], a[160:163], v[48:51], v[96:111]
    v_cvt_pk_bf16_f32 v57, v34, v35
    v_exp_f32 v37, v37
    v_exp_f32 v38, v38
    v_cvt_pk_bf16_f32 v58, v36, v37
    v_exp_f32 v39, v39
    v_mfma_f32_32x32x8_bf16 v[16:31], a[84:85], v[150:151], v[16:31]
    v_exp_f32 v40, v40
    v_cvt_pk_bf16_f32 v59, v38, v39
    v_exp_f32 v41, v41
    v_exp_f32 v42, v42
    v_cvt_pk_bf16_f32 v60, v40, v41
    v_exp_f32 v43, v43
    v_mfma_f32_32x32x16_bf16 v[96:111], a[164:167], v[52:55], v[96:111]
    v_exp_f32 v44, v44
    v_cvt_pk_bf16_f32 v61, v42, v43
    v_exp_f32 v45, v45
    v_exp_f32 v46, v46
    v_exp_f32 v47, v47
    v_cvt_pk_bf16_f32 v62, v44, v45
    v_cvt_pk_bf16_f32 v63, v46, v47
    v_exp_f32 v16, v16
    v_mfma_f32_32x32x16_bf16 v[32:47], a[44:47], v[146:149], 0
    v_exp_f32 v17, v17
    v_exp_f32 v18, v18
    v_cvt_pk_bf16_f32 v48, v16, v17
    v_exp_f32 v19, v19
    v_exp_f32 v20, v20
    v_mfma_f32_32x32x16_bf16 v[96:111], a[168:171], v[56:59], v[96:111]
    v_cvt_pk_bf16_f32 v49, v18, v19
    v_exp_f32 v21, v21
    v_exp_f32 v22, v22
    v_cvt_pk_bf16_f32 v50, v20, v21
    v_exp_f32 v23, v23
    v_mfma_f32_32x32x8_bf16 v[32:47], a[86:87], v[150:151], v[32:47]
    v_exp_f32 v24, v24
    v_cvt_pk_bf16_f32 v51, v22, v23
    v_exp_f32 v25, v25
    v_exp_f32 v26, v26
    v_cvt_pk_bf16_f32 v52, v24, v25
    v_exp_f32 v27, v27
    v_mfma_f32_32x32x16_bf16 v[96:111], a[172:175], v[60:63], v[96:111]
    v_exp_f32 v28, v28
    v_cvt_pk_bf16_f32 v53, v26, v27
    v_exp_f32 v29, v29
    v_exp_f32 v30, v30
    v_exp_f32 v31, v31
    v_cvt_pk_bf16_f32 v54, v28, v29
    v_cvt_pk_bf16_f32 v55, v30, v31
    v_exp_f32 v32, v32
    v_mfma_f32_32x32x16_bf16 v[16:31], a[48:51], v[146:149], 0
    v_exp_f32 v33, v33
    v_exp_f32 v34, v34
    v_cvt_pk_bf16_f32 v56, v32, v33
    v_exp_f32 v35, v35
    v_exp_f32 v36, v36
    v_mfma_f32_32x32x16_bf16 v[96:111], a[176:179], v[48:51], v[96:111]
    v_cvt_pk_bf16_f32 v57, v34, v35
    v_exp_f32 v37, v37
    v_exp_f32 v38, v38
    v_cvt_pk_bf16_f32 v58, v36, v37
    v_exp_f32 v39, v39
    v_mfma_f32_32x32x8_bf16 v[16:31], a[88:89], v[150:151], v[16:31]
    v_exp_f32 v40, v40
    v_cvt_pk_bf16_f32 v59, v38, v39
    v_exp_f32 v41, v41
    v_exp_f32 v42, v42
    v_cvt_pk_bf16_f32 v60, v40, v41
    v_exp_f32 v43, v43
    v_mfma_f32_32x32x16_bf16 v[96:111], a[180:183], v[52:55], v[96:111]
    v_exp_f32 v44, v44
    v_cvt_pk_bf16_f32 v61, v42, v43
    v_exp_f32 v45, v45
    v_exp_f32 v46, v46
    v_exp_f32 v47, v47
    v_cvt_pk_bf16_f32 v62, v44, v45
    v_cvt_pk_bf16_f32 v63, v46, v47
    v_exp_f32 v16, v16
    v_mfma_f32_32x32x16_bf16 v[32:47], a[52:55], v[146:149], 0
    v_exp_f32 v17, v17
    v_exp_f32 v18, v18
    v_cvt_pk_bf16_f32 v48, v16, v17
    v_exp_f32 v19, v19
    v_exp_f32 v20, v20
    v_mfma_f32_32x32x16_bf16 v[96:111], a[184:187], v[56:59], v[96:111]
    v_cvt_pk_bf16_f32 v49, v18, v19
    v_exp_f32 v21, v21
    v_exp_f32 v22, v22
    v_cvt_pk_bf16_f32 v50, v20, v21
    v_exp_f32 v23, v23
    v_mfma_f32_32x32x8_bf16 v[32:47], a[90:91], v[150:151], v[32:47]
    v_exp_f32 v24, v24
    v_cvt_pk_bf16_f32 v51, v22, v23
    v_exp_f32 v25, v25
    v_exp_f32 v26, v26
    v_cvt_pk_bf16_f32 v52, v24, v25
    v_exp_f32 v27, v27
    v_mfma_f32_32x32x16_bf16 v[96:111], a[188:191], v[60:63], v[96:111]
    v_exp_f32 v28, v28
    v_cvt_pk_bf16_f32 v53, v26, v27
    v_exp_f32 v29, v29
    v_exp_f32 v30, v30
    v_exp_f32 v31, v31
    v_cvt_pk_bf16_f32 v54, v28, v29
    v_cvt_pk_bf16_f32 v55, v30, v31
    v_exp_f32 v32, v32
    v_mfma_f32_32x32x16_bf16 v[16:31], a[56:59], v[146:149], 0
    v_exp_f32 v33, v33
    v_exp_f32 v34, v34
    v_cvt_pk_bf16_f32 v56, v32, v33
    v_exp_f32 v35, v35
    v_exp_f32 v36, v36
    v_mfma_f32_32x32x16_bf16 v[96:111], a[192:195], v[48:51], v[96:111]
    v_cvt_pk_bf16_f32 v57, v34, v35
    v_exp_f32 v37, v37
    v_exp_f32 v38, v38
    v_cvt_pk_bf16_f32 v58, v36, v37
    v_exp_f32 v39, v39
    v_mfma_f32_32x32x8_bf16 v[16:31], a[92:93], v[150:151], v[16:31]
    v_exp_f32 v40, v40
    v_cvt_pk_bf16_f32 v59, v38, v39
    v_exp_f32 v41, v41
    v_exp_f32 v42, v42
    v_cvt_pk_bf16_f32 v60, v40, v41
    v_exp_f32 v43, v43
    v_mfma_f32_32x32x16_bf16 v[96:111], a[196:199], v[52:55], v[96:111]
    v_exp_f32 v44, v44
    v_cvt_pk_bf16_f32 v61, v42, v43
    v_exp_f32 v45, v45
    v_exp_f32 v46, v46
    v_exp_f32 v47, v47
    v_cvt_pk_bf16_f32 v62, v44, v45
    v_cvt_pk_bf16_f32 v63, v46, v47
    v_exp_f32 v16, v16
    v_mfma_f32_32x32x16_bf16 v[32:47], a[60:63], v[146:149], 0
    v_exp_f32 v17, v17
    v_exp_f32 v18, v18
    v_cvt_pk_bf16_f32 v48, v16, v17
    v_exp_f32 v19, v19
    v_exp_f32 v20, v20
    v_mfma_f32_32x32x16_bf16 v[96:111], a[200:203], v[56:59], v[96:111]
    v_cvt_pk_bf16_f32 v49, v18, v19
    v_exp_f32 v21, v21
    v_exp_f32 v22, v22
    v_cvt_pk_bf16_f32 v50, v20, v21
    v_exp_f32 v23, v23
    v_mfma_f32_32x32x8_bf16 v[32:47], a[94:95], v[150:151], v[32:47]
    v_exp_f32 v24, v24
    v_cvt_pk_bf16_f32 v51, v22, v23
    v_exp_f32 v25, v25
    v_exp_f32 v26, v26
    v_cvt_pk_bf16_f32 v52, v24, v25
    v_exp_f32 v27, v27
    v_mfma_f32_32x32x16_bf16 v[96:111], a[204:207], v[60:63], v[96:111]
    v_exp_f32 v28, v28
    v_cvt_pk_bf16_f32 v53, v26, v27
    v_exp_f32 v29, v29
    v_exp_f32 v30, v30
    v_exp_f32 v31, v31
    v_cvt_pk_bf16_f32 v54, v28, v29
    v_cvt_pk_bf16_f32 v55, v30, v31
    v_exp_f32 v32, v32
    v_mfma_f32_32x32x16_bf16 v[16:31], a[0:3], v[152:155], 0
    v_exp_f32 v33, v33
    v_exp_f32 v34, v34
    v_cvt_pk_bf16_f32 v56, v32, v33
    v_exp_f32 v35, v35
    v_exp_f32 v36, v36
    v_mfma_f32_32x32x16_bf16 v[96:111], a[208:211], v[48:51], v[96:111]
    v_cvt_pk_bf16_f32 v57, v34, v35
    v_exp_f32 v37, v37
    v_exp_f32 v38, v38
    v_cvt_pk_bf16_f32 v58, v36, v37
    v_exp_f32 v39, v39
    v_mfma_f32_32x32x8_bf16 v[16:31], a[64:65], v[156:157], v[16:31]
    v_exp_f32 v40, v40
    v_cvt_pk_bf16_f32 v59, v38, v39
    v_exp_f32 v41, v41
    v_exp_f32 v42, v42
    v_cvt_pk_bf16_f32 v60, v40, v41
    v_exp_f32 v43, v43
    v_mfma_f32_32x32x16_bf16 v[96:111], a[212:215], v[52:55], v[96:111]
    v_exp_f32 v44, v44
    v_cvt_pk_bf16_f32 v61, v42, v43
    v_exp_f32 v45, v45
    v_exp_f32 v46, v46
    v_exp_f32 v47, v47
    v_cvt_pk_bf16_f32 v62, v44, v45
    v_cvt_pk_bf16_f32 v63, v46, v47
    v_exp_f32 v16, v16
    v_mfma_f32_32x32x16_bf16 v[32:47], a[4:7], v[152:155], 0
    v_exp_f32 v17, v17
    v_exp_f32 v18, v18
    v_cvt_pk_bf16_f32 v48, v16, v17
    v_exp_f32 v19, v19
    v_exp_f32 v20, v20
    v_mfma_f32_32x32x16_bf16 v[96:111], a[216:219], v[56:59], v[96:111]
    v_cvt_pk_bf16_f32 v49, v18, v19
    v_exp_f32 v21, v21
    v_exp_f32 v22, v22
    v_cvt_pk_bf16_f32 v50, v20, v21
    v_exp_f32 v23, v23
    v_mfma_f32_32x32x8_bf16 v[32:47], a[66:67], v[156:157], v[32:47]
    v_exp_f32 v24, v24
    v_cvt_pk_bf16_f32 v51, v22, v23
    v_exp_f32 v25, v25
    v_exp_f32 v26, v26
    v_cvt_pk_bf16_f32 v52, v24, v25
    v_exp_f32 v27, v27
    v_mfma_f32_32x32x16_bf16 v[96:111], a[220:223], v[60:63], v[96:111]
    v_exp_f32 v28, v28
    v_cvt_pk_bf16_f32 v53, v26, v27
    v_exp_f32 v29, v29
    v_exp_f32 v30, v30
    v_exp_f32 v31, v31
    v_cvt_pk_bf16_f32 v54, v28, v29
    v_cvt_pk_bf16_f32 v55, v30, v31
    v_exp_f32 v32, v32
    v_mfma_f32_32x32x16_bf16 v[16:31], a[8:11], v[152:155], 0
    v_exp_f32 v33, v33
    v_exp_f32 v34, v34
    v_cvt_pk_bf16_f32 v56, v32, v33
    v_exp_f32 v35, v35
    v_exp_f32 v36, v36
    v_mfma_f32_32x32x16_bf16 v[80:95], a[96:99], v[48:51], 0
    v_cvt_pk_bf16_f32 v57, v34, v35
    v_exp_f32 v37, v37
    v_exp_f32 v38, v38
    v_cvt_pk_bf16_f32 v58, v36, v37
    v_exp_f32 v39, v39
    v_mfma_f32_32x32x8_bf16 v[16:31], a[68:69], v[156:157], v[16:31]
    v_exp_f32 v40, v40
    v_cvt_pk_bf16_f32 v59, v38, v39
    v_exp_f32 v41, v41
    v_exp_f32 v42, v42
    v_cvt_pk_bf16_f32 v60, v40, v41
    v_exp_f32 v43, v43
    v_mfma_f32_32x32x16_bf16 v[80:95], a[100:103], v[52:55], v[80:95]
    v_exp_f32 v44, v44
    v_cvt_pk_bf16_f32 v61, v42, v43
    v_exp_f32 v45, v45
    v_exp_f32 v46, v46
    v_exp_f32 v47, v47
    v_cvt_pk_bf16_f32 v62, v44, v45
    v_cvt_pk_bf16_f32 v63, v46, v47
    v_exp_f32 v16, v16
    v_mfma_f32_32x32x16_bf16 v[32:47], a[12:15], v[152:155], 0
    v_exp_f32 v17, v17
    v_exp_f32 v18, v18
    v_cvt_pk_bf16_f32 v48, v16, v17
    v_exp_f32 v19, v19
    v_exp_f32 v20, v20
    v_mfma_f32_32x32x16_bf16 v[80:95], a[104:107], v[56:59], v[80:95]
    v_cvt_pk_bf16_f32 v49, v18, v19
    v_exp_f32 v21, v21
    v_exp_f32 v22, v22
    v_cvt_pk_bf16_f32 v50, v20, v21
    v_exp_f32 v23, v23
    v_mfma_f32_32x32x8_bf16 v[32:47], a[70:71], v[156:157], v[32:47]
    v_exp_f32 v24, v24
    v_cvt_pk_bf16_f32 v51, v22, v23
    v_exp_f32 v25, v25
    v_exp_f32 v26, v26
    v_cvt_pk_bf16_f32 v52, v24, v25
    v_exp_f32 v27, v27
    v_mfma_f32_32x32x16_bf16 v[80:95], a[108:111], v[60:63], v[80:95]
    v_exp_f32 v28, v28
    v_cvt_pk_bf16_f32 v53, v26, v27
    v_exp_f32 v29, v29
    v_exp_f32 v30, v30
    v_exp_f32 v31, v31
    v_cvt_pk_bf16_f32 v54, v28, v29
    v_cvt_pk_bf16_f32 v55, v30, v31
    v_exp_f32 v32, v32
    ds_write_b128 v241, v[96:99] offset:0
    v_mfma_f32_32x32x16_bf16 v[16:31], a[16:19], v[152:155], 0
    v_exp_f32 v33, v33
    v_exp_f32 v34, v34
    v_cvt_pk_bf16_f32 v56, v32, v33
    v_exp_f32 v35, v35
    v_exp_f32 v36, v36
    v_mfma_f32_32x32x16_bf16 v[80:95], a[112:115], v[48:51], v[80:95]
    v_cvt_pk_bf16_f32 v57, v34, v35
    v_exp_f32 v37, v37
    v_exp_f32 v38, v38
    v_cvt_pk_bf16_f32 v58, v36, v37
    v_exp_f32 v39, v39
    v_mfma_f32_32x32x8_bf16 v[16:31], a[72:73], v[156:157], v[16:31]
    v_exp_f32 v40, v40
    v_cvt_pk_bf16_f32 v59, v38, v39
    v_exp_f32 v41, v41
    v_exp_f32 v42, v42
    v_cvt_pk_bf16_f32 v60, v40, v41
    v_exp_f32 v43, v43
    v_mfma_f32_32x32x16_bf16 v[80:95], a[116:119], v[52:55], v[80:95]
    v_exp_f32 v44, v44
    v_cvt_pk_bf16_f32 v61, v42, v43
    v_exp_f32 v45, v45
    v_exp_f32 v46, v46
    v_exp_f32 v47, v47
    v_cvt_pk_bf16_f32 v62, v44, v45
    v_cvt_pk_bf16_f32 v63, v46, v47
    v_exp_f32 v16, v16
    ds_write_b128 v241, v[100:103] offset:1024
    v_mfma_f32_32x32x16_bf16 v[32:47], a[20:23], v[152:155], 0
    v_exp_f32 v17, v17
    v_exp_f32 v18, v18
    v_cvt_pk_bf16_f32 v48, v16, v17
    v_exp_f32 v19, v19
    v_exp_f32 v20, v20
    v_mfma_f32_32x32x16_bf16 v[80:95], a[120:123], v[56:59], v[80:95]
    v_cvt_pk_bf16_f32 v49, v18, v19
    v_exp_f32 v21, v21
    v_exp_f32 v22, v22
    v_cvt_pk_bf16_f32 v50, v20, v21
    v_exp_f32 v23, v23
    v_mfma_f32_32x32x8_bf16 v[32:47], a[74:75], v[156:157], v[32:47]
    v_exp_f32 v24, v24
    v_cvt_pk_bf16_f32 v51, v22, v23
    v_exp_f32 v25, v25
    v_exp_f32 v26, v26
    v_cvt_pk_bf16_f32 v52, v24, v25
    v_exp_f32 v27, v27
    v_mfma_f32_32x32x16_bf16 v[80:95], a[124:127], v[60:63], v[80:95]
    v_exp_f32 v28, v28
    v_cvt_pk_bf16_f32 v53, v26, v27
    v_exp_f32 v29, v29
    v_exp_f32 v30, v30
    v_exp_f32 v31, v31
    v_cvt_pk_bf16_f32 v54, v28, v29
    v_cvt_pk_bf16_f32 v55, v30, v31
    v_exp_f32 v32, v32
    s_waitcnt vmcnt(0)
    v_mfma_f32_32x32x16_bf16 v[16:31], a[24:27], v[152:155], 0
    v_exp_f32 v33, v33
    v_exp_f32 v34, v34
    v_cvt_pk_bf16_f32 v56, v32, v33
    v_exp_f32 v35, v35
    v_exp_f32 v36, v36
    v_mfma_f32_32x32x16_bf16 v[80:95], a[128:131], v[48:51], v[80:95]
    v_cvt_pk_bf16_f32 v57, v34, v35
    v_exp_f32 v37, v37
    ds_write_b32 v237, v176 offset:0
    v_exp_f32 v38, v38
    v_cvt_pk_bf16_f32 v58, v36, v37
    v_exp_f32 v39, v39
    v_mfma_f32_32x32x8_bf16 v[16:31], a[76:77], v[156:157], v[16:31]
    v_exp_f32 v40, v40
    v_cvt_pk_bf16_f32 v59, v38, v39
    v_exp_f32 v41, v41
    v_exp_f32 v42, v42
    ds_write_b32 v237, v177 offset:8320
    v_cvt_pk_bf16_f32 v60, v40, v41
    v_exp_f32 v43, v43
    v_mfma_f32_32x32x16_bf16 v[80:95], a[132:135], v[52:55], v[80:95]
    v_exp_f32 v44, v44
    v_cvt_pk_bf16_f32 v61, v42, v43
    v_exp_f32 v45, v45
    v_exp_f32 v46, v46
    v_exp_f32 v47, v47
    v_cvt_pk_bf16_f32 v62, v44, v45
    v_cvt_pk_bf16_f32 v63, v46, v47
    v_exp_f32 v16, v16
    ds_write_b128 v241, v[104:107] offset:2048
    v_mfma_f32_32x32x16_bf16 v[32:47], a[28:31], v[152:155], 0
    v_exp_f32 v17, v17
    v_exp_f32 v18, v18
    v_cvt_pk_bf16_f32 v48, v16, v17
    v_exp_f32 v19, v19
    v_exp_f32 v20, v20
    v_mfma_f32_32x32x16_bf16 v[80:95], a[136:139], v[56:59], v[80:95]
    v_cvt_pk_bf16_f32 v49, v18, v19
    v_exp_f32 v21, v21
    v_exp_f32 v22, v22
    v_cvt_pk_bf16_f32 v50, v20, v21
    v_exp_f32 v23, v23
    v_mfma_f32_32x32x8_bf16 v[32:47], a[78:79], v[156:157], v[32:47]
    v_exp_f32 v24, v24
    v_cvt_pk_bf16_f32 v51, v22, v23
    v_exp_f32 v25, v25
    v_exp_f32 v26, v26
    v_cvt_pk_bf16_f32 v52, v24, v25
    v_exp_f32 v27, v27
    v_mfma_f32_32x32x16_bf16 v[80:95], a[140:143], v[60:63], v[80:95]
    v_exp_f32 v28, v28
    v_cvt_pk_bf16_f32 v53, v26, v27
    v_exp_f32 v29, v29
    v_exp_f32 v30, v30
    v_exp_f32 v31, v31
    v_cvt_pk_bf16_f32 v54, v28, v29
    v_cvt_pk_bf16_f32 v55, v30, v31
    v_exp_f32 v32, v32
    v_mfma_f32_32x32x16_bf16 v[16:31], a[32:35], v[152:155], 0
    v_exp_f32 v33, v33
    v_exp_f32 v34, v34
    v_cvt_pk_bf16_f32 v56, v32, v33
    v_exp_f32 v35, v35
    v_exp_f32 v36, v36
    v_mfma_f32_32x32x16_bf16 v[80:95], a[144:147], v[48:51], v[80:95]
    v_cvt_pk_bf16_f32 v57, v34, v35
    v_exp_f32 v37, v37
    v_exp_f32 v38, v38
    v_cvt_pk_bf16_f32 v58, v36, v37
    v_exp_f32 v39, v39
    v_mfma_f32_32x32x8_bf16 v[16:31], a[80:81], v[156:157], v[16:31]
    v_exp_f32 v40, v40
    v_cvt_pk_bf16_f32 v59, v38, v39
    v_exp_f32 v41, v41
    v_exp_f32 v42, v42
    v_cvt_pk_bf16_f32 v60, v40, v41
    v_exp_f32 v43, v43
    v_mfma_f32_32x32x16_bf16 v[80:95], a[148:151], v[52:55], v[80:95]
    v_exp_f32 v44, v44
    v_cvt_pk_bf16_f32 v61, v42, v43
    v_exp_f32 v45, v45
    v_exp_f32 v46, v46
    v_exp_f32 v47, v47
    v_cvt_pk_bf16_f32 v62, v44, v45
    v_cvt_pk_bf16_f32 v63, v46, v47
    v_exp_f32 v16, v16
    ds_write_b32 v237, v178 offset:256
    v_mfma_f32_32x32x16_bf16 v[32:47], a[36:39], v[152:155], 0
    v_exp_f32 v17, v17
    v_exp_f32 v18, v18
    v_cvt_pk_bf16_f32 v48, v16, v17
    v_exp_f32 v19, v19
    v_exp_f32 v20, v20
    v_mfma_f32_32x32x16_bf16 v[80:95], a[152:155], v[56:59], v[80:95]
    v_cvt_pk_bf16_f32 v49, v18, v19
    v_exp_f32 v21, v21
    v_exp_f32 v22, v22
    v_cvt_pk_bf16_f32 v50, v20, v21
    v_exp_f32 v23, v23
    v_mfma_f32_32x32x8_bf16 v[32:47], a[82:83], v[156:157], v[32:47]
    v_exp_f32 v24, v24
    ds_write_b32 v237, v179 offset:8576
    v_cvt_pk_bf16_f32 v51, v22, v23
    v_exp_f32 v25, v25
    v_exp_f32 v26, v26
    v_cvt_pk_bf16_f32 v52, v24, v25
    v_exp_f32 v27, v27
    v_mfma_f32_32x32x16_bf16 v[80:95], a[156:159], v[60:63], v[80:95]
    v_exp_f32 v28, v28
    v_cvt_pk_bf16_f32 v53, v26, v27
    v_exp_f32 v29, v29
    v_exp_f32 v30, v30
    v_exp_f32 v31, v31
    v_cvt_pk_bf16_f32 v54, v28, v29
    v_cvt_pk_bf16_f32 v55, v30, v31
    v_exp_f32 v32, v32
    v_mfma_f32_32x32x16_bf16 v[16:31], a[40:43], v[152:155], 0
    v_exp_f32 v33, v33
    v_exp_f32 v34, v34
    v_cvt_pk_bf16_f32 v56, v32, v33
    v_exp_f32 v35, v35
    v_exp_f32 v36, v36
    v_mfma_f32_32x32x16_bf16 v[80:95], a[160:163], v[48:51], v[80:95]
    v_cvt_pk_bf16_f32 v57, v34, v35
    v_exp_f32 v37, v37
    v_exp_f32 v38, v38
    v_cvt_pk_bf16_f32 v58, v36, v37
    v_exp_f32 v39, v39
    v_mfma_f32_32x32x8_bf16 v[16:31], a[84:85], v[156:157], v[16:31]
    v_exp_f32 v40, v40
    v_cvt_pk_bf16_f32 v59, v38, v39
    v_exp_f32 v41, v41
    v_exp_f32 v42, v42
    v_cvt_pk_bf16_f32 v60, v40, v41
    v_exp_f32 v43, v43
    v_mfma_f32_32x32x16_bf16 v[80:95], a[164:167], v[52:55], v[80:95]
    v_exp_f32 v44, v44
    v_cvt_pk_bf16_f32 v61, v42, v43
    v_exp_f32 v45, v45
    v_exp_f32 v46, v46
    v_exp_f32 v47, v47
    v_cvt_pk_bf16_f32 v62, v44, v45
    v_cvt_pk_bf16_f32 v63, v46, v47
    v_exp_f32 v16, v16
    v_mfma_f32_32x32x16_bf16 v[32:47], a[44:47], v[152:155], 0
    v_exp_f32 v17, v17
    v_exp_f32 v18, v18
    v_cvt_pk_bf16_f32 v48, v16, v17
    v_exp_f32 v19, v19
    v_exp_f32 v20, v20
    v_mfma_f32_32x32x16_bf16 v[80:95], a[168:171], v[56:59], v[80:95]
    v_cvt_pk_bf16_f32 v49, v18, v19
    v_exp_f32 v21, v21
    v_exp_f32 v22, v22
    v_cvt_pk_bf16_f32 v50, v20, v21
    v_exp_f32 v23, v23
    v_mfma_f32_32x32x8_bf16 v[32:47], a[86:87], v[156:157], v[32:47]
    v_exp_f32 v24, v24
    v_cvt_pk_bf16_f32 v51, v22, v23
    v_exp_f32 v25, v25
    v_exp_f32 v26, v26
    v_cvt_pk_bf16_f32 v52, v24, v25
    v_exp_f32 v27, v27
    v_mfma_f32_32x32x16_bf16 v[80:95], a[172:175], v[60:63], v[80:95]
    v_exp_f32 v28, v28
    v_cvt_pk_bf16_f32 v53, v26, v27
    v_exp_f32 v29, v29
    v_exp_f32 v30, v30
    v_exp_f32 v31, v31
    v_cvt_pk_bf16_f32 v54, v28, v29
    v_cvt_pk_bf16_f32 v55, v30, v31
    v_exp_f32 v32, v32
    ds_write_b32 v237, v180 offset:512
    v_mfma_f32_32x32x16_bf16 v[16:31], a[48:51], v[152:155], 0
    v_exp_f32 v33, v33
    v_exp_f32 v34, v34
    v_cvt_pk_bf16_f32 v56, v32, v33
    v_exp_f32 v35, v35
    v_exp_f32 v36, v36
    v_mfma_f32_32x32x16_bf16 v[80:95], a[176:179], v[48:51], v[80:95]
    v_cvt_pk_bf16_f32 v57, v34, v35
    v_exp_f32 v37, v37
    v_exp_f32 v38, v38
    v_cvt_pk_bf16_f32 v58, v36, v37
    v_exp_f32 v39, v39
    v_mfma_f32_32x32x8_bf16 v[16:31], a[88:89], v[156:157], v[16:31]
    v_exp_f32 v40, v40
    ds_write_b32 v237, v181 offset:8832
    v_cvt_pk_bf16_f32 v59, v38, v39
    v_exp_f32 v41, v41
    v_exp_f32 v42, v42
    v_cvt_pk_bf16_f32 v60, v40, v41
    v_exp_f32 v43, v43
    v_mfma_f32_32x32x16_bf16 v[80:95], a[180:183], v[52:55], v[80:95]
    v_exp_f32 v44, v44
    v_cvt_pk_bf16_f32 v61, v42, v43
    v_exp_f32 v45, v45
    v_exp_f32 v46, v46
    v_exp_f32 v47, v47
    v_cvt_pk_bf16_f32 v62, v44, v45
    v_cvt_pk_bf16_f32 v63, v46, v47
    v_exp_f32 v16, v16
    v_mfma_f32_32x32x16_bf16 v[32:47], a[52:55], v[152:155], 0
    v_exp_f32 v17, v17
    v_exp_f32 v18, v18
    v_cvt_pk_bf16_f32 v48, v16, v17
    v_exp_f32 v19, v19
    v_exp_f32 v20, v20
    v_mfma_f32_32x32x16_bf16 v[80:95], a[184:187], v[56:59], v[80:95]
    v_cvt_pk_bf16_f32 v49, v18, v19
    v_exp_f32 v21, v21
    v_exp_f32 v22, v22
    v_cvt_pk_bf16_f32 v50, v20, v21
    v_exp_f32 v23, v23
    v_mfma_f32_32x32x8_bf16 v[32:47], a[90:91], v[156:157], v[32:47]
    v_exp_f32 v24, v24
    v_cvt_pk_bf16_f32 v51, v22, v23
    v_exp_f32 v25, v25
    v_exp_f32 v26, v26
    v_cvt_pk_bf16_f32 v52, v24, v25
    v_exp_f32 v27, v27
    v_mfma_f32_32x32x16_bf16 v[80:95], a[188:191], v[60:63], v[80:95]
    v_exp_f32 v28, v28
    v_cvt_pk_bf16_f32 v53, v26, v27
    v_exp_f32 v29, v29
    v_exp_f32 v30, v30
    v_exp_f32 v31, v31
    v_cvt_pk_bf16_f32 v54, v28, v29
    v_cvt_pk_bf16_f32 v55, v30, v31
    v_exp_f32 v32, v32
    v_mfma_f32_32x32x16_bf16 v[16:31], a[56:59], v[152:155], 0
    v_exp_f32 v33, v33
    v_exp_f32 v34, v34
    v_cvt_pk_bf16_f32 v56, v32, v33
    v_exp_f32 v35, v35
    v_exp_f32 v36, v36
    v_mfma_f32_32x32x16_bf16 v[80:95], a[192:195], v[48:51], v[80:95]
    v_cvt_pk_bf16_f32 v57, v34, v35
    v_exp_f32 v37, v37
    v_exp_f32 v38, v38
    v_cvt_pk_bf16_f32 v58, v36, v37
    v_exp_f32 v39, v39
    v_mfma_f32_32x32x8_bf16 v[16:31], a[92:93], v[156:157], v[16:31]
    v_exp_f32 v40, v40
    v_cvt_pk_bf16_f32 v59, v38, v39
    v_exp_f32 v41, v41
    v_exp_f32 v42, v42
    v_cvt_pk_bf16_f32 v60, v40, v41
    v_exp_f32 v43, v43
    v_mfma_f32_32x32x16_bf16 v[80:95], a[196:199], v[52:55], v[80:95]
    v_exp_f32 v44, v44
    v_cvt_pk_bf16_f32 v61, v42, v43
    v_exp_f32 v45, v45
    v_exp_f32 v46, v46
    v_exp_f32 v47, v47
    v_cvt_pk_bf16_f32 v62, v44, v45
    v_cvt_pk_bf16_f32 v63, v46, v47
    v_exp_f32 v16, v16
    ds_write_b32 v237, v182 offset:768
    v_mfma_f32_32x32x16_bf16 v[32:47], a[60:63], v[152:155], 0
    v_exp_f32 v17, v17
    v_exp_f32 v18, v18
    v_cvt_pk_bf16_f32 v48, v16, v17
    v_exp_f32 v19, v19
    v_exp_f32 v20, v20
    v_mfma_f32_32x32x16_bf16 v[80:95], a[200:203], v[56:59], v[80:95]
    v_cvt_pk_bf16_f32 v49, v18, v19
    v_exp_f32 v21, v21
    v_exp_f32 v22, v22
    v_cvt_pk_bf16_f32 v50, v20, v21
    v_exp_f32 v23, v23
    v_mfma_f32_32x32x8_bf16 v[32:47], a[94:95], v[156:157], v[32:47]
    v_exp_f32 v24, v24
    ds_write_b32 v237, v183 offset:9088
    v_cvt_pk_bf16_f32 v51, v22, v23
    v_exp_f32 v25, v25
    v_exp_f32 v26, v26
    v_cvt_pk_bf16_f32 v52, v24, v25
    v_exp_f32 v27, v27
    v_mfma_f32_32x32x16_bf16 v[80:95], a[204:207], v[60:63], v[80:95]
    v_exp_f32 v28, v28
    v_cvt_pk_bf16_f32 v53, v26, v27
    v_exp_f32 v29, v29
    v_exp_f32 v30, v30
    v_exp_f32 v31, v31
    v_cvt_pk_bf16_f32 v54, v28, v29
    v_cvt_pk_bf16_f32 v55, v30, v31
    v_exp_f32 v32, v32
    v_mfma_f32_32x32x16_bf16 v[16:31], a[0:3], v[158:161], 0
    v_exp_f32 v33, v33
    v_exp_f32 v34, v34
    v_cvt_pk_bf16_f32 v56, v32, v33
    v_exp_f32 v35, v35
    v_exp_f32 v36, v36
    v_mfma_f32_32x32x16_bf16 v[80:95], a[208:211], v[48:51], v[80:95]
    v_cvt_pk_bf16_f32 v57, v34, v35
    v_exp_f32 v37, v37
    v_exp_f32 v38, v38
    v_cvt_pk_bf16_f32 v58, v36, v37
    v_exp_f32 v39, v39
    v_mfma_f32_32x32x8_bf16 v[16:31], a[64:65], v[162:163], v[16:31]
    v_exp_f32 v40, v40
    v_cvt_pk_bf16_f32 v59, v38, v39
    v_exp_f32 v41, v41
    v_exp_f32 v42, v42
    v_cvt_pk_bf16_f32 v60, v40, v41
    v_exp_f32 v43, v43
    v_mfma_f32_32x32x16_bf16 v[80:95], a[212:215], v[52:55], v[80:95]
    v_exp_f32 v44, v44
    v_cvt_pk_bf16_f32 v61, v42, v43
    v_exp_f32 v45, v45
    v_exp_f32 v46, v46
    v_exp_f32 v47, v47
    v_cvt_pk_bf16_f32 v62, v44, v45
    v_cvt_pk_bf16_f32 v63, v46, v47
    v_exp_f32 v16, v16
    v_mfma_f32_32x32x16_bf16 v[32:47], a[4:7], v[158:161], 0
    v_exp_f32 v17, v17
    v_exp_f32 v18, v18
    v_cvt_pk_bf16_f32 v48, v16, v17
    v_exp_f32 v19, v19
    v_exp_f32 v20, v20
    v_mfma_f32_32x32x16_bf16 v[80:95], a[216:219], v[56:59], v[80:95]
    v_cvt_pk_bf16_f32 v49, v18, v19
    v_exp_f32 v21, v21
    v_exp_f32 v22, v22
    v_cvt_pk_bf16_f32 v50, v20, v21
    v_exp_f32 v23, v23
    v_mfma_f32_32x32x8_bf16 v[32:47], a[66:67], v[162:163], v[32:47]
    v_exp_f32 v24, v24
    v_cvt_pk_bf16_f32 v51, v22, v23
    v_exp_f32 v25, v25
    v_exp_f32 v26, v26
    v_cvt_pk_bf16_f32 v52, v24, v25
    v_exp_f32 v27, v27
    v_mfma_f32_32x32x16_bf16 v[80:95], a[220:223], v[60:63], v[80:95]
    v_exp_f32 v28, v28
    v_cvt_pk_bf16_f32 v53, v26, v27
    v_exp_f32 v29, v29
    v_exp_f32 v30, v30
    v_exp_f32 v31, v31
    v_cvt_pk_bf16_f32 v54, v28, v29
    v_cvt_pk_bf16_f32 v55, v30, v31
    v_exp_f32 v32, v32
    v_mfma_f32_32x32x16_bf16 v[16:31], a[8:11], v[158:161], 0
    v_exp_f32 v33, v33
    v_exp_f32 v34, v34
    v_cvt_pk_bf16_f32 v56, v32, v33
    v_exp_f32 v35, v35
    v_exp_f32 v36, v36
    v_mfma_f32_32x32x16_bf16 v[96:111], a[96:99], v[48:51], 0
    v_cvt_pk_bf16_f32 v57, v34, v35
    v_exp_f32 v37, v37
    v_exp_f32 v38, v38
    v_cvt_pk_bf16_f32 v58, v36, v37
    v_exp_f32 v39, v39
    v_mfma_f32_32x32x8_bf16 v[16:31], a[68:69], v[162:163], v[16:31]
    v_exp_f32 v40, v40
    v_cvt_pk_bf16_f32 v59, v38, v39
    v_exp_f32 v41, v41
    v_exp_f32 v42, v42
    v_cvt_pk_bf16_f32 v60, v40, v41
    v_exp_f32 v43, v43
    v_mfma_f32_32x32x16_bf16 v[96:111], a[100:103], v[52:55], v[96:111]
    v_exp_f32 v44, v44
    v_cvt_pk_bf16_f32 v61, v42, v43
    v_exp_f32 v45, v45
    v_exp_f32 v46, v46
    v_exp_f32 v47, v47
    v_cvt_pk_bf16_f32 v62, v44, v45
    v_cvt_pk_bf16_f32 v63, v46, v47
    v_exp_f32 v16, v16
    v_mfma_f32_32x32x16_bf16 v[32:47], a[12:15], v[158:161], 0
    v_exp_f32 v17, v17
    v_exp_f32 v18, v18
    v_cvt_pk_bf16_f32 v48, v16, v17
    v_exp_f32 v19, v19
    v_exp_f32 v20, v20
    v_mfma_f32_32x32x16_bf16 v[96:111], a[104:107], v[56:59], v[96:111]
    v_cvt_pk_bf16_f32 v49, v18, v19
    v_exp_f32 v21, v21
    v_exp_f32 v22, v22
    v_cvt_pk_bf16_f32 v50, v20, v21
    v_exp_f32 v23, v23
    v_mfma_f32_32x32x8_bf16 v[32:47], a[70:71], v[162:163], v[32:47]
    v_exp_f32 v24, v24
    v_cvt_pk_bf16_f32 v51, v22, v23
    v_exp_f32 v25, v25
    v_exp_f32 v26, v26
    v_cvt_pk_bf16_f32 v52, v24, v25
    v_exp_f32 v27, v27
    v_mfma_f32_32x32x16_bf16 v[96:111], a[108:111], v[60:63], v[96:111]
    v_exp_f32 v28, v28
    v_cvt_pk_bf16_f32 v53, v26, v27
    v_exp_f32 v29, v29
    v_exp_f32 v30, v30
    v_exp_f32 v31, v31
    v_cvt_pk_bf16_f32 v54, v28, v29
    v_cvt_pk_bf16_f32 v55, v30, v31
    v_exp_f32 v32, v32
    ds_write_b128 v242, v[80:83] offset:0
    v_mfma_f32_32x32x16_bf16 v[16:31], a[16:19], v[158:161], 0
    v_exp_f32 v33, v33
    v_exp_f32 v34, v34
    v_cvt_pk_bf16_f32 v56, v32, v33
    v_exp_f32 v35, v35
    v_exp_f32 v36, v36
    v_mfma_f32_32x32x16_bf16 v[96:111], a[112:115], v[48:51], v[96:111]
    v_cvt_pk_bf16_f32 v57, v34, v35
    v_exp_f32 v37, v37
    v_exp_f32 v38, v38
    v_cvt_pk_bf16_f32 v58, v36, v37
    v_exp_f32 v39, v39
    v_mfma_f32_32x32x8_bf16 v[16:31], a[72:73], v[162:163], v[16:31]
    v_exp_f32 v40, v40
    v_cvt_pk_bf16_f32 v59, v38, v39
    v_exp_f32 v41, v41
    v_exp_f32 v42, v42
    v_cvt_pk_bf16_f32 v60, v40, v41
    v_exp_f32 v43, v43
    v_mfma_f32_32x32x16_bf16 v[96:111], a[116:119], v[52:55], v[96:111]
    v_exp_f32 v44, v44
    v_cvt_pk_bf16_f32 v61, v42, v43
    v_exp_f32 v45, v45
    v_exp_f32 v46, v46
    v_exp_f32 v47, v47
    v_cvt_pk_bf16_f32 v62, v44, v45
    v_cvt_pk_bf16_f32 v63, v46, v47
    v_exp_f32 v16, v16
    ds_write_b128 v242, v[84:87] offset:1024
    v_mfma_f32_32x32x16_bf16 v[32:47], a[20:23], v[158:161], 0
    v_exp_f32 v17, v17
    v_exp_f32 v18, v18
    v_cvt_pk_bf16_f32 v48, v16, v17
    v_exp_f32 v19, v19
    v_exp_f32 v20, v20
    v_mfma_f32_32x32x16_bf16 v[96:111], a[120:123], v[56:59], v[96:111]
    v_cvt_pk_bf16_f32 v49, v18, v19
    v_exp_f32 v21, v21
    v_exp_f32 v22, v22
    v_cvt_pk_bf16_f32 v50, v20, v21
    v_exp_f32 v23, v23
    v_mfma_f32_32x32x8_bf16 v[32:47], a[74:75], v[162:163], v[32:47]
    v_exp_f32 v24, v24
    v_cvt_pk_bf16_f32 v51, v22, v23
    v_exp_f32 v25, v25
    v_exp_f32 v26, v26
    v_cvt_pk_bf16_f32 v52, v24, v25
    v_exp_f32 v27, v27
    v_mfma_f32_32x32x16_bf16 v[96:111], a[124:127], v[60:63], v[96:111]
    v_exp_f32 v28, v28
    v_cvt_pk_bf16_f32 v53, v26, v27
    v_exp_f32 v29, v29
    v_exp_f32 v30, v30
    v_exp_f32 v31, v31
    v_cvt_pk_bf16_f32 v54, v28, v29
    v_cvt_pk_bf16_f32 v55, v30, v31
    v_exp_f32 v32, v32
    ds_write_b32 v237, v184 offset:1024
    v_mfma_f32_32x32x16_bf16 v[16:31], a[24:27], v[158:161], 0
    v_exp_f32 v33, v33
    v_exp_f32 v34, v34
    v_cvt_pk_bf16_f32 v56, v32, v33
    v_exp_f32 v35, v35
    v_exp_f32 v36, v36
    v_mfma_f32_32x32x16_bf16 v[96:111], a[128:131], v[48:51], v[96:111]
    v_cvt_pk_bf16_f32 v57, v34, v35
    v_exp_f32 v37, v37
    v_exp_f32 v38, v38
    v_cvt_pk_bf16_f32 v58, v36, v37
    v_exp_f32 v39, v39
    v_mfma_f32_32x32x8_bf16 v[16:31], a[76:77], v[162:163], v[16:31]
    v_exp_f32 v40, v40
    ds_write_b32 v237, v185 offset:9344
    v_cvt_pk_bf16_f32 v59, v38, v39
    v_exp_f32 v41, v41
    v_exp_f32 v42, v42
    v_cvt_pk_bf16_f32 v60, v40, v41
    v_exp_f32 v43, v43
    v_mfma_f32_32x32x16_bf16 v[96:111], a[132:135], v[52:55], v[96:111]
    v_exp_f32 v44, v44
    v_cvt_pk_bf16_f32 v61, v42, v43
    v_exp_f32 v45, v45
    v_exp_f32 v46, v46
    v_exp_f32 v47, v47
    v_cvt_pk_bf16_f32 v62, v44, v45
    v_cvt_pk_bf16_f32 v63, v46, v47
    v_exp_f32 v16, v16
    ds_write_b128 v242, v[88:91] offset:2048
    v_mfma_f32_32x32x16_bf16 v[32:47], a[28:31], v[158:161], 0
    v_exp_f32 v17, v17
    v_exp_f32 v18, v18
    v_cvt_pk_bf16_f32 v48, v16, v17
    v_exp_f32 v19, v19
    v_exp_f32 v20, v20
    v_mfma_f32_32x32x16_bf16 v[96:111], a[136:139], v[56:59], v[96:111]
    v_cvt_pk_bf16_f32 v49, v18, v19
    v_exp_f32 v21, v21
    v_exp_f32 v22, v22
    v_cvt_pk_bf16_f32 v50, v20, v21
    v_exp_f32 v23, v23
    v_mfma_f32_32x32x8_bf16 v[32:47], a[78:79], v[162:163], v[32:47]
    v_exp_f32 v24, v24
    v_cvt_pk_bf16_f32 v51, v22, v23
    v_exp_f32 v25, v25
    v_exp_f32 v26, v26
    v_cvt_pk_bf16_f32 v52, v24, v25
    v_exp_f32 v27, v27
    v_mfma_f32_32x32x16_bf16 v[96:111], a[140:143], v[60:63], v[96:111]
    v_exp_f32 v28, v28
    v_cvt_pk_bf16_f32 v53, v26, v27
    v_exp_f32 v29, v29
    v_exp_f32 v30, v30
    v_exp_f32 v31, v31
    v_cvt_pk_bf16_f32 v54, v28, v29
    v_cvt_pk_bf16_f32 v55, v30, v31
    v_exp_f32 v32, v32
    v_mfma_f32_32x32x16_bf16 v[16:31], a[32:35], v[158:161], 0
    v_exp_f32 v33, v33
    v_exp_f32 v34, v34
    v_cvt_pk_bf16_f32 v56, v32, v33
    v_exp_f32 v35, v35
    v_exp_f32 v36, v36
    v_mfma_f32_32x32x16_bf16 v[96:111], a[144:147], v[48:51], v[96:111]
    v_cvt_pk_bf16_f32 v57, v34, v35
    v_exp_f32 v37, v37
    v_exp_f32 v38, v38
    v_cvt_pk_bf16_f32 v58, v36, v37
    v_exp_f32 v39, v39
    v_mfma_f32_32x32x8_bf16 v[16:31], a[80:81], v[162:163], v[16:31]
    v_exp_f32 v40, v40
    v_cvt_pk_bf16_f32 v59, v38, v39
    v_exp_f32 v41, v41
    v_exp_f32 v42, v42
    v_cvt_pk_bf16_f32 v60, v40, v41
    v_exp_f32 v43, v43
    v_mfma_f32_32x32x16_bf16 v[96:111], a[148:151], v[52:55], v[96:111]
    v_exp_f32 v44, v44
    v_cvt_pk_bf16_f32 v61, v42, v43
    v_exp_f32 v45, v45
    v_exp_f32 v46, v46
    v_exp_f32 v47, v47
    v_cvt_pk_bf16_f32 v62, v44, v45
    v_cvt_pk_bf16_f32 v63, v46, v47
    v_exp_f32 v16, v16
    ds_write_b32 v237, v186 offset:1280
    v_mfma_f32_32x32x16_bf16 v[32:47], a[36:39], v[158:161], 0
    v_exp_f32 v17, v17
    v_exp_f32 v18, v18
    v_cvt_pk_bf16_f32 v48, v16, v17
    v_exp_f32 v19, v19
    v_exp_f32 v20, v20
    v_mfma_f32_32x32x16_bf16 v[96:111], a[152:155], v[56:59], v[96:111]
    v_cvt_pk_bf16_f32 v49, v18, v19
    v_exp_f32 v21, v21
    v_exp_f32 v22, v22
    v_cvt_pk_bf16_f32 v50, v20, v21
    v_exp_f32 v23, v23
    v_mfma_f32_32x32x8_bf16 v[32:47], a[82:83], v[162:163], v[32:47]
    v_exp_f32 v24, v24
    ds_write_b32 v237, v187 offset:9600
    v_cvt_pk_bf16_f32 v51, v22, v23
    v_exp_f32 v25, v25
    v_exp_f32 v26, v26
    v_cvt_pk_bf16_f32 v52, v24, v25
    v_exp_f32 v27, v27
    v_mfma_f32_32x32x16_bf16 v[96:111], a[156:159], v[60:63], v[96:111]
    v_exp_f32 v28, v28
    v_cvt_pk_bf16_f32 v53, v26, v27
    v_exp_f32 v29, v29
    v_exp_f32 v30, v30
    v_exp_f32 v31, v31
    v_cvt_pk_bf16_f32 v54, v28, v29
    v_cvt_pk_bf16_f32 v55, v30, v31
    v_exp_f32 v32, v32
    v_mfma_f32_32x32x16_bf16 v[16:31], a[40:43], v[158:161], 0
    v_exp_f32 v33, v33
    v_exp_f32 v34, v34
    v_cvt_pk_bf16_f32 v56, v32, v33
    v_exp_f32 v35, v35
    v_exp_f32 v36, v36
    v_mfma_f32_32x32x16_bf16 v[96:111], a[160:163], v[48:51], v[96:111]
    v_cvt_pk_bf16_f32 v57, v34, v35
    v_exp_f32 v37, v37
    v_exp_f32 v38, v38
    v_cvt_pk_bf16_f32 v58, v36, v37
    v_exp_f32 v39, v39
    v_mfma_f32_32x32x8_bf16 v[16:31], a[84:85], v[162:163], v[16:31]
    v_exp_f32 v40, v40
    v_cvt_pk_bf16_f32 v59, v38, v39
    v_exp_f32 v41, v41
    v_exp_f32 v42, v42
    v_cvt_pk_bf16_f32 v60, v40, v41
    v_exp_f32 v43, v43
    v_mfma_f32_32x32x16_bf16 v[96:111], a[164:167], v[52:55], v[96:111]
    v_exp_f32 v44, v44
    v_cvt_pk_bf16_f32 v61, v42, v43
    v_exp_f32 v45, v45
    v_exp_f32 v46, v46
    v_exp_f32 v47, v47
    v_cvt_pk_bf16_f32 v62, v44, v45
    v_cvt_pk_bf16_f32 v63, v46, v47
    v_exp_f32 v16, v16
    v_mfma_f32_32x32x16_bf16 v[32:47], a[44:47], v[158:161], 0
    v_exp_f32 v17, v17
    v_exp_f32 v18, v18
    v_cvt_pk_bf16_f32 v48, v16, v17
    v_exp_f32 v19, v19
    v_exp_f32 v20, v20
    v_mfma_f32_32x32x16_bf16 v[96:111], a[168:171], v[56:59], v[96:111]
    v_cvt_pk_bf16_f32 v49, v18, v19
    v_exp_f32 v21, v21
    v_exp_f32 v22, v22
    v_cvt_pk_bf16_f32 v50, v20, v21
    v_exp_f32 v23, v23
    v_mfma_f32_32x32x8_bf16 v[32:47], a[86:87], v[162:163], v[32:47]
    v_exp_f32 v24, v24
    v_cvt_pk_bf16_f32 v51, v22, v23
    v_exp_f32 v25, v25
    v_exp_f32 v26, v26
    v_cvt_pk_bf16_f32 v52, v24, v25
    v_exp_f32 v27, v27
    v_mfma_f32_32x32x16_bf16 v[96:111], a[172:175], v[60:63], v[96:111]
    v_exp_f32 v28, v28
    v_cvt_pk_bf16_f32 v53, v26, v27
    v_exp_f32 v29, v29
    v_exp_f32 v30, v30
    v_exp_f32 v31, v31
    v_cvt_pk_bf16_f32 v54, v28, v29
    v_cvt_pk_bf16_f32 v55, v30, v31
    v_exp_f32 v32, v32
    ds_write_b32 v237, v188 offset:1536
    v_mfma_f32_32x32x16_bf16 v[16:31], a[48:51], v[158:161], 0
    v_exp_f32 v33, v33
    v_exp_f32 v34, v34
    v_cvt_pk_bf16_f32 v56, v32, v33
    v_exp_f32 v35, v35
    v_exp_f32 v36, v36
    v_mfma_f32_32x32x16_bf16 v[96:111], a[176:179], v[48:51], v[96:111]
    v_cvt_pk_bf16_f32 v57, v34, v35
    v_exp_f32 v37, v37
    v_exp_f32 v38, v38
    v_cvt_pk_bf16_f32 v58, v36, v37
    v_exp_f32 v39, v39
    v_mfma_f32_32x32x8_bf16 v[16:31], a[88:89], v[162:163], v[16:31]
    v_exp_f32 v40, v40
    ds_write_b32 v237, v189 offset:9856
    v_cvt_pk_bf16_f32 v59, v38, v39
    v_exp_f32 v41, v41
    v_exp_f32 v42, v42
    v_cvt_pk_bf16_f32 v60, v40, v41
    v_exp_f32 v43, v43
    v_mfma_f32_32x32x16_bf16 v[96:111], a[180:183], v[52:55], v[96:111]
    v_exp_f32 v44, v44
    v_cvt_pk_bf16_f32 v61, v42, v43
    v_exp_f32 v45, v45
    v_exp_f32 v46, v46
    v_exp_f32 v47, v47
    v_cvt_pk_bf16_f32 v62, v44, v45
    v_cvt_pk_bf16_f32 v63, v46, v47
    v_exp_f32 v16, v16
    v_mfma_f32_32x32x16_bf16 v[32:47], a[52:55], v[158:161], 0
    v_exp_f32 v17, v17
    v_exp_f32 v18, v18
    v_cvt_pk_bf16_f32 v48, v16, v17
    v_exp_f32 v19, v19
    v_exp_f32 v20, v20
    v_mfma_f32_32x32x16_bf16 v[96:111], a[184:187], v[56:59], v[96:111]
    v_cvt_pk_bf16_f32 v49, v18, v19
    v_exp_f32 v21, v21
    v_exp_f32 v22, v22
    v_cvt_pk_bf16_f32 v50, v20, v21
    v_exp_f32 v23, v23
    v_mfma_f32_32x32x8_bf16 v[32:47], a[90:91], v[162:163], v[32:47]
    v_exp_f32 v24, v24
    v_cvt_pk_bf16_f32 v51, v22, v23
    v_exp_f32 v25, v25
    v_exp_f32 v26, v26
    v_cvt_pk_bf16_f32 v52, v24, v25
    v_exp_f32 v27, v27
    v_mfma_f32_32x32x16_bf16 v[96:111], a[188:191], v[60:63], v[96:111]
    v_exp_f32 v28, v28
    v_cvt_pk_bf16_f32 v53, v26, v27
    v_exp_f32 v29, v29
    v_exp_f32 v30, v30
    v_exp_f32 v31, v31
    v_cvt_pk_bf16_f32 v54, v28, v29
    v_cvt_pk_bf16_f32 v55, v30, v31
    v_exp_f32 v32, v32
    v_mfma_f32_32x32x16_bf16 v[16:31], a[56:59], v[158:161], 0
    v_exp_f32 v33, v33
    v_exp_f32 v34, v34
    v_cvt_pk_bf16_f32 v56, v32, v33
    v_exp_f32 v35, v35
    v_exp_f32 v36, v36
    v_mfma_f32_32x32x16_bf16 v[96:111], a[192:195], v[48:51], v[96:111]
    v_cvt_pk_bf16_f32 v57, v34, v35
    v_exp_f32 v37, v37
    v_exp_f32 v38, v38
    v_cvt_pk_bf16_f32 v58, v36, v37
    v_exp_f32 v39, v39
    v_mfma_f32_32x32x8_bf16 v[16:31], a[92:93], v[162:163], v[16:31]
    v_exp_f32 v40, v40
    v_cvt_pk_bf16_f32 v59, v38, v39
    v_exp_f32 v41, v41
    v_exp_f32 v42, v42
    v_cvt_pk_bf16_f32 v60, v40, v41
    v_exp_f32 v43, v43
    v_mfma_f32_32x32x16_bf16 v[96:111], a[196:199], v[52:55], v[96:111]
    v_exp_f32 v44, v44
    v_cvt_pk_bf16_f32 v61, v42, v43
    v_exp_f32 v45, v45
    v_exp_f32 v46, v46
    v_exp_f32 v47, v47
    v_cvt_pk_bf16_f32 v62, v44, v45
    v_cvt_pk_bf16_f32 v63, v46, v47
    v_exp_f32 v16, v16
    ds_write_b32 v237, v190 offset:1792
    v_mfma_f32_32x32x16_bf16 v[32:47], a[60:63], v[158:161], 0
    v_exp_f32 v17, v17
    v_exp_f32 v18, v18
    v_cvt_pk_bf16_f32 v48, v16, v17
    v_exp_f32 v19, v19
    v_exp_f32 v20, v20
    v_mfma_f32_32x32x16_bf16 v[96:111], a[200:203], v[56:59], v[96:111]
    v_cvt_pk_bf16_f32 v49, v18, v19
    v_exp_f32 v21, v21
    v_exp_f32 v22, v22
    v_cvt_pk_bf16_f32 v50, v20, v21
    v_exp_f32 v23, v23
    v_mfma_f32_32x32x8_bf16 v[32:47], a[94:95], v[162:163], v[32:47]
    v_exp_f32 v24, v24
    ds_write_b32 v237, v191 offset:10112
    v_cvt_pk_bf16_f32 v51, v22, v23
    v_exp_f32 v25, v25
    v_exp_f32 v26, v26
    v_cvt_pk_bf16_f32 v52, v24, v25
    v_exp_f32 v27, v27
    v_mfma_f32_32x32x16_bf16 v[96:111], a[204:207], v[60:63], v[96:111]
    v_exp_f32 v28, v28
    v_cvt_pk_bf16_f32 v53, v26, v27
    v_exp_f32 v29, v29
    v_exp_f32 v30, v30
    v_exp_f32 v31, v31
    v_cvt_pk_bf16_f32 v54, v28, v29
    v_cvt_pk_bf16_f32 v55, v30, v31
    v_exp_f32 v32, v32
    v_mfma_f32_32x32x16_bf16 v[16:31], a[0:3], v[164:167], 0
    v_exp_f32 v33, v33
    v_exp_f32 v34, v34
    v_cvt_pk_bf16_f32 v56, v32, v33
    v_exp_f32 v35, v35
    v_exp_f32 v36, v36
    v_mfma_f32_32x32x16_bf16 v[96:111], a[208:211], v[48:51], v[96:111]
    v_cvt_pk_bf16_f32 v57, v34, v35
    v_exp_f32 v37, v37
    v_exp_f32 v38, v38
    v_cvt_pk_bf16_f32 v58, v36, v37
    v_exp_f32 v39, v39
    v_mfma_f32_32x32x8_bf16 v[16:31], a[64:65], v[168:169], v[16:31]
    v_exp_f32 v40, v40
    v_cvt_pk_bf16_f32 v59, v38, v39
    v_exp_f32 v41, v41
    v_exp_f32 v42, v42
    v_cvt_pk_bf16_f32 v60, v40, v41
    v_exp_f32 v43, v43
    v_mfma_f32_32x32x16_bf16 v[96:111], a[212:215], v[52:55], v[96:111]
    v_exp_f32 v44, v44
    v_cvt_pk_bf16_f32 v61, v42, v43
    v_exp_f32 v45, v45
    v_exp_f32 v46, v46
    v_exp_f32 v47, v47
    v_cvt_pk_bf16_f32 v62, v44, v45
    v_cvt_pk_bf16_f32 v63, v46, v47
    v_exp_f32 v16, v16
    v_mfma_f32_32x32x16_bf16 v[32:47], a[4:7], v[164:167], 0
    v_exp_f32 v17, v17
    v_exp_f32 v18, v18
    v_cvt_pk_bf16_f32 v48, v16, v17
    v_exp_f32 v19, v19
    v_exp_f32 v20, v20
    v_mfma_f32_32x32x16_bf16 v[96:111], a[216:219], v[56:59], v[96:111]
    v_cvt_pk_bf16_f32 v49, v18, v19
    v_exp_f32 v21, v21
    v_exp_f32 v22, v22
    v_cvt_pk_bf16_f32 v50, v20, v21
    v_exp_f32 v23, v23
    v_mfma_f32_32x32x8_bf16 v[32:47], a[66:67], v[168:169], v[32:47]
    v_exp_f32 v24, v24
    v_cvt_pk_bf16_f32 v51, v22, v23
    v_exp_f32 v25, v25
    v_exp_f32 v26, v26
    v_cvt_pk_bf16_f32 v52, v24, v25
    v_exp_f32 v27, v27
    v_mfma_f32_32x32x16_bf16 v[96:111], a[220:223], v[60:63], v[96:111]
    v_exp_f32 v28, v28
    v_cvt_pk_bf16_f32 v53, v26, v27
    v_exp_f32 v29, v29
    v_exp_f32 v30, v30
    v_exp_f32 v31, v31
    v_cvt_pk_bf16_f32 v54, v28, v29
    v_cvt_pk_bf16_f32 v55, v30, v31
    v_exp_f32 v32, v32
    v_mfma_f32_32x32x16_bf16 v[16:31], a[8:11], v[164:167], 0
    v_exp_f32 v33, v33
    v_exp_f32 v34, v34
    v_cvt_pk_bf16_f32 v56, v32, v33
    v_exp_f32 v35, v35
    v_exp_f32 v36, v36
    v_mfma_f32_32x32x16_bf16 v[80:95], a[96:99], v[48:51], 0
    v_cvt_pk_bf16_f32 v57, v34, v35
    v_exp_f32 v37, v37
    v_exp_f32 v38, v38
    v_cvt_pk_bf16_f32 v58, v36, v37
    v_exp_f32 v39, v39
    v_mfma_f32_32x32x8_bf16 v[16:31], a[68:69], v[168:169], v[16:31]
    v_exp_f32 v40, v40
    v_cvt_pk_bf16_f32 v59, v38, v39
    v_exp_f32 v41, v41
    v_exp_f32 v42, v42
    v_cvt_pk_bf16_f32 v60, v40, v41
    v_exp_f32 v43, v43
    v_mfma_f32_32x32x16_bf16 v[80:95], a[100:103], v[52:55], v[80:95]
    v_exp_f32 v44, v44
    v_cvt_pk_bf16_f32 v61, v42, v43
    v_exp_f32 v45, v45
    v_exp_f32 v46, v46
    v_exp_f32 v47, v47
    v_cvt_pk_bf16_f32 v62, v44, v45
    v_cvt_pk_bf16_f32 v63, v46, v47
    v_exp_f32 v16, v16
    v_mfma_f32_32x32x16_bf16 v[32:47], a[12:15], v[164:167], 0
    v_exp_f32 v17, v17
    v_exp_f32 v18, v18
    v_cvt_pk_bf16_f32 v48, v16, v17
    v_exp_f32 v19, v19
    v_exp_f32 v20, v20
    v_mfma_f32_32x32x16_bf16 v[80:95], a[104:107], v[56:59], v[80:95]
    v_cvt_pk_bf16_f32 v49, v18, v19
    v_exp_f32 v21, v21
    v_exp_f32 v22, v22
    v_cvt_pk_bf16_f32 v50, v20, v21
    v_exp_f32 v23, v23
    v_mfma_f32_32x32x8_bf16 v[32:47], a[70:71], v[168:169], v[32:47]
    v_exp_f32 v24, v24
    v_cvt_pk_bf16_f32 v51, v22, v23
    v_exp_f32 v25, v25
    v_exp_f32 v26, v26
    v_cvt_pk_bf16_f32 v52, v24, v25
    v_exp_f32 v27, v27
    v_mfma_f32_32x32x16_bf16 v[80:95], a[108:111], v[60:63], v[80:95]
    v_exp_f32 v28, v28
    v_cvt_pk_bf16_f32 v53, v26, v27
    v_exp_f32 v29, v29
    v_exp_f32 v30, v30
    v_exp_f32 v31, v31
    v_cvt_pk_bf16_f32 v54, v28, v29
    v_cvt_pk_bf16_f32 v55, v30, v31
    v_exp_f32 v32, v32
    ds_write_b128 v243, v[96:99] offset:0
    v_mfma_f32_32x32x16_bf16 v[16:31], a[16:19], v[164:167], 0
    v_exp_f32 v33, v33
    v_exp_f32 v34, v34
    v_cvt_pk_bf16_f32 v56, v32, v33
    v_exp_f32 v35, v35
    v_exp_f32 v36, v36
    v_mfma_f32_32x32x16_bf16 v[80:95], a[112:115], v[48:51], v[80:95]
    v_cvt_pk_bf16_f32 v57, v34, v35
    v_exp_f32 v37, v37
    v_exp_f32 v38, v38
    v_cvt_pk_bf16_f32 v58, v36, v37
    v_exp_f32 v39, v39
    v_mfma_f32_32x32x8_bf16 v[16:31], a[72:73], v[168:169], v[16:31]
    v_exp_f32 v40, v40
    v_cvt_pk_bf16_f32 v59, v38, v39
    v_exp_f32 v41, v41
    v_exp_f32 v42, v42
    v_cvt_pk_bf16_f32 v60, v40, v41
    v_exp_f32 v43, v43
    v_mfma_f32_32x32x16_bf16 v[80:95], a[116:119], v[52:55], v[80:95]
    v_exp_f32 v44, v44
    v_cvt_pk_bf16_f32 v61, v42, v43
    v_exp_f32 v45, v45
    v_exp_f32 v46, v46
    v_exp_f32 v47, v47
    v_cvt_pk_bf16_f32 v62, v44, v45
    v_cvt_pk_bf16_f32 v63, v46, v47
    v_exp_f32 v16, v16
    ds_write_b128 v243, v[100:103] offset:1024
    v_mfma_f32_32x32x16_bf16 v[32:47], a[20:23], v[164:167], 0
    v_exp_f32 v17, v17
    v_exp_f32 v18, v18
    v_cvt_pk_bf16_f32 v48, v16, v17
    v_exp_f32 v19, v19
    v_exp_f32 v20, v20
    v_mfma_f32_32x32x16_bf16 v[80:95], a[120:123], v[56:59], v[80:95]
    v_cvt_pk_bf16_f32 v49, v18, v19
    v_exp_f32 v21, v21
    v_exp_f32 v22, v22
    v_cvt_pk_bf16_f32 v50, v20, v21
    v_exp_f32 v23, v23
    v_mfma_f32_32x32x8_bf16 v[32:47], a[74:75], v[168:169], v[32:47]
    v_exp_f32 v24, v24
    v_cvt_pk_bf16_f32 v51, v22, v23
    v_exp_f32 v25, v25
    v_exp_f32 v26, v26
    v_cvt_pk_bf16_f32 v52, v24, v25
    v_exp_f32 v27, v27
    v_mfma_f32_32x32x16_bf16 v[80:95], a[124:127], v[60:63], v[80:95]
    v_exp_f32 v28, v28
    v_cvt_pk_bf16_f32 v53, v26, v27
    v_exp_f32 v29, v29
    v_exp_f32 v30, v30
    v_exp_f32 v31, v31
    v_cvt_pk_bf16_f32 v54, v28, v29
    v_cvt_pk_bf16_f32 v55, v30, v31
    v_exp_f32 v32, v32
    v_mfma_f32_32x32x16_bf16 v[16:31], a[24:27], v[164:167], 0
    v_exp_f32 v33, v33
    v_exp_f32 v34, v34
    v_cvt_pk_bf16_f32 v56, v32, v33
    v_exp_f32 v35, v35
    v_exp_f32 v36, v36
    v_mfma_f32_32x32x16_bf16 v[80:95], a[128:131], v[48:51], v[80:95]
    v_cvt_pk_bf16_f32 v57, v34, v35
    v_exp_f32 v37, v37
    v_exp_f32 v38, v38
    v_cvt_pk_bf16_f32 v58, v36, v37
    v_exp_f32 v39, v39
    v_mfma_f32_32x32x8_bf16 v[16:31], a[76:77], v[168:169], v[16:31]
    v_exp_f32 v40, v40
    v_cvt_pk_bf16_f32 v59, v38, v39
    v_exp_f32 v41, v41
    v_exp_f32 v42, v42
    v_cvt_pk_bf16_f32 v60, v40, v41
    v_exp_f32 v43, v43
    v_mfma_f32_32x32x16_bf16 v[80:95], a[132:135], v[52:55], v[80:95]
    v_exp_f32 v44, v44
    v_cvt_pk_bf16_f32 v61, v42, v43
    v_exp_f32 v45, v45
    v_exp_f32 v46, v46
    v_exp_f32 v47, v47
    v_cvt_pk_bf16_f32 v62, v44, v45
    v_cvt_pk_bf16_f32 v63, v46, v47
    v_exp_f32 v16, v16
    ds_write_b128 v243, v[104:107] offset:2048
    v_mfma_f32_32x32x16_bf16 v[32:47], a[28:31], v[164:167], 0
    v_exp_f32 v17, v17
    v_exp_f32 v18, v18
    v_cvt_pk_bf16_f32 v48, v16, v17
    v_exp_f32 v19, v19
    v_exp_f32 v20, v20
    v_mfma_f32_32x32x16_bf16 v[80:95], a[136:139], v[56:59], v[80:95]
    v_cvt_pk_bf16_f32 v49, v18, v19
    v_exp_f32 v21, v21
    v_exp_f32 v22, v22
    v_cvt_pk_bf16_f32 v50, v20, v21
    v_exp_f32 v23, v23
    v_mfma_f32_32x32x8_bf16 v[32:47], a[78:79], v[168:169], v[32:47]
    v_exp_f32 v24, v24
    v_cvt_pk_bf16_f32 v51, v22, v23
    v_exp_f32 v25, v25
    v_exp_f32 v26, v26
    v_cvt_pk_bf16_f32 v52, v24, v25
    v_exp_f32 v27, v27
    v_mfma_f32_32x32x16_bf16 v[80:95], a[140:143], v[60:63], v[80:95]
    v_exp_f32 v28, v28
    v_cvt_pk_bf16_f32 v53, v26, v27
    v_exp_f32 v29, v29
    v_exp_f32 v30, v30
    v_exp_f32 v31, v31
    v_cvt_pk_bf16_f32 v54, v28, v29
    v_cvt_pk_bf16_f32 v55, v30, v31
    v_exp_f32 v32, v32
    v_mfma_f32_32x32x16_bf16 v[16:31], a[32:35], v[164:167], 0
    v_exp_f32 v33, v33
    v_exp_f32 v34, v34
    v_cvt_pk_bf16_f32 v56, v32, v33
    v_exp_f32 v35, v35
    v_exp_f32 v36, v36
    v_mfma_f32_32x32x16_bf16 v[80:95], a[144:147], v[48:51], v[80:95]
    v_cvt_pk_bf16_f32 v57, v34, v35
    v_exp_f32 v37, v37
    v_exp_f32 v38, v38
    v_cvt_pk_bf16_f32 v58, v36, v37
    v_exp_f32 v39, v39
    v_mfma_f32_32x32x8_bf16 v[16:31], a[80:81], v[168:169], v[16:31]
    v_exp_f32 v40, v40
    v_cvt_pk_bf16_f32 v59, v38, v39
    v_exp_f32 v41, v41
    v_exp_f32 v42, v42
    v_cvt_pk_bf16_f32 v60, v40, v41
    v_exp_f32 v43, v43
    v_mfma_f32_32x32x16_bf16 v[80:95], a[148:151], v[52:55], v[80:95]
    v_exp_f32 v44, v44
    v_cvt_pk_bf16_f32 v61, v42, v43
    v_exp_f32 v45, v45
    v_exp_f32 v46, v46
    v_exp_f32 v47, v47
    v_cvt_pk_bf16_f32 v62, v44, v45
    v_cvt_pk_bf16_f32 v63, v46, v47
    v_exp_f32 v16, v16
    v_mfma_f32_32x32x16_bf16 v[32:47], a[36:39], v[164:167], 0
    v_exp_f32 v17, v17
    v_exp_f32 v18, v18
    v_cvt_pk_bf16_f32 v48, v16, v17
    v_exp_f32 v19, v19
    v_exp_f32 v20, v20
    v_mfma_f32_32x32x16_bf16 v[80:95], a[152:155], v[56:59], v[80:95]
    v_cvt_pk_bf16_f32 v49, v18, v19
    v_exp_f32 v21, v21
    v_exp_f32 v22, v22
    v_cvt_pk_bf16_f32 v50, v20, v21
    v_exp_f32 v23, v23
    v_mfma_f32_32x32x8_bf16 v[32:47], a[82:83], v[168:169], v[32:47]
    v_exp_f32 v24, v24
    v_cvt_pk_bf16_f32 v51, v22, v23
    v_exp_f32 v25, v25
    v_exp_f32 v26, v26
    v_cvt_pk_bf16_f32 v52, v24, v25
    v_exp_f32 v27, v27
    v_mfma_f32_32x32x16_bf16 v[80:95], a[156:159], v[60:63], v[80:95]
    v_exp_f32 v28, v28
    v_cvt_pk_bf16_f32 v53, v26, v27
    v_exp_f32 v29, v29
    v_exp_f32 v30, v30
    v_exp_f32 v31, v31
    v_cvt_pk_bf16_f32 v54, v28, v29
    v_cvt_pk_bf16_f32 v55, v30, v31
    v_exp_f32 v32, v32
    v_mfma_f32_32x32x16_bf16 v[16:31], a[40:43], v[164:167], 0
    v_exp_f32 v33, v33
    v_exp_f32 v34, v34
    v_cvt_pk_bf16_f32 v56, v32, v33
    v_exp_f32 v35, v35
    v_exp_f32 v36, v36
    v_mfma_f32_32x32x16_bf16 v[80:95], a[160:163], v[48:51], v[80:95]
    v_cvt_pk_bf16_f32 v57, v34, v35
    v_exp_f32 v37, v37
    v_exp_f32 v38, v38
    v_cvt_pk_bf16_f32 v58, v36, v37
    v_exp_f32 v39, v39
    v_mfma_f32_32x32x8_bf16 v[16:31], a[84:85], v[168:169], v[16:31]
    v_exp_f32 v40, v40
    v_cvt_pk_bf16_f32 v59, v38, v39
    v_exp_f32 v41, v41
    v_exp_f32 v42, v42
    v_cvt_pk_bf16_f32 v60, v40, v41
    v_exp_f32 v43, v43
    v_mfma_f32_32x32x16_bf16 v[80:95], a[164:167], v[52:55], v[80:95]
    v_exp_f32 v44, v44
    v_cvt_pk_bf16_f32 v61, v42, v43
    v_exp_f32 v45, v45
    v_exp_f32 v46, v46
    v_exp_f32 v47, v47
    v_cvt_pk_bf16_f32 v62, v44, v45
    v_cvt_pk_bf16_f32 v63, v46, v47
    v_exp_f32 v16, v16
    v_mfma_f32_32x32x16_bf16 v[32:47], a[44:47], v[164:167], 0
    v_exp_f32 v17, v17
    v_exp_f32 v18, v18
    v_cvt_pk_bf16_f32 v48, v16, v17
    v_exp_f32 v19, v19
    v_exp_f32 v20, v20
    v_mfma_f32_32x32x16_bf16 v[80:95], a[168:171], v[56:59], v[80:95]
    v_cvt_pk_bf16_f32 v49, v18, v19
    v_exp_f32 v21, v21
    v_exp_f32 v22, v22
    v_cvt_pk_bf16_f32 v50, v20, v21
    v_exp_f32 v23, v23
    v_mfma_f32_32x32x8_bf16 v[32:47], a[86:87], v[168:169], v[32:47]
    v_exp_f32 v24, v24
    v_cvt_pk_bf16_f32 v51, v22, v23
    v_exp_f32 v25, v25
    v_exp_f32 v26, v26
    v_cvt_pk_bf16_f32 v52, v24, v25
    v_exp_f32 v27, v27
    v_mfma_f32_32x32x16_bf16 v[80:95], a[172:175], v[60:63], v[80:95]
    v_exp_f32 v28, v28
    v_cvt_pk_bf16_f32 v53, v26, v27
    v_exp_f32 v29, v29
    v_exp_f32 v30, v30
    v_exp_f32 v31, v31
    v_cvt_pk_bf16_f32 v54, v28, v29
    v_cvt_pk_bf16_f32 v55, v30, v31
    v_exp_f32 v32, v32
    v_mfma_f32_32x32x16_bf16 v[16:31], a[48:51], v[164:167], 0
    v_exp_f32 v33, v33
    v_exp_f32 v34, v34
    v_cvt_pk_bf16_f32 v56, v32, v33
    v_exp_f32 v35, v35
    v_exp_f32 v36, v36
    v_mfma_f32_32x32x16_bf16 v[80:95], a[176:179], v[48:51], v[80:95]
    v_cvt_pk_bf16_f32 v57, v34, v35
    v_exp_f32 v37, v37
    v_exp_f32 v38, v38
    v_cvt_pk_bf16_f32 v58, v36, v37
    v_exp_f32 v39, v39
    v_mfma_f32_32x32x8_bf16 v[16:31], a[88:89], v[168:169], v[16:31]
    v_exp_f32 v40, v40
    v_cvt_pk_bf16_f32 v59, v38, v39
    v_exp_f32 v41, v41
    v_exp_f32 v42, v42
    v_cvt_pk_bf16_f32 v60, v40, v41
    v_exp_f32 v43, v43
    v_mfma_f32_32x32x16_bf16 v[80:95], a[180:183], v[52:55], v[80:95]
    v_exp_f32 v44, v44
    v_cvt_pk_bf16_f32 v61, v42, v43
    v_exp_f32 v45, v45
    v_exp_f32 v46, v46
    v_exp_f32 v47, v47
    v_cvt_pk_bf16_f32 v62, v44, v45
    v_cvt_pk_bf16_f32 v63, v46, v47
    v_exp_f32 v16, v16
    v_mfma_f32_32x32x16_bf16 v[32:47], a[52:55], v[164:167], 0
    v_exp_f32 v17, v17
    v_exp_f32 v18, v18
    v_cvt_pk_bf16_f32 v48, v16, v17
    v_exp_f32 v19, v19
    v_exp_f32 v20, v20
    v_mfma_f32_32x32x16_bf16 v[80:95], a[184:187], v[56:59], v[80:95]
    v_cvt_pk_bf16_f32 v49, v18, v19
    v_exp_f32 v21, v21
    v_exp_f32 v22, v22
    v_cvt_pk_bf16_f32 v50, v20, v21
    v_exp_f32 v23, v23
    v_mfma_f32_32x32x8_bf16 v[32:47], a[90:91], v[168:169], v[32:47]
    v_exp_f32 v24, v24
    v_cvt_pk_bf16_f32 v51, v22, v23
    v_exp_f32 v25, v25
    v_exp_f32 v26, v26
    v_cvt_pk_bf16_f32 v52, v24, v25
    v_exp_f32 v27, v27
    v_mfma_f32_32x32x16_bf16 v[80:95], a[188:191], v[60:63], v[80:95]
    v_exp_f32 v28, v28
    v_cvt_pk_bf16_f32 v53, v26, v27
    v_exp_f32 v29, v29
    v_exp_f32 v30, v30
    v_exp_f32 v31, v31
    v_cvt_pk_bf16_f32 v54, v28, v29
    v_cvt_pk_bf16_f32 v55, v30, v31
    v_exp_f32 v32, v32
    v_mfma_f32_32x32x16_bf16 v[16:31], a[56:59], v[164:167], 0
    v_exp_f32 v33, v33
    v_exp_f32 v34, v34
    v_cvt_pk_bf16_f32 v56, v32, v33
    v_exp_f32 v35, v35
    v_exp_f32 v36, v36
    v_mfma_f32_32x32x16_bf16 v[80:95], a[192:195], v[48:51], v[80:95]
    v_cvt_pk_bf16_f32 v57, v34, v35
    v_exp_f32 v37, v37
    v_exp_f32 v38, v38
    v_cvt_pk_bf16_f32 v58, v36, v37
    v_exp_f32 v39, v39
    v_mfma_f32_32x32x8_bf16 v[16:31], a[92:93], v[168:169], v[16:31]
    v_exp_f32 v40, v40
    v_cvt_pk_bf16_f32 v59, v38, v39
    v_exp_f32 v41, v41
    v_exp_f32 v42, v42
    v_cvt_pk_bf16_f32 v60, v40, v41
    v_exp_f32 v43, v43
    v_mfma_f32_32x32x16_bf16 v[80:95], a[196:199], v[52:55], v[80:95]
    v_exp_f32 v44, v44
    v_cvt_pk_bf16_f32 v61, v42, v43
    v_exp_f32 v45, v45
    v_exp_f32 v46, v46
    v_exp_f32 v47, v47
    v_cvt_pk_bf16_f32 v62, v44, v45
    v_cvt_pk_bf16_f32 v63, v46, v47
    v_exp_f32 v16, v16
    v_mfma_f32_32x32x16_bf16 v[32:47], a[60:63], v[164:167], 0
    v_exp_f32 v17, v17
    v_exp_f32 v18, v18
    v_cvt_pk_bf16_f32 v48, v16, v17
    v_exp_f32 v19, v19
    v_exp_f32 v20, v20
    v_mfma_f32_32x32x16_bf16 v[80:95], a[200:203], v[56:59], v[80:95]
    v_cvt_pk_bf16_f32 v49, v18, v19
    v_exp_f32 v21, v21
    v_exp_f32 v22, v22
    v_cvt_pk_bf16_f32 v50, v20, v21
    v_exp_f32 v23, v23
    v_mfma_f32_32x32x8_bf16 v[32:47], a[94:95], v[168:169], v[32:47]
    v_exp_f32 v24, v24
    v_cvt_pk_bf16_f32 v51, v22, v23
    v_exp_f32 v25, v25
    v_exp_f32 v26, v26
    v_cvt_pk_bf16_f32 v52, v24, v25
    v_exp_f32 v27, v27
    v_mfma_f32_32x32x16_bf16 v[80:95], a[204:207], v[60:63], v[80:95]
    v_exp_f32 v28, v28
    v_cvt_pk_bf16_f32 v53, v26, v27
    v_exp_f32 v29, v29
    v_exp_f32 v30, v30
    v_exp_f32 v31, v31
    v_cvt_pk_bf16_f32 v54, v28, v29
    v_cvt_pk_bf16_f32 v55, v30, v31
    v_exp_f32 v32, v32
    v_mfma_f32_32x32x16_bf16 v[16:31], a[0:3], v[170:173], 0
    v_exp_f32 v33, v33
    v_exp_f32 v34, v34
    v_cvt_pk_bf16_f32 v56, v32, v33
    v_exp_f32 v35, v35
    v_exp_f32 v36, v36
    v_mfma_f32_32x32x16_bf16 v[80:95], a[208:211], v[48:51], v[80:95]
    v_cvt_pk_bf16_f32 v57, v34, v35
    v_exp_f32 v37, v37
    v_exp_f32 v38, v38
    v_cvt_pk_bf16_f32 v58, v36, v37
    v_exp_f32 v39, v39
    v_mfma_f32_32x32x8_bf16 v[16:31], a[64:65], v[174:175], v[16:31]
    v_exp_f32 v40, v40
    v_cvt_pk_bf16_f32 v59, v38, v39
    v_exp_f32 v41, v41
    v_exp_f32 v42, v42
    v_cvt_pk_bf16_f32 v60, v40, v41
    v_exp_f32 v43, v43
    v_mfma_f32_32x32x16_bf16 v[80:95], a[212:215], v[52:55], v[80:95]
    v_exp_f32 v44, v44
    v_cvt_pk_bf16_f32 v61, v42, v43
    v_exp_f32 v45, v45
    v_exp_f32 v46, v46
    v_exp_f32 v47, v47
    v_cvt_pk_bf16_f32 v62, v44, v45
    v_cvt_pk_bf16_f32 v63, v46, v47
    s_branch mg_tau7
mg_btr:
    s_add_u32 s27, s44, 0
    buffer_load_dwordx4 a[0:3], v4, s[8:11], s27 offen
    s_add_u32 s28, s45, 0
    buffer_load_dwordx2 a[64:65], v5, s[8:11], s28 offen
    s_add_u32 s29, s46, 0
    buffer_load_dwordx4 a[96:99], v8, s[8:11], s29 offen
    buffer_load_dwordx4 a[100:103], v8, s[8:11], s29 offen offset:1024
    v_mov_b32 v12, 161024
    v_mov_b32 v13, 0
    ds_write_b32 v12, v13
    s_lshl_b32 s35, s20, 1
    s_add_u32 s36, s35, 2
    s_and_b32 s36, s36, 7
    s_mul_i32 s36, s36, 1280
    v_add_u32 v16, s36, v231
    ds_read_b128 v[128:131], v16
    v_mov_b32 v132, 0
    v_mov_b32 v133, 0
    s_add_u32 s36, s35, 3
    s_and_b32 s36, s36, 7
    s_mul_i32 s36, s36, 1280
    v_add_u32 v17, s36, v231
    ds_read_b128 v[134:137], v17
    v_mov_b32 v138, 0
    v_mov_b32 v139, 0
    s_add_u32 s36, s35, 4
    s_and_b32 s36, s36, 7
    s_mul_i32 s36, s36, 1280
    v_add_u32 v18, s36, v231
    ds_read_b128 v[140:143], v18
    v_mov_b32 v144, 0
    v_mov_b32 v145, 0
    s_add_u32 s36, s35, 5
    s_and_b32 s36, s36, 7
    s_mul_i32 s36, s36, 1280
    v_add_u32 v19, s36, v231
    ds_read_b128 v[146:149], v19
    v_mov_b32 v150, 0
    v_mov_b32 v151, 0
    s_add_u32 s36, s35, 6
    s_and_b32 s36, s36, 7
    s_mul_i32 s36, s36, 1280
    v_add_u32 v20, s36, v231
    ds_read_b128 v[152:155], v20
    v_mov_b32 v156, 0
    v_mov_b32 v157, 0
    s_add_u32 s36, s35, 7
    s_and_b32 s36, s36, 7
    s_mul_i32 s36, s36, 1280
    v_add_u32 v21, s36, v231
    ds_read_b128 v[158:161], v21
    v_mov_b32 v162, 0
    v_mov_b32 v163, 0
    s_add_u32 s36, s35, 8
    s_and_b32 s36, s36, 7
    s_mul_i32 s36, s36, 1280
    v_add_u32 v22, s36, v231
    ds_read_b128 v[164:167], v22
    v_mov_b32 v168, 0
    v_mov_b32 v169, 0
    s_add_u32 s36, s35, 9
    s_and_b32 s36, s36, 7
    s_mul_i32 s36, s36, 1280
    v_add_u32 v23, s36, v231
    ds_read_b128 v[170:173], v23
    v_mov_b32 v174, 0
    v_mov_b32 v175, 0
    s_mov_b32 exec_hi, 0
    v_sub_u32 v24, v16, v232
    ds_read_b64 v[132:133], v24 offset:1024
    v_sub_u32 v25, v17, v232
    ds_read_b64 v[138:139], v25 offset:1024
    v_sub_u32 v26, v18, v232
    ds_read_b64 v[144:145], v26 offset:1024
    v_sub_u32 v27, v19, v232
    ds_read_b64 v[150:151], v27 offset:1024
    v_sub_u32 v28, v20, v232
    ds_read_b64 v[156:157], v28 offset:1024
    v_sub_u32 v29, v21, v232
    ds_read_b64 v[162:163], v29 offset:1024
    v_sub_u32 v30, v22, v232
    ds_read_b64 v[168:169], v30 offset:1024
    v_sub_u32 v31, v23, v232
    ds_read_b64 v[174:175], v31 offset:1024
    s_mov_b32 exec_hi, -1
    s_add_u32 s27, s44, 1024
    buffer_load_dwordx4 a[4:7], v4, s[8:11], s27 offen
    s_add_u32 s28, s45, 512
    buffer_load_dwordx2 a[66:67], v5, s[8:11], s28 offen
    s_add_u32 s29, s46, 2048
    buffer_load_dwordx4 a[104:107], v8, s[8:11], s29 offen
    buffer_load_dwordx4 a[108:111], v8, s[8:11], s29 offen offset:1024
    s_add_u32 s27, s44, 2048
    buffer_load_dwordx4 a[8:11], v4, s[8:11], s27 offen
    s_add_u32 s28, s45, 1024
    buffer_load_dwordx2 a[68:69], v5, s[8:11], s28 offen
    s_add_u32 s29, s46, 4096
    buffer_load_dwordx4 a[112:115], v8, s[8:11], s29 offen
    buffer_load_dwordx4 a[116:119], v8, s[8:11], s29 offen offset:1024
    s_add_u32 s27, s44, 3072
    buffer_load_dwordx4 a[12:15], v4, s[8:11], s27 offen
    s_add_u32 s28, s45, 1536
    buffer_load_dwordx2 a[70:71], v5, s[8:11], s28 offen
    s_add_u32 s29, s46, 6144
    buffer_load_dwordx4 a[120:123], v8, s[8:11], s29 offen
    buffer_load_dwordx4 a[124:127], v8, s[8:11], s29 offen offset:1024
    s_add_u32 s27, s44, 4096
    buffer_load_dwordx4 a[16:19], v4, s[8:11], s27 offen
    s_add_u32 s28, s45, 2048
    buffer_load_dwordx2 a[72:73], v5, s[8:11], s28 offen
    s_add_u32 s29, s46, 8192
    buffer_load_dwordx4 a[128:131], v8, s[8:11], s29 offen
    buffer_load_dwordx4 a[132:135], v8, s[8:11], s29 offen offset:1024
    s_add_u32 s27, s44, 5120
    buffer_load_dwordx4 a[20:23], v4, s[8:11], s27 offen
    s_add_u32 s28, s45, 2560
    buffer_load_dwordx2 a[74:75], v5, s[8:11], s28 offen
    s_mul_i32 s21, s23, 160
    s_add_u32 s40, s90, s21
    s_addc_u32 s41, s91, 0
    s_mov_b32 s42, 0
    s_mov_b32 s43, 0x20000
    s_sub_u32 s42, 819200, s21
    s_mov_b32 s48, s64
    s_mov_b32 s49, s65
    s_mov_b32 s50, 2621440
    s_mov_b32 s51, 0x20000
    s_waitcnt lgkmcnt(0)
    s_barrier
    s_waitcnt vmcnt(20)
    v_mfma_f32_32x32x16_bf16 v[16:31], a[0:3], v[128:131], 0
    v_mfma_f32_32x32x8_bf16 v[16:31], a[64:65], v[132:133], v[16:31]
    s_nop 7
    s_nop 3
    s_waitcnt vmcnt(16)
    v_exp_f32 v16, v16
    s_add_u32 s27, s44, 6144
    v_mfma_f32_32x32x16_bf16 v[32:47], a[4:7], v[128:131], 0
    v_exp_f32 v17, v17
    v_exp_f32 v18, v18
    buffer_load_dwordx4 a[24:27], v4, s[8:11], s27 offen
    v_cvt_pk_bf16_f32 v48, v16, v17
    v_exp_f32 v19, v19
    v_exp_f32 v20, v20
    s_add_u32 s28, s45, 3072
    v_cvt_pk_bf16_f32 v49, v18, v19
    v_exp_f32 v21, v21
    v_exp_f32 v22, v22
    buffer_load_dwordx2 a[76:77], v5, s[8:11], s28 offen
    v_cvt_pk_bf16_f32 v50, v20, v21
    v_exp_f32 v23, v23
    v_mfma_f32_32x32x8_bf16 v[32:47], a[66:67], v[132:133], v[32:47]
    v_exp_f32 v24, v24
    v_cvt_pk_bf16_f32 v51, v22, v23
    v_exp_f32 v25, v25
    s_add_u32 s29, s46, 10240
    v_exp_f32 v26, v26
    v_cvt_pk_bf16_f32 v52, v24, v25
    v_exp_f32 v27, v27
    buffer_load_dwordx4 a[136:139], v8, s[8:11], s29 offen
    v_exp_f32 v28, v28
    v_cvt_pk_bf16_f32 v53, v26, v27
    v_exp_f32 v29, v29
    buffer_load_dwordx4 a[140:143], v8, s[8:11], s29 offen offset:1024
    v_exp_f32 v30, v30
    v_exp_f32 v31, v31
    v_cvt_pk_bf16_f32 v54, v28, v29
    v_cvt_pk_bf16_f32 v55, v30, v31
    s_waitcnt vmcnt(16)
    v_exp_f32 v32, v32
    s_add_u32 s27, s44, 7168
    v_mfma_f32_32x32x16_bf16 v[16:31], a[8:11], v[128:131], 0
    v_exp_f32 v33, v33
    v_exp_f32 v34, v34
    buffer_load_dwordx4 a[28:31], v4, s[8:11], s27 offen
    v_cvt_pk_bf16_f32 v56, v32, v33
    v_exp_f32 v35, v35
    v_exp_f32 v36, v36
    s_add_u32 s28, s45, 3584
    v_mfma_f32_32x32x16_bf16 v[80:95], a[96:99], v[48:51], 0
    v_cvt_pk_bf16_f32 v57, v34, v35
    v_exp_f32 v37, v37
    v_exp_f32 v38, v38
    buffer_load_dwordx2 a[78:79], v5, s[8:11], s28 offen
    v_cvt_pk_bf16_f32 v58, v36, v37
    v_exp_f32 v39, v39
    v_mfma_f32_32x32x8_bf16 v[16:31], a[68:69], v[132:133], v[16:31]
    v_exp_f32 v40, v40
    v_cvt_pk_bf16_f32 v59, v38, v39
    v_exp_f32 v41, v41
    s_add_u32 s29, s46, 12288
    v_exp_f32 v42, v42
    v_cvt_pk_bf16_f32 v60, v40, v41
    v_exp_f32 v43, v43
    buffer_load_dwordx4 a[144:147], v8, s[8:11], s29 offen
    v_mfma_f32_32x32x16_bf16 v[80:95], a[100:103], v[52:55], v[80:95]
    v_exp_f32 v44, v44
    v_cvt_pk_bf16_f32 v61, v42, v43
    v_exp_f32 v45, v45
    buffer_load_dwordx4 a[148:151], v8, s[8:11], s29 offen offset:1024
    v_exp_f32 v46, v46
    v_exp_f32 v47, v47
    v_cvt_pk_bf16_f32 v62, v44, v45
    v_cvt_pk_bf16_f32 v63, v46, v47
    s_waitcnt vmcnt(16)
    v_exp_f32 v16, v16
    s_add_u32 s27, s44, 8192
    v_mfma_f32_32x32x16_bf16 v[32:47], a[12:15], v[128:131], 0
    v_exp_f32 v17, v17
    v_exp_f32 v18, v18
    buffer_load_dwordx4 a[32:35], v4, s[8:11], s27 offen
    v_cvt_pk_bf16_f32 v48, v16, v17
    v_exp_f32 v19, v19
    v_exp_f32 v20, v20
    s_add_u32 s28, s45, 4096
    v_mfma_f32_32x32x16_bf16 v[80:95], a[104:107], v[56:59], v[80:95]
    v_cvt_pk_bf16_f32 v49, v18, v19
    v_exp_f32 v21, v21
    v_exp_f32 v22, v22
    buffer_load_dwordx2 a[80:81], v5, s[8:11], s28 offen
    v_cvt_pk_bf16_f32 v50, v20, v21
    v_exp_f32 v23, v23
    v_mfma_f32_32x32x8_bf16 v[32:47], a[70:71], v[132:133], v[32:47]
    v_exp_f32 v24, v24
    v_cvt_pk_bf16_f32 v51, v22, v23
    v_exp_f32 v25, v25
    s_add_u32 s29, s46, 14336
    v_exp_f32 v26, v26
    v_cvt_pk_bf16_f32 v52, v24, v25
    v_exp_f32 v27, v27
    buffer_load_dwordx4 a[152:155], v8, s[8:11], s29 offen
    v_mfma_f32_32x32x16_bf16 v[80:95], a[108:111], v[60:63], v[80:95]
    v_exp_f32 v28, v28
    v_cvt_pk_bf16_f32 v53, v26, v27
    v_exp_f32 v29, v29
    buffer_load_dwordx4 a[156:159], v8, s[8:11], s29 offen offset:1024
    v_exp_f32 v30, v30
    v_exp_f32 v31, v31
    v_cvt_pk_bf16_f32 v54, v28, v29
    v_cvt_pk_bf16_f32 v55, v30, v31
    s_waitcnt vmcnt(16)
    v_exp_f32 v32, v32
    s_add_u32 s27, s44, 9216
    v_mfma_f32_32x32x16_bf16 v[16:31], a[16:19], v[128:131], 0
    v_exp_f32 v33, v33
    v_exp_f32 v34, v34
    buffer_load_dwordx4 a[36:39], v4, s[8:11], s27 offen
    v_cvt_pk_bf16_f32 v56, v32, v33
    v_exp_f32 v35, v35
    v_exp_f32 v36, v36
    s_add_u32 s28, s45, 4608
    v_mfma_f32_32x32x16_bf16 v[80:95], a[112:115], v[48:51], v[80:95]
    v_cvt_pk_bf16_f32 v57, v34, v35
    v_exp_f32 v37, v37
    v_exp_f32 v38, v38
    buffer_load_dwordx2 a[82:83], v5, s[8:11], s28 offen
    v_cvt_pk_bf16_f32 v58, v36, v37
    v_exp_f32 v39, v39
    v_mfma_f32_32x32x8_bf16 v[16:31], a[72:73], v[132:133], v[16:31]
    v_exp_f32 v40, v40
    v_cvt_pk_bf16_f32 v59, v38, v39
    v_exp_f32 v41, v41
    s_add_u32 s29, s46, 16384
    v_exp_f32 v42, v42
    v_cvt_pk_bf16_f32 v60, v40, v41
    v_exp_f32 v43, v43
    buffer_load_dwordx4 a[160:163], v8, s[8:11], s29 offen
    v_mfma_f32_32x32x16_bf16 v[80:95], a[116:119], v[52:55], v[80:95]
    v_exp_f32 v44, v44
    v_cvt_pk_bf16_f32 v61, v42, v43
    v_exp_f32 v45, v45
    buffer_load_dwordx4 a[164:167], v8, s[8:11], s29 offen offset:1024
    v_exp_f32 v46, v46
    v_exp_f32 v47, v47
    v_cvt_pk_bf16_f32 v62, v44, v45
    v_cvt_pk_bf16_f32 v63, v46, v47
    s_waitcnt vmcnt(16)
    v_exp_f32 v16, v16
    s_add_u32 s27, s44, 10240
    v_mfma_f32_32x32x16_bf16 v[32:47], a[20:23], v[128:131], 0
    v_exp_f32 v17, v17
    v_exp_f32 v18, v18
    buffer_load_dwordx4 a[40:43], v4, s[8:11], s27 offen
    v_cvt_pk_bf16_f32 v48, v16, v17
    v_exp_f32 v19, v19
    v_exp_f32 v20, v20
    s_add_u32 s28, s45, 5120
    v_mfma_f32_32x32x16_bf16 v[80:95], a[120:123], v[56:59], v[80:95]
    v_cvt_pk_bf16_f32 v49, v18, v19
    v_exp_f32 v21, v21
    v_exp_f32 v22, v22
    buffer_load_dwordx2 a[84:85], v5, s[8:11], s28 offen
    v_cvt_pk_bf16_f32 v50, v20, v21
    v_exp_f32 v23, v23
    v_mfma_f32_32x32x8_bf16 v[32:47], a[74:75], v[132:133], v[32:47]
    v_exp_f32 v24, v24
    v_cvt_pk_bf16_f32 v51, v22, v23
    v_exp_f32 v25, v25
    s_add_u32 s29, s46, 18432
    v_exp_f32 v26, v26
    v_cvt_pk_bf16_f32 v52, v24, v25
    v_exp_f32 v27, v27
    buffer_load_dwordx4 a[168:171], v8, s[8:11], s29 offen
    v_mfma_f32_32x32x16_bf16 v[80:95], a[124:127], v[60:63], v[80:95]
    v_exp_f32 v28, v28
    v_cvt_pk_bf16_f32 v53, v26, v27
    v_exp_f32 v29, v29
    buffer_load_dwordx4 a[172:175], v8, s[8:11], s29 offen offset:1024
    v_exp_f32 v30, v30
    v_exp_f32 v31, v31
    v_cvt_pk_bf16_f32 v54, v28, v29
    v_cvt_pk_bf16_f32 v55, v30, v31
    s_waitcnt vmcnt(18)
    v_exp_f32 v32, v32
    s_add_u32 s27, s44, 11264
    v_mfma_f32_32x32x16_bf16 v[16:31], a[24:27], v[128:131], 0
    v_exp_f32 v33, v33
    v_exp_f32 v34, v34
    buffer_load_dwordx4 a[44:47], v4, s[8:11], s27 offen
    v_cvt_pk_bf16_f32 v56, v32, v33
    v_exp_f32 v35, v35
    v_exp_f32 v36, v36
    s_add_u32 s28, s45, 5632
    v_mfma_f32_32x32x16_bf16 v[80:95], a[128:131], v[48:51], v[80:95]
    v_cvt_pk_bf16_f32 v57, v34, v35
    v_exp_f32 v37, v37
    v_exp_f32 v38, v38
    buffer_load_dwordx2 a[86:87], v5, s[8:11], s28 offen
    v_cvt_pk_bf16_f32 v58, v36, v37
    v_exp_f32 v39, v39
    v_mfma_f32_32x32x8_bf16 v[16:31], a[76:77], v[132:133], v[16:31]
    v_exp_f32 v40, v40
    v_cvt_pk_bf16_f32 v59, v38, v39
    v_exp_f32 v41, v41
    s_add_u32 s29, s46, 20480
    v_exp_f32 v42, v42
    v_cvt_pk_bf16_f32 v60, v40, v41
    v_exp_f32 v43, v43
    buffer_load_dwordx4 a[176:179], v8, s[8:11], s29 offen
    v_mfma_f32_32x32x16_bf16 v[80:95], a[132:135], v[52:55], v[80:95]
    v_exp_f32 v44, v44
    v_cvt_pk_bf16_f32 v61, v42, v43
    v_exp_f32 v45, v45
    buffer_load_dwordx4 a[180:183], v8, s[8:11], s29 offen offset:1024
    v_exp_f32 v46, v46
    v_exp_f32 v47, v47
    v_cvt_pk_bf16_f32 v62, v44, v45
    v_cvt_pk_bf16_f32 v63, v46, v47
    s_waitcnt vmcnt(18)
    v_exp_f32 v16, v16
    s_add_u32 s27, s44, 12288
    v_mfma_f32_32x32x16_bf16 v[32:47], a[28:31], v[128:131], 0
    v_exp_f32 v17, v17
    v_exp_f32 v18, v18
    buffer_load_dwordx4 a[48:51], v4, s[8:11], s27 offen
    v_cvt_pk_bf16_f32 v48, v16, v17
    v_exp_f32 v19, v19
    v_exp_f32 v20, v20
    s_add_u32 s28, s45, 6144
    v_mfma_f32_32x32x16_bf16 v[80:95], a[136:139], v[56:59], v[80:95]
    v_cvt_pk_bf16_f32 v49, v18, v19
    v_exp_f32 v21, v21
    v_exp_f32 v22, v22
    buffer_load_dwordx2 a[88:89], v5, s[8:11], s28 offen
    v_cvt_pk_bf16_f32 v50, v20, v21
    v_exp_f32 v23, v23
    v_mfma_f32_32x32x8_bf16 v[32:47], a[78:79], v[132:133], v[32:47]
    v_exp_f32 v24, v24
    v_cvt_pk_bf16_f32 v51, v22, v23
    v_exp_f32 v25, v25
    s_add_u32 s29, s46, 22528
    v_exp_f32 v26, v26
    v_cvt_pk_bf16_f32 v52, v24, v25
    v_exp_f32 v27, v27
    buffer_load_dwordx4 a[184:187], v8, s[8:11], s29 offen
    v_mfma_f32_32x32x16_bf16 v[80:95], a[140:143], v[60:63], v[80:95]
    v_exp_f32 v28, v28
    v_cvt_pk_bf16_f32 v53, v26, v27
    v_exp_f32 v29, v29
    buffer_load_dwordx4 a[188:191], v8, s[8:11], s29 offen offset:1024
    v_exp_f32 v30, v30
    v_exp_f32 v31, v31
    v_cvt_pk_bf16_f32 v54, v28, v29
    v_cvt_pk_bf16_f32 v55, v30, v31
    s_waitcnt vmcnt(18)
    v_exp_f32 v32, v32
    s_add_u32 s27, s44, 13312
    v_mfma_f32_32x32x16_bf16 v[16:31], a[32:35], v[128:131], 0
    v_exp_f32 v33, v33
    v_exp_f32 v34, v34
    buffer_load_dwordx4 a[52:55], v4, s[8:11], s27 offen
    v_cvt_pk_bf16_f32 v56, v32, v33
    v_exp_f32 v35, v35
    v_exp_f32 v36, v36
    s_add_u32 s28, s45, 6656
    v_mfma_f32_32x32x16_bf16 v[80:95], a[144:147], v[48:51], v[80:95]
    v_cvt_pk_bf16_f32 v57, v34, v35
    v_exp_f32 v37, v37
    v_exp_f32 v38, v38
    buffer_load_dwordx2 a[90:91], v5, s[8:11], s28 offen
    v_cvt_pk_bf16_f32 v58, v36, v37
    v_exp_f32 v39, v39
    v_mfma_f32_32x32x8_bf16 v[16:31], a[80:81], v[132:133], v[16:31]
    v_exp_f32 v40, v40
    v_cvt_pk_bf16_f32 v59, v38, v39
    v_exp_f32 v41, v41
    s_add_u32 s29, s46, 24576
    v_exp_f32 v42, v42
    v_cvt_pk_bf16_f32 v60, v40, v41
    v_exp_f32 v43, v43
    buffer_load_dwordx4 a[192:195], v8, s[8:11], s29 offen
    v_mfma_f32_32x32x16_bf16 v[80:95], a[148:151], v[52:55], v[80:95]
    v_exp_f32 v44, v44
    v_cvt_pk_bf16_f32 v61, v42, v43
    v_exp_f32 v45, v45
    buffer_load_dwordx4 a[196:199], v8, s[8:11], s29 offen offset:1024
    v_exp_f32 v46, v46
    v_exp_f32 v47, v47
    v_cvt_pk_bf16_f32 v62, v44, v45
    v_cvt_pk_bf16_f32 v63, v46, v47
    s_waitcnt vmcnt(18)
    v_exp_f32 v16, v16
    s_add_u32 s27, s44, 14336
    v_mfma_f32_32x32x16_bf16 v[32:47], a[36:39], v[128:131], 0
    v_exp_f32 v17, v17
    v_exp_f32 v18, v18
    buffer_load_dwordx4 a[56:59], v4, s[8:11], s27 offen
    v_cvt_pk_bf16_f32 v48, v16, v17
    v_exp_f32 v19, v19
    v_exp_f32 v20, v20
    s_add_u32 s28, s45, 7168
    v_mfma_f32_32x32x16_bf16 v[80:95], a[152:155], v[56:59], v[80:95]
    v_cvt_pk_bf16_f32 v49, v18, v19
    v_exp_f32 v21, v21
    v_exp_f32 v22, v22
    buffer_load_dwordx2 a[92:93], v5, s[8:11], s28 offen
    v_cvt_pk_bf16_f32 v50, v20, v21
    v_exp_f32 v23, v23
    v_mfma_f32_32x32x8_bf16 v[32:47], a[82:83], v[132:133], v[32:47]
    v_exp_f32 v24, v24
    v_cvt_pk_bf16_f32 v51, v22, v23
    v_exp_f32 v25, v25
    s_add_u32 s29, s46, 26624
    v_exp_f32 v26, v26
    v_cvt_pk_bf16_f32 v52, v24, v25
    v_exp_f32 v27, v27
    buffer_load_dwordx4 a[200:203], v8, s[8:11], s29 offen
    v_mfma_f32_32x32x16_bf16 v[80:95], a[156:159], v[60:63], v[80:95]
    v_exp_f32 v28, v28
    v_cvt_pk_bf16_f32 v53, v26, v27
    v_exp_f32 v29, v29
    buffer_load_dwordx4 a[204:207], v8, s[8:11], s29 offen offset:1024
    v_exp_f32 v30, v30
    v_exp_f32 v31, v31
    v_cvt_pk_bf16_f32 v54, v28, v29
    v_cvt_pk_bf16_f32 v55, v30, v31
    s_waitcnt vmcnt(18)
    v_exp_f32 v32, v32
    s_add_u32 s27, s44, 15360
    v_mfma_f32_32x32x16_bf16 v[16:31], a[40:43], v[128:131], 0
    v_exp_f32 v33, v33
    v_exp_f32 v34, v34
    buffer_load_dwordx4 a[60:63], v4, s[8:11], s27 offen
    v_cvt_pk_bf16_f32 v56, v32, v33
    v_exp_f32 v35, v35
    v_exp_f32 v36, v36
    s_add_u32 s28, s45, 7680
    v_mfma_f32_32x32x16_bf16 v[80:95], a[160:163], v[48:51], v[80:95]
    v_cvt_pk_bf16_f32 v57, v34, v35
    v_exp_f32 v37, v37
    v_exp_f32 v38, v38
    buffer_load_dwordx2 a[94:95], v5, s[8:11], s28 offen
    v_cvt_pk_bf16_f32 v58, v36, v37
    v_exp_f32 v39, v39
    v_mfma_f32_32x32x8_bf16 v[16:31], a[84:85], v[132:133], v[16:31]
    v_exp_f32 v40, v40
    v_cvt_pk_bf16_f32 v59, v38, v39
    v_exp_f32 v41, v41
    s_add_u32 s29, s46, 28672
    v_exp_f32 v42, v42
    v_cvt_pk_bf16_f32 v60, v40, v41
    v_exp_f32 v43, v43
    buffer_load_dwordx4 a[208:211], v8, s[8:11], s29 offen
    v_mfma_f32_32x32x16_bf16 v[80:95], a[164:167], v[52:55], v[80:95]
    v_exp_f32 v44, v44
    v_cvt_pk_bf16_f32 v61, v42, v43
    v_exp_f32 v45, v45
    buffer_load_dwordx4 a[212:215], v8, s[8:11], s29 offen offset:1024
    v_exp_f32 v46, v46
    v_exp_f32 v47, v47
    v_cvt_pk_bf16_f32 v62, v44, v45
    v_cvt_pk_bf16_f32 v63, v46, v47
    s_waitcnt vmcnt(18)
    v_exp_f32 v16, v16
    s_add_u32 s29, s46, 30720
    v_mfma_f32_32x32x16_bf16 v[32:47], a[44:47], v[128:131], 0
    v_exp_f32 v17, v17
    v_exp_f32 v18, v18
    v_cvt_pk_bf16_f32 v48, v16, v17
    v_exp_f32 v19, v19
    v_exp_f32 v20, v20
    v_mfma_f32_32x32x16_bf16 v[80:95], a[168:171], v[56:59], v[80:95]
    v_cvt_pk_bf16_f32 v49, v18, v19
    v_exp_f32 v21, v21
    buffer_load_dwordx4 a[216:219], v8, s[8:11], s29 offen
    v_exp_f32 v22, v22
    v_cvt_pk_bf16_f32 v50, v20, v21
    v_exp_f32 v23, v23
    v_mfma_f32_32x32x8_bf16 v[32:47], a[86:87], v[132:133], v[32:47]
    v_exp_f32 v24, v24
    v_cvt_pk_bf16_f32 v51, v22, v23
    v_exp_f32 v25, v25
    v_exp_f32 v26, v26
    buffer_load_dwordx4 a[220:223], v8, s[8:11], s29 offen offset:1024
    v_cvt_pk_bf16_f32 v52, v24, v25
    v_exp_f32 v27, v27
    v_mfma_f32_32x32x16_bf16 v[80:95], a[172:175], v[60:63], v[80:95]
    v_exp_f32 v28, v28
    v_cvt_pk_bf16_f32 v53, v26, v27
    v_exp_f32 v29, v29
    v_exp_f32 v30, v30
    v_exp_f32 v31, v31
    v_cvt_pk_bf16_f32 v54, v28, v29
    v_cvt_pk_bf16_f32 v55, v30, v31
    s_waitcnt vmcnt(16)
    v_exp_f32 v32, v32
    v_mfma_f32_32x32x16_bf16 v[16:31], a[48:51], v[128:131], 0
    v_exp_f32 v33, v33
    v_exp_f32 v34, v34
    v_cvt_pk_bf16_f32 v56, v32, v33
    v_exp_f32 v35, v35
    v_exp_f32 v36, v36
    v_mfma_f32_32x32x16_bf16 v[80:95], a[176:179], v[48:51], v[80:95]
    v_cvt_pk_bf16_f32 v57, v34, v35
    v_exp_f32 v37, v37
    v_exp_f32 v38, v38
    v_cvt_pk_bf16_f32 v58, v36, v37
    v_exp_f32 v39, v39
    v_mfma_f32_32x32x8_bf16 v[16:31], a[88:89], v[132:133], v[16:31]
    v_exp_f32 v40, v40
    v_cvt_pk_bf16_f32 v59, v38, v39
    v_exp_f32 v41, v41
    v_exp_f32 v42, v42
    v_cvt_pk_bf16_f32 v60, v40, v41
    v_exp_f32 v43, v43
    v_mfma_f32_32x32x16_bf16 v[80:95], a[180:183], v[52:55], v[80:95]
    v_exp_f32 v44, v44
    v_cvt_pk_bf16_f32 v61, v42, v43
    v_exp_f32 v45, v45
    v_exp_f32 v46, v46
    v_exp_f32 v47, v47
    v_cvt_pk_bf16_f32 v62, v44, v45
    v_cvt_pk_bf16_f32 v63, v46, v47
    s_waitcnt vmcnt(12)
    v_exp_f32 v16, v16
    v_mfma_f32_32x32x16_bf16 v[32:47], a[52:55], v[128:131], 0
    v_exp_f32 v17, v17
    v_exp_f32 v18, v18
    v_cvt_pk_bf16_f32 v48, v16, v17
    v_exp_f32 v19, v19
    v_exp_f32 v20, v20
    v_mfma_f32_32x32x16_bf16 v[80:95], a[184:187], v[56:59], v[80:95]
    v_cvt_pk_bf16_f32 v49, v18, v19
    v_exp_f32 v21, v21
    v_exp_f32 v22, v22
    v_cvt_pk_bf16_f32 v50, v20, v21
    v_exp_f32 v23, v23
    v_mfma_f32_32x32x8_bf16 v[32:47], a[90:91], v[132:133], v[32:47]
    v_exp_f32 v24, v24
    v_cvt_pk_bf16_f32 v51, v22, v23
    v_exp_f32 v25, v25
    v_exp_f32 v26, v26
    v_cvt_pk_bf16_f32 v52, v24, v25
    v_exp_f32 v27, v27
    v_mfma_f32_32x32x16_bf16 v[80:95], a[188:191], v[60:63], v[80:95]
    v_exp_f32 v28, v28
    v_cvt_pk_bf16_f32 v53, v26, v27
    v_exp_f32 v29, v29
    v_exp_f32 v30, v30
    v_exp_f32 v31, v31
    v_cvt_pk_bf16_f32 v54, v28, v29
    v_cvt_pk_bf16_f32 v55, v30, v31
    s_waitcnt vmcnt(8)
    v_exp_f32 v32, v32
    v_mfma_f32_32x32x16_bf16 v[16:31], a[56:59], v[128:131], 0
    v_exp_f32 v33, v33
    v_exp_f32 v34, v34
    v_cvt_pk_bf16_f32 v56, v32, v33
    v_exp_f32 v35, v35
    v_exp_f32 v36, v36
    v_mfma_f32_32x32x16_bf16 v[80:95], a[192:195], v[48:51], v[80:95]
    v_cvt_pk_bf16_f32 v57, v34, v35
    v_exp_f32 v37, v37
    v_exp_f32 v38, v38
    v_cvt_pk_bf16_f32 v58, v36, v37
    v_exp_f32 v39, v39
    v_mfma_f32_32x32x8_bf16 v[16:31], a[92:93], v[132:133], v[16:31]
    v_exp_f32 v40, v40
    v_cvt_pk_bf16_f32 v59, v38, v39
    v_exp_f32 v41, v41
    v_exp_f32 v42, v42
    v_cvt_pk_bf16_f32 v60, v40, v41
    v_exp_f32 v43, v43
    v_mfma_f32_32x32x16_bf16 v[80:95], a[196:199], v[52:55], v[80:95]
    v_exp_f32 v44, v44
    v_cvt_pk_bf16_f32 v61, v42, v43
    v_exp_f32 v45, v45
    v_exp_f32 v46, v46
    v_exp_f32 v47, v47
    v_cvt_pk_bf16_f32 v62, v44, v45
    v_cvt_pk_bf16_f32 v63, v46, v47
    s_waitcnt vmcnt(4)
    v_exp_f32 v16, v16
    v_mfma_f32_32x32x16_bf16 v[32:47], a[60:63], v[128:131], 0
    v_exp_f32 v17, v17
    v_exp_f32 v18, v18
    v_cvt_pk_bf16_f32 v48, v16, v17
    v_exp_f32 v19, v19
    v_exp_f32 v20, v20
    v_mfma_f32_32x32x16_bf16 v[80:95], a[200:203], v[56:59], v[80:95]
    v_cvt_pk_bf16_f32 v49, v18, v19
    v_exp_f32 v21, v21
    v_exp_f32 v22, v22
    v_cvt_pk_bf16_f32 v50, v20, v21
    v_exp_f32 v23, v23
    v_mfma_f32_32x32x8_bf16 v[32:47], a[94:95], v[132:133], v[32:47]
    v_exp_f32 v24, v24
    v_cvt_pk_bf16_f32 v51, v22, v23
    v_exp_f32 v25, v25
    v_exp_f32 v26, v26
    v_cvt_pk_bf16_f32 v52, v24, v25
    v_exp_f32 v27, v27
    v_mfma_f32_32x32x16_bf16 v[80:95], a[204:207], v[60:63], v[80:95]
    v_exp_f32 v28, v28
    v_cvt_pk_bf16_f32 v53, v26, v27
    v_exp_f32 v29, v29
    v_exp_f32 v30, v30
    v_exp_f32 v31, v31
    v_cvt_pk_bf16_f32 v54, v28, v29
    v_cvt_pk_bf16_f32 v55, v30, v31
    s_waitcnt vmcnt(0)
    v_exp_f32 v32, v32
    v_mfma_f32_32x32x16_bf16 v[16:31], a[0:3], v[134:137], 0
    v_exp_f32 v33, v33
    v_exp_f32 v34, v34
    v_cvt_pk_bf16_f32 v56, v32, v33
    v_exp_f32 v35, v35
    v_exp_f32 v36, v36
    v_mfma_f32_32x32x16_bf16 v[80:95], a[208:211], v[48:51], v[80:95]
    v_cvt_pk_bf16_f32 v57, v34, v35
    v_exp_f32 v37, v37
    v_exp_f32 v38, v38
    v_cvt_pk_bf16_f32 v58, v36, v37
    v_exp_f32 v39, v39
    v_mfma_f32_32x32x8_bf16 v[16:31], a[64:65], v[138:139], v[16:31]
    v_exp_f32 v40, v40
    v_cvt_pk_bf16_f32 v59, v38, v39
    v_exp_f32 v41, v41
    v_exp_f32 v42, v42
    v_cvt_pk_bf16_f32 v60, v40, v41
    v_exp_f32 v43, v43
    v_mfma_f32_32x32x16_bf16 v[80:95], a[212:215], v[52:55], v[80:95]
    v_exp_f32 v44, v44
    v_cvt_pk_bf16_f32 v61, v42, v43
    v_exp_f32 v45, v45
    v_exp_f32 v46, v46
    v_exp_f32 v47, v47
    v_cvt_pk_bf16_f32 v62, v44, v45
    v_cvt_pk_bf16_f32 v63, v46, v47
    v_exp_f32 v16, v16
    v_mfma_f32_32x32x16_bf16 v[32:47], a[4:7], v[134:137], 0
    v_exp_f32 v17, v17
    v_exp_f32 v18, v18
    v_cvt_pk_bf16_f32 v48, v16, v17
    v_exp_f32 v19, v19
    v_exp_f32 v20, v20
    v_mfma_f32_32x32x16_bf16 v[80:95], a[216:219], v[56:59], v[80:95]
    v_cvt_pk_bf16_f32 v49, v18, v19
    v_exp_f32 v21, v21
    v_exp_f32 v22, v22
    v_cvt_pk_bf16_f32 v50, v20, v21
    v_exp_f32 v23, v23
    v_mfma_f32_32x32x8_bf16 v[32:47], a[66:67], v[138:139], v[32:47]
    v_exp_f32 v24, v24
    v_cvt_pk_bf16_f32 v51, v22, v23
    v_exp_f32 v25, v25
    v_exp_f32 v26, v26
    v_cvt_pk_bf16_f32 v52, v24, v25
    v_exp_f32 v27, v27
    v_mfma_f32_32x32x16_bf16 v[80:95], a[220:223], v[60:63], v[80:95]
    v_exp_f32 v28, v28
    v_cvt_pk_bf16_f32 v53, v26, v27
    v_exp_f32 v29, v29
    v_exp_f32 v30, v30
    v_exp_f32 v31, v31
    v_cvt_pk_bf16_f32 v54, v28, v29
    v_cvt_pk_bf16_f32 v55, v30, v31
    v_exp_f32 v32, v32
    v_mfma_f32_32x32x16_bf16 v[16:31], a[8:11], v[134:137], 0
    v_exp_f32 v33, v33
    v_exp_f32 v34, v34
    v_cvt_pk_bf16_f32 v56, v32, v33
    v_exp_f32 v35, v35
    v_exp_f32 v36, v36
    v_mfma_f32_32x32x16_bf16 v[96:111], a[96:99], v[48:51], 0
    v_cvt_pk_bf16_f32 v57, v34, v35
    v_exp_f32 v37, v37
    v_exp_f32 v38, v38
    v_cvt_pk_bf16_f32 v58, v36, v37
    v_exp_f32 v39, v39
    v_mfma_f32_32x32x8_bf16 v[16:31], a[68:69], v[138:139], v[16:31]
    v_exp_f32 v40, v40
    v_cvt_pk_bf16_f32 v59, v38, v39
    v_exp_f32 v41, v41
    v_exp_f32 v42, v42
    v_cvt_pk_bf16_f32 v60, v40, v41
    v_exp_f32 v43, v43
    v_mfma_f32_32x32x16_bf16 v[96:111], a[100:103], v[52:55], v[96:111]
    v_exp_f32 v44, v44
    v_cvt_pk_bf16_f32 v61, v42, v43
    v_exp_f32 v45, v45
    v_exp_f32 v46, v46
    v_exp_f32 v47, v47
    v_cvt_pk_bf16_f32 v62, v44, v45
    v_cvt_pk_bf16_f32 v63, v46, v47
    v_exp_f32 v16, v16
    v_mfma_f32_32x32x16_bf16 v[32:47], a[12:15], v[134:137], 0
    v_exp_f32 v17, v17
    v_exp_f32 v18, v18
    v_cvt_pk_bf16_f32 v48, v16, v17
    v_exp_f32 v19, v19
    v_exp_f32 v20, v20
    v_mfma_f32_32x32x16_bf16 v[96:111], a[104:107], v[56:59], v[96:111]
    v_cvt_pk_bf16_f32 v49, v18, v19
    v_exp_f32 v21, v21
    v_exp_f32 v22, v22
    v_cvt_pk_bf16_f32 v50, v20, v21
    v_exp_f32 v23, v23
    v_mfma_f32_32x32x8_bf16 v[32:47], a[70:71], v[138:139], v[32:47]
    v_exp_f32 v24, v24
    v_cvt_pk_bf16_f32 v51, v22, v23
    v_exp_f32 v25, v25
    v_exp_f32 v26, v26
    v_cvt_pk_bf16_f32 v52, v24, v25
    v_exp_f32 v27, v27
    v_mfma_f32_32x32x16_bf16 v[96:111], a[108:111], v[60:63], v[96:111]
    v_exp_f32 v28, v28
    v_cvt_pk_bf16_f32 v53, v26, v27
    v_exp_f32 v29, v29
    v_exp_f32 v30, v30
    v_exp_f32 v31, v31
    v_cvt_pk_bf16_f32 v54, v28, v29
    v_cvt_pk_bf16_f32 v55, v30, v31
    v_exp_f32 v32, v32
    ds_write_b128 v238, v[80:83] offset:0
    v_mfma_f32_32x32x16_bf16 v[16:31], a[16:19], v[134:137], 0
    v_exp_f32 v33, v33
    v_exp_f32 v34, v34
    v_cvt_pk_bf16_f32 v56, v32, v33
    v_exp_f32 v35, v35
    v_exp_f32 v36, v36
    v_mfma_f32_32x32x16_bf16 v[96:111], a[112:115], v[48:51], v[96:111]
    v_cvt_pk_bf16_f32 v57, v34, v35
    v_exp_f32 v37, v37
    v_exp_f32 v38, v38
    v_cvt_pk_bf16_f32 v58, v36, v37
    v_exp_f32 v39, v39
    v_mfma_f32_32x32x8_bf16 v[16:31], a[72:73], v[138:139], v[16:31]
    v_exp_f32 v40, v40
    v_cvt_pk_bf16_f32 v59, v38, v39
    v_exp_f32 v41, v41
    v_exp_f32 v42, v42
    v_cvt_pk_bf16_f32 v60, v40, v41
    v_exp_f32 v43, v43
    v_mfma_f32_32x32x16_bf16 v[96:111], a[116:119], v[52:55], v[96:111]
    v_exp_f32 v44, v44
    v_cvt_pk_bf16_f32 v61, v42, v43
    v_exp_f32 v45, v45
    v_exp_f32 v46, v46
    v_exp_f32 v47, v47
    v_cvt_pk_bf16_f32 v62, v44, v45
    v_cvt_pk_bf16_f32 v63, v46, v47
    v_exp_f32 v16, v16
    ds_write_b128 v238, v[84:87] offset:1024
    v_mfma_f32_32x32x16_bf16 v[32:47], a[20:23], v[134:137], 0
    v_exp_f32 v17, v17
    v_exp_f32 v18, v18
    v_cvt_pk_bf16_f32 v48, v16, v17
    v_exp_f32 v19, v19
    v_exp_f32 v20, v20
    v_mfma_f32_32x32x16_bf16 v[96:111], a[120:123], v[56:59], v[96:111]
    v_cvt_pk_bf16_f32 v49, v18, v19
    v_exp_f32 v21, v21
    v_exp_f32 v22, v22
    v_cvt_pk_bf16_f32 v50, v20, v21
    v_exp_f32 v23, v23
    v_mfma_f32_32x32x8_bf16 v[32:47], a[74:75], v[138:139], v[32:47]
    v_exp_f32 v24, v24
    v_cvt_pk_bf16_f32 v51, v22, v23
    v_exp_f32 v25, v25
    v_exp_f32 v26, v26
    v_cvt_pk_bf16_f32 v52, v24, v25
    v_exp_f32 v27, v27
    v_mfma_f32_32x32x16_bf16 v[96:111], a[124:127], v[60:63], v[96:111]
    v_exp_f32 v28, v28
    v_cvt_pk_bf16_f32 v53, v26, v27
    v_exp_f32 v29, v29
    v_exp_f32 v30, v30
    v_exp_f32 v31, v31
    v_cvt_pk_bf16_f32 v54, v28, v29
    v_cvt_pk_bf16_f32 v55, v30, v31
    v_exp_f32 v32, v32
    s_add_u32 m0, s32, 73728
    s_mov_b32 s38, 0
    buffer_load_dwordx4 v202, s[40:43], s38 offen lds
    v_mfma_f32_32x32x16_bf16 v[16:31], a[24:27], v[134:137], 0
    v_exp_f32 v33, v33
    v_exp_f32 v34, v34
    v_cvt_pk_bf16_f32 v56, v32, v33
    v_exp_f32 v35, v35
    v_exp_f32 v36, v36
    v_mfma_f32_32x32x16_bf16 v[96:111], a[128:131], v[48:51], v[96:111]
    v_cvt_pk_bf16_f32 v57, v34, v35
    v_exp_f32 v37, v37
    v_exp_f32 v38, v38
    v_cvt_pk_bf16_f32 v58, v36, v37
    v_exp_f32 v39, v39
    v_mfma_f32_32x32x8_bf16 v[16:31], a[76:77], v[138:139], v[16:31]
    v_exp_f32 v40, v40
    v_cvt_pk_bf16_f32 v59, v38, v39
    v_exp_f32 v41, v41
    v_exp_f32 v42, v42
    v_cvt_pk_bf16_f32 v60, v40, v41
    v_exp_f32 v43, v43
    v_mfma_f32_32x32x16_bf16 v[96:111], a[132:135], v[52:55], v[96:111]
    v_exp_f32 v44, v44
    v_cvt_pk_bf16_f32 v61, v42, v43
    v_exp_f32 v45, v45
    v_exp_f32 v46, v46
    v_exp_f32 v47, v47
    v_cvt_pk_bf16_f32 v62, v44, v45
    v_cvt_pk_bf16_f32 v63, v46, v47
    v_exp_f32 v16, v16
    ds_write_b128 v238, v[88:91] offset:2048
    v_mfma_f32_32x32x16_bf16 v[32:47], a[28:31], v[134:137], 0
    v_exp_f32 v17, v17
    v_exp_f32 v18, v18
    v_cvt_pk_bf16_f32 v48, v16, v17
    v_exp_f32 v19, v19
    v_exp_f32 v20, v20
    v_mfma_f32_32x32x16_bf16 v[96:111], a[136:139], v[56:59], v[96:111]
    v_cvt_pk_bf16_f32 v49, v18, v19
    v_exp_f32 v21, v21
    v_exp_f32 v22, v22
    v_cvt_pk_bf16_f32 v50, v20, v21
    v_exp_f32 v23, v23
    v_mfma_f32_32x32x8_bf16 v[32:47], a[78:79], v[138:139], v[32:47]
    v_exp_f32 v24, v24
    v_cvt_pk_bf16_f32 v51, v22, v23
    v_exp_f32 v25, v25
    v_exp_f32 v26, v26
    v_cvt_pk_bf16_f32 v52, v24, v25
    v_exp_f32 v27, v27
    v_mfma_f32_32x32x16_bf16 v[96:111], a[140:143], v[60:63], v[96:111]
    v_exp_f32 v28, v28
    v_cvt_pk_bf16_f32 v53, v26, v27
    v_exp_f32 v29, v29
    v_exp_f32 v30, v30
    v_exp_f32 v31, v31
    v_cvt_pk_bf16_f32 v54, v28, v29
    v_cvt_pk_bf16_f32 v55, v30, v31
    v_exp_f32 v32, v32
    v_mfma_f32_32x32x16_bf16 v[16:31], a[32:35], v[134:137], 0
    v_exp_f32 v33, v33
    v_exp_f32 v34, v34
    v_cvt_pk_bf16_f32 v56, v32, v33
    v_exp_f32 v35, v35
    v_exp_f32 v36, v36
    v_mfma_f32_32x32x16_bf16 v[96:111], a[144:147], v[48:51], v[96:111]
    v_cvt_pk_bf16_f32 v57, v34, v35
    v_exp_f32 v37, v37
    v_exp_f32 v38, v38
    v_cvt_pk_bf16_f32 v58, v36, v37
    v_exp_f32 v39, v39
    v_mfma_f32_32x32x8_bf16 v[16:31], a[80:81], v[138:139], v[16:31]
    v_exp_f32 v40, v40
    v_cvt_pk_bf16_f32 v59, v38, v39
    v_exp_f32 v41, v41
    v_exp_f32 v42, v42
    v_cvt_pk_bf16_f32 v60, v40, v41
    v_exp_f32 v43, v43
    v_mfma_f32_32x32x16_bf16 v[96:111], a[148:151], v[52:55], v[96:111]
    v_exp_f32 v44, v44
    v_cvt_pk_bf16_f32 v61, v42, v43
    v_exp_f32 v45, v45
    v_exp_f32 v46, v46
    v_exp_f32 v47, v47
    v_cvt_pk_bf16_f32 v62, v44, v45
    v_cvt_pk_bf16_f32 v63, v46, v47
    v_exp_f32 v16, v16
    s_add_u32 m0, s32, 77824
    s_nop 0
    buffer_load_dwordx4 v203, s[40:43], s38 offen lds
    v_mfma_f32_32x32x16_bf16 v[32:47], a[36:39], v[134:137], 0
    v_exp_f32 v17, v17
    v_exp_f32 v18, v18
    v_cvt_pk_bf16_f32 v48, v16, v17
    v_exp_f32 v19, v19
    v_exp_f32 v20, v20
    v_mfma_f32_32x32x16_bf16 v[96:111], a[152:155], v[56:59], v[96:111]
    v_cvt_pk_bf16_f32 v49, v18, v19
    v_exp_f32 v21, v21
    v_exp_f32 v22, v22
    v_cvt_pk_bf16_f32 v50, v20, v21
    v_exp_f32 v23, v23
    v_mfma_f32_32x32x8_bf16 v[32:47], a[82:83], v[138:139], v[32:47]
    v_exp_f32 v24, v24
    v_cvt_pk_bf16_f32 v51, v22, v23
    v_exp_f32 v25, v25
    v_exp_f32 v26, v26
    v_cvt_pk_bf16_f32 v52, v24, v25
    v_exp_f32 v27, v27
    v_mfma_f32_32x32x16_bf16 v[96:111], a[156:159], v[60:63], v[96:111]
    v_exp_f32 v28, v28
    v_cvt_pk_bf16_f32 v53, v26, v27
    v_exp_f32 v29, v29
    v_exp_f32 v30, v30
    v_exp_f32 v31, v31
    v_cvt_pk_bf16_f32 v54, v28, v29
    v_cvt_pk_bf16_f32 v55, v30, v31
    v_exp_f32 v32, v32
    v_mfma_f32_32x32x16_bf16 v[16:31], a[40:43], v[134:137], 0
    v_exp_f32 v33, v33
    v_exp_f32 v34, v34
    v_cvt_pk_bf16_f32 v56, v32, v33
    v_exp_f32 v35, v35
    v_exp_f32 v36, v36
    v_mfma_f32_32x32x16_bf16 v[96:111], a[160:163], v[48:51], v[96:111]
    v_cvt_pk_bf16_f32 v57, v34, v35
    v_exp_f32 v37, v37
    v_exp_f32 v38, v38
    v_cvt_pk_bf16_f32 v58, v36, v37
    v_exp_f32 v39, v39
    v_mfma_f32_32x32x8_bf16 v[16:31], a[84:85], v[138:139], v[16:31]
    v_exp_f32 v40, v40
    v_cvt_pk_bf16_f32 v59, v38, v39
    v_exp_f32 v41, v41
    v_exp_f32 v42, v42
    v_cvt_pk_bf16_f32 v60, v40, v41
    v_exp_f32 v43, v43
    v_mfma_f32_32x32x16_bf16 v[96:111], a[164:167], v[52:55], v[96:111]
    v_exp_f32 v44, v44
    v_cvt_pk_bf16_f32 v61, v42, v43
    v_exp_f32 v45, v45
    v_exp_f32 v46, v46
    v_exp_f32 v47, v47
    v_cvt_pk_bf16_f32 v62, v44, v45
    v_cvt_pk_bf16_f32 v63, v46, v47
    v_exp_f32 v16, v16
    v_mfma_f32_32x32x16_bf16 v[32:47], a[44:47], v[134:137], 0
    v_exp_f32 v17, v17
    v_exp_f32 v18, v18
    v_cvt_pk_bf16_f32 v48, v16, v17
    v_exp_f32 v19, v19
    v_exp_f32 v20, v20
    v_mfma_f32_32x32x16_bf16 v[96:111], a[168:171], v[56:59], v[96:111]
    v_cvt_pk_bf16_f32 v49, v18, v19
    v_exp_f32 v21, v21
    v_exp_f32 v22, v22
    v_cvt_pk_bf16_f32 v50, v20, v21
    v_exp_f32 v23, v23
    v_mfma_f32_32x32x8_bf16 v[32:47], a[86:87], v[138:139], v[32:47]
    v_exp_f32 v24, v24
    v_cvt_pk_bf16_f32 v51, v22, v23
    v_exp_f32 v25, v25
    v_exp_f32 v26, v26
    v_cvt_pk_bf16_f32 v52, v24, v25
    v_exp_f32 v27, v27
    v_mfma_f32_32x32x16_bf16 v[96:111], a[172:175], v[60:63], v[96:111]
    v_exp_f32 v28, v28
    v_cvt_pk_bf16_f32 v53, v26, v27
    v_exp_f32 v29, v29
    v_exp_f32 v30, v30
    v_exp_f32 v31, v31
    v_cvt_pk_bf16_f32 v54, v28, v29
    v_cvt_pk_bf16_f32 v55, v30, v31
    v_exp_f32 v32, v32
    s_add_u32 s39, s32, 81920
    s_cmp_lt_u32 s20, 2
    s_cselect_b32 m0, s39, 160000
    s_nop 0
    buffer_load_dwordx4 v204, s[40:43], s38 offen lds
    v_mfma_f32_32x32x16_bf16 v[16:31], a[48:51], v[134:137], 0
    v_exp_f32 v33, v33
    v_exp_f32 v34, v34
    v_cvt_pk_bf16_f32 v56, v32, v33
    v_exp_f32 v35, v35
    v_exp_f32 v36, v36
    v_mfma_f32_32x32x16_bf16 v[96:111], a[176:179], v[48:51], v[96:111]
    v_cvt_pk_bf16_f32 v57, v34, v35
    v_exp_f32 v37, v37
    v_exp_f32 v38, v38
    v_cvt_pk_bf16_f32 v58, v36, v37
    v_exp_f32 v39, v39
    v_mfma_f32_32x32x8_bf16 v[16:31], a[88:89], v[138:139], v[16:31]
    v_exp_f32 v40, v40
    v_cvt_pk_bf16_f32 v59, v38, v39
    v_exp_f32 v41, v41
    v_exp_f32 v42, v42
    v_cvt_pk_bf16_f32 v60, v40, v41
    v_exp_f32 v43, v43
    v_mfma_f32_32x32x16_bf16 v[96:111], a[180:183], v[52:55], v[96:111]
    v_exp_f32 v44, v44
    v_cvt_pk_bf16_f32 v61, v42, v43
    v_exp_f32 v45, v45
    v_exp_f32 v46, v46
    v_exp_f32 v47, v47
    v_cvt_pk_bf16_f32 v62, v44, v45
    v_cvt_pk_bf16_f32 v63, v46, v47
    v_exp_f32 v16, v16
    v_mfma_f32_32x32x16_bf16 v[32:47], a[52:55], v[134:137], 0
    v_exp_f32 v17, v17
    v_exp_f32 v18, v18
    v_cvt_pk_bf16_f32 v48, v16, v17
    v_exp_f32 v19, v19
    v_exp_f32 v20, v20
    v_mfma_f32_32x32x16_bf16 v[96:111], a[184:187], v[56:59], v[96:111]
    v_cvt_pk_bf16_f32 v49, v18, v19
    v_exp_f32 v21, v21
    v_exp_f32 v22, v22
    v_cvt_pk_bf16_f32 v50, v20, v21
    v_exp_f32 v23, v23
    v_mfma_f32_32x32x8_bf16 v[32:47], a[90:91], v[138:139], v[32:47]
    v_exp_f32 v24, v24
    v_cvt_pk_bf16_f32 v51, v22, v23
    v_exp_f32 v25, v25
    v_exp_f32 v26, v26
    v_cvt_pk_bf16_f32 v52, v24, v25
    v_exp_f32 v27, v27
    v_mfma_f32_32x32x16_bf16 v[96:111], a[188:191], v[60:63], v[96:111]
    v_exp_f32 v28, v28
    v_cvt_pk_bf16_f32 v53, v26, v27
    v_exp_f32 v29, v29
    v_exp_f32 v30, v30
    v_exp_f32 v31, v31
    v_cvt_pk_bf16_f32 v54, v28, v29
    v_cvt_pk_bf16_f32 v55, v30, v31
    v_exp_f32 v32, v32
    v_mfma_f32_32x32x16_bf16 v[16:31], a[56:59], v[134:137], 0
    v_exp_f32 v33, v33
    v_exp_f32 v34, v34
    v_cvt_pk_bf16_f32 v56, v32, v33
    v_exp_f32 v35, v35
    v_exp_f32 v36, v36
    v_mfma_f32_32x32x16_bf16 v[96:111], a[192:195], v[48:51], v[96:111]
    v_cvt_pk_bf16_f32 v57, v34, v35
    v_exp_f32 v37, v37
    v_exp_f32 v38, v38
    v_cvt_pk_bf16_f32 v58, v36, v37
    v_exp_f32 v39, v39
    v_mfma_f32_32x32x8_bf16 v[16:31], a[92:93], v[138:139], v[16:31]
    v_exp_f32 v40, v40
    v_cvt_pk_bf16_f32 v59, v38, v39
    v_exp_f32 v41, v41
    v_exp_f32 v42, v42
    v_cvt_pk_bf16_f32 v60, v40, v41
    v_exp_f32 v43, v43
    v_mfma_f32_32x32x16_bf16 v[96:111], a[196:199], v[52:55], v[96:111]
    v_exp_f32 v44, v44
    v_cvt_pk_bf16_f32 v61, v42, v43
    v_exp_f32 v45, v45
    v_exp_f32 v46, v46
    v_exp_f32 v47, v47
    v_cvt_pk_bf16_f32 v62, v44, v45
    v_cvt_pk_bf16_f32 v63, v46, v47
    v_exp_f32 v16, v16
    s_add_u32 m0, s32, 83968
    s_mov_b32 s38, 81920
    buffer_load_dwordx4 v202, s[40:43], s38 offen lds
    v_mfma_f32_32x32x16_bf16 v[32:47], a[60:63], v[134:137], 0
    v_exp_f32 v17, v17
    v_exp_f32 v18, v18
    v_cvt_pk_bf16_f32 v48, v16, v17
    v_exp_f32 v19, v19
    v_exp_f32 v20, v20
    v_mfma_f32_32x32x16_bf16 v[96:111], a[200:203], v[56:59], v[96:111]
    v_cvt_pk_bf16_f32 v49, v18, v19
    v_exp_f32 v21, v21
    v_exp_f32 v22, v22
    v_cvt_pk_bf16_f32 v50, v20, v21
    v_exp_f32 v23, v23
    v_mfma_f32_32x32x8_bf16 v[32:47], a[94:95], v[138:139], v[32:47]
    v_exp_f32 v24, v24
    v_cvt_pk_bf16_f32 v51, v22, v23
    v_exp_f32 v25, v25
    v_exp_f32 v26, v26
    v_cvt_pk_bf16_f32 v52, v24, v25
    v_exp_f32 v27, v27
    v_mfma_f32_32x32x16_bf16 v[96:111], a[204:207], v[60:63], v[96:111]
    v_exp_f32 v28, v28
    v_cvt_pk_bf16_f32 v53, v26, v27
    v_exp_f32 v29, v29
    v_exp_f32 v30, v30
    v_exp_f32 v31, v31
    v_cvt_pk_bf16_f32 v54, v28, v29
    v_cvt_pk_bf16_f32 v55, v30, v31
    v_exp_f32 v32, v32
    v_mfma_f32_32x32x16_bf16 v[16:31], a[0:3], v[140:143], 0
    v_exp_f32 v33, v33
    v_exp_f32 v34, v34
    v_cvt_pk_bf16_f32 v56, v32, v33
    v_exp_f32 v35, v35
    v_exp_f32 v36, v36
    v_mfma_f32_32x32x16_bf16 v[96:111], a[208:211], v[48:51], v[96:111]
    v_cvt_pk_bf16_f32 v57, v34, v35
    v_exp_f32 v37, v37
    v_exp_f32 v38, v38
    v_cvt_pk_bf16_f32 v58, v36, v37
    v_exp_f32 v39, v39
    v_mfma_f32_32x32x8_bf16 v[16:31], a[64:65], v[144:145], v[16:31]
    v_exp_f32 v40, v40
    v_cvt_pk_bf16_f32 v59, v38, v39
    v_exp_f32 v41, v41
    v_exp_f32 v42, v42
    v_cvt_pk_bf16_f32 v60, v40, v41
    v_exp_f32 v43, v43
    v_mfma_f32_32x32x16_bf16 v[96:111], a[212:215], v[52:55], v[96:111]
    v_exp_f32 v44, v44
    v_cvt_pk_bf16_f32 v61, v42, v43
    v_exp_f32 v45, v45
    v_exp_f32 v46, v46
    v_exp_f32 v47, v47
    v_cvt_pk_bf16_f32 v62, v44, v45
    v_cvt_pk_bf16_f32 v63, v46, v47
    v_exp_f32 v16, v16
    v_mfma_f32_32x32x16_bf16 v[32:47], a[4:7], v[140:143], 0
    v_exp_f32 v17, v17
    v_exp_f32 v18, v18
    v_cvt_pk_bf16_f32 v48, v16, v17
    v_exp_f32 v19, v19
    v_exp_f32 v20, v20
    v_mfma_f32_32x32x16_bf16 v[96:111], a[216:219], v[56:59], v[96:111]
    v_cvt_pk_bf16_f32 v49, v18, v19
    v_exp_f32 v21, v21
    v_exp_f32 v22, v22
    v_cvt_pk_bf16_f32 v50, v20, v21
    v_exp_f32 v23, v23
    v_mfma_f32_32x32x8_bf16 v[32:47], a[66:67], v[144:145], v[32:47]
    v_exp_f32 v24, v24
    v_cvt_pk_bf16_f32 v51, v22, v23
    v_exp_f32 v25, v25
    v_exp_f32 v26, v26
    v_cvt_pk_bf16_f32 v52, v24, v25
    v_exp_f32 v27, v27
    v_mfma_f32_32x32x16_bf16 v[96:111], a[220:223], v[60:63], v[96:111]
    v_exp_f32 v28, v28
    v_cvt_pk_bf16_f32 v53, v26, v27
    v_exp_f32 v29, v29
    v_exp_f32 v30, v30
    v_exp_f32 v31, v31
    v_cvt_pk_bf16_f32 v54, v28, v29
    v_cvt_pk_bf16_f32 v55, v30, v31
    v_exp_f32 v32, v32
    v_mfma_f32_32x32x16_bf16 v[16:31], a[8:11], v[140:143], 0
    v_exp_f32 v33, v33
    v_exp_f32 v34, v34
    v_cvt_pk_bf16_f32 v56, v32, v33
    v_exp_f32 v35, v35
    v_exp_f32 v36, v36
    v_mfma_f32_32x32x16_bf16 v[80:95], a[96:99], v[48:51], 0
    v_cvt_pk_bf16_f32 v57, v34, v35
    v_exp_f32 v37, v37
    v_exp_f32 v38, v38
    v_cvt_pk_bf16_f32 v58, v36, v37
    v_exp_f32 v39, v39
    v_mfma_f32_32x32x8_bf16 v[16:31], a[68:69], v[144:145], v[16:31]
    v_exp_f32 v40, v40
    v_cvt_pk_bf16_f32 v59, v38, v39
    v_exp_f32 v41, v41
    v_exp_f32 v42, v42
    v_cvt_pk_bf16_f32 v60, v40, v41
    v_exp_f32 v43, v43
    v_mfma_f32_32x32x16_bf16 v[80:95], a[100:103], v[52:55], v[80:95]
    v_exp_f32 v44, v44
    v_cvt_pk_bf16_f32 v61, v42, v43
    v_exp_f32 v45, v45
    v_exp_f32 v46, v46
    v_exp_f32 v47, v47
    v_cvt_pk_bf16_f32 v62, v44, v45
    v_cvt_pk_bf16_f32 v63, v46, v47
    v_exp_f32 v16, v16
    v_mfma_f32_32x32x16_bf16 v[32:47], a[12:15], v[140:143], 0
    v_exp_f32 v17, v17
    v_exp_f32 v18, v18
    v_cvt_pk_bf16_f32 v48, v16, v17
    v_exp_f32 v19, v19
    v_exp_f32 v20, v20
    v_mfma_f32_32x32x16_bf16 v[80:95], a[104:107], v[56:59], v[80:95]
    v_cvt_pk_bf16_f32 v49, v18, v19
    v_exp_f32 v21, v21
    v_exp_f32 v22, v22
    v_cvt_pk_bf16_f32 v50, v20, v21
    v_exp_f32 v23, v23
    v_mfma_f32_32x32x8_bf16 v[32:47], a[70:71], v[144:145], v[32:47]
    v_exp_f32 v24, v24
    v_cvt_pk_bf16_f32 v51, v22, v23
    v_exp_f32 v25, v25
    v_exp_f32 v26, v26
    v_cvt_pk_bf16_f32 v52, v24, v25
    v_exp_f32 v27, v27
    v_mfma_f32_32x32x16_bf16 v[80:95], a[108:111], v[60:63], v[80:95]
    v_exp_f32 v28, v28
    v_cvt_pk_bf16_f32 v53, v26, v27
    v_exp_f32 v29, v29
    v_exp_f32 v30, v30
    v_exp_f32 v31, v31
    v_cvt_pk_bf16_f32 v54, v28, v29
    v_cvt_pk_bf16_f32 v55, v30, v31
    v_exp_f32 v32, v32
    ds_write_b128 v239, v[96:99] offset:0
    v_mfma_f32_32x32x16_bf16 v[16:31], a[16:19], v[140:143], 0
    v_exp_f32 v33, v33
    v_exp_f32 v34, v34
    v_cvt_pk_bf16_f32 v56, v32, v33
    v_exp_f32 v35, v35
    v_exp_f32 v36, v36
    v_mfma_f32_32x32x16_bf16 v[80:95], a[112:115], v[48:51], v[80:95]
    v_cvt_pk_bf16_f32 v57, v34, v35
    v_exp_f32 v37, v37
    v_exp_f32 v38, v38
    v_cvt_pk_bf16_f32 v58, v36, v37
    v_exp_f32 v39, v39
    v_mfma_f32_32x32x8_bf16 v[16:31], a[72:73], v[144:145], v[16:31]
    v_exp_f32 v40, v40
    v_cvt_pk_bf16_f32 v59, v38, v39
    v_exp_f32 v41, v41
    v_exp_f32 v42, v42
    v_cvt_pk_bf16_f32 v60, v40, v41
    v_exp_f32 v43, v43
    v_mfma_f32_32x32x16_bf16 v[80:95], a[116:119], v[52:55], v[80:95]
    v_exp_f32 v44, v44
    v_cvt_pk_bf16_f32 v61, v42, v43
    v_exp_f32 v45, v45
    v_exp_f32 v46, v46
    v_exp_f32 v47, v47
    v_cvt_pk_bf16_f32 v62, v44, v45
    v_cvt_pk_bf16_f32 v63, v46, v47
    v_exp_f32 v16, v16
    ds_write_b128 v239, v[100:103] offset:1024
    v_mfma_f32_32x32x16_bf16 v[32:47], a[20:23], v[140:143], 0
    v_exp_f32 v17, v17
    v_exp_f32 v18, v18
    v_cvt_pk_bf16_f32 v48, v16, v17
    v_exp_f32 v19, v19
    v_exp_f32 v20, v20
    v_mfma_f32_32x32x16_bf16 v[80:95], a[120:123], v[56:59], v[80:95]
    v_cvt_pk_bf16_f32 v49, v18, v19
    v_exp_f32 v21, v21
    v_exp_f32 v22, v22
    v_cvt_pk_bf16_f32 v50, v20, v21
    v_exp_f32 v23, v23
    v_mfma_f32_32x32x8_bf16 v[32:47], a[74:75], v[144:145], v[32:47]
    v_exp_f32 v24, v24
    v_cvt_pk_bf16_f32 v51, v22, v23
    v_exp_f32 v25, v25
    v_exp_f32 v26, v26
    v_cvt_pk_bf16_f32 v52, v24, v25
    v_exp_f32 v27, v27
    v_mfma_f32_32x32x16_bf16 v[80:95], a[124:127], v[60:63], v[80:95]
    v_exp_f32 v28, v28
    v_cvt_pk_bf16_f32 v53, v26, v27
    v_exp_f32 v29, v29
    v_exp_f32 v30, v30
    v_exp_f32 v31, v31
    v_cvt_pk_bf16_f32 v54, v28, v29
    v_cvt_pk_bf16_f32 v55, v30, v31
    v_exp_f32 v32, v32
    s_add_u32 m0, s32, 88064
    s_nop 0
    buffer_load_dwordx4 v203, s[40:43], s38 offen lds
    v_mfma_f32_32x32x16_bf16 v[16:31], a[24:27], v[140:143], 0
    v_exp_f32 v33, v33
    v_exp_f32 v34, v34
    v_cvt_pk_bf16_f32 v56, v32, v33
    v_exp_f32 v35, v35
    v_exp_f32 v36, v36
    v_mfma_f32_32x32x16_bf16 v[80:95], a[128:131], v[48:51], v[80:95]
    v_cvt_pk_bf16_f32 v57, v34, v35
    v_exp_f32 v37, v37
    v_exp_f32 v38, v38
    v_cvt_pk_bf16_f32 v58, v36, v37
    v_exp_f32 v39, v39
    v_mfma_f32_32x32x8_bf16 v[16:31], a[76:77], v[144:145], v[16:31]
    v_exp_f32 v40, v40
    v_cvt_pk_bf16_f32 v59, v38, v39
    v_exp_f32 v41, v41
    v_exp_f32 v42, v42
    v_cvt_pk_bf16_f32 v60, v40, v41
    v_exp_f32 v43, v43
    v_mfma_f32_32x32x16_bf16 v[80:95], a[132:135], v[52:55], v[80:95]
    v_exp_f32 v44, v44
    v_cvt_pk_bf16_f32 v61, v42, v43
    v_exp_f32 v45, v45
    v_exp_f32 v46, v46
    v_exp_f32 v47, v47
    v_cvt_pk_bf16_f32 v62, v44, v45
    v_cvt_pk_bf16_f32 v63, v46, v47
    v_exp_f32 v16, v16
    ds_write_b128 v239, v[104:107] offset:2048
    v_mfma_f32_32x32x16_bf16 v[32:47], a[28:31], v[140:143], 0
    v_exp_f32 v17, v17
    v_exp_f32 v18, v18
    v_cvt_pk_bf16_f32 v48, v16, v17
    v_exp_f32 v19, v19
    v_exp_f32 v20, v20
    v_mfma_f32_32x32x16_bf16 v[80:95], a[136:139], v[56:59], v[80:95]
    v_cvt_pk_bf16_f32 v49, v18, v19
    v_exp_f32 v21, v21
    v_exp_f32 v22, v22
    v_cvt_pk_bf16_f32 v50, v20, v21
    v_exp_f32 v23, v23
    v_mfma_f32_32x32x8_bf16 v[32:47], a[78:79], v[144:145], v[32:47]
    v_exp_f32 v24, v24
    v_cvt_pk_bf16_f32 v51, v22, v23
    v_exp_f32 v25, v25
    v_exp_f32 v26, v26
    v_cvt_pk_bf16_f32 v52, v24, v25
    v_exp_f32 v27, v27
    v_mfma_f32_32x32x16_bf16 v[80:95], a[140:143], v[60:63], v[80:95]
    v_exp_f32 v28, v28
    v_cvt_pk_bf16_f32 v53, v26, v27
    v_exp_f32 v29, v29
    v_exp_f32 v30, v30
    v_exp_f32 v31, v31
    v_cvt_pk_bf16_f32 v54, v28, v29
    v_cvt_pk_bf16_f32 v55, v30, v31
    v_exp_f32 v32, v32
    v_mfma_f32_32x32x16_bf16 v[16:31], a[32:35], v[140:143], 0
    v_exp_f32 v33, v33
    v_exp_f32 v34, v34
    v_cvt_pk_bf16_f32 v56, v32, v33
    v_exp_f32 v35, v35
    v_exp_f32 v36, v36
    v_mfma_f32_32x32x16_bf16 v[80:95], a[144:147], v[48:51], v[80:95]
    v_cvt_pk_bf16_f32 v57, v34, v35
    v_exp_f32 v37, v37
    v_exp_f32 v38, v38
    v_cvt_pk_bf16_f32 v58, v36, v37
    v_exp_f32 v39, v39
    v_mfma_f32_32x32x8_bf16 v[16:31], a[80:81], v[144:145], v[16:31]
    v_exp_f32 v40, v40
    v_cvt_pk_bf16_f32 v59, v38, v39
    v_exp_f32 v41, v41
    v_exp_f32 v42, v42
    v_cvt_pk_bf16_f32 v60, v40, v41
    v_exp_f32 v43, v43
    v_mfma_f32_32x32x16_bf16 v[80:95], a[148:151], v[52:55], v[80:95]
    v_exp_f32 v44, v44
    v_cvt_pk_bf16_f32 v61, v42, v43
    v_exp_f32 v45, v45
    v_exp_f32 v46, v46
    v_exp_f32 v47, v47
    v_cvt_pk_bf16_f32 v62, v44, v45
    v_cvt_pk_bf16_f32 v63, v46, v47
    v_exp_f32 v16, v16
    s_add_u32 s39, s32, 92160
    s_cmp_lt_u32 s20, 2
    s_cselect_b32 m0, s39, 160000
    s_nop 0
    buffer_load_dwordx4 v204, s[40:43], s38 offen lds
    v_mfma_f32_32x32x16_bf16 v[32:47], a[36:39], v[140:143], 0
    v_exp_f32 v17, v17
    v_exp_f32 v18, v18
    v_cvt_pk_bf16_f32 v48, v16, v17
    v_exp_f32 v19, v19
    v_exp_f32 v20, v20
    v_mfma_f32_32x32x16_bf16 v[80:95], a[152:155], v[56:59], v[80:95]
    v_cvt_pk_bf16_f32 v49, v18, v19
    v_exp_f32 v21, v21
    v_exp_f32 v22, v22
    v_cvt_pk_bf16_f32 v50, v20, v21
    v_exp_f32 v23, v23
    v_mfma_f32_32x32x8_bf16 v[32:47], a[82:83], v[144:145], v[32:47]
    v_exp_f32 v24, v24
    v_cvt_pk_bf16_f32 v51, v22, v23
    v_exp_f32 v25, v25
    v_exp_f32 v26, v26
    v_cvt_pk_bf16_f32 v52, v24, v25
    v_exp_f32 v27, v27
    v_mfma_f32_32x32x16_bf16 v[80:95], a[156:159], v[60:63], v[80:95]
    v_exp_f32 v28, v28
    v_cvt_pk_bf16_f32 v53, v26, v27
    v_exp_f32 v29, v29
    v_exp_f32 v30, v30
    v_exp_f32 v31, v31
    v_cvt_pk_bf16_f32 v54, v28, v29
    v_cvt_pk_bf16_f32 v55, v30, v31
    v_exp_f32 v32, v32
    v_mfma_f32_32x32x16_bf16 v[16:31], a[40:43], v[140:143], 0
    v_exp_f32 v33, v33
    v_exp_f32 v34, v34
    v_cvt_pk_bf16_f32 v56, v32, v33
    v_exp_f32 v35, v35
    v_exp_f32 v36, v36
    v_mfma_f32_32x32x16_bf16 v[80:95], a[160:163], v[48:51], v[80:95]
    v_cvt_pk_bf16_f32 v57, v34, v35
    v_exp_f32 v37, v37
    v_exp_f32 v38, v38
    v_cvt_pk_bf16_f32 v58, v36, v37
    v_exp_f32 v39, v39
    v_mfma_f32_32x32x8_bf16 v[16:31], a[84:85], v[144:145], v[16:31]
    v_exp_f32 v40, v40
    v_cvt_pk_bf16_f32 v59, v38, v39
    v_exp_f32 v41, v41
    v_exp_f32 v42, v42
    v_cvt_pk_bf16_f32 v60, v40, v41
    v_exp_f32 v43, v43
    v_mfma_f32_32x32x16_bf16 v[80:95], a[164:167], v[52:55], v[80:95]
    v_exp_f32 v44, v44
    v_cvt_pk_bf16_f32 v61, v42, v43
    v_exp_f32 v45, v45
    v_exp_f32 v46, v46
    v_exp_f32 v47, v47
    v_cvt_pk_bf16_f32 v62, v44, v45
    v_cvt_pk_bf16_f32 v63, v46, v47
    v_exp_f32 v16, v16
    v_mfma_f32_32x32x16_bf16 v[32:47], a[44:47], v[140:143], 0
    v_exp_f32 v17, v17
    v_exp_f32 v18, v18
    v_cvt_pk_bf16_f32 v48, v16, v17
    v_exp_f32 v19, v19
    v_exp_f32 v20, v20
    v_mfma_f32_32x32x16_bf16 v[80:95], a[168:171], v[56:59], v[80:95]
    v_cvt_pk_bf16_f32 v49, v18, v19
    v_exp_f32 v21, v21
    v_exp_f32 v22, v22
    v_cvt_pk_bf16_f32 v50, v20, v21
    v_exp_f32 v23, v23
    v_mfma_f32_32x32x8_bf16 v[32:47], a[86:87], v[144:145], v[32:47]
    v_exp_f32 v24, v24
    v_cvt_pk_bf16_f32 v51, v22, v23
    v_exp_f32 v25, v25
    v_exp_f32 v26, v26
    v_cvt_pk_bf16_f32 v52, v24, v25
    v_exp_f32 v27, v27
    v_mfma_f32_32x32x16_bf16 v[80:95], a[172:175], v[60:63], v[80:95]
    v_exp_f32 v28, v28
    v_cvt_pk_bf16_f32 v53, v26, v27
    v_exp_f32 v29, v29
    v_exp_f32 v30, v30
    v_exp_f32 v31, v31
    v_cvt_pk_bf16_f32 v54, v28, v29
    v_cvt_pk_bf16_f32 v55, v30, v31
    v_exp_f32 v32, v32
    s_add_u32 m0, s32, 94208
    s_mov_b32 s38, 163840
    buffer_load_dwordx4 v202, s[40:43], s38 offen lds
    v_mfma_f32_32x32x16_bf16 v[16:31], a[48:51], v[140:143], 0
    v_exp_f32 v33, v33
    v_exp_f32 v34, v34
    v_cvt_pk_bf16_f32 v56, v32, v33
    v_exp_f32 v35, v35
    v_exp_f32 v36, v36
    v_mfma_f32_32x32x16_bf16 v[80:95], a[176:179], v[48:51], v[80:95]
    v_cvt_pk_bf16_f32 v57, v34, v35
    v_exp_f32 v37, v37
    v_exp_f32 v38, v38
    v_cvt_pk_bf16_f32 v58, v36, v37
    v_exp_f32 v39, v39
    v_mfma_f32_32x32x8_bf16 v[16:31], a[88:89], v[144:145], v[16:31]
    v_exp_f32 v40, v40
    v_cvt_pk_bf16_f32 v59, v38, v39
    v_exp_f32 v41, v41
    v_exp_f32 v42, v42
    v_cvt_pk_bf16_f32 v60, v40, v41
    v_exp_f32 v43, v43
    v_mfma_f32_32x32x16_bf16 v[80:95], a[180:183], v[52:55], v[80:95]
    v_exp_f32 v44, v44
    v_cvt_pk_bf16_f32 v61, v42, v43
    v_exp_f32 v45, v45
    v_exp_f32 v46, v46
    v_exp_f32 v47, v47
    v_cvt_pk_bf16_f32 v62, v44, v45
    v_cvt_pk_bf16_f32 v63, v46, v47
    v_exp_f32 v16, v16
    v_mfma_f32_32x32x16_bf16 v[32:47], a[52:55], v[140:143], 0
    v_exp_f32 v17, v17
    v_exp_f32 v18, v18
    v_cvt_pk_bf16_f32 v48, v16, v17
    v_exp_f32 v19, v19
    v_exp_f32 v20, v20
    v_mfma_f32_32x32x16_bf16 v[80:95], a[184:187], v[56:59], v[80:95]
    v_cvt_pk_bf16_f32 v49, v18, v19
    v_exp_f32 v21, v21
    v_exp_f32 v22, v22
    v_cvt_pk_bf16_f32 v50, v20, v21
    v_exp_f32 v23, v23
    v_mfma_f32_32x32x8_bf16 v[32:47], a[90:91], v[144:145], v[32:47]
    v_exp_f32 v24, v24
    v_cvt_pk_bf16_f32 v51, v22, v23
    v_exp_f32 v25, v25
    v_exp_f32 v26, v26
    v_cvt_pk_bf16_f32 v52, v24, v25
    v_exp_f32 v27, v27
    v_mfma_f32_32x32x16_bf16 v[80:95], a[188:191], v[60:63], v[80:95]
    v_exp_f32 v28, v28
    v_cvt_pk_bf16_f32 v53, v26, v27
    v_exp_f32 v29, v29
    v_exp_f32 v30, v30
    v_exp_f32 v31, v31
    v_cvt_pk_bf16_f32 v54, v28, v29
    v_cvt_pk_bf16_f32 v55, v30, v31
    v_exp_f32 v32, v32
    v_mfma_f32_32x32x16_bf16 v[16:31], a[56:59], v[140:143], 0
    v_exp_f32 v33, v33
    v_exp_f32 v34, v34
    v_cvt_pk_bf16_f32 v56, v32, v33
    v_exp_f32 v35, v35
    v_exp_f32 v36, v36
    v_mfma_f32_32x32x16_bf16 v[80:95], a[192:195], v[48:51], v[80:95]
    v_cvt_pk_bf16_f32 v57, v34, v35
    v_exp_f32 v37, v37
    v_exp_f32 v38, v38
    v_cvt_pk_bf16_f32 v58, v36, v37
    v_exp_f32 v39, v39
    v_mfma_f32_32x32x8_bf16 v[16:31], a[92:93], v[144:145], v[16:31]
    v_exp_f32 v40, v40
    v_cvt_pk_bf16_f32 v59, v38, v39
    v_exp_f32 v41, v41
    v_exp_f32 v42, v42
    v_cvt_pk_bf16_f32 v60, v40, v41
    v_exp_f32 v43, v43
    v_mfma_f32_32x32x16_bf16 v[80:95], a[196:199], v[52:55], v[80:95]
    v_exp_f32 v44, v44
    v_cvt_pk_bf16_f32 v61, v42, v43
    v_exp_f32 v45, v45
    v_exp_f32 v46, v46
    v_exp_f32 v47, v47
    v_cvt_pk_bf16_f32 v62, v44, v45
    v_cvt_pk_bf16_f32 v63, v46, v47
    v_exp_f32 v16, v16
    s_add_u32 m0, s32, 98304
    s_nop 0
    buffer_load_dwordx4 v203, s[40:43], s38 offen lds
    v_mfma_f32_32x32x16_bf16 v[32:47], a[60:63], v[140:143], 0
    v_exp_f32 v17, v17
    v_exp_f32 v18, v18
    v_cvt_pk_bf16_f32 v48, v16, v17
    v_exp_f32 v19, v19
    v_exp_f32 v20, v20
    v_mfma_f32_32x32x16_bf16 v[80:95], a[200:203], v[56:59], v[80:95]
    v_cvt_pk_bf16_f32 v49, v18, v19
    v_exp_f32 v21, v21
    v_exp_f32 v22, v22
    v_cvt_pk_bf16_f32 v50, v20, v21
    v_exp_f32 v23, v23
    v_mfma_f32_32x32x8_bf16 v[32:47], a[94:95], v[144:145], v[32:47]
    v_exp_f32 v24, v24
    v_cvt_pk_bf16_f32 v51, v22, v23
    v_exp_f32 v25, v25
    v_exp_f32 v26, v26
    v_cvt_pk_bf16_f32 v52, v24, v25
    v_exp_f32 v27, v27
    v_mfma_f32_32x32x16_bf16 v[80:95], a[204:207], v[60:63], v[80:95]
    v_exp_f32 v28, v28
    v_cvt_pk_bf16_f32 v53, v26, v27
    v_exp_f32 v29, v29
    v_exp_f32 v30, v30
    v_exp_f32 v31, v31
    v_cvt_pk_bf16_f32 v54, v28, v29
    v_cvt_pk_bf16_f32 v55, v30, v31
    v_exp_f32 v32, v32
    v_mfma_f32_32x32x16_bf16 v[16:31], a[0:3], v[146:149], 0
    v_exp_f32 v33, v33
    v_exp_f32 v34, v34
    v_cvt_pk_bf16_f32 v56, v32, v33
    v_exp_f32 v35, v35
    v_exp_f32 v36, v36
    v_mfma_f32_32x32x16_bf16 v[80:95], a[208:211], v[48:51], v[80:95]
    v_cvt_pk_bf16_f32 v57, v34, v35
    v_exp_f32 v37, v37
    v_exp_f32 v38, v38
    v_cvt_pk_bf16_f32 v58, v36, v37
    v_exp_f32 v39, v39
    v_mfma_f32_32x32x8_bf16 v[16:31], a[64:65], v[150:151], v[16:31]
    v_exp_f32 v40, v40
    v_cvt_pk_bf16_f32 v59, v38, v39
    v_exp_f32 v41, v41
    v_exp_f32 v42, v42
    v_cvt_pk_bf16_f32 v60, v40, v41
    v_exp_f32 v43, v43
    v_mfma_f32_32x32x16_bf16 v[80:95], a[212:215], v[52:55], v[80:95]
    v_exp_f32 v44, v44
    v_cvt_pk_bf16_f32 v61, v42, v43
    v_exp_f32 v45, v45
    v_exp_f32 v46, v46
    v_exp_f32 v47, v47
    v_cvt_pk_bf16_f32 v62, v44, v45
    v_cvt_pk_bf16_f32 v63, v46, v47
    v_exp_f32 v16, v16
    v_mfma_f32_32x32x16_bf16 v[32:47], a[4:7], v[146:149], 0
    v_exp_f32 v17, v17
    v_exp_f32 v18, v18
    v_cvt_pk_bf16_f32 v48, v16, v17
    v_exp_f32 v19, v19
    v_exp_f32 v20, v20
    v_mfma_f32_32x32x16_bf16 v[80:95], a[216:219], v[56:59], v[80:95]
    v_cvt_pk_bf16_f32 v49, v18, v19
    v_exp_f32 v21, v21
    v_exp_f32 v22, v22
    v_cvt_pk_bf16_f32 v50, v20, v21
    v_exp_f32 v23, v23
    v_mfma_f32_32x32x8_bf16 v[32:47], a[66:67], v[150:151], v[32:47]
    v_exp_f32 v24, v24
    v_cvt_pk_bf16_f32 v51, v22, v23
    v_exp_f32 v25, v25
    v_exp_f32 v26, v26
    v_cvt_pk_bf16_f32 v52, v24, v25
    v_exp_f32 v27, v27
    v_mfma_f32_32x32x16_bf16 v[80:95], a[220:223], v[60:63], v[80:95]
    v_exp_f32 v28, v28
    v_cvt_pk_bf16_f32 v53, v26, v27
    v_exp_f32 v29, v29
    v_exp_f32 v30, v30
    v_exp_f32 v31, v31
    v_cvt_pk_bf16_f32 v54, v28, v29
    v_cvt_pk_bf16_f32 v55, v30, v31
    v_exp_f32 v32, v32
    v_mfma_f32_32x32x16_bf16 v[16:31], a[8:11], v[146:149], 0
    v_exp_f32 v33, v33
    v_exp_f32 v34, v34
    v_cvt_pk_bf16_f32 v56, v32, v33
    v_exp_f32 v35, v35
    v_exp_f32 v36, v36
    v_mfma_f32_32x32x16_bf16 v[96:111], a[96:99], v[48:51], 0
    v_cvt_pk_bf16_f32 v57, v34, v35
    v_exp_f32 v37, v37
    v_exp_f32 v38, v38
    v_cvt_pk_bf16_f32 v58, v36, v37
    v_exp_f32 v39, v39
    v_mfma_f32_32x32x8_bf16 v[16:31], a[68:69], v[150:151], v[16:31]
    v_exp_f32 v40, v40
    v_cvt_pk_bf16_f32 v59, v38, v39
    v_exp_f32 v41, v41
    v_exp_f32 v42, v42
    v_cvt_pk_bf16_f32 v60, v40, v41
    v_exp_f32 v43, v43
    v_mfma_f32_32x32x16_bf16 v[96:111], a[100:103], v[52:55], v[96:111]
    v_exp_f32 v44, v44
    v_cvt_pk_bf16_f32 v61, v42, v43
    v_exp_f32 v45, v45
    v_exp_f32 v46, v46
    v_exp_f32 v47, v47
    v_cvt_pk_bf16_f32 v62, v44, v45
    v_cvt_pk_bf16_f32 v63, v46, v47
    v_exp_f32 v16, v16
    v_mfma_f32_32x32x16_bf16 v[32:47], a[12:15], v[146:149], 0
    v_exp_f32 v17, v17
    v_exp_f32 v18, v18
    v_cvt_pk_bf16_f32 v48, v16, v17
    v_exp_f32 v19, v19
    v_exp_f32 v20, v20
    v_mfma_f32_32x32x16_bf16 v[96:111], a[104:107], v[56:59], v[96:111]
    v_cvt_pk_bf16_f32 v49, v18, v19
    v_exp_f32 v21, v21
    v_exp_f32 v22, v22
    v_cvt_pk_bf16_f32 v50, v20, v21
    v_exp_f32 v23, v23
    v_mfma_f32_32x32x8_bf16 v[32:47], a[70:71], v[150:151], v[32:47]
    v_exp_f32 v24, v24
    v_cvt_pk_bf16_f32 v51, v22, v23
    v_exp_f32 v25, v25
    v_exp_f32 v26, v26
    v_cvt_pk_bf16_f32 v52, v24, v25
    v_exp_f32 v27, v27
    v_mfma_f32_32x32x16_bf16 v[96:111], a[108:111], v[60:63], v[96:111]
    v_exp_f32 v28, v28
    v_cvt_pk_bf16_f32 v53, v26, v27
    v_exp_f32 v29, v29
    v_exp_f32 v30, v30
    v_exp_f32 v31, v31
    v_cvt_pk_bf16_f32 v54, v28, v29
    v_cvt_pk_bf16_f32 v55, v30, v31
    v_exp_f32 v32, v32
    ds_write_b128 v240, v[80:83] offset:0
    v_mfma_f32_32x32x16_bf16 v[16:31], a[16:19], v[146:149], 0
    v_exp_f32 v33, v33
    v_exp_f32 v34, v34
    v_cvt_pk_bf16_f32 v56, v32, v33
    v_exp_f32 v35, v35
    v_exp_f32 v36, v36
    v_mfma_f32_32x32x16_bf16 v[96:111], a[112:115], v[48:51], v[96:111]
    v_cvt_pk_bf16_f32 v57, v34, v35
    v_exp_f32 v37, v37
    v_exp_f32 v38, v38
    v_cvt_pk_bf16_f32 v58, v36, v37
    v_exp_f32 v39, v39
    v_mfma_f32_32x32x8_bf16 v[16:31], a[72:73], v[150:151], v[16:31]
    v_exp_f32 v40, v40
    v_cvt_pk_bf16_f32 v59, v38, v39
    v_exp_f32 v41, v41
    v_exp_f32 v42, v42
    v_cvt_pk_bf16_f32 v60, v40, v41
    v_exp_f32 v43, v43
    v_mfma_f32_32x32x16_bf16 v[96:111], a[116:119], v[52:55], v[96:111]
    v_exp_f32 v44, v44
    v_cvt_pk_bf16_f32 v61, v42, v43
    v_exp_f32 v45, v45
    v_exp_f32 v46, v46
    v_exp_f32 v47, v47
    v_cvt_pk_bf16_f32 v62, v44, v45
    v_cvt_pk_bf16_f32 v63, v46, v47
    v_exp_f32 v16, v16
    ds_write_b128 v240, v[84:87] offset:1024
    v_mfma_f32_32x32x16_bf16 v[32:47], a[20:23], v[146:149], 0
    v_exp_f32 v17, v17
    v_exp_f32 v18, v18
    v_cvt_pk_bf16_f32 v48, v16, v17
    v_exp_f32 v19, v19
    v_exp_f32 v20, v20
    v_mfma_f32_32x32x16_bf16 v[96:111], a[120:123], v[56:59], v[96:111]
    v_cvt_pk_bf16_f32 v49, v18, v19
    v_exp_f32 v21, v21
    v_exp_f32 v22, v22
    v_cvt_pk_bf16_f32 v50, v20, v21
    v_exp_f32 v23, v23
    v_mfma_f32_32x32x8_bf16 v[32:47], a[74:75], v[150:151], v[32:47]
    v_exp_f32 v24, v24
    v_cvt_pk_bf16_f32 v51, v22, v23
    v_exp_f32 v25, v25
    v_exp_f32 v26, v26
    v_cvt_pk_bf16_f32 v52, v24, v25
    v_exp_f32 v27, v27
    v_mfma_f32_32x32x16_bf16 v[96:111], a[124:127], v[60:63], v[96:111]
    v_exp_f32 v28, v28
    v_cvt_pk_bf16_f32 v53, v26, v27
    v_exp_f32 v29, v29
    v_exp_f32 v30, v30
    v_exp_f32 v31, v31
    v_cvt_pk_bf16_f32 v54, v28, v29
    v_cvt_pk_bf16_f32 v55, v30, v31
    v_exp_f32 v32, v32
    s_add_u32 s39, s32, 102400
    s_cmp_lt_u32 s20, 2
    s_cselect_b32 m0, s39, 160000
    s_nop 0
    buffer_load_dwordx4 v204, s[40:43], s38 offen lds
    v_mfma_f32_32x32x16_bf16 v[16:31], a[24:27], v[146:149], 0
    v_exp_f32 v33, v33
    v_exp_f32 v34, v34
    v_cvt_pk_bf16_f32 v56, v32, v33
    v_exp_f32 v35, v35
    v_exp_f32 v36, v36
    v_mfma_f32_32x32x16_bf16 v[96:111], a[128:131], v[48:51], v[96:111]
    v_cvt_pk_bf16_f32 v57, v34, v35
    v_exp_f32 v37, v37
    v_exp_f32 v38, v38
    v_cvt_pk_bf16_f32 v58, v36, v37
    v_exp_f32 v39, v39
    v_mfma_f32_32x32x8_bf16 v[16:31], a[76:77], v[150:151], v[16:31]
    v_exp_f32 v40, v40
    v_cvt_pk_bf16_f32 v59, v38, v39
    v_exp_f32 v41, v41
    v_exp_f32 v42, v42
    v_cvt_pk_bf16_f32 v60, v40, v41
    v_exp_f32 v43, v43
    v_mfma_f32_32x32x16_bf16 v[96:111], a[132:135], v[52:55], v[96:111]
    v_exp_f32 v44, v44
    v_cvt_pk_bf16_f32 v61, v42, v43
    v_exp_f32 v45, v45
    v_exp_f32 v46, v46
    v_exp_f32 v47, v47
    v_cvt_pk_bf16_f32 v62, v44, v45
    v_cvt_pk_bf16_f32 v63, v46, v47
    v_exp_f32 v16, v16
    ds_write_b128 v240, v[88:91] offset:2048
    v_mfma_f32_32x32x16_bf16 v[32:47], a[28:31], v[146:149], 0
    v_exp_f32 v17, v17
    v_exp_f32 v18, v18
    v_cvt_pk_bf16_f32 v48, v16, v17
    v_exp_f32 v19, v19
    v_exp_f32 v20, v20
    v_mfma_f32_32x32x16_bf16 v[96:111], a[136:139], v[56:59], v[96:111]
    v_cvt_pk_bf16_f32 v49, v18, v19
    v_exp_f32 v21, v21
    v_exp_f32 v22, v22
    v_cvt_pk_bf16_f32 v50, v20, v21
    v_exp_f32 v23, v23
    v_mfma_f32_32x32x8_bf16 v[32:47], a[78:79], v[150:151], v[32:47]
    v_exp_f32 v24, v24
    v_cvt_pk_bf16_f32 v51, v22, v23
    v_exp_f32 v25, v25
    v_exp_f32 v26, v26
    v_cvt_pk_bf16_f32 v52, v24, v25
    v_exp_f32 v27, v27
    v_mfma_f32_32x32x16_bf16 v[96:111], a[140:143], v[60:63], v[96:111]
    v_exp_f32 v28, v28
    v_cvt_pk_bf16_f32 v53, v26, v27
    v_exp_f32 v29, v29
    v_exp_f32 v30, v30
    v_exp_f32 v31, v31
    v_cvt_pk_bf16_f32 v54, v28, v29
    v_cvt_pk_bf16_f32 v55, v30, v31
    v_exp_f32 v32, v32
    v_mfma_f32_32x32x16_bf16 v[16:31], a[32:35], v[146:149], 0
    v_exp_f32 v33, v33
    v_exp_f32 v34, v34
    v_cvt_pk_bf16_f32 v56, v32, v33
    v_exp_f32 v35, v35
    v_exp_f32 v36, v36
    v_mfma_f32_32x32x16_bf16 v[96:111], a[144:147], v[48:51], v[96:111]
    v_cvt_pk_bf16_f32 v57, v34, v35
    v_exp_f32 v37, v37
    v_exp_f32 v38, v38
    v_cvt_pk_bf16_f32 v58, v36, v37
    v_exp_f32 v39, v39
    v_mfma_f32_32x32x8_bf16 v[16:31], a[80:81], v[150:151], v[16:31]
    v_exp_f32 v40, v40
    v_cvt_pk_bf16_f32 v59, v38, v39
    v_exp_f32 v41, v41
    v_exp_f32 v42, v42
    v_cvt_pk_bf16_f32 v60, v40, v41
    v_exp_f32 v43, v43
    v_mfma_f32_32x32x16_bf16 v[96:111], a[148:151], v[52:55], v[96:111]
    v_exp_f32 v44, v44
    v_cvt_pk_bf16_f32 v61, v42, v43
    v_exp_f32 v45, v45
    v_exp_f32 v46, v46
    v_exp_f32 v47, v47
    v_cvt_pk_bf16_f32 v62, v44, v45
    v_cvt_pk_bf16_f32 v63, v46, v47
    v_exp_f32 v16, v16
    s_add_u32 m0, s32, 104448
    s_mov_b32 s38, 245760
    buffer_load_dwordx4 v202, s[40:43], s38 offen lds
    v_mfma_f32_32x32x16_bf16 v[32:47], a[36:39], v[146:149], 0
    v_exp_f32 v17, v17
    v_exp_f32 v18, v18
    v_cvt_pk_bf16_f32 v48, v16, v17
    v_exp_f32 v19, v19
    v_exp_f32 v20, v20
    v_mfma_f32_32x32x16_bf16 v[96:111], a[152:155], v[56:59], v[96:111]
    v_cvt_pk_bf16_f32 v49, v18, v19
    v_exp_f32 v21, v21
    v_exp_f32 v22, v22
    v_cvt_pk_bf16_f32 v50, v20, v21
    v_exp_f32 v23, v23
    v_mfma_f32_32x32x8_bf16 v[32:47], a[82:83], v[150:151], v[32:47]
    v_exp_f32 v24, v24
    v_cvt_pk_bf16_f32 v51, v22, v23
    v_exp_f32 v25, v25
    v_exp_f32 v26, v26
    v_cvt_pk_bf16_f32 v52, v24, v25
    v_exp_f32 v27, v27
    v_mfma_f32_32x32x16_bf16 v[96:111], a[156:159], v[60:63], v[96:111]
    v_exp_f32 v28, v28
    v_cvt_pk_bf16_f32 v53, v26, v27
    v_exp_f32 v29, v29
    v_exp_f32 v30, v30
    v_exp_f32 v31, v31
    v_cvt_pk_bf16_f32 v54, v28, v29
    v_cvt_pk_bf16_f32 v55, v30, v31
    v_exp_f32 v32, v32
    v_mfma_f32_32x32x16_bf16 v[16:31], a[40:43], v[146:149], 0
    v_exp_f32 v33, v33
    v_exp_f32 v34, v34
    v_cvt_pk_bf16_f32 v56, v32, v33
    v_exp_f32 v35, v35
    v_exp_f32 v36, v36
    v_mfma_f32_32x32x16_bf16 v[96:111], a[160:163], v[48:51], v[96:111]
    v_cvt_pk_bf16_f32 v57, v34, v35
    v_exp_f32 v37, v37
    v_exp_f32 v38, v38
    v_cvt_pk_bf16_f32 v58, v36, v37
    v_exp_f32 v39, v39
    v_mfma_f32_32x32x8_bf16 v[16:31], a[84:85], v[150:151], v[16:31]
    v_exp_f32 v40, v40
    v_cvt_pk_bf16_f32 v59, v38, v39
    v_exp_f32 v41, v41
    v_exp_f32 v42, v42
    v_cvt_pk_bf16_f32 v60, v40, v41
    v_exp_f32 v43, v43
    v_mfma_f32_32x32x16_bf16 v[96:111], a[164:167], v[52:55], v[96:111]
    v_exp_f32 v44, v44
    v_cvt_pk_bf16_f32 v61, v42, v43
    v_exp_f32 v45, v45
    v_exp_f32 v46, v46
    v_exp_f32 v47, v47
    v_cvt_pk_bf16_f32 v62, v44, v45
    v_cvt_pk_bf16_f32 v63, v46, v47
    v_exp_f32 v16, v16
    v_mfma_f32_32x32x16_bf16 v[32:47], a[44:47], v[146:149], 0
    v_exp_f32 v17, v17
    v_exp_f32 v18, v18
    v_cvt_pk_bf16_f32 v48, v16, v17
    v_exp_f32 v19, v19
    v_exp_f32 v20, v20
    v_mfma_f32_32x32x16_bf16 v[96:111], a[168:171], v[56:59], v[96:111]
    v_cvt_pk_bf16_f32 v49, v18, v19
    v_exp_f32 v21, v21
    v_exp_f32 v22, v22
    v_cvt_pk_bf16_f32 v50, v20, v21
    v_exp_f32 v23, v23
    v_mfma_f32_32x32x8_bf16 v[32:47], a[86:87], v[150:151], v[32:47]
    v_exp_f32 v24, v24
    v_cvt_pk_bf16_f32 v51, v22, v23
    v_exp_f32 v25, v25
    v_exp_f32 v26, v26
    v_cvt_pk_bf16_f32 v52, v24, v25
    v_exp_f32 v27, v27
    v_mfma_f32_32x32x16_bf16 v[96:111], a[172:175], v[60:63], v[96:111]
    v_exp_f32 v28, v28
    v_cvt_pk_bf16_f32 v53, v26, v27
    v_exp_f32 v29, v29
    v_exp_f32 v30, v30
    v_exp_f32 v31, v31
    v_cvt_pk_bf16_f32 v54, v28, v29
    v_cvt_pk_bf16_f32 v55, v30, v31
    v_exp_f32 v32, v32
    s_add_u32 m0, s32, 108544
    s_nop 0
    buffer_load_dwordx4 v203, s[40:43], s38 offen lds
    v_mfma_f32_32x32x16_bf16 v[16:31], a[48:51], v[146:149], 0
    v_exp_f32 v33, v33
    v_exp_f32 v34, v34
    v_cvt_pk_bf16_f32 v56, v32, v33
    v_exp_f32 v35, v35
    v_exp_f32 v36, v36
    v_mfma_f32_32x32x16_bf16 v[96:111], a[176:179], v[48:51], v[96:111]
    v_cvt_pk_bf16_f32 v57, v34, v35
    v_exp_f32 v37, v37
    v_exp_f32 v38, v38
    v_cvt_pk_bf16_f32 v58, v36, v37
    v_exp_f32 v39, v39
    v_mfma_f32_32x32x8_bf16 v[16:31], a[88:89], v[150:151], v[16:31]
    v_exp_f32 v40, v40
    v_cvt_pk_bf16_f32 v59, v38, v39
    v_exp_f32 v41, v41
    v_exp_f32 v42, v42
    v_cvt_pk_bf16_f32 v60, v40, v41
    v_exp_f32 v43, v43
    v_mfma_f32_32x32x16_bf16 v[96:111], a[180:183], v[52:55], v[96:111]
    v_exp_f32 v44, v44
    v_cvt_pk_bf16_f32 v61, v42, v43
    v_exp_f32 v45, v45
    v_exp_f32 v46, v46
    v_exp_f32 v47, v47
    v_cvt_pk_bf16_f32 v62, v44, v45
    v_cvt_pk_bf16_f32 v63, v46, v47
    v_exp_f32 v16, v16
    v_mfma_f32_32x32x16_bf16 v[32:47], a[52:55], v[146:149], 0
    v_exp_f32 v17, v17
    v_exp_f32 v18, v18
    v_cvt_pk_bf16_f32 v48, v16, v17
    v_exp_f32 v19, v19
    v_exp_f32 v20, v20
    v_mfma_f32_32x32x16_bf16 v[96:111], a[184:187], v[56:59], v[96:111]
    v_cvt_pk_bf16_f32 v49, v18, v19
    v_exp_f32 v21, v21
    v_exp_f32 v22, v22
    v_cvt_pk_bf16_f32 v50, v20, v21
    v_exp_f32 v23, v23
    v_mfma_f32_32x32x8_bf16 v[32:47], a[90:91], v[150:151], v[32:47]
    v_exp_f32 v24, v24
    v_cvt_pk_bf16_f32 v51, v22, v23
    v_exp_f32 v25, v25
    v_exp_f32 v26, v26
    v_cvt_pk_bf16_f32 v52, v24, v25
    v_exp_f32 v27, v27
    v_mfma_f32_32x32x16_bf16 v[96:111], a[188:191], v[60:63], v[96:111]
    v_exp_f32 v28, v28
    v_cvt_pk_bf16_f32 v53, v26, v27
    v_exp_f32 v29, v29
    v_exp_f32 v30, v30
    v_exp_f32 v31, v31
    v_cvt_pk_bf16_f32 v54, v28, v29
    v_cvt_pk_bf16_f32 v55, v30, v31
    v_exp_f32 v32, v32
    v_mfma_f32_32x32x16_bf16 v[16:31], a[56:59], v[146:149], 0
    v_exp_f32 v33, v33
    v_exp_f32 v34, v34
    v_cvt_pk_bf16_f32 v56, v32, v33
    v_exp_f32 v35, v35
    v_exp_f32 v36, v36
    v_mfma_f32_32x32x16_bf16 v[96:111], a[192:195], v[48:51], v[96:111]
    v_cvt_pk_bf16_f32 v57, v34, v35
    v_exp_f32 v37, v37
    v_exp_f32 v38, v38
    v_cvt_pk_bf16_f32 v58, v36, v37
    v_exp_f32 v39, v39
    v_mfma_f32_32x32x8_bf16 v[16:31], a[92:93], v[150:151], v[16:31]
    v_exp_f32 v40, v40
    v_cvt_pk_bf16_f32 v59, v38, v39
    v_exp_f32 v41, v41
    v_exp_f32 v42, v42
    v_cvt_pk_bf16_f32 v60, v40, v41
    v_exp_f32 v43, v43
    v_mfma_f32_32x32x16_bf16 v[96:111], a[196:199], v[52:55], v[96:111]
    v_exp_f32 v44, v44
    v_cvt_pk_bf16_f32 v61, v42, v43
    v_exp_f32 v45, v45
    v_exp_f32 v46, v46
    v_exp_f32 v47, v47
    v_cvt_pk_bf16_f32 v62, v44, v45
    v_cvt_pk_bf16_f32 v63, v46, v47
    v_exp_f32 v16, v16
    s_add_u32 s39, s32, 112640
    s_cmp_lt_u32 s20, 2
    s_cselect_b32 m0, s39, 160000
    s_nop 0
    buffer_load_dwordx4 v204, s[40:43], s38 offen lds
    v_mfma_f32_32x32x16_bf16 v[32:47], a[60:63], v[146:149], 0
    v_exp_f32 v17, v17
    v_exp_f32 v18, v18
    v_cvt_pk_bf16_f32 v48, v16, v17
    v_exp_f32 v19, v19
    v_exp_f32 v20, v20
    v_mfma_f32_32x32x16_bf16 v[96:111], a[200:203], v[56:59], v[96:111]
    v_cvt_pk_bf16_f32 v49, v18, v19
    v_exp_f32 v21, v21
    v_exp_f32 v22, v22
    v_cvt_pk_bf16_f32 v50, v20, v21
    v_exp_f32 v23, v23
    v_mfma_f32_32x32x8_bf16 v[32:47], a[94:95], v[150:151], v[32:47]
    v_exp_f32 v24, v24
    v_cvt_pk_bf16_f32 v51, v22, v23
    v_exp_f32 v25, v25
    v_exp_f32 v26, v26
    v_cvt_pk_bf16_f32 v52, v24, v25
    v_exp_f32 v27, v27
    v_mfma_f32_32x32x16_bf16 v[96:111], a[204:207], v[60:63], v[96:111]
    v_exp_f32 v28, v28
    v_cvt_pk_bf16_f32 v53, v26, v27
    v_exp_f32 v29, v29
    v_exp_f32 v30, v30
    v_exp_f32 v31, v31
    v_cvt_pk_bf16_f32 v54, v28, v29
    v_cvt_pk_bf16_f32 v55, v30, v31
    v_exp_f32 v32, v32
    v_mfma_f32_32x32x16_bf16 v[16:31], a[0:3], v[152:155], 0
    v_exp_f32 v33, v33
    v_exp_f32 v34, v34
    v_cvt_pk_bf16_f32 v56, v32, v33
    v_exp_f32 v35, v35
    v_exp_f32 v36, v36
    v_mfma_f32_32x32x16_bf16 v[96:111], a[208:211], v[48:51], v[96:111]
    v_cvt_pk_bf16_f32 v57, v34, v35
    v_exp_f32 v37, v37
    v_exp_f32 v38, v38
    v_cvt_pk_bf16_f32 v58, v36, v37
    v_exp_f32 v39, v39
    v_mfma_f32_32x32x8_bf16 v[16:31], a[64:65], v[156:157], v[16:31]
    v_exp_f32 v40, v40
    v_cvt_pk_bf16_f32 v59, v38, v39
    v_exp_f32 v41, v41
    v_exp_f32 v42, v42
    v_cvt_pk_bf16_f32 v60, v40, v41
    v_exp_f32 v43, v43
    v_mfma_f32_32x32x16_bf16 v[96:111], a[212:215], v[52:55], v[96:111]
    v_exp_f32 v44, v44
    v_cvt_pk_bf16_f32 v61, v42, v43
    v_exp_f32 v45, v45
    v_exp_f32 v46, v46
    v_exp_f32 v47, v47
    v_cvt_pk_bf16_f32 v62, v44, v45
    v_cvt_pk_bf16_f32 v63, v46, v47
    v_exp_f32 v16, v16
    v_mfma_f32_32x32x16_bf16 v[32:47], a[4:7], v[152:155], 0
    v_exp_f32 v17, v17
    v_exp_f32 v18, v18
    v_cvt_pk_bf16_f32 v48, v16, v17
    v_exp_f32 v19, v19
    v_exp_f32 v20, v20
    v_mfma_f32_32x32x16_bf16 v[96:111], a[216:219], v[56:59], v[96:111]
    v_cvt_pk_bf16_f32 v49, v18, v19
    v_exp_f32 v21, v21
    v_exp_f32 v22, v22
    v_cvt_pk_bf16_f32 v50, v20, v21
    v_exp_f32 v23, v23
    v_mfma_f32_32x32x8_bf16 v[32:47], a[66:67], v[156:157], v[32:47]
    v_exp_f32 v24, v24
    v_cvt_pk_bf16_f32 v51, v22, v23
    v_exp_f32 v25, v25
    v_exp_f32 v26, v26
    v_cvt_pk_bf16_f32 v52, v24, v25
    v_exp_f32 v27, v27
    v_mfma_f32_32x32x16_bf16 v[96:111], a[220:223], v[60:63], v[96:111]
    v_exp_f32 v28, v28
    v_cvt_pk_bf16_f32 v53, v26, v27
    v_exp_f32 v29, v29
    v_exp_f32 v30, v30
    v_exp_f32 v31, v31
    v_cvt_pk_bf16_f32 v54, v28, v29
    v_cvt_pk_bf16_f32 v55, v30, v31
    v_exp_f32 v32, v32
    v_mfma_f32_32x32x16_bf16 v[16:31], a[8:11], v[152:155], 0
    v_exp_f32 v33, v33
    v_exp_f32 v34, v34
    v_cvt_pk_bf16_f32 v56, v32, v33
    v_exp_f32 v35, v35
    v_exp_f32 v36, v36
    v_mfma_f32_32x32x16_bf16 v[80:95], a[96:99], v[48:51], 0
    v_cvt_pk_bf16_f32 v57, v34, v35
    v_exp_f32 v37, v37
    v_exp_f32 v38, v38
    v_cvt_pk_bf16_f32 v58, v36, v37
    v_exp_f32 v39, v39
    v_mfma_f32_32x32x8_bf16 v[16:31], a[68:69], v[156:157], v[16:31]
    v_exp_f32 v40, v40
    v_cvt_pk_bf16_f32 v59, v38, v39
    v_exp_f32 v41, v41
    v_exp_f32 v42, v42
    v_cvt_pk_bf16_f32 v60, v40, v41
    v_exp_f32 v43, v43
    v_mfma_f32_32x32x16_bf16 v[80:95], a[100:103], v[52:55], v[80:95]
    v_exp_f32 v44, v44
    v_cvt_pk_bf16_f32 v61, v42, v43
    v_exp_f32 v45, v45
    v_exp_f32 v46, v46
    v_exp_f32 v47, v47
    v_cvt_pk_bf16_f32 v62, v44, v45
    v_cvt_pk_bf16_f32 v63, v46, v47
    v_exp_f32 v16, v16
    v_mfma_f32_32x32x16_bf16 v[32:47], a[12:15], v[152:155], 0
    v_exp_f32 v17, v17
    v_exp_f32 v18, v18
    v_cvt_pk_bf16_f32 v48, v16, v17
    v_exp_f32 v19, v19
    v_exp_f32 v20, v20
    v_mfma_f32_32x32x16_bf16 v[80:95], a[104:107], v[56:59], v[80:95]
    v_cvt_pk_bf16_f32 v49, v18, v19
    v_exp_f32 v21, v21
    v_exp_f32 v22, v22
    v_cvt_pk_bf16_f32 v50, v20, v21
    v_exp_f32 v23, v23
    v_mfma_f32_32x32x8_bf16 v[32:47], a[70:71], v[156:157], v[32:47]
    v_exp_f32 v24, v24
    v_cvt_pk_bf16_f32 v51, v22, v23
    v_exp_f32 v25, v25
    v_exp_f32 v26, v26
    v_cvt_pk_bf16_f32 v52, v24, v25
    v_exp_f32 v27, v27
    v_mfma_f32_32x32x16_bf16 v[80:95], a[108:111], v[60:63], v[80:95]
    v_exp_f32 v28, v28
    v_cvt_pk_bf16_f32 v53, v26, v27
    v_exp_f32 v29, v29
    v_exp_f32 v30, v30
    v_exp_f32 v31, v31
    v_cvt_pk_bf16_f32 v54, v28, v29
    v_cvt_pk_bf16_f32 v55, v30, v31
    v_exp_f32 v32, v32
    ds_write_b128 v241, v[96:99] offset:0
    v_mfma_f32_32x32x16_bf16 v[16:31], a[16:19], v[152:155], 0
    v_exp_f32 v33, v33
    v_exp_f32 v34, v34
    v_cvt_pk_bf16_f32 v56, v32, v33
    v_exp_f32 v35, v35
    v_exp_f32 v36, v36
    v_mfma_f32_32x32x16_bf16 v[80:95], a[112:115], v[48:51], v[80:95]
    v_cvt_pk_bf16_f32 v57, v34, v35
    v_exp_f32 v37, v37
    v_exp_f32 v38, v38
    v_cvt_pk_bf16_f32 v58, v36, v37
    v_exp_f32 v39, v39
    v_mfma_f32_32x32x8_bf16 v[16:31], a[72:73], v[156:157], v[16:31]
    v_exp_f32 v40, v40
    v_cvt_pk_bf16_f32 v59, v38, v39
    v_exp_f32 v41, v41
    v_exp_f32 v42, v42
    v_cvt_pk_bf16_f32 v60, v40, v41
    v_exp_f32 v43, v43
    v_mfma_f32_32x32x16_bf16 v[80:95], a[116:119], v[52:55], v[80:95]
    v_exp_f32 v44, v44
    v_cvt_pk_bf16_f32 v61, v42, v43
    v_exp_f32 v45, v45
    v_exp_f32 v46, v46
    v_exp_f32 v47, v47
    v_cvt_pk_bf16_f32 v62, v44, v45
    v_cvt_pk_bf16_f32 v63, v46, v47
    v_exp_f32 v16, v16
    ds_write_b128 v241, v[100:103] offset:1024
    v_mfma_f32_32x32x16_bf16 v[32:47], a[20:23], v[152:155], 0
    v_exp_f32 v17, v17
    v_exp_f32 v18, v18
    v_cvt_pk_bf16_f32 v48, v16, v17
    v_exp_f32 v19, v19
    v_exp_f32 v20, v20
    v_mfma_f32_32x32x16_bf16 v[80:95], a[120:123], v[56:59], v[80:95]
    v_cvt_pk_bf16_f32 v49, v18, v19
    v_exp_f32 v21, v21
    v_exp_f32 v22, v22
    v_cvt_pk_bf16_f32 v50, v20, v21
    v_exp_f32 v23, v23
    v_mfma_f32_32x32x8_bf16 v[32:47], a[74:75], v[156:157], v[32:47]
    v_exp_f32 v24, v24
    v_cvt_pk_bf16_f32 v51, v22, v23
    v_exp_f32 v25, v25
    v_exp_f32 v26, v26
    v_cvt_pk_bf16_f32 v52, v24, v25
    v_exp_f32 v27, v27
    v_mfma_f32_32x32x16_bf16 v[80:95], a[124:127], v[60:63], v[80:95]
    v_exp_f32 v28, v28
    v_cvt_pk_bf16_f32 v53, v26, v27
    v_exp_f32 v29, v29
    v_exp_f32 v30, v30
    v_exp_f32 v31, v31
    v_cvt_pk_bf16_f32 v54, v28, v29
    v_cvt_pk_bf16_f32 v55, v30, v31
    v_exp_f32 v32, v32
    s_add_u32 m0, s32, 114688
    s_mov_b32 s38, 327680
    buffer_load_dwordx4 v202, s[40:43], s38 offen lds
    v_mfma_f32_32x32x16_bf16 v[16:31], a[24:27], v[152:155], 0
    v_exp_f32 v33, v33
    v_exp_f32 v34, v34
    v_cvt_pk_bf16_f32 v56, v32, v33
    v_exp_f32 v35, v35
    v_exp_f32 v36, v36
    v_mfma_f32_32x32x16_bf16 v[80:95], a[128:131], v[48:51], v[80:95]
    v_cvt_pk_bf16_f32 v57, v34, v35
    v_exp_f32 v37, v37
    v_exp_f32 v38, v38
    v_cvt_pk_bf16_f32 v58, v36, v37
    v_exp_f32 v39, v39
    v_mfma_f32_32x32x8_bf16 v[16:31], a[76:77], v[156:157], v[16:31]
    v_exp_f32 v40, v40
    v_cvt_pk_bf16_f32 v59, v38, v39
    v_exp_f32 v41, v41
    v_exp_f32 v42, v42
    v_cvt_pk_bf16_f32 v60, v40, v41
    v_exp_f32 v43, v43
    v_mfma_f32_32x32x16_bf16 v[80:95], a[132:135], v[52:55], v[80:95]
    v_exp_f32 v44, v44
    v_cvt_pk_bf16_f32 v61, v42, v43
    v_exp_f32 v45, v45
    v_exp_f32 v46, v46
    v_exp_f32 v47, v47
    v_cvt_pk_bf16_f32 v62, v44, v45
    v_cvt_pk_bf16_f32 v63, v46, v47
    v_exp_f32 v16, v16
    ds_write_b128 v241, v[104:107] offset:2048
    v_mfma_f32_32x32x16_bf16 v[32:47], a[28:31], v[152:155], 0
    v_exp_f32 v17, v17
    v_exp_f32 v18, v18
    v_cvt_pk_bf16_f32 v48, v16, v17
    v_exp_f32 v19, v19
    v_exp_f32 v20, v20
    v_mfma_f32_32x32x16_bf16 v[80:95], a[136:139], v[56:59], v[80:95]
    v_cvt_pk_bf16_f32 v49, v18, v19
    v_exp_f32 v21, v21
    v_exp_f32 v22, v22
    v_cvt_pk_bf16_f32 v50, v20, v21
    v_exp_f32 v23, v23
    v_mfma_f32_32x32x8_bf16 v[32:47], a[78:79], v[156:157], v[32:47]
    v_exp_f32 v24, v24
    v_cvt_pk_bf16_f32 v51, v22, v23
    v_exp_f32 v25, v25
    v_exp_f32 v26, v26
    v_cvt_pk_bf16_f32 v52, v24, v25
    v_exp_f32 v27, v27
    v_mfma_f32_32x32x16_bf16 v[80:95], a[140:143], v[60:63], v[80:95]
    v_exp_f32 v28, v28
    v_cvt_pk_bf16_f32 v53, v26, v27
    v_exp_f32 v29, v29
    v_exp_f32 v30, v30
    v_exp_f32 v31, v31
    v_cvt_pk_bf16_f32 v54, v28, v29
    v_cvt_pk_bf16_f32 v55, v30, v31
    v_exp_f32 v32, v32
    v_mfma_f32_32x32x16_bf16 v[16:31], a[32:35], v[152:155], 0
    v_exp_f32 v33, v33
    v_exp_f32 v34, v34
    v_cvt_pk_bf16_f32 v56, v32, v33
    v_exp_f32 v35, v35
    v_exp_f32 v36, v36
    v_mfma_f32_32x32x16_bf16 v[80:95], a[144:147], v[48:51], v[80:95]
    v_cvt_pk_bf16_f32 v57, v34, v35
    v_exp_f32 v37, v37
    v_exp_f32 v38, v38
    v_cvt_pk_bf16_f32 v58, v36, v37
    v_exp_f32 v39, v39
    v_mfma_f32_32x32x8_bf16 v[16:31], a[80:81], v[156:157], v[16:31]
    v_exp_f32 v40, v40
    v_cvt_pk_bf16_f32 v59, v38, v39
    v_exp_f32 v41, v41
    v_exp_f32 v42, v42
    v_cvt_pk_bf16_f32 v60, v40, v41
    v_exp_f32 v43, v43
    v_mfma_f32_32x32x16_bf16 v[80:95], a[148:151], v[52:55], v[80:95]
    v_exp_f32 v44, v44
    v_cvt_pk_bf16_f32 v61, v42, v43
    v_exp_f32 v45, v45
    v_exp_f32 v46, v46
    v_exp_f32 v47, v47
    v_cvt_pk_bf16_f32 v62, v44, v45
    v_cvt_pk_bf16_f32 v63, v46, v47
    v_exp_f32 v16, v16
    s_add_u32 m0, s32, 118784
    s_nop 0
    buffer_load_dwordx4 v203, s[40:43], s38 offen lds
    v_mfma_f32_32x32x16_bf16 v[32:47], a[36:39], v[152:155], 0
    v_exp_f32 v17, v17
    v_exp_f32 v18, v18
    v_cvt_pk_bf16_f32 v48, v16, v17
    v_exp_f32 v19, v19
    v_exp_f32 v20, v20
    v_mfma_f32_32x32x16_bf16 v[80:95], a[152:155], v[56:59], v[80:95]
    v_cvt_pk_bf16_f32 v49, v18, v19
    v_exp_f32 v21, v21
    v_exp_f32 v22, v22
    v_cvt_pk_bf16_f32 v50, v20, v21
    v_exp_f32 v23, v23
    v_mfma_f32_32x32x8_bf16 v[32:47], a[82:83], v[156:157], v[32:47]
    v_exp_f32 v24, v24
    v_cvt_pk_bf16_f32 v51, v22, v23
    v_exp_f32 v25, v25
    v_exp_f32 v26, v26
    v_cvt_pk_bf16_f32 v52, v24, v25
    v_exp_f32 v27, v27
    v_mfma_f32_32x32x16_bf16 v[80:95], a[156:159], v[60:63], v[80:95]
    v_exp_f32 v28, v28
    v_cvt_pk_bf16_f32 v53, v26, v27
    v_exp_f32 v29, v29
    v_exp_f32 v30, v30
    v_exp_f32 v31, v31
    v_cvt_pk_bf16_f32 v54, v28, v29
    v_cvt_pk_bf16_f32 v55, v30, v31
    v_exp_f32 v32, v32
    v_mfma_f32_32x32x16_bf16 v[16:31], a[40:43], v[152:155], 0
    v_exp_f32 v33, v33
    v_exp_f32 v34, v34
    v_cvt_pk_bf16_f32 v56, v32, v33
    v_exp_f32 v35, v35
    v_exp_f32 v36, v36
    v_mfma_f32_32x32x16_bf16 v[80:95], a[160:163], v[48:51], v[80:95]
    v_cvt_pk_bf16_f32 v57, v34, v35
    v_exp_f32 v37, v37
    v_exp_f32 v38, v38
    v_cvt_pk_bf16_f32 v58, v36, v37
    v_exp_f32 v39, v39
    v_mfma_f32_32x32x8_bf16 v[16:31], a[84:85], v[156:157], v[16:31]
    v_exp_f32 v40, v40
    v_cvt_pk_bf16_f32 v59, v38, v39
    v_exp_f32 v41, v41
    v_exp_f32 v42, v42
    v_cvt_pk_bf16_f32 v60, v40, v41
    v_exp_f32 v43, v43
    v_mfma_f32_32x32x16_bf16 v[80:95], a[164:167], v[52:55], v[80:95]
    v_exp_f32 v44, v44
    v_cvt_pk_bf16_f32 v61, v42, v43
    v_exp_f32 v45, v45
    v_exp_f32 v46, v46
    v_exp_f32 v47, v47
    v_cvt_pk_bf16_f32 v62, v44, v45
    v_cvt_pk_bf16_f32 v63, v46, v47
    v_exp_f32 v16, v16
    v_mfma_f32_32x32x16_bf16 v[32:47], a[44:47], v[152:155], 0
    v_exp_f32 v17, v17
    v_exp_f32 v18, v18
    v_cvt_pk_bf16_f32 v48, v16, v17
    v_exp_f32 v19, v19
    v_exp_f32 v20, v20
    v_mfma_f32_32x32x16_bf16 v[80:95], a[168:171], v[56:59], v[80:95]
    v_cvt_pk_bf16_f32 v49, v18, v19
    v_exp_f32 v21, v21
    v_exp_f32 v22, v22
    v_cvt_pk_bf16_f32 v50, v20, v21
    v_exp_f32 v23, v23
    v_mfma_f32_32x32x8_bf16 v[32:47], a[86:87], v[156:157], v[32:47]
    v_exp_f32 v24, v24
    v_cvt_pk_bf16_f32 v51, v22, v23
    v_exp_f32 v25, v25
    v_exp_f32 v26, v26
    v_cvt_pk_bf16_f32 v52, v24, v25
    v_exp_f32 v27, v27
    v_mfma_f32_32x32x16_bf16 v[80:95], a[172:175], v[60:63], v[80:95]
    v_exp_f32 v28, v28
    v_cvt_pk_bf16_f32 v53, v26, v27
    v_exp_f32 v29, v29
    v_exp_f32 v30, v30
    v_exp_f32 v31, v31
    v_cvt_pk_bf16_f32 v54, v28, v29
    v_cvt_pk_bf16_f32 v55, v30, v31
    v_exp_f32 v32, v32
    s_add_u32 s39, s32, 122880
    s_cmp_lt_u32 s20, 2
    s_cselect_b32 m0, s39, 160000
    s_nop 0
    buffer_load_dwordx4 v204, s[40:43], s38 offen lds
    v_mfma_f32_32x32x16_bf16 v[16:31], a[48:51], v[152:155], 0
    v_exp_f32 v33, v33
    v_exp_f32 v34, v34
    v_cvt_pk_bf16_f32 v56, v32, v33
    v_exp_f32 v35, v35
    v_exp_f32 v36, v36
    v_mfma_f32_32x32x16_bf16 v[80:95], a[176:179], v[48:51], v[80:95]
    v_cvt_pk_bf16_f32 v57, v34, v35
    v_exp_f32 v37, v37
    v_exp_f32 v38, v38
    v_cvt_pk_bf16_f32 v58, v36, v37
    v_exp_f32 v39, v39
    v_mfma_f32_32x32x8_bf16 v[16:31], a[88:89], v[156:157], v[16:31]
    v_exp_f32 v40, v40
    v_cvt_pk_bf16_f32 v59, v38, v39
    v_exp_f32 v41, v41
    v_exp_f32 v42, v42
    v_cvt_pk_bf16_f32 v60, v40, v41
    v_exp_f32 v43, v43
    v_mfma_f32_32x32x16_bf16 v[80:95], a[180:183], v[52:55], v[80:95]
    v_exp_f32 v44, v44
    v_cvt_pk_bf16_f32 v61, v42, v43
    v_exp_f32 v45, v45
    v_exp_f32 v46, v46
    v_exp_f32 v47, v47
    v_cvt_pk_bf16_f32 v62, v44, v45
    v_cvt_pk_bf16_f32 v63, v46, v47
    v_exp_f32 v16, v16
    v_mfma_f32_32x32x16_bf16 v[32:47], a[52:55], v[152:155], 0
    v_exp_f32 v17, v17
    v_exp_f32 v18, v18
    v_cvt_pk_bf16_f32 v48, v16, v17
    v_exp_f32 v19, v19
    v_exp_f32 v20, v20
    v_mfma_f32_32x32x16_bf16 v[80:95], a[184:187], v[56:59], v[80:95]
    v_cvt_pk_bf16_f32 v49, v18, v19
    v_exp_f32 v21, v21
    v_exp_f32 v22, v22
    v_cvt_pk_bf16_f32 v50, v20, v21
    v_exp_f32 v23, v23
    v_mfma_f32_32x32x8_bf16 v[32:47], a[90:91], v[156:157], v[32:47]
    v_exp_f32 v24, v24
    v_cvt_pk_bf16_f32 v51, v22, v23
    v_exp_f32 v25, v25
    v_exp_f32 v26, v26
    v_cvt_pk_bf16_f32 v52, v24, v25
    v_exp_f32 v27, v27
    v_mfma_f32_32x32x16_bf16 v[80:95], a[188:191], v[60:63], v[80:95]
    v_exp_f32 v28, v28
    v_cvt_pk_bf16_f32 v53, v26, v27
    v_exp_f32 v29, v29
    v_exp_f32 v30, v30
    v_exp_f32 v31, v31
    v_cvt_pk_bf16_f32 v54, v28, v29
    v_cvt_pk_bf16_f32 v55, v30, v31
    v_exp_f32 v32, v32
    v_mfma_f32_32x32x16_bf16 v[16:31], a[56:59], v[152:155], 0
    v_exp_f32 v33, v33
    v_exp_f32 v34, v34
    v_cvt_pk_bf16_f32 v56, v32, v33
    v_exp_f32 v35, v35
    v_exp_f32 v36, v36
    v_mfma_f32_32x32x16_bf16 v[80:95], a[192:195], v[48:51], v[80:95]
    v_cvt_pk_bf16_f32 v57, v34, v35
    v_exp_f32 v37, v37
    v_exp_f32 v38, v38
    v_cvt_pk_bf16_f32 v58, v36, v37
    v_exp_f32 v39, v39
    v_mfma_f32_32x32x8_bf16 v[16:31], a[92:93], v[156:157], v[16:31]
    v_exp_f32 v40, v40
    v_cvt_pk_bf16_f32 v59, v38, v39
    v_exp_f32 v41, v41
    v_exp_f32 v42, v42
    v_cvt_pk_bf16_f32 v60, v40, v41
    v_exp_f32 v43, v43
    v_mfma_f32_32x32x16_bf16 v[80:95], a[196:199], v[52:55], v[80:95]
    v_exp_f32 v44, v44
    v_cvt_pk_bf16_f32 v61, v42, v43
    v_exp_f32 v45, v45
    v_exp_f32 v46, v46
    v_exp_f32 v47, v47
    v_cvt_pk_bf16_f32 v62, v44, v45
    v_cvt_pk_bf16_f32 v63, v46, v47
    v_exp_f32 v16, v16
    s_add_u32 m0, s32, 124928
    s_mov_b32 s38, 409600
    buffer_load_dwordx4 v202, s[40:43], s38 offen lds
    v_mfma_f32_32x32x16_bf16 v[32:47], a[60:63], v[152:155], 0
    v_exp_f32 v17, v17
    v_exp_f32 v18, v18
    v_cvt_pk_bf16_f32 v48, v16, v17
    v_exp_f32 v19, v19
    v_exp_f32 v20, v20
    v_mfma_f32_32x32x16_bf16 v[80:95], a[200:203], v[56:59], v[80:95]
    v_cvt_pk_bf16_f32 v49, v18, v19
    v_exp_f32 v21, v21
    v_exp_f32 v22, v22
    v_cvt_pk_bf16_f32 v50, v20, v21
    v_exp_f32 v23, v23
    v_mfma_f32_32x32x8_bf16 v[32:47], a[94:95], v[156:157], v[32:47]
    v_exp_f32 v24, v24
    v_cvt_pk_bf16_f32 v51, v22, v23
    v_exp_f32 v25, v25
    v_exp_f32 v26, v26
    v_cvt_pk_bf16_f32 v52, v24, v25
    v_exp_f32 v27, v27
    v_mfma_f32_32x32x16_bf16 v[80:95], a[204:207], v[60:63], v[80:95]
    v_exp_f32 v28, v28
    v_cvt_pk_bf16_f32 v53, v26, v27
    v_exp_f32 v29, v29
    v_exp_f32 v30, v30
    v_exp_f32 v31, v31
    v_cvt_pk_bf16_f32 v54, v28, v29
    v_cvt_pk_bf16_f32 v55, v30, v31
    v_exp_f32 v32, v32
    v_mfma_f32_32x32x16_bf16 v[16:31], a[0:3], v[158:161], 0
    v_exp_f32 v33, v33
    v_exp_f32 v34, v34
    v_cvt_pk_bf16_f32 v56, v32, v33
    v_exp_f32 v35, v35
    v_exp_f32 v36, v36
    v_mfma_f32_32x32x16_bf16 v[80:95], a[208:211], v[48:51], v[80:95]
    v_cvt_pk_bf16_f32 v57, v34, v35
    v_exp_f32 v37, v37
    v_exp_f32 v38, v38
    v_cvt_pk_bf16_f32 v58, v36, v37
    v_exp_f32 v39, v39
    v_mfma_f32_32x32x8_bf16 v[16:31], a[64:65], v[162:163], v[16:31]
    v_exp_f32 v40, v40
    v_cvt_pk_bf16_f32 v59, v38, v39
    v_exp_f32 v41, v41
    v_exp_f32 v42, v42
    v_cvt_pk_bf16_f32 v60, v40, v41
    v_exp_f32 v43, v43
    v_mfma_f32_32x32x16_bf16 v[80:95], a[212:215], v[52:55], v[80:95]
    v_exp_f32 v44, v44
    v_cvt_pk_bf16_f32 v61, v42, v43
    v_exp_f32 v45, v45
    v_exp_f32 v46, v46
    v_exp_f32 v47, v47
    v_cvt_pk_bf16_f32 v62, v44, v45
    v_cvt_pk_bf16_f32 v63, v46, v47
    v_exp_f32 v16, v16
    v_mfma_f32_32x32x16_bf16 v[32:47], a[4:7], v[158:161], 0
    v_exp_f32 v17, v17
    v_exp_f32 v18, v18
    v_cvt_pk_bf16_f32 v48, v16, v17
    v_exp_f32 v19, v19
    v_exp_f32 v20, v20
    v_mfma_f32_32x32x16_bf16 v[80:95], a[216:219], v[56:59], v[80:95]
    v_cvt_pk_bf16_f32 v49, v18, v19
    v_exp_f32 v21, v21
    v_exp_f32 v22, v22
    v_cvt_pk_bf16_f32 v50, v20, v21
    v_exp_f32 v23, v23
    v_mfma_f32_32x32x8_bf16 v[32:47], a[66:67], v[162:163], v[32:47]
    v_exp_f32 v24, v24
    v_cvt_pk_bf16_f32 v51, v22, v23
    v_exp_f32 v25, v25
    v_exp_f32 v26, v26
    v_cvt_pk_bf16_f32 v52, v24, v25
    v_exp_f32 v27, v27
    v_mfma_f32_32x32x16_bf16 v[80:95], a[220:223], v[60:63], v[80:95]
    v_exp_f32 v28, v28
    v_cvt_pk_bf16_f32 v53, v26, v27
    v_exp_f32 v29, v29
    v_exp_f32 v30, v30
    v_exp_f32 v31, v31
    v_cvt_pk_bf16_f32 v54, v28, v29
    v_cvt_pk_bf16_f32 v55, v30, v31
    v_exp_f32 v32, v32
    v_mfma_f32_32x32x16_bf16 v[16:31], a[8:11], v[158:161], 0
    v_exp_f32 v33, v33
    v_exp_f32 v34, v34
    v_cvt_pk_bf16_f32 v56, v32, v33
    v_exp_f32 v35, v35
    v_exp_f32 v36, v36
    v_mfma_f32_32x32x16_bf16 v[96:111], a[96:99], v[48:51], 0
    v_cvt_pk_bf16_f32 v57, v34, v35
    v_exp_f32 v37, v37
    v_exp_f32 v38, v38
    v_cvt_pk_bf16_f32 v58, v36, v37
    v_exp_f32 v39, v39
    v_mfma_f32_32x32x8_bf16 v[16:31], a[68:69], v[162:163], v[16:31]
    v_exp_f32 v40, v40
    v_cvt_pk_bf16_f32 v59, v38, v39
    v_exp_f32 v41, v41
    v_exp_f32 v42, v42
    v_cvt_pk_bf16_f32 v60, v40, v41
    v_exp_f32 v43, v43
    v_mfma_f32_32x32x16_bf16 v[96:111], a[100:103], v[52:55], v[96:111]
    v_exp_f32 v44, v44
    v_cvt_pk_bf16_f32 v61, v42, v43
    v_exp_f32 v45, v45
    v_exp_f32 v46, v46
    v_exp_f32 v47, v47
    v_cvt_pk_bf16_f32 v62, v44, v45
    v_cvt_pk_bf16_f32 v63, v46, v47
    v_exp_f32 v16, v16
    v_mfma_f32_32x32x16_bf16 v[32:47], a[12:15], v[158:161], 0
    v_exp_f32 v17, v17
    v_exp_f32 v18, v18
    v_cvt_pk_bf16_f32 v48, v16, v17
    v_exp_f32 v19, v19
    v_exp_f32 v20, v20
    v_mfma_f32_32x32x16_bf16 v[96:111], a[104:107], v[56:59], v[96:111]
    v_cvt_pk_bf16_f32 v49, v18, v19
    v_exp_f32 v21, v21
    v_exp_f32 v22, v22
    v_cvt_pk_bf16_f32 v50, v20, v21
    v_exp_f32 v23, v23
    v_mfma_f32_32x32x8_bf16 v[32:47], a[70:71], v[162:163], v[32:47]
    v_exp_f32 v24, v24
    v_cvt_pk_bf16_f32 v51, v22, v23
    v_exp_f32 v25, v25
    v_exp_f32 v26, v26
    v_cvt_pk_bf16_f32 v52, v24, v25
    v_exp_f32 v27, v27
    v_mfma_f32_32x32x16_bf16 v[96:111], a[108:111], v[60:63], v[96:111]
    v_exp_f32 v28, v28
    v_cvt_pk_bf16_f32 v53, v26, v27
    v_exp_f32 v29, v29
    v_exp_f32 v30, v30
    v_exp_f32 v31, v31
    v_cvt_pk_bf16_f32 v54, v28, v29
    v_cvt_pk_bf16_f32 v55, v30, v31
    v_exp_f32 v32, v32
    ds_write_b128 v242, v[80:83] offset:0
    v_mfma_f32_32x32x16_bf16 v[16:31], a[16:19], v[158:161], 0
    v_exp_f32 v33, v33
    v_exp_f32 v34, v34
    v_cvt_pk_bf16_f32 v56, v32, v33
    v_exp_f32 v35, v35
    v_exp_f32 v36, v36
    v_mfma_f32_32x32x16_bf16 v[96:111], a[112:115], v[48:51], v[96:111]
    v_cvt_pk_bf16_f32 v57, v34, v35
    v_exp_f32 v37, v37
    v_exp_f32 v38, v38
    v_cvt_pk_bf16_f32 v58, v36, v37
    v_exp_f32 v39, v39
    v_mfma_f32_32x32x8_bf16 v[16:31], a[72:73], v[162:163], v[16:31]
    v_exp_f32 v40, v40
    v_cvt_pk_bf16_f32 v59, v38, v39
    v_exp_f32 v41, v41
    v_exp_f32 v42, v42
    v_cvt_pk_bf16_f32 v60, v40, v41
    v_exp_f32 v43, v43
    v_mfma_f32_32x32x16_bf16 v[96:111], a[116:119], v[52:55], v[96:111]
    v_exp_f32 v44, v44
    v_cvt_pk_bf16_f32 v61, v42, v43
    v_exp_f32 v45, v45
    v_exp_f32 v46, v46
    v_exp_f32 v47, v47
    v_cvt_pk_bf16_f32 v62, v44, v45
    v_cvt_pk_bf16_f32 v63, v46, v47
    v_exp_f32 v16, v16
    ds_write_b128 v242, v[84:87] offset:1024
    v_mfma_f32_32x32x16_bf16 v[32:47], a[20:23], v[158:161], 0
    v_exp_f32 v17, v17
    v_exp_f32 v18, v18
    v_cvt_pk_bf16_f32 v48, v16, v17
    v_exp_f32 v19, v19
    v_exp_f32 v20, v20
    v_mfma_f32_32x32x16_bf16 v[96:111], a[120:123], v[56:59], v[96:111]
    v_cvt_pk_bf16_f32 v49, v18, v19
    v_exp_f32 v21, v21
    v_exp_f32 v22, v22
    v_cvt_pk_bf16_f32 v50, v20, v21
    v_exp_f32 v23, v23
    v_mfma_f32_32x32x8_bf16 v[32:47], a[74:75], v[162:163], v[32:47]
    v_exp_f32 v24, v24
    v_cvt_pk_bf16_f32 v51, v22, v23
    v_exp_f32 v25, v25
    v_exp_f32 v26, v26
    v_cvt_pk_bf16_f32 v52, v24, v25
    v_exp_f32 v27, v27
    v_mfma_f32_32x32x16_bf16 v[96:111], a[124:127], v[60:63], v[96:111]
    v_exp_f32 v28, v28
    v_cvt_pk_bf16_f32 v53, v26, v27
    v_exp_f32 v29, v29
    v_exp_f32 v30, v30
    v_exp_f32 v31, v31
    v_cvt_pk_bf16_f32 v54, v28, v29
    v_cvt_pk_bf16_f32 v55, v30, v31
    v_exp_f32 v32, v32
    s_add_u32 m0, s32, 129024
    s_nop 0
    buffer_load_dwordx4 v203, s[40:43], s38 offen lds
    v_mfma_f32_32x32x16_bf16 v[16:31], a[24:27], v[158:161], 0
    v_exp_f32 v33, v33
    v_exp_f32 v34, v34
    v_cvt_pk_bf16_f32 v56, v32, v33
    v_exp_f32 v35, v35
    v_exp_f32 v36, v36
    v_mfma_f32_32x32x16_bf16 v[96:111], a[128:131], v[48:51], v[96:111]
    v_cvt_pk_bf16_f32 v57, v34, v35
    v_exp_f32 v37, v37
    v_exp_f32 v38, v38
    v_cvt_pk_bf16_f32 v58, v36, v37
    v_exp_f32 v39, v39
    v_mfma_f32_32x32x8_bf16 v[16:31], a[76:77], v[162:163], v[16:31]
    v_exp_f32 v40, v40
    v_cvt_pk_bf16_f32 v59, v38, v39
    v_exp_f32 v41, v41
    v_exp_f32 v42, v42
    v_cvt_pk_bf16_f32 v60, v40, v41
    v_exp_f32 v43, v43
    v_mfma_f32_32x32x16_bf16 v[96:111], a[132:135], v[52:55], v[96:111]
    v_exp_f32 v44, v44
    v_cvt_pk_bf16_f32 v61, v42, v43
    v_exp_f32 v45, v45
    v_exp_f32 v46, v46
    v_exp_f32 v47, v47
    v_cvt_pk_bf16_f32 v62, v44, v45
    v_cvt_pk_bf16_f32 v63, v46, v47
    v_exp_f32 v16, v16
    ds_write_b128 v242, v[88:91] offset:2048
    v_mfma_f32_32x32x16_bf16 v[32:47], a[28:31], v[158:161], 0
    v_exp_f32 v17, v17
    v_exp_f32 v18, v18
    v_cvt_pk_bf16_f32 v48, v16, v17
    v_exp_f32 v19, v19
    v_exp_f32 v20, v20
    v_mfma_f32_32x32x16_bf16 v[96:111], a[136:139], v[56:59], v[96:111]
    v_cvt_pk_bf16_f32 v49, v18, v19
    v_exp_f32 v21, v21
    v_exp_f32 v22, v22
    v_cvt_pk_bf16_f32 v50, v20, v21
    v_exp_f32 v23, v23
    v_mfma_f32_32x32x8_bf16 v[32:47], a[78:79], v[162:163], v[32:47]
    v_exp_f32 v24, v24
    v_cvt_pk_bf16_f32 v51, v22, v23
    v_exp_f32 v25, v25
    v_exp_f32 v26, v26
    v_cvt_pk_bf16_f32 v52, v24, v25
    v_exp_f32 v27, v27
    v_mfma_f32_32x32x16_bf16 v[96:111], a[140:143], v[60:63], v[96:111]
    v_exp_f32 v28, v28
    v_cvt_pk_bf16_f32 v53, v26, v27
    v_exp_f32 v29, v29
    v_exp_f32 v30, v30
    v_exp_f32 v31, v31
    v_cvt_pk_bf16_f32 v54, v28, v29
    v_cvt_pk_bf16_f32 v55, v30, v31
    v_exp_f32 v32, v32
    v_mfma_f32_32x32x16_bf16 v[16:31], a[32:35], v[158:161], 0
    v_exp_f32 v33, v33
    v_exp_f32 v34, v34
    v_cvt_pk_bf16_f32 v56, v32, v33
    v_exp_f32 v35, v35
    v_exp_f32 v36, v36
    v_mfma_f32_32x32x16_bf16 v[96:111], a[144:147], v[48:51], v[96:111]
    v_cvt_pk_bf16_f32 v57, v34, v35
    v_exp_f32 v37, v37
    v_exp_f32 v38, v38
    v_cvt_pk_bf16_f32 v58, v36, v37
    v_exp_f32 v39, v39
    v_mfma_f32_32x32x8_bf16 v[16:31], a[80:81], v[162:163], v[16:31]
    v_exp_f32 v40, v40
    v_cvt_pk_bf16_f32 v59, v38, v39
    v_exp_f32 v41, v41
    v_exp_f32 v42, v42
    v_cvt_pk_bf16_f32 v60, v40, v41
    v_exp_f32 v43, v43
    v_mfma_f32_32x32x16_bf16 v[96:111], a[148:151], v[52:55], v[96:111]
    v_exp_f32 v44, v44
    v_cvt_pk_bf16_f32 v61, v42, v43
    v_exp_f32 v45, v45
    v_exp_f32 v46, v46
    v_exp_f32 v47, v47
    v_cvt_pk_bf16_f32 v62, v44, v45
    v_cvt_pk_bf16_f32 v63, v46, v47
    v_exp_f32 v16, v16
    s_add_u32 s39, s32, 133120
    s_cmp_lt_u32 s20, 2
    s_cselect_b32 m0, s39, 160000
    s_nop 0
    buffer_load_dwordx4 v204, s[40:43], s38 offen lds
    v_mfma_f32_32x32x16_bf16 v[32:47], a[36:39], v[158:161], 0
    v_exp_f32 v17, v17
    v_exp_f32 v18, v18
    v_cvt_pk_bf16_f32 v48, v16, v17
    v_exp_f32 v19, v19
    v_exp_f32 v20, v20
    v_mfma_f32_32x32x16_bf16 v[96:111], a[152:155], v[56:59], v[96:111]
    v_cvt_pk_bf16_f32 v49, v18, v19
    v_exp_f32 v21, v21
    v_exp_f32 v22, v22
    v_cvt_pk_bf16_f32 v50, v20, v21
    v_exp_f32 v23, v23
    v_mfma_f32_32x32x8_bf16 v[32:47], a[82:83], v[162:163], v[32:47]
    v_exp_f32 v24, v24
    v_cvt_pk_bf16_f32 v51, v22, v23
    v_exp_f32 v25, v25
    v_exp_f32 v26, v26
    v_cvt_pk_bf16_f32 v52, v24, v25
    v_exp_f32 v27, v27
    v_mfma_f32_32x32x16_bf16 v[96:111], a[156:159], v[60:63], v[96:111]
    v_exp_f32 v28, v28
    v_cvt_pk_bf16_f32 v53, v26, v27
    v_exp_f32 v29, v29
    v_exp_f32 v30, v30
    v_exp_f32 v31, v31
    v_cvt_pk_bf16_f32 v54, v28, v29
    v_cvt_pk_bf16_f32 v55, v30, v31
    v_exp_f32 v32, v32
    v_mfma_f32_32x32x16_bf16 v[16:31], a[40:43], v[158:161], 0
    v_exp_f32 v33, v33
    v_exp_f32 v34, v34
    v_cvt_pk_bf16_f32 v56, v32, v33
    v_exp_f32 v35, v35
    v_exp_f32 v36, v36
    v_mfma_f32_32x32x16_bf16 v[96:111], a[160:163], v[48:51], v[96:111]
    v_cvt_pk_bf16_f32 v57, v34, v35
    v_exp_f32 v37, v37
    v_exp_f32 v38, v38
    v_cvt_pk_bf16_f32 v58, v36, v37
    v_exp_f32 v39, v39
    v_mfma_f32_32x32x8_bf16 v[16:31], a[84:85], v[162:163], v[16:31]
    v_exp_f32 v40, v40
    v_cvt_pk_bf16_f32 v59, v38, v39
    v_exp_f32 v41, v41
    v_exp_f32 v42, v42
    v_cvt_pk_bf16_f32 v60, v40, v41
    v_exp_f32 v43, v43
    v_mfma_f32_32x32x16_bf16 v[96:111], a[164:167], v[52:55], v[96:111]
    v_exp_f32 v44, v44
    v_cvt_pk_bf16_f32 v61, v42, v43
    v_exp_f32 v45, v45
    v_exp_f32 v46, v46
    v_exp_f32 v47, v47
    v_cvt_pk_bf16_f32 v62, v44, v45
    v_cvt_pk_bf16_f32 v63, v46, v47
    v_exp_f32 v16, v16
    v_mfma_f32_32x32x16_bf16 v[32:47], a[44:47], v[158:161], 0
    v_exp_f32 v17, v17
    v_exp_f32 v18, v18
    v_cvt_pk_bf16_f32 v48, v16, v17
    v_exp_f32 v19, v19
    v_exp_f32 v20, v20
    v_mfma_f32_32x32x16_bf16 v[96:111], a[168:171], v[56:59], v[96:111]
    v_cvt_pk_bf16_f32 v49, v18, v19
    v_exp_f32 v21, v21
    v_exp_f32 v22, v22
    v_cvt_pk_bf16_f32 v50, v20, v21
    v_exp_f32 v23, v23
    v_mfma_f32_32x32x8_bf16 v[32:47], a[86:87], v[162:163], v[32:47]
    v_exp_f32 v24, v24
    v_cvt_pk_bf16_f32 v51, v22, v23
    v_exp_f32 v25, v25
    v_exp_f32 v26, v26
    v_cvt_pk_bf16_f32 v52, v24, v25
    v_exp_f32 v27, v27
    v_mfma_f32_32x32x16_bf16 v[96:111], a[172:175], v[60:63], v[96:111]
    v_exp_f32 v28, v28
    v_cvt_pk_bf16_f32 v53, v26, v27
    v_exp_f32 v29, v29
    v_exp_f32 v30, v30
    v_exp_f32 v31, v31
    v_cvt_pk_bf16_f32 v54, v28, v29
    v_cvt_pk_bf16_f32 v55, v30, v31
    v_exp_f32 v32, v32
    s_add_u32 m0, s32, 135168
    s_mov_b32 s38, 491520
    buffer_load_dwordx4 v202, s[40:43], s38 offen lds
    v_mfma_f32_32x32x16_bf16 v[16:31], a[48:51], v[158:161], 0
    v_exp_f32 v33, v33
    v_exp_f32 v34, v34
    v_cvt_pk_bf16_f32 v56, v32, v33
    v_exp_f32 v35, v35
    v_exp_f32 v36, v36
    v_mfma_f32_32x32x16_bf16 v[96:111], a[176:179], v[48:51], v[96:111]
    v_cvt_pk_bf16_f32 v57, v34, v35
    v_exp_f32 v37, v37
    v_exp_f32 v38, v38
    v_cvt_pk_bf16_f32 v58, v36, v37
    v_exp_f32 v39, v39
    v_mfma_f32_32x32x8_bf16 v[16:31], a[88:89], v[162:163], v[16:31]
    v_exp_f32 v40, v40
    v_cvt_pk_bf16_f32 v59, v38, v39
    v_exp_f32 v41, v41
    v_exp_f32 v42, v42
    v_cvt_pk_bf16_f32 v60, v40, v41
    v_exp_f32 v43, v43
    v_mfma_f32_32x32x16_bf16 v[96:111], a[180:183], v[52:55], v[96:111]
    v_exp_f32 v44, v44
    v_cvt_pk_bf16_f32 v61, v42, v43
    v_exp_f32 v45, v45
    v_exp_f32 v46, v46
    v_exp_f32 v47, v47
    v_cvt_pk_bf16_f32 v62, v44, v45
    v_cvt_pk_bf16_f32 v63, v46, v47
    v_exp_f32 v16, v16
    v_mfma_f32_32x32x16_bf16 v[32:47], a[52:55], v[158:161], 0
    v_exp_f32 v17, v17
    v_exp_f32 v18, v18
    v_cvt_pk_bf16_f32 v48, v16, v17
    v_exp_f32 v19, v19
    v_exp_f32 v20, v20
    v_mfma_f32_32x32x16_bf16 v[96:111], a[184:187], v[56:59], v[96:111]
    v_cvt_pk_bf16_f32 v49, v18, v19
    v_exp_f32 v21, v21
    v_exp_f32 v22, v22
    v_cvt_pk_bf16_f32 v50, v20, v21
    v_exp_f32 v23, v23
    v_mfma_f32_32x32x8_bf16 v[32:47], a[90:91], v[162:163], v[32:47]
    v_exp_f32 v24, v24
    v_cvt_pk_bf16_f32 v51, v22, v23
    v_exp_f32 v25, v25
    v_exp_f32 v26, v26
    v_cvt_pk_bf16_f32 v52, v24, v25
    v_exp_f32 v27, v27
    v_mfma_f32_32x32x16_bf16 v[96:111], a[188:191], v[60:63], v[96:111]
    v_exp_f32 v28, v28
    v_cvt_pk_bf16_f32 v53, v26, v27
    v_exp_f32 v29, v29
    v_exp_f32 v30, v30
    v_exp_f32 v31, v31
    v_cvt_pk_bf16_f32 v54, v28, v29
    v_cvt_pk_bf16_f32 v55, v30, v31
    v_exp_f32 v32, v32
    v_mfma_f32_32x32x16_bf16 v[16:31], a[56:59], v[158:161], 0
    v_exp_f32 v33, v33
    v_exp_f32 v34, v34
    v_cvt_pk_bf16_f32 v56, v32, v33
    v_exp_f32 v35, v35
    v_exp_f32 v36, v36
    v_mfma_f32_32x32x16_bf16 v[96:111], a[192:195], v[48:51], v[96:111]
    v_cvt_pk_bf16_f32 v57, v34, v35
    v_exp_f32 v37, v37
    v_exp_f32 v38, v38
    v_cvt_pk_bf16_f32 v58, v36, v37
    v_exp_f32 v39, v39
    v_mfma_f32_32x32x8_bf16 v[16:31], a[92:93], v[162:163], v[16:31]
    v_exp_f32 v40, v40
    v_cvt_pk_bf16_f32 v59, v38, v39
    v_exp_f32 v41, v41
    v_exp_f32 v42, v42
    v_cvt_pk_bf16_f32 v60, v40, v41
    v_exp_f32 v43, v43
    v_mfma_f32_32x32x16_bf16 v[96:111], a[196:199], v[52:55], v[96:111]
    v_exp_f32 v44, v44
    v_cvt_pk_bf16_f32 v61, v42, v43
    v_exp_f32 v45, v45
    v_exp_f32 v46, v46
    v_exp_f32 v47, v47
    v_cvt_pk_bf16_f32 v62, v44, v45
    v_cvt_pk_bf16_f32 v63, v46, v47
    v_exp_f32 v16, v16
    s_add_u32 m0, s32, 139264
    s_nop 0
    buffer_load_dwordx4 v203, s[40:43], s38 offen lds
    v_mfma_f32_32x32x16_bf16 v[32:47], a[60:63], v[158:161], 0
    v_exp_f32 v17, v17
    v_exp_f32 v18, v18
    v_cvt_pk_bf16_f32 v48, v16, v17
    v_exp_f32 v19, v19
    v_exp_f32 v20, v20
    v_mfma_f32_32x32x16_bf16 v[96:111], a[200:203], v[56:59], v[96:111]
    v_cvt_pk_bf16_f32 v49, v18, v19
    v_exp_f32 v21, v21
    v_exp_f32 v22, v22
    v_cvt_pk_bf16_f32 v50, v20, v21
    v_exp_f32 v23, v23
    v_mfma_f32_32x32x8_bf16 v[32:47], a[94:95], v[162:163], v[32:47]
    v_exp_f32 v24, v24
    v_cvt_pk_bf16_f32 v51, v22, v23
    v_exp_f32 v25, v25
    v_exp_f32 v26, v26
    v_cvt_pk_bf16_f32 v52, v24, v25
    v_exp_f32 v27, v27
    v_mfma_f32_32x32x16_bf16 v[96:111], a[204:207], v[60:63], v[96:111]
    v_exp_f32 v28, v28
    v_cvt_pk_bf16_f32 v53, v26, v27
    v_exp_f32 v29, v29
    v_exp_f32 v30, v30
    v_exp_f32 v31, v31
    v_cvt_pk_bf16_f32 v54, v28, v29
    v_cvt_pk_bf16_f32 v55, v30, v31
    v_exp_f32 v32, v32
    v_mfma_f32_32x32x16_bf16 v[16:31], a[0:3], v[164:167], 0
    v_exp_f32 v33, v33
    v_exp_f32 v34, v34
    v_cvt_pk_bf16_f32 v56, v32, v33
    v_exp_f32 v35, v35
    v_exp_f32 v36, v36
    v_mfma_f32_32x32x16_bf16 v[96:111], a[208:211], v[48:51], v[96:111]
    v_cvt_pk_bf16_f32 v57, v34, v35
    v_exp_f32 v37, v37
    v_exp_f32 v38, v38
    v_cvt_pk_bf16_f32 v58, v36, v37
    v_exp_f32 v39, v39
    v_mfma_f32_32x32x8_bf16 v[16:31], a[64:65], v[168:169], v[16:31]
    v_exp_f32 v40, v40
    v_cvt_pk_bf16_f32 v59, v38, v39
    v_exp_f32 v41, v41
    v_exp_f32 v42, v42
    v_cvt_pk_bf16_f32 v60, v40, v41
    v_exp_f32 v43, v43
    v_mfma_f32_32x32x16_bf16 v[96:111], a[212:215], v[52:55], v[96:111]
    v_exp_f32 v44, v44
    v_cvt_pk_bf16_f32 v61, v42, v43
    v_exp_f32 v45, v45
    v_exp_f32 v46, v46
    v_exp_f32 v47, v47
    v_cvt_pk_bf16_f32 v62, v44, v45
    v_cvt_pk_bf16_f32 v63, v46, v47
    v_exp_f32 v16, v16
    v_mfma_f32_32x32x16_bf16 v[32:47], a[4:7], v[164:167], 0
    v_exp_f32 v17, v17
    v_exp_f32 v18, v18
    v_cvt_pk_bf16_f32 v48, v16, v17
    v_exp_f32 v19, v19
    v_exp_f32 v20, v20
    v_mfma_f32_32x32x16_bf16 v[96:111], a[216:219], v[56:59], v[96:111]
    v_cvt_pk_bf16_f32 v49, v18, v19
    v_exp_f32 v21, v21
    v_exp_f32 v22, v22
    v_cvt_pk_bf16_f32 v50, v20, v21
    v_exp_f32 v23, v23
    v_mfma_f32_32x32x8_bf16 v[32:47], a[66:67], v[168:169], v[32:47]
    v_exp_f32 v24, v24
    v_cvt_pk_bf16_f32 v51, v22, v23
    v_exp_f32 v25, v25
    v_exp_f32 v26, v26
    v_cvt_pk_bf16_f32 v52, v24, v25
    v_exp_f32 v27, v27
    v_mfma_f32_32x32x16_bf16 v[96:111], a[220:223], v[60:63], v[96:111]
    v_exp_f32 v28, v28
    v_cvt_pk_bf16_f32 v53, v26, v27
    v_exp_f32 v29, v29
    v_exp_f32 v30, v30
    v_exp_f32 v31, v31
    v_cvt_pk_bf16_f32 v54, v28, v29
    v_cvt_pk_bf16_f32 v55, v30, v31
    v_exp_f32 v32, v32
    v_mfma_f32_32x32x16_bf16 v[16:31], a[8:11], v[164:167], 0
    v_exp_f32 v33, v33
    v_exp_f32 v34, v34
    v_cvt_pk_bf16_f32 v56, v32, v33
    v_exp_f32 v35, v35
    v_exp_f32 v36, v36
    v_mfma_f32_32x32x16_bf16 v[80:95], a[96:99], v[48:51], 0
    v_cvt_pk_bf16_f32 v57, v34, v35
    v_exp_f32 v37, v37
    v_exp_f32 v38, v38
    v_cvt_pk_bf16_f32 v58, v36, v37
    v_exp_f32 v39, v39
    v_mfma_f32_32x32x8_bf16 v[16:31], a[68:69], v[168:169], v[16:31]
    v_exp_f32 v40, v40
    v_cvt_pk_bf16_f32 v59, v38, v39
    v_exp_f32 v41, v41
    v_exp_f32 v42, v42
    v_cvt_pk_bf16_f32 v60, v40, v41
    v_exp_f32 v43, v43
    v_mfma_f32_32x32x16_bf16 v[80:95], a[100:103], v[52:55], v[80:95]
    v_exp_f32 v44, v44
    v_cvt_pk_bf16_f32 v61, v42, v43
    v_exp_f32 v45, v45
    v_exp_f32 v46, v46
    v_exp_f32 v47, v47
    v_cvt_pk_bf16_f32 v62, v44, v45
    v_cvt_pk_bf16_f32 v63, v46, v47
    v_exp_f32 v16, v16
    v_mfma_f32_32x32x16_bf16 v[32:47], a[12:15], v[164:167], 0
    v_exp_f32 v17, v17
    v_exp_f32 v18, v18
    v_cvt_pk_bf16_f32 v48, v16, v17
    v_exp_f32 v19, v19
    v_exp_f32 v20, v20
    v_mfma_f32_32x32x16_bf16 v[80:95], a[104:107], v[56:59], v[80:95]
    v_cvt_pk_bf16_f32 v49, v18, v19
    v_exp_f32 v21, v21
    v_exp_f32 v22, v22
    v_cvt_pk_bf16_f32 v50, v20, v21
    v_exp_f32 v23, v23
    v_mfma_f32_32x32x8_bf16 v[32:47], a[70:71], v[168:169], v[32:47]
    v_exp_f32 v24, v24
    v_cvt_pk_bf16_f32 v51, v22, v23
    v_exp_f32 v25, v25
    v_exp_f32 v26, v26
    v_cvt_pk_bf16_f32 v52, v24, v25
    v_exp_f32 v27, v27
    v_mfma_f32_32x32x16_bf16 v[80:95], a[108:111], v[60:63], v[80:95]
    v_exp_f32 v28, v28
    v_cvt_pk_bf16_f32 v53, v26, v27
    v_exp_f32 v29, v29
    v_exp_f32 v30, v30
    v_exp_f32 v31, v31
    v_cvt_pk_bf16_f32 v54, v28, v29
    v_cvt_pk_bf16_f32 v55, v30, v31
    v_exp_f32 v32, v32
    ds_write_b128 v243, v[96:99] offset:0
    v_mfma_f32_32x32x16_bf16 v[16:31], a[16:19], v[164:167], 0
    v_exp_f32 v33, v33
    v_exp_f32 v34, v34
    v_cvt_pk_bf16_f32 v56, v32, v33
    v_exp_f32 v35, v35
    v_exp_f32 v36, v36
    v_mfma_f32_32x32x16_bf16 v[80:95], a[112:115], v[48:51], v[80:95]
    v_cvt_pk_bf16_f32 v57, v34, v35
    v_exp_f32 v37, v37
    v_exp_f32 v38, v38
    v_cvt_pk_bf16_f32 v58, v36, v37
    v_exp_f32 v39, v39
    v_mfma_f32_32x32x8_bf16 v[16:31], a[72:73], v[168:169], v[16:31]
    v_exp_f32 v40, v40
    v_cvt_pk_bf16_f32 v59, v38, v39
    v_exp_f32 v41, v41
    v_exp_f32 v42, v42
    v_cvt_pk_bf16_f32 v60, v40, v41
    v_exp_f32 v43, v43
    v_mfma_f32_32x32x16_bf16 v[80:95], a[116:119], v[52:55], v[80:95]
    v_exp_f32 v44, v44
    v_cvt_pk_bf16_f32 v61, v42, v43
    v_exp_f32 v45, v45
    v_exp_f32 v46, v46
    v_exp_f32 v47, v47
    v_cvt_pk_bf16_f32 v62, v44, v45
    v_cvt_pk_bf16_f32 v63, v46, v47
    v_exp_f32 v16, v16
    ds_write_b128 v243, v[100:103] offset:1024
    v_mfma_f32_32x32x16_bf16 v[32:47], a[20:23], v[164:167], 0
    v_exp_f32 v17, v17
    v_exp_f32 v18, v18
    v_cvt_pk_bf16_f32 v48, v16, v17
    v_exp_f32 v19, v19
    v_exp_f32 v20, v20
    v_mfma_f32_32x32x16_bf16 v[80:95], a[120:123], v[56:59], v[80:95]
    v_cvt_pk_bf16_f32 v49, v18, v19
    v_exp_f32 v21, v21
    v_exp_f32 v22, v22
    v_cvt_pk_bf16_f32 v50, v20, v21
    v_exp_f32 v23, v23
    v_mfma_f32_32x32x8_bf16 v[32:47], a[74:75], v[168:169], v[32:47]
    v_exp_f32 v24, v24
    v_cvt_pk_bf16_f32 v51, v22, v23
    v_exp_f32 v25, v25
    v_exp_f32 v26, v26
    v_cvt_pk_bf16_f32 v52, v24, v25
    v_exp_f32 v27, v27
    v_mfma_f32_32x32x16_bf16 v[80:95], a[124:127], v[60:63], v[80:95]
    v_exp_f32 v28, v28
    v_cvt_pk_bf16_f32 v53, v26, v27
    v_exp_f32 v29, v29
    v_exp_f32 v30, v30
    v_exp_f32 v31, v31
    v_cvt_pk_bf16_f32 v54, v28, v29
    v_cvt_pk_bf16_f32 v55, v30, v31
    v_exp_f32 v32, v32
    s_add_u32 s39, s32, 143360
    s_cmp_lt_u32 s20, 2
    s_cselect_b32 m0, s39, 160000
    s_nop 0
    buffer_load_dwordx4 v204, s[40:43], s38 offen lds
    v_mfma_f32_32x32x16_bf16 v[16:31], a[24:27], v[164:167], 0
    v_exp_f32 v33, v33
    v_exp_f32 v34, v34
    v_cvt_pk_bf16_f32 v56, v32, v33
    v_exp_f32 v35, v35
    v_exp_f32 v36, v36
    v_mfma_f32_32x32x16_bf16 v[80:95], a[128:131], v[48:51], v[80:95]
    v_cvt_pk_bf16_f32 v57, v34, v35
    v_exp_f32 v37, v37
    v_exp_f32 v38, v38
    v_cvt_pk_bf16_f32 v58, v36, v37
    v_exp_f32 v39, v39
    v_mfma_f32_32x32x8_bf16 v[16:31], a[76:77], v[168:169], v[16:31]
    v_exp_f32 v40, v40
    v_cvt_pk_bf16_f32 v59, v38, v39
    v_exp_f32 v41, v41
    v_exp_f32 v42, v42
    v_cvt_pk_bf16_f32 v60, v40, v41
    v_exp_f32 v43, v43
    v_mfma_f32_32x32x16_bf16 v[80:95], a[132:135], v[52:55], v[80:95]
    v_exp_f32 v44, v44
    v_cvt_pk_bf16_f32 v61, v42, v43
    v_exp_f32 v45, v45
    v_exp_f32 v46, v46
    v_exp_f32 v47, v47
    v_cvt_pk_bf16_f32 v62, v44, v45
    v_cvt_pk_bf16_f32 v63, v46, v47
    v_exp_f32 v16, v16
    ds_write_b128 v243, v[104:107] offset:2048
    v_mfma_f32_32x32x16_bf16 v[32:47], a[28:31], v[164:167], 0
    v_exp_f32 v17, v17
    v_exp_f32 v18, v18
    v_cvt_pk_bf16_f32 v48, v16, v17
    v_exp_f32 v19, v19
    v_exp_f32 v20, v20
    v_mfma_f32_32x32x16_bf16 v[80:95], a[136:139], v[56:59], v[80:95]
    v_cvt_pk_bf16_f32 v49, v18, v19
    v_exp_f32 v21, v21
    v_exp_f32 v22, v22
    v_cvt_pk_bf16_f32 v50, v20, v21
    v_exp_f32 v23, v23
    v_mfma_f32_32x32x8_bf16 v[32:47], a[78:79], v[168:169], v[32:47]
    v_exp_f32 v24, v24
    v_cvt_pk_bf16_f32 v51, v22, v23
    v_exp_f32 v25, v25
    v_exp_f32 v26, v26
    v_cvt_pk_bf16_f32 v52, v24, v25
    v_exp_f32 v27, v27
    v_mfma_f32_32x32x16_bf16 v[80:95], a[140:143], v[60:63], v[80:95]
    v_exp_f32 v28, v28
    v_cvt_pk_bf16_f32 v53, v26, v27
    v_exp_f32 v29, v29
    v_exp_f32 v30, v30
    v_exp_f32 v31, v31
    v_cvt_pk_bf16_f32 v54, v28, v29
    v_cvt_pk_bf16_f32 v55, v30, v31
    v_exp_f32 v32, v32
    v_mfma_f32_32x32x16_bf16 v[16:31], a[32:35], v[164:167], 0
    v_exp_f32 v33, v33
    v_exp_f32 v34, v34
    v_cvt_pk_bf16_f32 v56, v32, v33
    v_exp_f32 v35, v35
    v_exp_f32 v36, v36
    v_mfma_f32_32x32x16_bf16 v[80:95], a[144:147], v[48:51], v[80:95]
    v_cvt_pk_bf16_f32 v57, v34, v35
    v_exp_f32 v37, v37
    v_exp_f32 v38, v38
    v_cvt_pk_bf16_f32 v58, v36, v37
    v_exp_f32 v39, v39
    v_mfma_f32_32x32x8_bf16 v[16:31], a[80:81], v[168:169], v[16:31]
    v_exp_f32 v40, v40
    v_cvt_pk_bf16_f32 v59, v38, v39
    v_exp_f32 v41, v41
    v_exp_f32 v42, v42
    v_cvt_pk_bf16_f32 v60, v40, v41
    v_exp_f32 v43, v43
    v_mfma_f32_32x32x16_bf16 v[80:95], a[148:151], v[52:55], v[80:95]
    v_exp_f32 v44, v44
    v_cvt_pk_bf16_f32 v61, v42, v43
    v_exp_f32 v45, v45
    v_exp_f32 v46, v46
    v_exp_f32 v47, v47
    v_cvt_pk_bf16_f32 v62, v44, v45
    v_cvt_pk_bf16_f32 v63, v46, v47
    v_exp_f32 v16, v16
    s_add_u32 m0, s32, 145408
    s_mov_b32 s38, 573440
    buffer_load_dwordx4 v202, s[40:43], s38 offen lds
    v_mfma_f32_32x32x16_bf16 v[32:47], a[36:39], v[164:167], 0
    v_exp_f32 v17, v17
    v_exp_f32 v18, v18
    v_cvt_pk_bf16_f32 v48, v16, v17
    v_exp_f32 v19, v19
    v_exp_f32 v20, v20
    v_mfma_f32_32x32x16_bf16 v[80:95], a[152:155], v[56:59], v[80:95]
    v_cvt_pk_bf16_f32 v49, v18, v19
    v_exp_f32 v21, v21
    v_exp_f32 v22, v22
    v_cvt_pk_bf16_f32 v50, v20, v21
    v_exp_f32 v23, v23
    v_mfma_f32_32x32x8_bf16 v[32:47], a[82:83], v[168:169], v[32:47]
    v_exp_f32 v24, v24
    v_cvt_pk_bf16_f32 v51, v22, v23
    v_exp_f32 v25, v25
    v_exp_f32 v26, v26
    v_cvt_pk_bf16_f32 v52, v24, v25
    v_exp_f32 v27, v27
    v_mfma_f32_32x32x16_bf16 v[80:95], a[156:159], v[60:63], v[80:95]
    v_exp_f32 v28, v28
    v_cvt_pk_bf16_f32 v53, v26, v27
    v_exp_f32 v29, v29
    v_exp_f32 v30, v30
    v_exp_f32 v31, v31
    v_cvt_pk_bf16_f32 v54, v28, v29
    v_cvt_pk_bf16_f32 v55, v30, v31
    v_exp_f32 v32, v32
    v_mfma_f32_32x32x16_bf16 v[16:31], a[40:43], v[164:167], 0
    v_exp_f32 v33, v33
    v_exp_f32 v34, v34
    v_cvt_pk_bf16_f32 v56, v32, v33
    v_exp_f32 v35, v35
    v_exp_f32 v36, v36
    v_mfma_f32_32x32x16_bf16 v[80:95], a[160:163], v[48:51], v[80:95]
    v_cvt_pk_bf16_f32 v57, v34, v35
    v_exp_f32 v37, v37
    v_exp_f32 v38, v38
    v_cvt_pk_bf16_f32 v58, v36, v37
    v_exp_f32 v39, v39
    v_mfma_f32_32x32x8_bf16 v[16:31], a[84:85], v[168:169], v[16:31]
    v_exp_f32 v40, v40
    v_cvt_pk_bf16_f32 v59, v38, v39
    v_exp_f32 v41, v41
    v_exp_f32 v42, v42
    v_cvt_pk_bf16_f32 v60, v40, v41
    v_exp_f32 v43, v43
    v_mfma_f32_32x32x16_bf16 v[80:95], a[164:167], v[52:55], v[80:95]
    v_exp_f32 v44, v44
    v_cvt_pk_bf16_f32 v61, v42, v43
    v_exp_f32 v45, v45
    v_exp_f32 v46, v46
    v_exp_f32 v47, v47
    v_cvt_pk_bf16_f32 v62, v44, v45
    v_cvt_pk_bf16_f32 v63, v46, v47
    v_exp_f32 v16, v16
    v_mfma_f32_32x32x16_bf16 v[32:47], a[44:47], v[164:167], 0
    v_exp_f32 v17, v17
    v_exp_f32 v18, v18
    v_cvt_pk_bf16_f32 v48, v16, v17
    v_exp_f32 v19, v19
    v_exp_f32 v20, v20
    v_mfma_f32_32x32x16_bf16 v[80:95], a[168:171], v[56:59], v[80:95]
    v_cvt_pk_bf16_f32 v49, v18, v19
    v_exp_f32 v21, v21
    v_exp_f32 v22, v22
    v_cvt_pk_bf16_f32 v50, v20, v21
    v_exp_f32 v23, v23
    v_mfma_f32_32x32x8_bf16 v[32:47], a[86:87], v[168:169], v[32:47]
    v_exp_f32 v24, v24
    v_cvt_pk_bf16_f32 v51, v22, v23
    v_exp_f32 v25, v25
    v_exp_f32 v26, v26
    v_cvt_pk_bf16_f32 v52, v24, v25
    v_exp_f32 v27, v27
    v_mfma_f32_32x32x16_bf16 v[80:95], a[172:175], v[60:63], v[80:95]
    v_exp_f32 v28, v28
    v_cvt_pk_bf16_f32 v53, v26, v27
    v_exp_f32 v29, v29
    v_exp_f32 v30, v30
    v_exp_f32 v31, v31
    v_cvt_pk_bf16_f32 v54, v28, v29
    v_cvt_pk_bf16_f32 v55, v30, v31
    v_exp_f32 v32, v32
    s_add_u32 m0, s32, 149504
    s_nop 0
    buffer_load_dwordx4 v203, s[40:43], s38 offen lds
    v_mfma_f32_32x32x16_bf16 v[16:31], a[48:51], v[164:167], 0
    v_exp_f32 v33, v33
    v_exp_f32 v34, v34
    v_cvt_pk_bf16_f32 v56, v32, v33
    v_exp_f32 v35, v35
    v_exp_f32 v36, v36
    v_mfma_f32_32x32x16_bf16 v[80:95], a[176:179], v[48:51], v[80:95]
    v_cvt_pk_bf16_f32 v57, v34, v35
    v_exp_f32 v37, v37
    v_exp_f32 v38, v38
    v_cvt_pk_bf16_f32 v58, v36, v37
    v_exp_f32 v39, v39
    v_mfma_f32_32x32x8_bf16 v[16:31], a[88:89], v[168:169], v[16:31]
    v_exp_f32 v40, v40
    v_cvt_pk_bf16_f32 v59, v38, v39
    v_exp_f32 v41, v41
    v_exp_f32 v42, v42
    v_cvt_pk_bf16_f32 v60, v40, v41
    v_exp_f32 v43, v43
    v_mfma_f32_32x32x16_bf16 v[80:95], a[180:183], v[52:55], v[80:95]
    v_exp_f32 v44, v44
    v_cvt_pk_bf16_f32 v61, v42, v43
    v_exp_f32 v45, v45
    v_exp_f32 v46, v46
    v_exp_f32 v47, v47
    v_cvt_pk_bf16_f32 v62, v44, v45
    v_cvt_pk_bf16_f32 v63, v46, v47
    v_exp_f32 v16, v16
    v_mfma_f32_32x32x16_bf16 v[32:47], a[52:55], v[164:167], 0
    v_exp_f32 v17, v17
    v_exp_f32 v18, v18
    v_cvt_pk_bf16_f32 v48, v16, v17
    v_exp_f32 v19, v19
    v_exp_f32 v20, v20
    v_mfma_f32_32x32x16_bf16 v[80:95], a[184:187], v[56:59], v[80:95]
    v_cvt_pk_bf16_f32 v49, v18, v19
    v_exp_f32 v21, v21
    v_exp_f32 v22, v22
    v_cvt_pk_bf16_f32 v50, v20, v21
    v_exp_f32 v23, v23
    v_mfma_f32_32x32x8_bf16 v[32:47], a[90:91], v[168:169], v[32:47]
    v_exp_f32 v24, v24
    v_cvt_pk_bf16_f32 v51, v22, v23
    v_exp_f32 v25, v25
    v_exp_f32 v26, v26
    v_cvt_pk_bf16_f32 v52, v24, v25
    v_exp_f32 v27, v27
    v_mfma_f32_32x32x16_bf16 v[80:95], a[188:191], v[60:63], v[80:95]
    v_exp_f32 v28, v28
    v_cvt_pk_bf16_f32 v53, v26, v27
    v_exp_f32 v29, v29
    v_exp_f32 v30, v30
    v_exp_f32 v31, v31
    v_cvt_pk_bf16_f32 v54, v28, v29
    v_cvt_pk_bf16_f32 v55, v30, v31
    v_exp_f32 v32, v32
    v_mfma_f32_32x32x16_bf16 v[16:31], a[56:59], v[164:167], 0
    v_exp_f32 v33, v33
    v_exp_f32 v34, v34
    v_cvt_pk_bf16_f32 v56, v32, v33
    v_exp_f32 v35, v35
    v_exp_f32 v36, v36
    v_mfma_f32_32x32x16_bf16 v[80:95], a[192:195], v[48:51], v[80:95]
    v_cvt_pk_bf16_f32 v57, v34, v35
    v_exp_f32 v37, v37
    v_exp_f32 v38, v38
    v_cvt_pk_bf16_f32 v58, v36, v37
    v_exp_f32 v39, v39
    v_mfma_f32_32x32x8_bf16 v[16:31], a[92:93], v[168:169], v[16:31]
    v_exp_f32 v40, v40
    v_cvt_pk_bf16_f32 v59, v38, v39
    v_exp_f32 v41, v41
    v_exp_f32 v42, v42
    v_cvt_pk_bf16_f32 v60, v40, v41
    v_exp_f32 v43, v43
    v_mfma_f32_32x32x16_bf16 v[80:95], a[196:199], v[52:55], v[80:95]
    v_exp_f32 v44, v44
    v_cvt_pk_bf16_f32 v61, v42, v43
    v_exp_f32 v45, v45
    v_exp_f32 v46, v46
    v_exp_f32 v47, v47
    v_cvt_pk_bf16_f32 v62, v44, v45
    v_cvt_pk_bf16_f32 v63, v46, v47
    v_exp_f32 v16, v16
    s_add_u32 s39, s32, 153600
    s_cmp_lt_u32 s20, 2
    s_cselect_b32 m0, s39, 160000
    s_nop 0
    buffer_load_dwordx4 v204, s[40:43], s38 offen lds
    v_mfma_f32_32x32x16_bf16 v[32:47], a[60:63], v[164:167], 0
    v_exp_f32 v17, v17
    v_exp_f32 v18, v18
    v_cvt_pk_bf16_f32 v48, v16, v17
    v_exp_f32 v19, v19
    v_exp_f32 v20, v20
    v_mfma_f32_32x32x16_bf16 v[80:95], a[200:203], v[56:59], v[80:95]
    v_cvt_pk_bf16_f32 v49, v18, v19
    v_exp_f32 v21, v21
    v_exp_f32 v22, v22
    v_cvt_pk_bf16_f32 v50, v20, v21
    v_exp_f32 v23, v23
    v_mfma_f32_32x32x8_bf16 v[32:47], a[94:95], v[168:169], v[32:47]
    v_exp_f32 v24, v24
    v_cvt_pk_bf16_f32 v51, v22, v23
    v_exp_f32 v25, v25
    v_exp_f32 v26, v26
    v_cvt_pk_bf16_f32 v52, v24, v25
    v_exp_f32 v27, v27
    v_mfma_f32_32x32x16_bf16 v[80:95], a[204:207], v[60:63], v[80:95]
    v_exp_f32 v28, v28
    v_cvt_pk_bf16_f32 v53, v26, v27
    v_exp_f32 v29, v29
    v_exp_f32 v30, v30
    v_exp_f32 v31, v31
    v_cvt_pk_bf16_f32 v54, v28, v29
    v_cvt_pk_bf16_f32 v55, v30, v31
    v_exp_f32 v32, v32
    v_mfma_f32_32x32x16_bf16 v[16:31], a[0:3], v[170:173], 0
    v_exp_f32 v33, v33
    v_exp_f32 v34, v34
    v_cvt_pk_bf16_f32 v56, v32, v33
    v_exp_f32 v35, v35
    v_exp_f32 v36, v36
    v_mfma_f32_32x32x16_bf16 v[80:95], a[208:211], v[48:51], v[80:95]
    v_cvt_pk_bf16_f32 v57, v34, v35
    v_exp_f32 v37, v37
    v_exp_f32 v38, v38
    v_cvt_pk_bf16_f32 v58, v36, v37
    v_exp_f32 v39, v39
    v_mfma_f32_32x32x8_bf16 v[16:31], a[64:65], v[174:175], v[16:31]
    v_exp_f32 v40, v40
    v_cvt_pk_bf16_f32 v59, v38, v39
    v_exp_f32 v41, v41
    v_exp_f32 v42, v42
    v_cvt_pk_bf16_f32 v60, v40, v41
    v_exp_f32 v43, v43
    v_mfma_f32_32x32x16_bf16 v[80:95], a[212:215], v[52:55], v[80:95]
    v_exp_f32 v44, v44
    v_cvt_pk_bf16_f32 v61, v42, v43
    v_exp_f32 v45, v45
    v_exp_f32 v46, v46
    v_exp_f32 v47, v47
    v_cvt_pk_bf16_f32 v62, v44, v45
    v_cvt_pk_bf16_f32 v63, v46, v47
mg_tau7:
    v_exp_f32 v16, v16
    v_mfma_f32_32x32x16_bf16 v[32:47], a[4:7], v[170:173], 0
    v_exp_f32 v17, v17
    v_exp_f32 v18, v18
    v_cvt_pk_bf16_f32 v48, v16, v17
    v_exp_f32 v19, v19
    v_exp_f32 v20, v20
    v_mfma_f32_32x32x16_bf16 v[80:95], a[216:219], v[56:59], v[80:95]
    v_cvt_pk_bf16_f32 v49, v18, v19
    v_exp_f32 v21, v21
    v_exp_f32 v22, v22
    v_cvt_pk_bf16_f32 v50, v20, v21
    v_exp_f32 v23, v23
    v_mfma_f32_32x32x8_bf16 v[32:47], a[66:67], v[174:175], v[32:47]
    v_exp_f32 v24, v24
    v_cvt_pk_bf16_f32 v51, v22, v23
    v_exp_f32 v25, v25
    v_exp_f32 v26, v26
    v_cvt_pk_bf16_f32 v52, v24, v25
    v_exp_f32 v27, v27
    v_mfma_f32_32x32x16_bf16 v[80:95], a[220:223], v[60:63], v[80:95]
    v_exp_f32 v28, v28
    v_cvt_pk_bf16_f32 v53, v26, v27
    v_exp_f32 v29, v29
    v_exp_f32 v30, v30
    v_exp_f32 v31, v31
    v_cvt_pk_bf16_f32 v54, v28, v29
    v_cvt_pk_bf16_f32 v55, v30, v31
    v_exp_f32 v32, v32
    v_mfma_f32_32x32x16_bf16 v[16:31], a[8:11], v[170:173], 0
    v_exp_f32 v33, v33
    v_exp_f32 v34, v34
    v_cvt_pk_bf16_f32 v56, v32, v33
    v_exp_f32 v35, v35
    v_exp_f32 v36, v36
    v_mfma_f32_32x32x16_bf16 v[96:111], a[96:99], v[48:51], 0
    v_cvt_pk_bf16_f32 v57, v34, v35
    v_exp_f32 v37, v37
    v_exp_f32 v38, v38
    v_cvt_pk_bf16_f32 v58, v36, v37
    v_exp_f32 v39, v39
    v_mfma_f32_32x32x8_bf16 v[16:31], a[68:69], v[174:175], v[16:31]
    v_exp_f32 v40, v40
    v_cvt_pk_bf16_f32 v59, v38, v39
    v_exp_f32 v41, v41
    v_exp_f32 v42, v42
    v_cvt_pk_bf16_f32 v60, v40, v41
    v_exp_f32 v43, v43
    v_mfma_f32_32x32x16_bf16 v[96:111], a[100:103], v[52:55], v[96:111]
    v_exp_f32 v44, v44
    v_cvt_pk_bf16_f32 v61, v42, v43
    v_exp_f32 v45, v45
    v_exp_f32 v46, v46
    v_exp_f32 v47, v47
    v_cvt_pk_bf16_f32 v62, v44, v45
    v_cvt_pk_bf16_f32 v63, v46, v47
    v_exp_f32 v16, v16
    v_mfma_f32_32x32x16_bf16 v[32:47], a[12:15], v[170:173], 0
    v_exp_f32 v17, v17
    v_exp_f32 v18, v18
    v_cvt_pk_bf16_f32 v48, v16, v17
    v_exp_f32 v19, v19
    v_exp_f32 v20, v20
    v_mfma_f32_32x32x16_bf16 v[96:111], a[104:107], v[56:59], v[96:111]
    v_cvt_pk_bf16_f32 v49, v18, v19
    v_exp_f32 v21, v21
    v_exp_f32 v22, v22
    v_cvt_pk_bf16_f32 v50, v20, v21
    v_exp_f32 v23, v23
    v_mfma_f32_32x32x8_bf16 v[32:47], a[70:71], v[174:175], v[32:47]
    v_exp_f32 v24, v24
    v_cvt_pk_bf16_f32 v51, v22, v23
    v_exp_f32 v25, v25
    v_exp_f32 v26, v26
    v_cvt_pk_bf16_f32 v52, v24, v25
    v_exp_f32 v27, v27
    v_mfma_f32_32x32x16_bf16 v[96:111], a[108:111], v[60:63], v[96:111]
    v_exp_f32 v28, v28
    v_cvt_pk_bf16_f32 v53, v26, v27
    v_exp_f32 v29, v29
    v_exp_f32 v30, v30
    v_exp_f32 v31, v31
    v_cvt_pk_bf16_f32 v54, v28, v29
    v_cvt_pk_bf16_f32 v55, v30, v31
    v_exp_f32 v32, v32
    v_mfma_f32_32x32x16_bf16 v[16:31], a[16:19], v[170:173], 0
    v_exp_f32 v33, v33
    v_exp_f32 v34, v34
    v_cvt_pk_bf16_f32 v56, v32, v33
    v_exp_f32 v35, v35
    v_exp_f32 v36, v36
    v_mfma_f32_32x32x16_bf16 v[96:111], a[112:115], v[48:51], v[96:111]
    v_cvt_pk_bf16_f32 v57, v34, v35
    v_exp_f32 v37, v37
    v_exp_f32 v38, v38
    v_cvt_pk_bf16_f32 v58, v36, v37
    v_exp_f32 v39, v39
    v_mfma_f32_32x32x8_bf16 v[16:31], a[72:73], v[174:175], v[16:31]
    v_exp_f32 v40, v40
    v_cvt_pk_bf16_f32 v59, v38, v39
    v_exp_f32 v41, v41
    v_exp_f32 v42, v42
    v_cvt_pk_bf16_f32 v60, v40, v41
    v_exp_f32 v43, v43
    v_mfma_f32_32x32x16_bf16 v[96:111], a[116:119], v[52:55], v[96:111]
    v_exp_f32 v44, v44
    v_cvt_pk_bf16_f32 v61, v42, v43
    v_exp_f32 v45, v45
    v_exp_f32 v46, v46
    v_exp_f32 v47, v47
    v_cvt_pk_bf16_f32 v62, v44, v45
    v_cvt_pk_bf16_f32 v63, v46, v47
    v_exp_f32 v16, v16
    v_mfma_f32_32x32x16_bf16 v[32:47], a[20:23], v[170:173], 0
    v_exp_f32 v17, v17
    v_exp_f32 v18, v18
    v_cvt_pk_bf16_f32 v48, v16, v17
    v_exp_f32 v19, v19
    v_exp_f32 v20, v20
    v_mfma_f32_32x32x16_bf16 v[96:111], a[120:123], v[56:59], v[96:111]
    v_cvt_pk_bf16_f32 v49, v18, v19
    v_exp_f32 v21, v21
    v_exp_f32 v22, v22
    v_cvt_pk_bf16_f32 v50, v20, v21
    v_exp_f32 v23, v23
    v_mfma_f32_32x32x8_bf16 v[32:47], a[74:75], v[174:175], v[32:47]
    v_exp_f32 v24, v24
    v_cvt_pk_bf16_f32 v51, v22, v23
    v_exp_f32 v25, v25
    v_exp_f32 v26, v26
    v_cvt_pk_bf16_f32 v52, v24, v25
    v_exp_f32 v27, v27
    v_mfma_f32_32x32x16_bf16 v[96:111], a[124:127], v[60:63], v[96:111]
    v_exp_f32 v28, v28
    v_cvt_pk_bf16_f32 v53, v26, v27
    v_exp_f32 v29, v29
    v_exp_f32 v30, v30
    v_exp_f32 v31, v31
    v_cvt_pk_bf16_f32 v54, v28, v29
    v_cvt_pk_bf16_f32 v55, v30, v31
    v_exp_f32 v32, v32
    v_mfma_f32_32x32x16_bf16 v[16:31], a[24:27], v[170:173], 0
    v_exp_f32 v33, v33
    v_exp_f32 v34, v34
    v_cvt_pk_bf16_f32 v56, v32, v33
    v_exp_f32 v35, v35
    v_exp_f32 v36, v36
    v_mfma_f32_32x32x16_bf16 v[96:111], a[128:131], v[48:51], v[96:111]
    v_cvt_pk_bf16_f32 v57, v34, v35
    v_exp_f32 v37, v37
    v_exp_f32 v38, v38
    v_cvt_pk_bf16_f32 v58, v36, v37
    v_exp_f32 v39, v39
    v_mfma_f32_32x32x8_bf16 v[16:31], a[76:77], v[174:175], v[16:31]
    v_exp_f32 v40, v40
    v_cvt_pk_bf16_f32 v59, v38, v39
    v_exp_f32 v41, v41
    v_exp_f32 v42, v42
    v_cvt_pk_bf16_f32 v60, v40, v41
    v_exp_f32 v43, v43
    v_mfma_f32_32x32x16_bf16 v[96:111], a[132:135], v[52:55], v[96:111]
    v_exp_f32 v44, v44
    v_cvt_pk_bf16_f32 v61, v42, v43
    v_exp_f32 v45, v45
    v_exp_f32 v46, v46
    v_exp_f32 v47, v47
    v_cvt_pk_bf16_f32 v62, v44, v45
    v_cvt_pk_bf16_f32 v63, v46, v47
    v_exp_f32 v16, v16
    v_mfma_f32_32x32x16_bf16 v[32:47], a[28:31], v[170:173], 0
    v_exp_f32 v17, v17
    v_exp_f32 v18, v18
    v_cvt_pk_bf16_f32 v48, v16, v17
    v_exp_f32 v19, v19
    v_exp_f32 v20, v20
    v_mfma_f32_32x32x16_bf16 v[96:111], a[136:139], v[56:59], v[96:111]
    v_cvt_pk_bf16_f32 v49, v18, v19
    v_exp_f32 v21, v21
    v_exp_f32 v22, v22
    v_cvt_pk_bf16_f32 v50, v20, v21
    v_exp_f32 v23, v23
    v_mfma_f32_32x32x8_bf16 v[32:47], a[78:79], v[174:175], v[32:47]
    v_exp_f32 v24, v24
    v_cvt_pk_bf16_f32 v51, v22, v23
    v_exp_f32 v25, v25
    v_exp_f32 v26, v26
    v_cvt_pk_bf16_f32 v52, v24, v25
    v_exp_f32 v27, v27
    v_mfma_f32_32x32x16_bf16 v[96:111], a[140:143], v[60:63], v[96:111]
    v_exp_f32 v28, v28
    v_cvt_pk_bf16_f32 v53, v26, v27
    v_exp_f32 v29, v29
    v_exp_f32 v30, v30
    v_exp_f32 v31, v31
    v_cvt_pk_bf16_f32 v54, v28, v29
    v_cvt_pk_bf16_f32 v55, v30, v31
    v_exp_f32 v32, v32
    v_mfma_f32_32x32x16_bf16 v[16:31], a[32:35], v[170:173], 0
    v_exp_f32 v33, v33
    v_exp_f32 v34, v34
    v_cvt_pk_bf16_f32 v56, v32, v33
    v_exp_f32 v35, v35
    v_exp_f32 v36, v36
    v_mfma_f32_32x32x16_bf16 v[96:111], a[144:147], v[48:51], v[96:111]
    v_cvt_pk_bf16_f32 v57, v34, v35
    v_exp_f32 v37, v37
    v_exp_f32 v38, v38
    v_cvt_pk_bf16_f32 v58, v36, v37
    v_exp_f32 v39, v39
    v_mfma_f32_32x32x8_bf16 v[16:31], a[80:81], v[174:175], v[16:31]
    v_exp_f32 v40, v40
    v_cvt_pk_bf16_f32 v59, v38, v39
    v_exp_f32 v41, v41
    v_exp_f32 v42, v42
    v_cvt_pk_bf16_f32 v60, v40, v41
    v_exp_f32 v43, v43
    v_mfma_f32_32x32x16_bf16 v[96:111], a[148:151], v[52:55], v[96:111]
    v_exp_f32 v44, v44
    v_cvt_pk_bf16_f32 v61, v42, v43
    v_exp_f32 v45, v45
    v_exp_f32 v46, v46
    v_exp_f32 v47, v47
    v_cvt_pk_bf16_f32 v62, v44, v45
    v_cvt_pk_bf16_f32 v63, v46, v47
    v_exp_f32 v16, v16
    v_mfma_f32_32x32x16_bf16 v[32:47], a[36:39], v[170:173], 0
    v_exp_f32 v17, v17
    v_exp_f32 v18, v18
    v_cvt_pk_bf16_f32 v48, v16, v17
    v_exp_f32 v19, v19
    v_exp_f32 v20, v20
    v_mfma_f32_32x32x16_bf16 v[96:111], a[152:155], v[56:59], v[96:111]
    v_cvt_pk_bf16_f32 v49, v18, v19
    v_exp_f32 v21, v21
    v_exp_f32 v22, v22
    v_cvt_pk_bf16_f32 v50, v20, v21
    v_exp_f32 v23, v23
    v_mfma_f32_32x32x8_bf16 v[32:47], a[82:83], v[174:175], v[32:47]
    v_exp_f32 v24, v24
    v_cvt_pk_bf16_f32 v51, v22, v23
    v_exp_f32 v25, v25
    v_exp_f32 v26, v26
    v_cvt_pk_bf16_f32 v52, v24, v25
    v_exp_f32 v27, v27
    v_mfma_f32_32x32x16_bf16 v[96:111], a[156:159], v[60:63], v[96:111]
    v_exp_f32 v28, v28
    v_cvt_pk_bf16_f32 v53, v26, v27
    v_exp_f32 v29, v29
    v_exp_f32 v30, v30
    v_exp_f32 v31, v31
    v_cvt_pk_bf16_f32 v54, v28, v29
    v_cvt_pk_bf16_f32 v55, v30, v31
    v_exp_f32 v32, v32
    v_mfma_f32_32x32x16_bf16 v[16:31], a[40:43], v[170:173], 0
    v_exp_f32 v33, v33
    v_exp_f32 v34, v34
    v_cvt_pk_bf16_f32 v56, v32, v33
    v_exp_f32 v35, v35
    v_exp_f32 v36, v36
    v_mfma_f32_32x32x16_bf16 v[96:111], a[160:163], v[48:51], v[96:111]
    v_cvt_pk_bf16_f32 v57, v34, v35
    v_exp_f32 v37, v37
    v_exp_f32 v38, v38
    v_cvt_pk_bf16_f32 v58, v36, v37
    v_exp_f32 v39, v39
    v_mfma_f32_32x32x8_bf16 v[16:31], a[84:85], v[174:175], v[16:31]
    v_exp_f32 v40, v40
    v_cvt_pk_bf16_f32 v59, v38, v39
    v_exp_f32 v41, v41
    v_exp_f32 v42, v42
    v_cvt_pk_bf16_f32 v60, v40, v41
    v_exp_f32 v43, v43
    v_mfma_f32_32x32x16_bf16 v[96:111], a[164:167], v[52:55], v[96:111]
    v_exp_f32 v44, v44
    v_cvt_pk_bf16_f32 v61, v42, v43
    v_exp_f32 v45, v45
    v_exp_f32 v46, v46
    v_exp_f32 v47, v47
    v_cvt_pk_bf16_f32 v62, v44, v45
    v_cvt_pk_bf16_f32 v63, v46, v47
    v_exp_f32 v16, v16
    v_mfma_f32_32x32x16_bf16 v[32:47], a[44:47], v[170:173], 0
    v_exp_f32 v17, v17
    v_exp_f32 v18, v18
    v_cvt_pk_bf16_f32 v48, v16, v17
    v_exp_f32 v19, v19
    v_exp_f32 v20, v20
    v_mfma_f32_32x32x16_bf16 v[96:111], a[168:171], v[56:59], v[96:111]
    v_cvt_pk_bf16_f32 v49, v18, v19
    v_exp_f32 v21, v21
    v_exp_f32 v22, v22
    v_cvt_pk_bf16_f32 v50, v20, v21
    v_exp_f32 v23, v23
    v_mfma_f32_32x32x8_bf16 v[32:47], a[86:87], v[174:175], v[32:47]
    v_exp_f32 v24, v24
    v_cvt_pk_bf16_f32 v51, v22, v23
    v_exp_f32 v25, v25
    v_exp_f32 v26, v26
    v_cvt_pk_bf16_f32 v52, v24, v25
    v_exp_f32 v27, v27
    v_mfma_f32_32x32x16_bf16 v[96:111], a[172:175], v[60:63], v[96:111]
    v_exp_f32 v28, v28
    v_cvt_pk_bf16_f32 v53, v26, v27
    v_exp_f32 v29, v29
    v_exp_f32 v30, v30
    v_exp_f32 v31, v31
    v_cvt_pk_bf16_f32 v54, v28, v29
    v_cvt_pk_bf16_f32 v55, v30, v31
    v_exp_f32 v32, v32
    v_mfma_f32_32x32x16_bf16 v[16:31], a[48:51], v[170:173], 0
    v_exp_f32 v33, v33
    v_exp_f32 v34, v34
    v_cvt_pk_bf16_f32 v56, v32, v33
    v_exp_f32 v35, v35
    v_exp_f32 v36, v36
    v_mfma_f32_32x32x16_bf16 v[96:111], a[176:179], v[48:51], v[96:111]
    v_cvt_pk_bf16_f32 v57, v34, v35
    v_exp_f32 v37, v37
    v_exp_f32 v38, v38
    v_cvt_pk_bf16_f32 v58, v36, v37
    v_exp_f32 v39, v39
    v_mfma_f32_32x32x8_bf16 v[16:31], a[88:89], v[174:175], v[16:31]
    v_exp_f32 v40, v40
    v_cvt_pk_bf16_f32 v59, v38, v39
    v_exp_f32 v41, v41
    v_exp_f32 v42, v42
    v_cvt_pk_bf16_f32 v60, v40, v41
    v_exp_f32 v43, v43
    v_mfma_f32_32x32x16_bf16 v[96:111], a[180:183], v[52:55], v[96:111]
    v_exp_f32 v44, v44
    v_cvt_pk_bf16_f32 v61, v42, v43
    v_exp_f32 v45, v45
    v_exp_f32 v46, v46
    v_exp_f32 v47, v47
    v_cvt_pk_bf16_f32 v62, v44, v45
    v_cvt_pk_bf16_f32 v63, v46, v47
    v_exp_f32 v16, v16
    v_mfma_f32_32x32x16_bf16 v[32:47], a[52:55], v[170:173], 0
    v_exp_f32 v17, v17
    v_exp_f32 v18, v18
    v_cvt_pk_bf16_f32 v48, v16, v17
    v_exp_f32 v19, v19
    v_exp_f32 v20, v20
    v_mfma_f32_32x32x16_bf16 v[96:111], a[184:187], v[56:59], v[96:111]
    v_cvt_pk_bf16_f32 v49, v18, v19
    v_exp_f32 v21, v21
    v_exp_f32 v22, v22
    v_cvt_pk_bf16_f32 v50, v20, v21
    v_exp_f32 v23, v23
    v_mfma_f32_32x32x8_bf16 v[32:47], a[90:91], v[174:175], v[32:47]
    v_exp_f32 v24, v24
    v_cvt_pk_bf16_f32 v51, v22, v23
    v_exp_f32 v25, v25
    v_exp_f32 v26, v26
    v_cvt_pk_bf16_f32 v52, v24, v25
    v_exp_f32 v27, v27
    v_mfma_f32_32x32x16_bf16 v[96:111], a[188:191], v[60:63], v[96:111]
    v_exp_f32 v28, v28
    v_cvt_pk_bf16_f32 v53, v26, v27
    v_exp_f32 v29, v29
    v_exp_f32 v30, v30
    v_exp_f32 v31, v31
    v_cvt_pk_bf16_f32 v54, v28, v29
    v_cvt_pk_bf16_f32 v55, v30, v31
    v_exp_f32 v32, v32
    v_mfma_f32_32x32x16_bf16 v[16:31], a[56:59], v[170:173], 0
    v_exp_f32 v33, v33
    v_exp_f32 v34, v34
    v_cvt_pk_bf16_f32 v56, v32, v33
    v_exp_f32 v35, v35
    v_exp_f32 v36, v36
    v_mfma_f32_32x32x16_bf16 v[96:111], a[192:195], v[48:51], v[96:111]
    v_cvt_pk_bf16_f32 v57, v34, v35
    v_exp_f32 v37, v37
    v_exp_f32 v38, v38
    v_cvt_pk_bf16_f32 v58, v36, v37
    v_exp_f32 v39, v39
    v_mfma_f32_32x32x8_bf16 v[16:31], a[92:93], v[174:175], v[16:31]
    v_exp_f32 v40, v40
    v_cvt_pk_bf16_f32 v59, v38, v39
    v_exp_f32 v41, v41
    v_exp_f32 v42, v42
    v_cvt_pk_bf16_f32 v60, v40, v41
    v_exp_f32 v43, v43
    v_mfma_f32_32x32x16_bf16 v[96:111], a[196:199], v[52:55], v[96:111]
    v_exp_f32 v44, v44
    v_cvt_pk_bf16_f32 v61, v42, v43
    v_exp_f32 v45, v45
    v_exp_f32 v46, v46
    v_exp_f32 v47, v47
    v_cvt_pk_bf16_f32 v62, v44, v45
    v_cvt_pk_bf16_f32 v63, v46, v47
    v_exp_f32 v16, v16
    v_mfma_f32_32x32x16_bf16 v[32:47], a[60:63], v[170:173], 0
    v_exp_f32 v17, v17
    v_exp_f32 v18, v18
    v_cvt_pk_bf16_f32 v48, v16, v17
    v_exp_f32 v19, v19
    v_exp_f32 v20, v20
    v_mfma_f32_32x32x16_bf16 v[96:111], a[200:203], v[56:59], v[96:111]
    v_cvt_pk_bf16_f32 v49, v18, v19
    v_exp_f32 v21, v21
    v_exp_f32 v22, v22
    v_cvt_pk_bf16_f32 v50, v20, v21
    v_exp_f32 v23, v23
    v_mfma_f32_32x32x8_bf16 v[32:47], a[94:95], v[174:175], v[32:47]
    v_exp_f32 v24, v24
    v_cvt_pk_bf16_f32 v51, v22, v23
    v_exp_f32 v25, v25
    v_exp_f32 v26, v26
    v_cvt_pk_bf16_f32 v52, v24, v25
    v_exp_f32 v27, v27
    v_mfma_f32_32x32x16_bf16 v[96:111], a[204:207], v[60:63], v[96:111]
    v_exp_f32 v28, v28
    v_cvt_pk_bf16_f32 v53, v26, v27
    v_exp_f32 v29, v29
    v_exp_f32 v30, v30
    v_exp_f32 v31, v31
    v_cvt_pk_bf16_f32 v54, v28, v29
    v_cvt_pk_bf16_f32 v55, v30, v31
    v_exp_f32 v32, v32
    v_exp_f32 v33, v33
    v_exp_f32 v34, v34
    v_cvt_pk_bf16_f32 v56, v32, v33
    v_exp_f32 v35, v35
    v_exp_f32 v36, v36
    v_mfma_f32_32x32x16_bf16 v[96:111], a[208:211], v[48:51], v[96:111]
    v_cvt_pk_bf16_f32 v57, v34, v35
    v_exp_f32 v37, v37
    v_exp_f32 v38, v38
    v_cvt_pk_bf16_f32 v58, v36, v37
    v_exp_f32 v39, v39
    v_exp_f32 v40, v40
    v_cvt_pk_bf16_f32 v59, v38, v39
    v_exp_f32 v41, v41
    v_exp_f32 v42, v42
    v_cvt_pk_bf16_f32 v60, v40, v41
    v_exp_f32 v43, v43
    v_mfma_f32_32x32x16_bf16 v[96:111], a[212:215], v[52:55], v[96:111]
    v_exp_f32 v44, v44
    v_cvt_pk_bf16_f32 v61, v42, v43
    v_exp_f32 v45, v45
    v_exp_f32 v46, v46
    v_exp_f32 v47, v47
    v_cvt_pk_bf16_f32 v62, v44, v45
    v_cvt_pk_bf16_f32 v63, v46, v47
    s_nop 1
    v_mfma_f32_32x32x16_bf16 v[96:111], a[216:219], v[56:59], v[96:111]
    v_mfma_f32_32x32x16_bf16 v[96:111], a[220:223], v[60:63], v[96:111]
    s_waitcnt vmcnt(0) lgkmcnt(0)
    s_barrier
    ds_read_b128 v[64:67], v221 offset:0
    ds_read_b128 v[68:71], v221 offset:1024
    ds_read_b128 v[72:75], v221 offset:2048
    ds_read_b128 v[76:79], v221 offset:3072
    ds_read_b128 v[112:115], v221 offset:4096
    ds_read_b128 v[116:119], v221 offset:5120
    ds_read_b128 v[120:123], v221 offset:6144
    ds_read_b128 v[124:127], v221 offset:7168
    ds_read_b128 v[176:179], v221 offset:8192
    s_add_u32 s16, s4, 4194304
    s_addc_u32 s17, s5, 0
    s_mov_b32 s18, 2621440
    s_mov_b32 s19, 0x20000
    s_mov_b64 s[56:57], 0
    s_waitcnt lgkmcnt(0)
    ds_read_b128 v[180:183], v221 offset:9216
    ds_read_b128 v[184:187], v221 offset:10240
    ds_read_b128 v[188:191], v221 offset:11264
    ds_read_b128 v[192:195], v221 offset:12288
    ds_read_b128 v[196:199], v221 offset:13312
    ds_read_b128 v[44:47], v221 offset:14336
    ds_read_b128 v[48:51], v221 offset:15360
    ds_read_b128 v[52:55], v221 offset:16384
    ds_read_b128 v[56:59], v221 offset:17408
    v_add_f32 v80, v80, v64
    v_add_f32 v81, v81, v65
    v_add_f32 v82, v82, v66
    v_add_f32 v83, v83, v67
    v_add_f32 v84, v84, v68
    v_add_f32 v85, v85, v69
    v_add_f32 v86, v86, v70
    v_add_f32 v87, v87, v71
    v_add_f32 v88, v88, v72
    v_add_f32 v89, v89, v73
    v_add_f32 v90, v90, v74
    v_add_f32 v91, v91, v75
    v_add_f32 v80, v80, v76
    v_add_f32 v81, v81, v77
    v_add_f32 v82, v82, v78
    v_add_f32 v83, v83, v79
    v_add_f32 v84, v84, v112
    v_add_f32 v85, v85, v113
    v_add_f32 v86, v86, v114
    v_add_f32 v87, v87, v115
    v_add_f32 v88, v88, v116
    v_add_f32 v89, v89, v117
    v_add_f32 v90, v90, v118
    v_add_f32 v91, v91, v119
    v_add_f32 v80, v80, v120
    v_add_f32 v81, v81, v121
    v_add_f32 v82, v82, v122
    v_add_f32 v83, v83, v123
    v_add_f32 v84, v84, v124
    v_add_f32 v85, v85, v125
    v_add_f32 v86, v86, v126
    v_add_f32 v87, v87, v127
    v_add_f32 v88, v88, v176
    v_add_f32 v89, v89, v177
    v_add_f32 v90, v90, v178
    v_add_f32 v91, v91, v179
    v_mov_b32 v28, v88
    v_mov_b32 v29, v88
    v_max3_f32 v30, |v80|, |v81|, |v82|
    v_max3_f32 v30, v30, |v83|, |v84|
    v_permlane32_swap_b32 v28, v29
    v_max3_f32 v30, v30, |v85|, |v86|
    v_max3_f32 v30, v30, |v87|, |v88|
    v_max3_f32 v30, v30, |v89|, |v90|
    v_max_f32 v30, v30, |v91|
    v_cmp_nle_f32 vcc, 0x2b800000, v29
    v_mov_b32 v31, 0x7f800000
    v_rcp_f32 v28, v29
    s_or_b64 s[56:57], s[56:57], vcc
    v_cmp_nge_f32 vcc, 0x53800000, v29
    v_cmp_ngt_f32 s[58:59], v31, v30
    v_mov_b32 v29, v28
    s_or_b64 s[56:57], s[56:57], vcc
    s_or_b64 s[56:57], s[56:57], s[58:59]
    v_mul_f32 v16, v80, v29
    v_mul_f32 v17, v81, v29
    v_mul_f32 v18, v82, v29
    v_mul_f32 v19, v83, v29
    v_mul_f32 v20, v84, v29
    v_mul_f32 v21, v85, v29
    v_mul_f32 v22, v86, v29
    v_mul_f32 v23, v87, v29
    v_mul_f32 v24, v88, v29
    v_mul_f32 v25, v89, v29
    v_mul_f32 v26, v90, v29
    v_mul_f32 v27, v91, v29
    v_cvt_pk_bf16_f32 v32, v16, v17
    v_cvt_pk_bf16_f32 v33, v18, v19
    v_cvt_pk_bf16_f32 v34, v20, v21
    v_cvt_pk_bf16_f32 v35, v22, v23
    v_cvt_pk_bf16_f32 v36, v24, v25
    v_cvt_pk_bf16_f32 v37, v26, v27
    s_waitcnt lgkmcnt(0)
    v_add_f32 v96, v96, v180
    v_add_f32 v97, v97, v181
    v_add_f32 v98, v98, v182
    v_add_f32 v99, v99, v183
    v_add_f32 v100, v100, v184
    v_add_f32 v101, v101, v185
    v_add_f32 v102, v102, v186
    v_add_f32 v103, v103, v187
    v_add_f32 v104, v104, v188
    v_add_f32 v105, v105, v189
    v_add_f32 v106, v106, v190
    v_add_f32 v107, v107, v191
    v_add_f32 v96, v96, v192
    v_add_f32 v97, v97, v193
    v_add_f32 v98, v98, v194
    v_add_f32 v99, v99, v195
    v_add_f32 v100, v100, v196
    v_add_f32 v101, v101, v197
    v_add_f32 v102, v102, v198
    v_add_f32 v103, v103, v199
    v_add_f32 v104, v104, v44
    v_add_f32 v105, v105, v45
    v_add_f32 v106, v106, v46
    v_add_f32 v107, v107, v47
    v_add_f32 v96, v96, v48
    v_add_f32 v97, v97, v49
    v_add_f32 v98, v98, v50
    v_add_f32 v99, v99, v51
    v_add_f32 v100, v100, v52
    v_add_f32 v101, v101, v53
    v_add_f32 v102, v102, v54
    v_add_f32 v103, v103, v55
    v_add_f32 v104, v104, v56
    v_add_f32 v105, v105, v57
    v_add_f32 v106, v106, v58
    v_add_f32 v107, v107, v59
    v_mov_b32 v28, v104
    v_mov_b32 v29, v104
    v_max3_f32 v30, |v96|, |v97|, |v98|
    v_max3_f32 v30, v30, |v99|, |v100|
    v_permlane32_swap_b32 v28, v29
    v_max3_f32 v30, v30, |v101|, |v102|
    v_max3_f32 v30, v30, |v103|, |v104|
    v_max3_f32 v30, v30, |v105|, |v106|
    v_max_f32 v30, v30, |v107|
    v_cmp_nle_f32 vcc, 0x2b800000, v29
    v_mov_b32 v31, 0x7f800000
    v_rcp_f32 v28, v29
    s_or_b64 s[56:57], s[56:57], vcc
    v_cmp_nge_f32 vcc, 0x53800000, v29
    v_cmp_ngt_f32 s[58:59], v31, v30
    v_mov_b32 v29, v28
    s_or_b64 s[56:57], s[56:57], vcc
    s_or_b64 s[56:57], s[56:57], s[58:59]
    v_mul_f32 v16, v96, v29
    v_mul_f32 v17, v97, v29
    v_mul_f32 v18, v98, v29
    v_mul_f32 v19, v99, v29
    v_mul_f32 v20, v100, v29
    v_mul_f32 v21, v101, v29
    v_mul_f32 v22, v102, v29
    v_mul_f32 v23, v103, v29
    v_mul_f32 v24, v104, v29
    v_mul_f32 v25, v105, v29
    v_mul_f32 v26, v106, v29
    v_mul_f32 v27, v107, v29
    v_cvt_pk_bf16_f32 v38, v16, v17
    v_cvt_pk_bf16_f32 v39, v18, v19
    v_cvt_pk_bf16_f32 v40, v20, v21
    v_cvt_pk_bf16_f32 v41, v22, v23
    v_cvt_pk_bf16_f32 v42, v24, v25
    v_cvt_pk_bf16_f32 v43, v26, v27
    v_mov_b32 v14, 161024
    s_cmp_eq_u64 s[56:57], 0
    s_cbranch_scc1 mg_safe
    v_mov_b32 v15, 1
    ds_write_b32 v14, v15
    s_waitcnt lgkmcnt(0)
mg_safe:
    s_barrier
    ds_read_b32 v15, v14
    ds_write_b64 v207, v[32:33] offset:0
    ds_write_b64 v207, v[34:35] offset:16
    ds_write_b64 v208, v[36:37]
    ds_write_b64 v207, v[38:39] offset:5120
    ds_write_b64 v207, v[40:41] offset:5136
    ds_write_b64 v209, v[42:43]
    s_mul_i32 s24, s23, 10
    s_add_u32 s24, s24, s20
    s_lshr_b32 s25, s24, 2
    s_lshl_b32 s25, s25, 10
    s_and_b32 s24, s24, 3
    s_lshl_b32 s24, s24, 8
    s_add_u32 s24, s24, s25
    s_mul_i32 s25, s22, 81920
    s_add_u32 s28, s24, s25
    s_mul_i32 s24, s23, 10
    s_add_u32 s24, s24, s20
    s_add_u32 s24, s24, 4
    s_lshr_b32 s25, s24, 2
    s_lshl_b32 s25, s25, 10
    s_and_b32 s24, s24, 3
    s_lshl_b32 s24, s24, 8
    s_add_u32 s24, s24, s25
    s_mul_i32 s25, s22, 81920
    s_add_u32 s29, s24, s25
    s_mul_i32 s24, s23, 10
    s_add_u32 s24, s24, s20
    s_add_u32 s24, s24, 8
    s_lshr_b32 s25, s24, 2
    s_lshl_b32 s25, s25, 10
    s_and_b32 s24, s24, 3
    s_lshl_b32 s24, s24, 8
    s_add_u32 s24, s24, s25
    s_mul_i32 s25, s22, 81920
    s_add_u32 s30, s24, s25
    s_waitcnt lgkmcnt(0)
    v_readfirstlane_b32 s56, v15
    s_nop 0
    s_cmp_lg_u32 s56, 0
    s_cbranch_scc1 mg_slow
mg_staged:
    s_barrier
    ds_read_b128 v[44:47], v213 offset:0
    ds_read_b128 v[48:51], v213 offset:64
    ds_read_b128 v[52:55], v213 offset:128
    s_waitcnt lgkmcnt(2)
    buffer_store_dwordx4 v[44:47], v210, s[16:19], s28 offen sc1
    s_waitcnt lgkmcnt(1)
    buffer_store_dwordx4 v[48:51], v210, s[16:19], s29 offen sc1
    s_cmp_ge_u32 s20, 2
    s_cbranch_scc1 mg_no3rd
    s_waitcnt lgkmcnt(0)
    buffer_store_dwordx4 v[52:55], v210, s[16:19], s30 offen sc1
mg_no3rd:
    s_waitcnt lgkmcnt(0)
    s_lshl_b32 s21, s22, 7
    s_add_u32 s21, s21, 17825792
    s_add_u32 s44, s4, s21
    s_addc_u32 s45, s5, 0
    s_mov_b32 s46, 128
    s_mov_b32 s47, 0x20000
    s_cmp_ge_u32 s3, 160
    s_cbranch_scc1 mg_nouprep
    ds_read_b128 v[64:67], v219 offset:0
    ds_read_b128 v[68:71], v219 offset:16
    ds_read_b32 v72, v219 offset:32
    ds_read_b128 v[74:77], v219 offset:2048
    ds_read_b128 v[78:81], v219 offset:2064
    ds_read_b32 v82, v219 offset:2080
    ds_read_b128 v[84:87], v219 offset:4096
    ds_read_b128 v[88:91], v219 offset:4112
    ds_read_b32 v92, v219 offset:4128
    ds_read_b128 v[94:97], v219 offset:6144
    ds_read_b128 v[98:101], v219 offset:6160
    ds_read_b32 v102, v219 offset:6176
    ds_read_b128 v[104:107], v219 offset:8192
    ds_read_b128 v[108:111], v219 offset:8208
    ds_read_b32 v112, v219 offset:8224
    s_and_b32 s21, s20, 1
    s_cmp_eq_u32 s21, 0
    s_mov_b32 s25, 0x07060302
    s_cselect_b32 s26, 0x05040100, s25
    v_add_u32 v12, 92160, v220
    s_waitcnt lgkmcnt(0)
    s_barrier
    v_perm_b32 v116, v65, v64, s26
    v_perm_b32 v117, v67, v66, s26
    v_perm_b32 v118, v69, v68, s26
    v_perm_b32 v119, v71, v70, s26
    v_perm_b32 v120, v66, v65, s26
    v_perm_b32 v121, v68, v67, s26
    v_perm_b32 v122, v70, v69, s26
    v_perm_b32 v123, v72, v71, s26
    ds_write_b128 v12, v[116:119] offset:0
    ds_write_b128 v220, v[120:123] offset:64
    v_perm_b32 v124, v75, v74, s26
    v_perm_b32 v125, v77, v76, s26
    v_perm_b32 v126, v79, v78, s26
    v_perm_b32 v127, v81, v80, s26
    v_perm_b32 v128, v76, v75, s26
    v_perm_b32 v129, v78, v77, s26
    v_perm_b32 v130, v80, v79, s26
    v_perm_b32 v131, v82, v81, s26
    ds_write_b128 v12, v[124:127] offset:1024
    ds_write_b128 v220, v[128:131] offset:1088
    v_perm_b32 v116, v85, v84, s26
    v_perm_b32 v117, v87, v86, s26
    v_perm_b32 v118, v89, v88, s26
    v_perm_b32 v119, v91, v90, s26
    v_perm_b32 v120, v86, v85, s26
    v_perm_b32 v121, v88, v87, s26
    v_perm_b32 v122, v90, v89, s26
    v_perm_b32 v123, v92, v91, s26
    ds_write_b128 v12, v[116:119] offset:2048
    ds_write_b128 v220, v[120:123] offset:2112
    v_perm_b32 v124, v95, v94, s26
    v_perm_b32 v125, v97, v96, s26
    v_perm_b32 v126, v99, v98, s26
    v_perm_b32 v127, v101, v100, s26
    v_perm_b32 v128, v96, v95, s26
    v_perm_b32 v129, v98, v97, s26
    v_perm_b32 v130, v100, v99, s26
    v_perm_b32 v131, v102, v101, s26
    ds_write_b128 v12, v[124:127] offset:3072
    ds_write_b128 v220, v[128:131] offset:3136
    s_mov_b64 exec, 15
    v_perm_b32 v116, v105, v104, s26
    v_perm_b32 v117, v107, v106, s26
    v_perm_b32 v118, v109, v108, s26
    v_perm_b32 v119, v111, v110, s26
    v_perm_b32 v120, v106, v105, s26
    v_perm_b32 v121, v108, v107, s26
    v_perm_b32 v122, v110, v109, s26
    v_perm_b32 v123, v112, v111, s26
    ds_write_b128 v12, v[116:119] offset:4096
    ds_write_b128 v220, v[120:123] offset:4160
    s_mov_b64 exec, -1
mg_nouprep:
    s_waitcnt vmcnt(0)
    s_barrier
    s_cmp_lg_u32 s20, 0
    s_cbranch_scc1 mg_noflag
    s_lshl_b32 s21, s23, 2
    v_mov_b32 v12, s21
    v_mov_b32 v13, 1
    s_mov_b64 exec, 1
    buffer_store_dword v13, v12, s[44:47], 0 offen sc1
    s_mov_b64 exec, -1
mg_noflag:
    s_cmp_ge_u32 s3, 160
    s_cbranch_scc1 mg_bback
    s_mov_b32 s56, s92
    s_mov_b32 s57, s93
    s_mov_b32 s58, 5242880
    s_mov_b32 s59, 0x20000
    s_waitcnt lgkmcnt(0)
    v_add_u32 v11, 0, v214
    ds_read2_b32 v[64:65], v11 offset0:0 offset1:1
    ds_read2_b32 v[66:67], v11 offset0:2 offset1:3
    ds_read2_b32 v[68:69], v11 offset0:16 offset1:17
    ds_read2_b32 v[70:71], v11 offset0:18 offset1:19
    ds_read2_b32 v[72:73], v11 offset0:32 offset1:33
    ds_read2_b32 v[74:75], v11 offset0:34 offset1:35
    ds_read2_b32 v[76:77], v11 offset0:48 offset1:49
    ds_read2_b32 v[78:79], v11 offset0:50 offset1:51
    ds_read2_b32 v[80:81], v11 offset0:64 offset1:65
    ds_read2_b32 v[82:83], v11 offset0:66 offset1:67
    ds_read2_b32 v[84:85], v11 offset0:80 offset1:81
    ds_read2_b32 v[86:87], v11 offset0:82 offset1:83
    ds_read2_b32 v[88:89], v11 offset0:96 offset1:97
    ds_read2_b32 v[90:91], v11 offset0:98 offset1:99
    ds_read2_b32 v[92:93], v11 offset0:112 offset1:113
    ds_read2_b32 v[94:95], v11 offset0:114 offset1:115
    ds_read_b128 a[0:3], v215 offset:3584
    ds_read_b128 a[4:7], v215 offset:3648
    ds_read_b128 a[8:11], v215 offset:3712
    ds_read_b128 a[12:15], v215 offset:3776
    ds_read_b128 a[16:19], v215 offset:3840
    ds_read_b128 a[20:23], v215 offset:3904
    ds_read_b128 a[24:27], v215 offset:3968
    ds_read_b128 a[28:31], v215 offset:4032
    s_waitcnt lgkmcnt(7)
    v_mfma_f32_16x16x32_bf16 v[16:19], v[64:67], a[0:3], 0
    ds_read_b128 a[32:35], v215 offset:3072
    s_waitcnt lgkmcnt(7)
    v_mfma_f32_16x16x32_bf16 v[16:19], v[68:71], a[4:7], v[16:19]
    ds_read_b128 a[36:39], v215 offset:3136
    s_waitcnt lgkmcnt(7)
    v_mfma_f32_16x16x32_bf16 v[16:19], v[72:75], a[8:11], v[16:19]
    ds_read_b128 a[40:43], v215 offset:3200
    s_waitcnt lgkmcnt(7)
    v_mfma_f32_16x16x32_bf16 v[16:19], v[76:79], a[12:15], v[16:19]
    ds_read_b128 a[44:47], v215 offset:3264
    s_waitcnt lgkmcnt(7)
    v_mfma_f32_16x16x32_bf16 v[16:19], v[80:83], a[16:19], v[16:19]
    ds_read_b128 a[48:51], v215 offset:3328
    s_waitcnt lgkmcnt(7)
    v_mfma_f32_16x16x32_bf16 v[16:19], v[84:87], a[20:23], v[16:19]
    ds_read_b128 a[52:55], v215 offset:3392
    s_waitcnt lgkmcnt(7)
    v_mfma_f32_16x16x32_bf16 v[16:19], v[88:91], a[24:27], v[16:19]
    ds_read_b128 a[56:59], v215 offset:3456
    s_waitcnt lgkmcnt(7)
    v_mfma_f32_16x16x32_bf16 v[16:19], v[92:95], a[28:31], v[16:19]
    ds_read_b128 a[60:63], v215 offset:3520
    s_waitcnt lgkmcnt(7)
    v_mfma_f32_16x16x32_bf16 v[20:23], v[64:67], a[32:35], 0
    ds_read_b128 a[64:67], v215 offset:2560
    s_waitcnt lgkmcnt(7)
    v_mfma_f32_16x16x32_bf16 v[20:23], v[68:71], a[36:39], v[20:23]
    ds_read_b128 a[68:71], v215 offset:2624
    s_waitcnt lgkmcnt(7)
    v_mfma_f32_16x16x32_bf16 v[20:23], v[72:75], a[40:43], v[20:23]
    ds_read_b128 a[72:75], v215 offset:2688
    s_waitcnt lgkmcnt(7)
    v_mfma_f32_16x16x32_bf16 v[20:23], v[76:79], a[44:47], v[20:23]
    ds_read_b128 a[76:79], v215 offset:2752
    s_waitcnt lgkmcnt(7)
    v_mfma_f32_16x16x32_bf16 v[20:23], v[80:83], a[48:51], v[20:23]
    ds_read_b128 a[80:83], v215 offset:2816
    s_waitcnt lgkmcnt(7)
    v_mfma_f32_16x16x32_bf16 v[20:23], v[84:87], a[52:55], v[20:23]
    ds_read_b128 a[84:87], v215 offset:2880
    s_waitcnt lgkmcnt(7)
    v_mfma_f32_16x16x32_bf16 v[20:23], v[88:91], a[56:59], v[20:23]
    ds_read_b128 a[88:91], v215 offset:2944
    s_waitcnt lgkmcnt(7)
    v_mfma_f32_16x16x32_bf16 v[20:23], v[92:95], a[60:63], v[20:23]
    ds_read_b128 a[92:95], v215 offset:3008
    s_waitcnt lgkmcnt(7)
    v_mfma_f32_16x16x32_bf16 v[24:27], v[64:67], a[64:67], 0
    ds_read_b128 a[96:99], v215 offset:2048
    s_waitcnt lgkmcnt(7)
    v_mfma_f32_16x16x32_bf16 v[24:27], v[68:71], a[68:71], v[24:27]
    ds_read_b128 a[100:103], v215 offset:2112
    s_waitcnt lgkmcnt(7)
    v_mfma_f32_16x16x32_bf16 v[24:27], v[72:75], a[72:75], v[24:27]
    ds_read_b128 a[104:107], v215 offset:2176
    s_waitcnt lgkmcnt(7)
    v_mfma_f32_16x16x32_bf16 v[24:27], v[76:79], a[76:79], v[24:27]
    ds_read_b128 a[108:111], v215 offset:2240
    s_waitcnt lgkmcnt(7)
    v_mfma_f32_16x16x32_bf16 v[24:27], v[80:83], a[80:83], v[24:27]
    ds_read_b128 a[112:115], v215 offset:2304
    s_waitcnt lgkmcnt(7)
    v_mfma_f32_16x16x32_bf16 v[24:27], v[84:87], a[84:87], v[24:27]
    ds_read_b128 a[116:119], v215 offset:2368
    s_waitcnt lgkmcnt(7)
    v_mfma_f32_16x16x32_bf16 v[24:27], v[88:91], a[88:91], v[24:27]
    ds_read_b128 a[120:123], v215 offset:2432
    s_waitcnt lgkmcnt(7)
    v_mfma_f32_16x16x32_bf16 v[24:27], v[92:95], a[92:95], v[24:27]
    ds_read_b128 a[124:127], v215 offset:2496
    s_waitcnt lgkmcnt(7)
    v_mfma_f32_16x16x32_bf16 v[28:31], v[64:67], a[96:99], 0
    ds_read_b128 a[128:131], v215 offset:1536
    s_waitcnt lgkmcnt(7)
    v_mfma_f32_16x16x32_bf16 v[28:31], v[68:71], a[100:103], v[28:31]
    ds_read_b128 a[132:135], v215 offset:1600
    s_waitcnt lgkmcnt(7)
    v_mfma_f32_16x16x32_bf16 v[28:31], v[72:75], a[104:107], v[28:31]
    ds_read_b128 a[136:139], v215 offset:1664
    s_waitcnt lgkmcnt(7)
    v_mfma_f32_16x16x32_bf16 v[28:31], v[76:79], a[108:111], v[28:31]
    ds_read_b128 a[140:143], v215 offset:1728
    s_waitcnt lgkmcnt(7)
    v_mfma_f32_16x16x32_bf16 v[28:31], v[80:83], a[112:115], v[28:31]
    ds_read_b128 a[144:147], v215 offset:1792
    s_waitcnt lgkmcnt(7)
    v_mfma_f32_16x16x32_bf16 v[28:31], v[84:87], a[116:119], v[28:31]
    ds_read_b128 a[148:151], v215 offset:1856
    s_waitcnt lgkmcnt(7)
    v_mfma_f32_16x16x32_bf16 v[28:31], v[88:91], a[120:123], v[28:31]
    ds_read_b128 a[152:155], v215 offset:1920
    s_waitcnt lgkmcnt(7)
    v_mfma_f32_16x16x32_bf16 v[28:31], v[92:95], a[124:127], v[28:31]
    ds_read_b128 a[156:159], v215 offset:1984
    s_waitcnt lgkmcnt(7)
    v_mfma_f32_16x16x32_bf16 v[32:35], v[64:67], a[128:131], 0
    ds_read_b128 a[160:163], v215 offset:1024
    s_waitcnt lgkmcnt(7)
    v_mfma_f32_16x16x32_bf16 v[32:35], v[68:71], a[132:135], v[32:35]
    ds_read_b128 a[164:167], v215 offset:1088
    s_waitcnt lgkmcnt(7)
    v_mfma_f32_16x16x32_bf16 v[32:35], v[72:75], a[136:139], v[32:35]
    ds_read_b128 a[168:171], v215 offset:1152
    s_waitcnt lgkmcnt(7)
    v_mfma_f32_16x16x32_bf16 v[32:35], v[76:79], a[140:143], v[32:35]
    ds_read_b128 a[172:175], v215 offset:1216
    s_waitcnt lgkmcnt(7)
    v_mfma_f32_16x16x32_bf16 v[32:35], v[80:83], a[144:147], v[32:35]
    ds_read_b128 a[176:179], v215 offset:1280
    s_waitcnt lgkmcnt(7)
    v_mfma_f32_16x16x32_bf16 v[32:35], v[84:87], a[148:151], v[32:35]
    ds_read_b128 a[180:183], v215 offset:1344
    s_waitcnt lgkmcnt(7)
    v_mfma_f32_16x16x32_bf16 v[32:35], v[88:91], a[152:155], v[32:35]
    ds_read_b128 a[184:187], v215 offset:1408
    s_waitcnt lgkmcnt(7)
    v_mfma_f32_16x16x32_bf16 v[32:35], v[92:95], a[156:159], v[32:35]
    ds_read_b128 a[188:191], v215 offset:1472
    s_waitcnt lgkmcnt(7)
    v_mfma_f32_16x16x32_bf16 v[36:39], v[64:67], a[160:163], 0
    ds_read_b128 a[192:195], v215 offset:512
    s_waitcnt lgkmcnt(7)
    v_mfma_f32_16x16x32_bf16 v[36:39], v[68:71], a[164:167], v[36:39]
    ds_read_b128 a[196:199], v215 offset:576
    s_waitcnt lgkmcnt(7)
    v_mfma_f32_16x16x32_bf16 v[36:39], v[72:75], a[168:171], v[36:39]
    ds_read_b128 a[200:203], v215 offset:640
    s_waitcnt lgkmcnt(7)
    v_mfma_f32_16x16x32_bf16 v[36:39], v[76:79], a[172:175], v[36:39]
    ds_read_b128 a[204:207], v215 offset:704
    s_waitcnt lgkmcnt(7)
    v_mfma_f32_16x16x32_bf16 v[36:39], v[80:83], a[176:179], v[36:39]
    ds_read_b128 a[208:211], v215 offset:768
    s_waitcnt lgkmcnt(7)
    v_mfma_f32_16x16x32_bf16 v[36:39], v[84:87], a[180:183], v[36:39]
    ds_read_b128 a[212:215], v215 offset:832
    s_waitcnt lgkmcnt(7)
    v_mfma_f32_16x16x32_bf16 v[36:39], v[88:91], a[184:187], v[36:39]
    ds_read_b128 a[216:219], v215 offset:896
    s_waitcnt lgkmcnt(7)
    v_mfma_f32_16x16x32_bf16 v[36:39], v[92:95], a[188:191], v[36:39]
    ds_read_b128 a[220:223], v215 offset:960
    s_waitcnt lgkmcnt(7)
    v_mfma_f32_16x16x32_bf16 v[40:43], v[64:67], a[192:195], 0
    ds_read_b128 a[224:227], v215 offset:0
    s_waitcnt lgkmcnt(7)
    v_mfma_f32_16x16x32_bf16 v[40:43], v[68:71], a[196:199], v[40:43]
    ds_read_b128 a[228:231], v215 offset:64
    s_waitcnt lgkmcnt(7)
    v_mfma_f32_16x16x32_bf16 v[40:43], v[72:75], a[200:203], v[40:43]
    ds_read_b128 a[232:235], v215 offset:128
    s_waitcnt lgkmcnt(7)
    v_mfma_f32_16x16x32_bf16 v[40:43], v[76:79], a[204:207], v[40:43]
    ds_read_b128 a[236:239], v215 offset:192
    s_waitcnt lgkmcnt(7)
    v_mfma_f32_16x16x32_bf16 v[40:43], v[80:83], a[208:211], v[40:43]
    ds_read_b128 a[240:243], v215 offset:256
    s_waitcnt lgkmcnt(7)
    v_mfma_f32_16x16x32_bf16 v[40:43], v[84:87], a[212:215], v[40:43]
    ds_read_b128 a[244:247], v215 offset:320
    s_waitcnt lgkmcnt(7)
    v_mfma_f32_16x16x32_bf16 v[40:43], v[88:91], a[216:219], v[40:43]
    ds_read_b128 a[248:251], v215 offset:384
    s_waitcnt lgkmcnt(7)
    v_mfma_f32_16x16x32_bf16 v[40:43], v[92:95], a[220:223], v[40:43]
    ds_read_b128 a[252:255], v215 offset:448
    s_waitcnt lgkmcnt(7)
    v_mfma_f32_16x16x32_bf16 v[44:47], v[64:67], a[224:227], 0
    v_add_u32 v11, 512, v214
    ds_read2_b32 v[96:97], v11 offset0:0 offset1:1
    s_waitcnt lgkmcnt(7)
    v_mfma_f32_16x16x32_bf16 v[44:47], v[68:71], a[228:231], v[44:47]
    ds_read2_b32 v[98:99], v11 offset0:2 offset1:3
    ds_read2_b32 v[100:101], v11 offset0:16 offset1:17
    s_waitcnt lgkmcnt(8)
    v_mfma_f32_16x16x32_bf16 v[44:47], v[72:75], a[232:235], v[44:47]
    ds_read2_b32 v[102:103], v11 offset0:18 offset1:19
    ds_read2_b32 v[104:105], v11 offset0:32 offset1:33
    s_waitcnt lgkmcnt(9)
    v_mfma_f32_16x16x32_bf16 v[44:47], v[76:79], a[236:239], v[44:47]
    ds_read2_b32 v[106:107], v11 offset0:34 offset1:35
    ds_read2_b32 v[108:109], v11 offset0:48 offset1:49
    s_waitcnt lgkmcnt(10)
    v_mfma_f32_16x16x32_bf16 v[44:47], v[80:83], a[240:243], v[44:47]
    ds_read2_b32 v[110:111], v11 offset0:50 offset1:51
    ds_read2_b32 v[112:113], v11 offset0:64 offset1:65
    s_waitcnt lgkmcnt(11)
    v_mfma_f32_16x16x32_bf16 v[44:47], v[84:87], a[244:247], v[44:47]
    ds_read2_b32 v[114:115], v11 offset0:66 offset1:67
    ds_read2_b32 v[116:117], v11 offset0:80 offset1:81
    s_waitcnt lgkmcnt(12)
    v_mfma_f32_16x16x32_bf16 v[44:47], v[88:91], a[248:251], v[44:47]
    ds_read2_b32 v[118:119], v11 offset0:82 offset1:83
    ds_read2_b32 v[120:121], v11 offset0:96 offset1:97
    s_waitcnt lgkmcnt(13)
    v_mfma_f32_16x16x32_bf16 v[44:47], v[92:95], a[252:255], v[44:47]
    ds_read2_b32 v[122:123], v11 offset0:98 offset1:99
    ds_read2_b32 v[124:125], v11 offset0:112 offset1:113
    ds_read2_b32 v[126:127], v11 offset0:114 offset1:115
    s_waitcnt lgkmcnt(14)
    v_mfma_f32_16x16x32_bf16 v[20:23], v[96:99], a[0:3], v[20:23]
    v_mfma_f32_16x16x32_bf16 v[24:27], v[96:99], a[32:35], v[24:27]
    v_mfma_f32_16x16x32_bf16 v[28:31], v[96:99], a[64:67], v[28:31]
    v_mfma_f32_16x16x32_bf16 v[32:35], v[96:99], a[96:99], v[32:35]
    v_mfma_f32_16x16x32_bf16 v[36:39], v[96:99], a[128:131], v[36:39]
    v_cvt_pk_bf16_f32 v48, v16, v17
    v_cvt_pk_bf16_f32 v49, v18, v19
    ds_write_b64 v216, v[48:49] offset:0
    v_mfma_f32_16x16x32_bf16 v[40:43], v[96:99], a[160:163], v[40:43]
    v_mfma_f32_16x16x32_bf16 v[44:47], v[96:99], a[192:195], v[44:47]
    s_waitcnt lgkmcnt(13)
    v_mfma_f32_16x16x32_bf16 v[20:23], v[100:103], a[4:7], v[20:23]
    v_add_u32 v11, 1024, v214
    v_mfma_f32_16x16x32_bf16 v[24:27], v[100:103], a[36:39], v[24:27]
    v_mfma_f32_16x16x32_bf16 v[28:31], v[100:103], a[68:71], v[28:31]
    v_mfma_f32_16x16x32_bf16 v[32:35], v[100:103], a[100:103], v[32:35]
    ds_read2_b32 v[64:65], v11 offset0:0 offset1:1
    v_mfma_f32_16x16x32_bf16 v[36:39], v[100:103], a[132:135], v[36:39]
    v_mfma_f32_16x16x32_bf16 v[40:43], v[100:103], a[164:167], v[40:43]
    v_mfma_f32_16x16x32_bf16 v[44:47], v[100:103], a[196:199], v[44:47]
    ds_read2_b32 v[66:67], v11 offset0:2 offset1:3
    s_waitcnt lgkmcnt(13)
    v_mfma_f32_16x16x32_bf16 v[20:23], v[104:107], a[8:11], v[20:23]
    v_mfma_f32_16x16x32_bf16 v[24:27], v[104:107], a[40:43], v[24:27]
    v_mfma_f32_16x16x32_bf16 v[28:31], v[104:107], a[72:75], v[28:31]
    ds_read2_b32 v[68:69], v11 offset0:16 offset1:17
    v_mfma_f32_16x16x32_bf16 v[32:35], v[104:107], a[104:107], v[32:35]
    v_mfma_f32_16x16x32_bf16 v[36:39], v[104:107], a[136:139], v[36:39]
    v_mfma_f32_16x16x32_bf16 v[40:43], v[104:107], a[168:171], v[40:43]
    ds_read2_b32 v[70:71], v11 offset0:18 offset1:19
    v_mfma_f32_16x16x32_bf16 v[44:47], v[104:107], a[200:203], v[44:47]
    s_waitcnt lgkmcnt(13)
    v_mfma_f32_16x16x32_bf16 v[20:23], v[108:111], a[12:15], v[20:23]
    v_mfma_f32_16x16x32_bf16 v[24:27], v[108:111], a[44:47], v[24:27]
    ds_read2_b32 v[72:73], v11 offset0:32 offset1:33
    v_mfma_f32_16x16x32_bf16 v[28:31], v[108:111], a[76:79], v[28:31]
    v_mfma_f32_16x16x32_bf16 v[32:35], v[108:111], a[108:111], v[32:35]
    v_mfma_f32_16x16x32_bf16 v[36:39], v[108:111], a[140:143], v[36:39]
    ds_read2_b32 v[74:75], v11 offset0:34 offset1:35
    v_mfma_f32_16x16x32_bf16 v[40:43], v[108:111], a[172:175], v[40:43]
    v_mfma_f32_16x16x32_bf16 v[44:47], v[108:111], a[204:207], v[44:47]
    ds_read2_b32 v[76:77], v11 offset0:48 offset1:49
    s_waitcnt lgkmcnt(7)
    s_barrier
    ds_read_b64_tr_b16 v[50:51], v217 offset:0
    v_mfma_f32_16x16x32_bf16 v[20:23], v[112:115], a[16:19], v[20:23]
    v_mfma_f32_16x16x32_bf16 v[24:27], v[112:115], a[48:51], v[24:27]
    v_mfma_f32_16x16x32_bf16 v[28:31], v[112:115], a[80:83], v[28:31]
    v_mfma_f32_16x16x32_bf16 v[32:35], v[112:115], a[112:115], v[32:35]
    ds_read2_b32 v[78:79], v11 offset0:50 offset1:51
    v_mfma_f32_16x16x32_bf16 v[36:39], v[112:115], a[144:147], v[36:39]
    v_mfma_f32_16x16x32_bf16 v[40:43], v[112:115], a[176:179], v[40:43]
    v_mfma_f32_16x16x32_bf16 v[44:47], v[112:115], a[208:211], v[44:47]
    ds_read2_b32 v[80:81], v11 offset0:64 offset1:65
    v_mfma_f32_16x16x32_bf16 v[20:23], v[116:119], a[20:23], v[20:23]
    v_mfma_f32_16x16x32_bf16 v[24:27], v[116:119], a[52:55], v[24:27]
    v_mfma_f32_16x16x32_bf16 v[28:31], v[116:119], a[84:87], v[28:31]
    ds_read2_b32 v[82:83], v11 offset0:66 offset1:67
    v_mfma_f32_16x16x32_bf16 v[32:35], v[116:119], a[116:119], v[32:35]
    v_mfma_f32_16x16x32_bf16 v[36:39], v[116:119], a[148:151], v[36:39]
    v_mfma_f32_16x16x32_bf16 v[40:43], v[116:119], a[180:183], v[40:43]
    ds_read2_b32 v[84:85], v11 offset0:80 offset1:81
    v_mfma_f32_16x16x32_bf16 v[44:47], v[116:119], a[212:215], v[44:47]
    v_mfma_f32_16x16x32_bf16 v[20:23], v[120:123], a[24:27], v[20:23]
    v_mfma_f32_16x16x32_bf16 v[24:27], v[120:123], a[56:59], v[24:27]
    ds_read2_b32 v[86:87], v11 offset0:82 offset1:83
    v_mfma_f32_16x16x32_bf16 v[28:31], v[120:123], a[88:91], v[28:31]
    v_mfma_f32_16x16x32_bf16 v[32:35], v[120:123], a[120:123], v[32:35]
    v_mfma_f32_16x16x32_bf16 v[36:39], v[120:123], a[152:155], v[36:39]
    ds_read2_b32 v[88:89], v11 offset0:96 offset1:97
    v_mfma_f32_16x16x32_bf16 v[40:43], v[120:123], a[184:187], v[40:43]
    v_mfma_f32_16x16x32_bf16 v[44:47], v[120:123], a[216:219], v[44:47]
    v_mfma_f32_16x16x32_bf16 v[20:23], v[124:127], a[28:31], v[20:23]
    ds_read2_b32 v[90:91], v11 offset0:98 offset1:99
    v_mfma_f32_16x16x32_bf16 v[24:27], v[124:127], a[60:63], v[24:27]
    v_mfma_f32_16x16x32_bf16 v[28:31], v[124:127], a[92:95], v[28:31]
    v_mfma_f32_16x16x32_bf16 v[32:35], v[124:127], a[124:127], v[32:35]
    ds_read2_b32 v[92:93], v11 offset0:112 offset1:113
    v_mfma_f32_16x16x32_bf16 v[36:39], v[124:127], a[156:159], v[36:39]
    v_mfma_f32_16x16x32_bf16 v[40:43], v[124:127], a[188:191], v[40:43]
    v_mfma_f32_16x16x32_bf16 v[44:47], v[124:127], a[220:223], v[44:47]
    ds_read2_b32 v[94:95], v11 offset0:114 offset1:115
    s_waitcnt lgkmcnt(9)
    s_mov_b32 s28, 0
    buffer_store_dwordx2 v[50:51], v206, s[56:59], s28 offen
    v_mfma_f32_16x16x32_bf16 v[24:27], v[64:67], a[0:3], v[24:27]
    v_mfma_f32_16x16x32_bf16 v[28:31], v[64:67], a[32:35], v[28:31]
    v_mfma_f32_16x16x32_bf16 v[32:35], v[64:67], a[64:67], v[32:35]
    v_mfma_f32_16x16x32_bf16 v[36:39], v[64:67], a[96:99], v[36:39]
    v_mfma_f32_16x16x32_bf16 v[40:43], v[64:67], a[128:131], v[40:43]
    v_cvt_pk_bf16_f32 v48, v20, v21
    v_cvt_pk_bf16_f32 v49, v22, v23
    ds_write_b64 v216, v[48:49] offset:2304
    v_mfma_f32_16x16x32_bf16 v[44:47], v[64:67], a[160:163], v[44:47]
    v_mfma_f32_16x16x32_bf16 v[24:27], v[68:71], a[4:7], v[24:27]
    v_mfma_f32_16x16x32_bf16 v[28:31], v[68:71], a[36:39], v[28:31]
    v_add_u32 v11, 1536, v214
    v_mfma_f32_16x16x32_bf16 v[32:35], v[68:71], a[68:71], v[32:35]
    v_mfma_f32_16x16x32_bf16 v[36:39], v[68:71], a[100:103], v[36:39]
    ds_read2_b32 v[96:97], v11 offset0:0 offset1:1
    v_mfma_f32_16x16x32_bf16 v[40:43], v[68:71], a[132:135], v[40:43]
    v_mfma_f32_16x16x32_bf16 v[44:47], v[68:71], a[164:167], v[44:47]
    v_mfma_f32_16x16x32_bf16 v[24:27], v[72:75], a[8:11], v[24:27]
    ds_read2_b32 v[98:99], v11 offset0:2 offset1:3
    v_mfma_f32_16x16x32_bf16 v[28:31], v[72:75], a[40:43], v[28:31]
    v_mfma_f32_16x16x32_bf16 v[32:35], v[72:75], a[72:75], v[32:35]
    ds_read2_b32 v[100:101], v11 offset0:16 offset1:17
    v_mfma_f32_16x16x32_bf16 v[36:39], v[72:75], a[104:107], v[36:39]
    v_mfma_f32_16x16x32_bf16 v[40:43], v[72:75], a[136:139], v[40:43]
    ds_read2_b32 v[102:103], v11 offset0:18 offset1:19
    v_mfma_f32_16x16x32_bf16 v[44:47], v[72:75], a[168:171], v[44:47]
    s_waitcnt lgkmcnt(13)
    v_mfma_f32_16x16x32_bf16 v[24:27], v[76:79], a[12:15], v[24:27]
    v_mfma_f32_16x16x32_bf16 v[28:31], v[76:79], a[44:47], v[28:31]
    ds_read2_b32 v[104:105], v11 offset0:32 offset1:33
    v_mfma_f32_16x16x32_bf16 v[32:35], v[76:79], a[76:79], v[32:35]
    v_mfma_f32_16x16x32_bf16 v[36:39], v[76:79], a[108:111], v[36:39]
    ds_read2_b32 v[106:107], v11 offset0:34 offset1:35
    v_mfma_f32_16x16x32_bf16 v[40:43], v[76:79], a[140:143], v[40:43]
    v_mfma_f32_16x16x32_bf16 v[44:47], v[76:79], a[172:175], v[44:47]
    ds_read2_b32 v[108:109], v11 offset0:48 offset1:49
    s_waitcnt lgkmcnt(7)
    s_barrier
    ds_read_b64_tr_b16 v[52:53], v217 offset:2304
    v_mfma_f32_16x16x32_bf16 v[24:27], v[80:83], a[16:19], v[24:27]
    v_mfma_f32_16x16x32_bf16 v[28:31], v[80:83], a[48:51], v[28:31]
    v_mfma_f32_16x16x32_bf16 v[32:35], v[80:83], a[80:83], v[32:35]
    ds_read2_b32 v[110:111], v11 offset0:50 offset1:51
    v_mfma_f32_16x16x32_bf16 v[36:39], v[80:83], a[112:115], v[36:39]
    v_mfma_f32_16x16x32_bf16 v[40:43], v[80:83], a[144:147], v[40:43]
    v_mfma_f32_16x16x32_bf16 v[44:47], v[80:83], a[176:179], v[44:47]
    ds_read2_b32 v[112:113], v11 offset0:64 offset1:65
    v_mfma_f32_16x16x32_bf16 v[24:27], v[84:87], a[20:23], v[24:27]
    v_mfma_f32_16x16x32_bf16 v[28:31], v[84:87], a[52:55], v[28:31]
    ds_read2_b32 v[114:115], v11 offset0:66 offset1:67
    v_mfma_f32_16x16x32_bf16 v[32:35], v[84:87], a[84:87], v[32:35]
    v_mfma_f32_16x16x32_bf16 v[36:39], v[84:87], a[116:119], v[36:39]
    v_mfma_f32_16x16x32_bf16 v[40:43], v[84:87], a[148:151], v[40:43]
    ds_read2_b32 v[116:117], v11 offset0:80 offset1:81
    v_mfma_f32_16x16x32_bf16 v[44:47], v[84:87], a[180:183], v[44:47]
    v_mfma_f32_16x16x32_bf16 v[24:27], v[88:91], a[24:27], v[24:27]
    v_mfma_f32_16x16x32_bf16 v[28:31], v[88:91], a[56:59], v[28:31]
    ds_read2_b32 v[118:119], v11 offset0:82 offset1:83
    v_mfma_f32_16x16x32_bf16 v[32:35], v[88:91], a[88:91], v[32:35]
    v_mfma_f32_16x16x32_bf16 v[36:39], v[88:91], a[120:123], v[36:39]
    ds_read2_b32 v[120:121], v11 offset0:96 offset1:97
    v_mfma_f32_16x16x32_bf16 v[40:43], v[88:91], a[152:155], v[40:43]
    v_mfma_f32_16x16x32_bf16 v[44:47], v[88:91], a[184:187], v[44:47]
    v_mfma_f32_16x16x32_bf16 v[24:27], v[92:95], a[28:31], v[24:27]
    ds_read2_b32 v[122:123], v11 offset0:98 offset1:99
    v_mfma_f32_16x16x32_bf16 v[28:31], v[92:95], a[60:63], v[28:31]
    v_mfma_f32_16x16x32_bf16 v[32:35], v[92:95], a[92:95], v[32:35]
    v_mfma_f32_16x16x32_bf16 v[36:39], v[92:95], a[124:127], v[36:39]
    ds_read2_b32 v[124:125], v11 offset0:112 offset1:113
    v_mfma_f32_16x16x32_bf16 v[40:43], v[92:95], a[156:159], v[40:43]
    v_mfma_f32_16x16x32_bf16 v[44:47], v[92:95], a[188:191], v[44:47]
    ds_read2_b32 v[126:127], v11 offset0:114 offset1:115
    s_waitcnt lgkmcnt(9)
    s_mov_b32 s28, 655360
    buffer_store_dwordx2 v[52:53], v206, s[56:59], s28 offen
    v_mfma_f32_16x16x32_bf16 v[28:31], v[96:99], a[0:3], v[28:31]
    v_mfma_f32_16x16x32_bf16 v[32:35], v[96:99], a[32:35], v[32:35]
    v_mfma_f32_16x16x32_bf16 v[36:39], v[96:99], a[64:67], v[36:39]
    v_mfma_f32_16x16x32_bf16 v[40:43], v[96:99], a[96:99], v[40:43]
    v_mfma_f32_16x16x32_bf16 v[44:47], v[96:99], a[128:131], v[44:47]
    v_cvt_pk_bf16_f32 v48, v24, v25
    v_cvt_pk_bf16_f32 v49, v26, v27
    ds_write_b64 v216, v[48:49] offset:0
    v_mfma_f32_16x16x32_bf16 v[28:31], v[100:103], a[4:7], v[28:31]
    v_mfma_f32_16x16x32_bf16 v[32:35], v[100:103], a[36:39], v[32:35]
    v_add_u32 v11, 2048, v214
    v_mfma_f32_16x16x32_bf16 v[36:39], v[100:103], a[68:71], v[36:39]
    v_mfma_f32_16x16x32_bf16 v[40:43], v[100:103], a[100:103], v[40:43]
    ds_read2_b32 v[64:65], v11 offset0:0 offset1:1
    v_mfma_f32_16x16x32_bf16 v[44:47], v[100:103], a[132:135], v[44:47]
    v_mfma_f32_16x16x32_bf16 v[28:31], v[104:107], a[8:11], v[28:31]
    ds_read2_b32 v[66:67], v11 offset0:2 offset1:3
    v_mfma_f32_16x16x32_bf16 v[32:35], v[104:107], a[40:43], v[32:35]
    v_mfma_f32_16x16x32_bf16 v[36:39], v[104:107], a[72:75], v[36:39]
    ds_read2_b32 v[68:69], v11 offset0:16 offset1:17
    v_mfma_f32_16x16x32_bf16 v[40:43], v[104:107], a[104:107], v[40:43]
    v_mfma_f32_16x16x32_bf16 v[44:47], v[104:107], a[136:139], v[44:47]
    ds_read2_b32 v[70:71], v11 offset0:18 offset1:19
    s_waitcnt lgkmcnt(13)
    v_mfma_f32_16x16x32_bf16 v[28:31], v[108:111], a[12:15], v[28:31]
    v_mfma_f32_16x16x32_bf16 v[32:35], v[108:111], a[44:47], v[32:35]
    ds_read2_b32 v[72:73], v11 offset0:32 offset1:33
    v_mfma_f32_16x16x32_bf16 v[36:39], v[108:111], a[76:79], v[36:39]
    v_mfma_f32_16x16x32_bf16 v[40:43], v[108:111], a[108:111], v[40:43]
    ds_read2_b32 v[74:75], v11 offset0:34 offset1:35
    v_mfma_f32_16x16x32_bf16 v[44:47], v[108:111], a[140:143], v[44:47]
    ds_read2_b32 v[76:77], v11 offset0:48 offset1:49
    s_waitcnt lgkmcnt(7)
    s_barrier
    ds_read_b64_tr_b16 v[50:51], v217 offset:0
    v_mfma_f32_16x16x32_bf16 v[28:31], v[112:115], a[16:19], v[28:31]
    v_mfma_f32_16x16x32_bf16 v[32:35], v[112:115], a[48:51], v[32:35]
    v_mfma_f32_16x16x32_bf16 v[36:39], v[112:115], a[80:83], v[36:39]
    ds_read2_b32 v[78:79], v11 offset0:50 offset1:51
    v_mfma_f32_16x16x32_bf16 v[40:43], v[112:115], a[112:115], v[40:43]
    v_mfma_f32_16x16x32_bf16 v[44:47], v[112:115], a[144:147], v[44:47]
    ds_read2_b32 v[80:81], v11 offset0:64 offset1:65
    v_mfma_f32_16x16x32_bf16 v[28:31], v[116:119], a[20:23], v[28:31]
    v_mfma_f32_16x16x32_bf16 v[32:35], v[116:119], a[52:55], v[32:35]
    ds_read2_b32 v[82:83], v11 offset0:66 offset1:67
    v_mfma_f32_16x16x32_bf16 v[36:39], v[116:119], a[84:87], v[36:39]
    v_mfma_f32_16x16x32_bf16 v[40:43], v[116:119], a[116:119], v[40:43]
    ds_read2_b32 v[84:85], v11 offset0:80 offset1:81
    v_mfma_f32_16x16x32_bf16 v[44:47], v[116:119], a[148:151], v[44:47]
    v_mfma_f32_16x16x32_bf16 v[28:31], v[120:123], a[24:27], v[28:31]
    v_mfma_f32_16x16x32_bf16 v[32:35], v[120:123], a[56:59], v[32:35]
    ds_read2_b32 v[86:87], v11 offset0:82 offset1:83
    v_mfma_f32_16x16x32_bf16 v[36:39], v[120:123], a[88:91], v[36:39]
    v_mfma_f32_16x16x32_bf16 v[40:43], v[120:123], a[120:123], v[40:43]
    ds_read2_b32 v[88:89], v11 offset0:96 offset1:97
    v_mfma_f32_16x16x32_bf16 v[44:47], v[120:123], a[152:155], v[44:47]
    v_mfma_f32_16x16x32_bf16 v[28:31], v[124:127], a[28:31], v[28:31]
    ds_read2_b32 v[90:91], v11 offset0:98 offset1:99
    v_mfma_f32_16x16x32_bf16 v[32:35], v[124:127], a[60:63], v[32:35]
    v_mfma_f32_16x16x32_bf16 v[36:39], v[124:127], a[92:95], v[36:39]
    ds_read2_b32 v[92:93], v11 offset0:112 offset1:113
    v_mfma_f32_16x16x32_bf16 v[40:43], v[124:127], a[124:127], v[40:43]
    v_mfma_f32_16x16x32_bf16 v[44:47], v[124:127], a[156:159], v[44:47]
    ds_read2_b32 v[94:95], v11 offset0:114 offset1:115
    s_waitcnt lgkmcnt(9)
    s_mov_b32 s28, 1310720
    buffer_store_dwordx2 v[50:51], v206, s[56:59], s28 offen
    v_mfma_f32_16x16x32_bf16 v[32:35], v[64:67], a[0:3], v[32:35]
    v_mfma_f32_16x16x32_bf16 v[36:39], v[64:67], a[32:35], v[36:39]
    v_mfma_f32_16x16x32_bf16 v[40:43], v[64:67], a[64:67], v[40:43]
    v_mfma_f32_16x16x32_bf16 v[44:47], v[64:67], a[96:99], v[44:47]
    v_mfma_f32_16x16x32_bf16 v[32:35], v[68:71], a[4:7], v[32:35]
    v_cvt_pk_bf16_f32 v48, v28, v29
    v_cvt_pk_bf16_f32 v49, v30, v31
    ds_write_b64 v216, v[48:49] offset:2304
    v_mfma_f32_16x16x32_bf16 v[36:39], v[68:71], a[36:39], v[36:39]
    v_mfma_f32_16x16x32_bf16 v[40:43], v[68:71], a[68:71], v[40:43]
    v_add_u32 v11, 2560, v214
    v_mfma_f32_16x16x32_bf16 v[44:47], v[68:71], a[100:103], v[44:47]
    ds_read2_b32 v[96:97], v11 offset0:0 offset1:1
    v_mfma_f32_16x16x32_bf16 v[32:35], v[72:75], a[8:11], v[32:35]
    v_mfma_f32_16x16x32_bf16 v[36:39], v[72:75], a[40:43], v[36:39]
    ds_read2_b32 v[98:99], v11 offset0:2 offset1:3
    v_mfma_f32_16x16x32_bf16 v[40:43], v[72:75], a[72:75], v[40:43]
    ds_read2_b32 v[100:101], v11 offset0:16 offset1:17
    v_mfma_f32_16x16x32_bf16 v[44:47], v[72:75], a[104:107], v[44:47]
    ds_read2_b32 v[102:103], v11 offset0:18 offset1:19
    s_waitcnt lgkmcnt(13)
    v_mfma_f32_16x16x32_bf16 v[32:35], v[76:79], a[12:15], v[32:35]
    v_mfma_f32_16x16x32_bf16 v[36:39], v[76:79], a[44:47], v[36:39]
    ds_read2_b32 v[104:105], v11 offset0:32 offset1:33
    v_mfma_f32_16x16x32_bf16 v[40:43], v[76:79], a[76:79], v[40:43]
    ds_read2_b32 v[106:107], v11 offset0:34 offset1:35
    v_mfma_f32_16x16x32_bf16 v[44:47], v[76:79], a[108:111], v[44:47]
    ds_read2_b32 v[108:109], v11 offset0:48 offset1:49
    s_waitcnt lgkmcnt(7)
    s_barrier
    ds_read_b64_tr_b16 v[52:53], v217 offset:2304
    v_mfma_f32_16x16x32_bf16 v[32:35], v[80:83], a[16:19], v[32:35]
    v_mfma_f32_16x16x32_bf16 v[36:39], v[80:83], a[48:51], v[36:39]
    ds_read2_b32 v[110:111], v11 offset0:50 offset1:51
    v_mfma_f32_16x16x32_bf16 v[40:43], v[80:83], a[80:83], v[40:43]
    v_mfma_f32_16x16x32_bf16 v[44:47], v[80:83], a[112:115], v[44:47]
    ds_read2_b32 v[112:113], v11 offset0:64 offset1:65
    v_mfma_f32_16x16x32_bf16 v[32:35], v[84:87], a[20:23], v[32:35]
    v_mfma_f32_16x16x32_bf16 v[36:39], v[84:87], a[52:55], v[36:39]
    ds_read2_b32 v[114:115], v11 offset0:66 offset1:67
    v_mfma_f32_16x16x32_bf16 v[40:43], v[84:87], a[84:87], v[40:43]
    v_mfma_f32_16x16x32_bf16 v[44:47], v[84:87], a[116:119], v[44:47]
    ds_read2_b32 v[116:117], v11 offset0:80 offset1:81
    v_mfma_f32_16x16x32_bf16 v[32:35], v[88:91], a[24:27], v[32:35]
    ds_read2_b32 v[118:119], v11 offset0:82 offset1:83
    v_mfma_f32_16x16x32_bf16 v[36:39], v[88:91], a[56:59], v[36:39]
    v_mfma_f32_16x16x32_bf16 v[40:43], v[88:91], a[88:91], v[40:43]
    ds_read2_b32 v[120:121], v11 offset0:96 offset1:97
    v_mfma_f32_16x16x32_bf16 v[44:47], v[88:91], a[120:123], v[44:47]
    v_mfma_f32_16x16x32_bf16 v[32:35], v[92:95], a[28:31], v[32:35]
    ds_read2_b32 v[122:123], v11 offset0:98 offset1:99
    v_mfma_f32_16x16x32_bf16 v[36:39], v[92:95], a[60:63], v[36:39]
    v_mfma_f32_16x16x32_bf16 v[40:43], v[92:95], a[92:95], v[40:43]
    ds_read2_b32 v[124:125], v11 offset0:112 offset1:113
    v_mfma_f32_16x16x32_bf16 v[44:47], v[92:95], a[124:127], v[44:47]
    ds_read2_b32 v[126:127], v11 offset0:114 offset1:115
    s_waitcnt lgkmcnt(9)
    s_mov_b32 s28, 1966080
    buffer_store_dwordx2 v[52:53], v206, s[56:59], s28 offen
    v_mfma_f32_16x16x32_bf16 v[36:39], v[96:99], a[0:3], v[36:39]
    v_mfma_f32_16x16x32_bf16 v[40:43], v[96:99], a[32:35], v[40:43]
    v_mfma_f32_16x16x32_bf16 v[44:47], v[96:99], a[64:67], v[44:47]
    v_mfma_f32_16x16x32_bf16 v[36:39], v[100:103], a[4:7], v[36:39]
    v_mfma_f32_16x16x32_bf16 v[40:43], v[100:103], a[36:39], v[40:43]
    v_cvt_pk_bf16_f32 v48, v32, v33
    v_cvt_pk_bf16_f32 v49, v34, v35
    ds_write_b64 v216, v[48:49] offset:0
    v_mfma_f32_16x16x32_bf16 v[44:47], v[100:103], a[68:71], v[44:47]
    v_add_u32 v11, 3072, v214
    v_mfma_f32_16x16x32_bf16 v[36:39], v[104:107], a[8:11], v[36:39]
    ds_read2_b32 v[64:65], v11 offset0:0 offset1:1
    v_mfma_f32_16x16x32_bf16 v[40:43], v[104:107], a[40:43], v[40:43]
    ds_read2_b32 v[66:67], v11 offset0:2 offset1:3
    v_mfma_f32_16x16x32_bf16 v[44:47], v[104:107], a[72:75], v[44:47]
    ds_read2_b32 v[68:69], v11 offset0:16 offset1:17
    s_waitcnt lgkmcnt(12)
    v_mfma_f32_16x16x32_bf16 v[36:39], v[108:111], a[12:15], v[36:39]
    ds_read2_b32 v[70:71], v11 offset0:18 offset1:19
    v_mfma_f32_16x16x32_bf16 v[40:43], v[108:111], a[44:47], v[40:43]
    ds_read2_b32 v[72:73], v11 offset0:32 offset1:33
    v_mfma_f32_16x16x32_bf16 v[44:47], v[108:111], a[76:79], v[44:47]
    ds_read2_b32 v[74:75], v11 offset0:34 offset1:35
    ds_read2_b32 v[76:77], v11 offset0:48 offset1:49
    s_waitcnt lgkmcnt(7)
    s_barrier
    ds_read_b64_tr_b16 v[50:51], v217 offset:0
    v_mfma_f32_16x16x32_bf16 v[36:39], v[112:115], a[16:19], v[36:39]
    v_mfma_f32_16x16x32_bf16 v[40:43], v[112:115], a[48:51], v[40:43]
    ds_read2_b32 v[78:79], v11 offset0:50 offset1:51
    v_mfma_f32_16x16x32_bf16 v[44:47], v[112:115], a[80:83], v[44:47]
    ds_read2_b32 v[80:81], v11 offset0:64 offset1:65
    v_mfma_f32_16x16x32_bf16 v[36:39], v[116:119], a[20:23], v[36:39]
    ds_read2_b32 v[82:83], v11 offset0:66 offset1:67
    v_mfma_f32_16x16x32_bf16 v[40:43], v[116:119], a[52:55], v[40:43]
    v_mfma_f32_16x16x32_bf16 v[44:47], v[116:119], a[84:87], v[44:47]
    ds_read2_b32 v[84:85], v11 offset0:80 offset1:81
    v_mfma_f32_16x16x32_bf16 v[36:39], v[120:123], a[24:27], v[36:39]
    ds_read2_b32 v[86:87], v11 offset0:82 offset1:83
    v_mfma_f32_16x16x32_bf16 v[40:43], v[120:123], a[56:59], v[40:43]
    ds_read2_b32 v[88:89], v11 offset0:96 offset1:97
    v_mfma_f32_16x16x32_bf16 v[44:47], v[120:123], a[88:91], v[44:47]
    v_mfma_f32_16x16x32_bf16 v[36:39], v[124:127], a[28:31], v[36:39]
    ds_read2_b32 v[90:91], v11 offset0:98 offset1:99
    v_mfma_f32_16x16x32_bf16 v[40:43], v[124:127], a[60:63], v[40:43]
    ds_read2_b32 v[92:93], v11 offset0:112 offset1:113
    v_mfma_f32_16x16x32_bf16 v[44:47], v[124:127], a[92:95], v[44:47]
    ds_read2_b32 v[94:95], v11 offset0:114 offset1:115
    s_waitcnt lgkmcnt(9)
    s_mov_b32 s28, 2621440
    buffer_store_dwordx2 v[50:51], v206, s[56:59], s28 offen
    v_mfma_f32_16x16x32_bf16 v[40:43], v[64:67], a[0:3], v[40:43]
    v_mfma_f32_16x16x32_bf16 v[44:47], v[64:67], a[32:35], v[44:47]
    v_mfma_f32_16x16x32_bf16 v[40:43], v[68:71], a[4:7], v[40:43]
    v_mfma_f32_16x16x32_bf16 v[44:47], v[68:71], a[36:39], v[44:47]
    v_mfma_f32_16x16x32_bf16 v[40:43], v[72:75], a[8:11], v[40:43]
    v_cvt_pk_bf16_f32 v48, v36, v37
    v_cvt_pk_bf16_f32 v49, v38, v39
    ds_write_b64 v216, v[48:49] offset:2304
    v_mfma_f32_16x16x32_bf16 v[44:47], v[72:75], a[40:43], v[44:47]
    v_add_u32 v11, 3584, v214
    ds_read2_b32 v[96:97], v11 offset0:0 offset1:1
    s_waitcnt lgkmcnt(10)
    v_mfma_f32_16x16x32_bf16 v[40:43], v[76:79], a[12:15], v[40:43]
    ds_read2_b32 v[98:99], v11 offset0:2 offset1:3
    ds_read2_b32 v[100:101], v11 offset0:16 offset1:17
    ds_read2_b32 v[102:103], v11 offset0:18 offset1:19
    v_mfma_f32_16x16x32_bf16 v[44:47], v[76:79], a[44:47], v[44:47]
    ds_read2_b32 v[104:105], v11 offset0:32 offset1:33
    ds_read2_b32 v[106:107], v11 offset0:34 offset1:35
    ds_read2_b32 v[108:109], v11 offset0:48 offset1:49
    s_waitcnt lgkmcnt(7)
    s_barrier
    ds_read_b64_tr_b16 v[52:53], v217 offset:2304
    v_mfma_f32_16x16x32_bf16 v[40:43], v[80:83], a[16:19], v[40:43]
    ds_read2_b32 v[110:111], v11 offset0:50 offset1:51
    v_mfma_f32_16x16x32_bf16 v[44:47], v[80:83], a[48:51], v[44:47]
    ds_read2_b32 v[112:113], v11 offset0:64 offset1:65
    v_mfma_f32_16x16x32_bf16 v[40:43], v[84:87], a[20:23], v[40:43]
    ds_read2_b32 v[114:115], v11 offset0:66 offset1:67
    v_mfma_f32_16x16x32_bf16 v[44:47], v[84:87], a[52:55], v[44:47]
    ds_read2_b32 v[116:117], v11 offset0:80 offset1:81
    v_mfma_f32_16x16x32_bf16 v[40:43], v[88:91], a[24:27], v[40:43]
    ds_read2_b32 v[118:119], v11 offset0:82 offset1:83
    v_mfma_f32_16x16x32_bf16 v[44:47], v[88:91], a[56:59], v[44:47]
    ds_read2_b32 v[120:121], v11 offset0:96 offset1:97
    v_mfma_f32_16x16x32_bf16 v[40:43], v[92:95], a[28:31], v[40:43]
    ds_read2_b32 v[122:123], v11 offset0:98 offset1:99
    v_mfma_f32_16x16x32_bf16 v[44:47], v[92:95], a[60:63], v[44:47]
    ds_read2_b32 v[124:125], v11 offset0:112 offset1:113
    ds_read2_b32 v[126:127], v11 offset0:114 offset1:115
    s_waitcnt lgkmcnt(9)
    s_mov_b32 s28, 3276800
    buffer_store_dwordx2 v[52:53], v206, s[56:59], s28 offen
    v_mfma_f32_16x16x32_bf16 v[44:47], v[96:99], a[0:3], v[44:47]
    v_mfma_f32_16x16x32_bf16 v[44:47], v[100:103], a[4:7], v[44:47]
    v_mfma_f32_16x16x32_bf16 v[44:47], v[104:107], a[8:11], v[44:47]
    s_waitcnt lgkmcnt(8)
    v_mfma_f32_16x16x32_bf16 v[44:47], v[108:111], a[12:15], v[44:47]
    s_waitcnt lgkmcnt(6)
    v_mfma_f32_16x16x32_bf16 v[44:47], v[112:115], a[16:19], v[44:47]
    s_nop 2
    v_cvt_pk_bf16_f32 v48, v40, v41
    v_cvt_pk_bf16_f32 v49, v42, v43
    ds_write_b64 v216, v[48:49] offset:0
    s_waitcnt lgkmcnt(0)
    s_barrier
    ds_read_b64_tr_b16 v[50:51], v217 offset:0
    v_mfma_f32_16x16x32_bf16 v[44:47], v[116:119], a[20:23], v[44:47]
    v_mfma_f32_16x16x32_bf16 v[44:47], v[120:123], a[24:27], v[44:47]
    v_mfma_f32_16x16x32_bf16 v[44:47], v[124:127], a[28:31], v[44:47]
    s_waitcnt lgkmcnt(0)
    s_mov_b32 s28, 3932160
    buffer_store_dwordx2 v[50:51], v206, s[56:59], s28 offen
    s_nop 7
    v_cvt_pk_bf16_f32 v48, v44, v45
    v_cvt_pk_bf16_f32 v49, v46, v47
    ds_write_b64 v216, v[48:49] offset:2304
    s_waitcnt lgkmcnt(0)
    s_barrier
    ds_read_b64_tr_b16 v[52:53], v217 offset:2304
    s_waitcnt lgkmcnt(0)
    s_mov_b32 s28, 4587520
    buffer_store_dwordx2 v[52:53], v206, s[56:59], s28 offen
    s_endpgm
mg_bback:
    s_mov_b32 s60, s22
    s_sub_u32 s61, s22, 20
    s_add_u32 s62, s61, 12
    s_cmp_lt_u32 s62, 20
    s_cselect_b32 s63, 3, 2
    s_cselect_b32 s62, s62, s61
    s_add_u32 m0, s32, 16704
    s_mov_b32 s38, 655360
    buffer_load_dwordx4 v202, s[40:43], s38 offen lds
    s_add_u32 m0, s32, 20800
    s_nop 0
    buffer_load_dwordx4 v203, s[40:43], s38 offen lds
    s_add_u32 s39, s32, 24896
    s_cmp_lt_u32 s20, 2
    s_cselect_b32 m0, s39, 160000
    s_nop 0
    buffer_load_dwordx4 v204, s[40:43], s38 offen lds
    s_add_u32 m0, s32, 26944
    s_mov_b32 s38, 737280
    buffer_load_dwordx4 v202, s[40:43], s38 offen lds
    s_add_u32 m0, s32, 31040
    s_nop 0
    buffer_load_dwordx4 v203, s[40:43], s38 offen lds
    s_add_u32 s39, s32, 35136
    s_cmp_lt_u32 s20, 2
    s_cselect_b32 m0, s39, 160000
    s_nop 0
    buffer_load_dwordx4 v204, s[40:43], s38 offen lds
    s_add_u32 s44, s4, 17825792
    s_addc_u32 s45, s5, 0
    s_mov_b32 s46, 4096
    s_mov_b32 s47, 0x20000
    s_cmp_lg_u32 s20, 0
    s_cbranch_scc1 mg_o_np
    v_mov_b32 v14, s60
    v_and_b32 v12, 7, v1
    v_lshlrev_b32 v12, 2, v12
    v_lshl_add_u32 v12, v14, 7, v12
    s_mov_b32 s35, 262144
    s_mov_b64 exec, 0xff
mg_o_p:
    buffer_load_dword v13, v12, s[44:47], 0 offen sc1
    s_waitcnt vmcnt(0)
    v_cmp_ne_u32 vcc, 0, v13
    s_sub_u32 s35, s35, 1
    s_cmp_eq_u32 s35, 0
    s_cbranch_scc1 mg_o_d
    s_cmp_eq_u32 vcc_lo, 0xff
    s_cbranch_scc1 mg_o_d
    s_branch mg_o_p
mg_o_d:
    s_mov_b64 exec, -1
mg_o_np:
    s_waitcnt vmcnt(0)
    s_barrier
    s_add_u32 s8, s4, 4194304
    s_addc_u32 s9, s5, 0
    s_mov_b32 s10, 2621440
    s_mov_b32 s11, 0x20000
    s_mov_b32 s16, s92
    s_mov_b32 s17, s93
    s_mov_b32 s18, 5242880
    s_mov_b32 s19, 0x20000
    s_lshl_b32 s21, s60, 2
    s_add_u32 s21, s21, s20
    s_mul_i32 s56, s21, 20480
    s_lshl_b32 s21, s61, 2
    s_add_u32 s21, s21, s20
    s_mul_i32 s57, s21, 20480
    s_lshl_b32 s21, s62, 2
    s_add_u32 s21, s21, s20
    s_mul_i32 s58, s21, 20480
    s_mul_i32 s55, s23, 160
    s_add_u32 s55, s55, 1280
    s_add_u32 s36, s56, 0
    buffer_load_dwordx4 a[0:3], v4, s[8:11], s36 offen
    s_add_u32 s36, s56, 1024
    buffer_load_dwordx4 a[4:7], v4, s[8:11], s36 offen
    s_add_u32 s36, s56, 2048
    buffer_load_dwordx4 a[8:11], v4, s[8:11], s36 offen
    s_add_u32 s36, s56, 3072
    buffer_load_dwordx4 a[12:15], v4, s[8:11], s36 offen
    s_add_u32 s36, s56, 4096
    buffer_load_dwordx4 a[16:19], v4, s[8:11], s36 offen
    s_add_u32 s36, s56, 5120
    buffer_load_dwordx4 a[20:23], v4, s[8:11], s36 offen
    s_add_u32 s36, s56, 6144
    buffer_load_dwordx4 a[24:27], v4, s[8:11], s36 offen
    s_add_u32 s36, s56, 7168
    buffer_load_dwordx4 a[28:31], v4, s[8:11], s36 offen
    ds_read_b64_tr_b16 v[56:57], v235 offset:8192
    ds_read_b64_tr_b16 v[58:59], v235 offset:9472
    ds_read_b64_tr_b16 v[60:61], v235 offset:8224
    ds_read_b64_tr_b16 v[62:63], v235 offset:9504
    ds_read_b64_tr_b16 v[64:65], v235 offset:8256
    ds_read_b64_tr_b16 v[66:67], v235 offset:9536
    ds_read_b64_tr_b16 v[68:69], v235 offset:8288
    ds_read_b64_tr_b16 v[70:71], v235 offset:9568
    ds_read_b64_tr_b16 v[72:73], v235 offset:8320
    ds_read_b64_tr_b16 v[74:75], v235 offset:9600
    s_waitcnt vmcnt(7)
    s_waitcnt lgkmcnt(4)
    v_mfma_f32_16x16x32_bf16 v[16:19], v[56:59], a[0:3], 0
    s_add_u32 s36, s56, 8192
    buffer_load_dwordx4 a[32:35], v4, s[8:11], s36 offen
    ds_read_b64_tr_b16 v[56:57], v235 offset:13312
    ds_read_b64_tr_b16 v[58:59], v235 offset:14592
    v_mfma_f32_16x16x32_bf16 v[20:23], v[60:63], a[0:3], 0
    ds_read_b64_tr_b16 v[60:61], v235 offset:13344
    ds_read_b64_tr_b16 v[62:63], v235 offset:14624
    v_mfma_f32_16x16x32_bf16 v[24:27], v[64:67], a[0:3], 0
    ds_read_b64_tr_b16 v[64:65], v235 offset:13376
    ds_read_b64_tr_b16 v[66:67], v235 offset:14656
    s_waitcnt lgkmcnt(6)
    v_mfma_f32_16x16x32_bf16 v[28:31], v[68:71], a[0:3], 0
    ds_read_b64_tr_b16 v[68:69], v235 offset:13408
    ds_read_b64_tr_b16 v[70:71], v235 offset:14688
    v_mfma_f32_16x16x32_bf16 v[32:35], v[72:75], a[0:3], 0
    ds_read_b64_tr_b16 v[72:73], v235 offset:13440
    ds_read_b64_tr_b16 v[74:75], v235 offset:14720
    s_waitcnt vmcnt(7)
    s_waitcnt lgkmcnt(4)
    v_mfma_f32_16x16x32_bf16 v[16:19], v[56:59], a[4:7], v[16:19]
    s_add_u32 s36, s56, 9216
    buffer_load_dwordx4 a[36:39], v4, s[8:11], s36 offen
    ds_read_b64_tr_b16 v[56:57], v235 offset:18432
    ds_read_b64_tr_b16 v[58:59], v235 offset:19712
    v_mfma_f32_16x16x32_bf16 v[20:23], v[60:63], a[4:7], v[20:23]
    ds_read_b64_tr_b16 v[60:61], v235 offset:18464
    ds_read_b64_tr_b16 v[62:63], v235 offset:19744
    v_mfma_f32_16x16x32_bf16 v[24:27], v[64:67], a[4:7], v[24:27]
    ds_read_b64_tr_b16 v[64:65], v235 offset:18496
    ds_read_b64_tr_b16 v[66:67], v235 offset:19776
    s_waitcnt lgkmcnt(6)
    v_mfma_f32_16x16x32_bf16 v[28:31], v[68:71], a[4:7], v[28:31]
    ds_read_b64_tr_b16 v[68:69], v235 offset:18528
    ds_read_b64_tr_b16 v[70:71], v235 offset:19808
    v_mfma_f32_16x16x32_bf16 v[32:35], v[72:75], a[4:7], v[32:35]
    ds_read_b64_tr_b16 v[72:73], v235 offset:18560
    ds_read_b64_tr_b16 v[74:75], v235 offset:19840
    s_waitcnt vmcnt(7)
    s_waitcnt lgkmcnt(4)
    v_mfma_f32_16x16x32_bf16 v[16:19], v[56:59], a[8:11], v[16:19]
    s_add_u32 s36, s56, 10240
    buffer_load_dwordx4 a[40:43], v4, s[8:11], s36 offen
    ds_read_b64_tr_b16 v[56:57], v235 offset:23552
    ds_read_b64_tr_b16 v[58:59], v235 offset:24832
    v_mfma_f32_16x16x32_bf16 v[20:23], v[60:63], a[8:11], v[20:23]
    ds_read_b64_tr_b16 v[60:61], v235 offset:23584
    ds_read_b64_tr_b16 v[62:63], v235 offset:24864
    v_mfma_f32_16x16x32_bf16 v[24:27], v[64:67], a[8:11], v[24:27]
    ds_read_b64_tr_b16 v[64:65], v235 offset:23616
    ds_read_b64_tr_b16 v[66:67], v235 offset:24896
    s_waitcnt lgkmcnt(6)
    v_mfma_f32_16x16x32_bf16 v[28:31], v[68:71], a[8:11], v[28:31]
    ds_read_b64_tr_b16 v[68:69], v235 offset:23648
    ds_read_b64_tr_b16 v[70:71], v235 offset:24928
    v_mfma_f32_16x16x32_bf16 v[32:35], v[72:75], a[8:11], v[32:35]
    ds_read_b64_tr_b16 v[72:73], v235 offset:23680
    ds_read_b64_tr_b16 v[74:75], v235 offset:24960
    s_waitcnt vmcnt(7)
    s_waitcnt lgkmcnt(4)
    v_mfma_f32_16x16x32_bf16 v[16:19], v[56:59], a[12:15], v[16:19]
    s_add_u32 s36, s56, 11264
    buffer_load_dwordx4 a[44:47], v4, s[8:11], s36 offen
    ds_read_b64_tr_b16 v[56:57], v235 offset:28672
    ds_read_b64_tr_b16 v[58:59], v235 offset:29952
    v_mfma_f32_16x16x32_bf16 v[20:23], v[60:63], a[12:15], v[20:23]
    ds_read_b64_tr_b16 v[60:61], v235 offset:28704
    ds_read_b64_tr_b16 v[62:63], v235 offset:29984
    v_mfma_f32_16x16x32_bf16 v[24:27], v[64:67], a[12:15], v[24:27]
    ds_read_b64_tr_b16 v[64:65], v235 offset:28736
    ds_read_b64_tr_b16 v[66:67], v235 offset:30016
    s_waitcnt lgkmcnt(6)
    v_mfma_f32_16x16x32_bf16 v[28:31], v[68:71], a[12:15], v[28:31]
    ds_read_b64_tr_b16 v[68:69], v235 offset:28768
    ds_read_b64_tr_b16 v[70:71], v235 offset:30048
    v_mfma_f32_16x16x32_bf16 v[32:35], v[72:75], a[12:15], v[32:35]
    ds_read_b64_tr_b16 v[72:73], v235 offset:28800
    ds_read_b64_tr_b16 v[74:75], v235 offset:30080
    s_waitcnt vmcnt(7)
    s_waitcnt lgkmcnt(4)
    v_mfma_f32_16x16x32_bf16 v[16:19], v[56:59], a[16:19], v[16:19]
    s_add_u32 s36, s56, 12288
    buffer_load_dwordx4 a[48:51], v4, s[8:11], s36 offen
    ds_read_b64_tr_b16 v[56:57], v235 offset:33792
    ds_read_b64_tr_b16 v[58:59], v235 offset:35072
    v_mfma_f32_16x16x32_bf16 v[20:23], v[60:63], a[16:19], v[20:23]
    ds_read_b64_tr_b16 v[60:61], v235 offset:33824
    ds_read_b64_tr_b16 v[62:63], v235 offset:35104
    v_mfma_f32_16x16x32_bf16 v[24:27], v[64:67], a[16:19], v[24:27]
    ds_read_b64_tr_b16 v[64:65], v235 offset:33856
    ds_read_b64_tr_b16 v[66:67], v235 offset:35136
    s_waitcnt lgkmcnt(6)
    v_mfma_f32_16x16x32_bf16 v[28:31], v[68:71], a[16:19], v[28:31]
    ds_read_b64_tr_b16 v[68:69], v235 offset:33888
    ds_read_b64_tr_b16 v[70:71], v235 offset:35168
    v_mfma_f32_16x16x32_bf16 v[32:35], v[72:75], a[16:19], v[32:35]
    ds_read_b64_tr_b16 v[72:73], v235 offset:33920
    ds_read_b64_tr_b16 v[74:75], v235 offset:35200
    s_waitcnt vmcnt(7)
    s_waitcnt lgkmcnt(4)
    v_mfma_f32_16x16x32_bf16 v[16:19], v[56:59], a[20:23], v[16:19]
    s_add_u32 s36, s56, 13312
    buffer_load_dwordx4 a[52:55], v4, s[8:11], s36 offen
    ds_read_b64_tr_b16 v[56:57], v235 offset:38912
    ds_read_b64_tr_b16 v[58:59], v235 offset:40192
    v_mfma_f32_16x16x32_bf16 v[20:23], v[60:63], a[20:23], v[20:23]
    ds_read_b64_tr_b16 v[60:61], v235 offset:38944
    ds_read_b64_tr_b16 v[62:63], v235 offset:40224
    v_mfma_f32_16x16x32_bf16 v[24:27], v[64:67], a[20:23], v[24:27]
    ds_read_b64_tr_b16 v[64:65], v235 offset:38976
    ds_read_b64_tr_b16 v[66:67], v235 offset:40256
    s_waitcnt lgkmcnt(6)
    v_mfma_f32_16x16x32_bf16 v[28:31], v[68:71], a[20:23], v[28:31]
    ds_read_b64_tr_b16 v[68:69], v235 offset:39008
    ds_read_b64_tr_b16 v[70:71], v235 offset:40288
    v_mfma_f32_16x16x32_bf16 v[32:35], v[72:75], a[20:23], v[32:35]
    ds_read_b64_tr_b16 v[72:73], v235 offset:39040
    ds_read_b64_tr_b16 v[74:75], v235 offset:40320
    s_waitcnt vmcnt(7)
    s_waitcnt lgkmcnt(4)
    v_mfma_f32_16x16x32_bf16 v[16:19], v[56:59], a[24:27], v[16:19]
    s_add_u32 s36, s56, 14336
    buffer_load_dwordx4 a[56:59], v4, s[8:11], s36 offen
    ds_read_b64_tr_b16 v[56:57], v235 offset:44032
    ds_read_b64_tr_b16 v[58:59], v235 offset:45312
    v_mfma_f32_16x16x32_bf16 v[20:23], v[60:63], a[24:27], v[20:23]
    ds_read_b64_tr_b16 v[60:61], v235 offset:44064
    ds_read_b64_tr_b16 v[62:63], v235 offset:45344
    v_mfma_f32_16x16x32_bf16 v[24:27], v[64:67], a[24:27], v[24:27]
    ds_read_b64_tr_b16 v[64:65], v235 offset:44096
    ds_read_b64_tr_b16 v[66:67], v235 offset:45376
    s_waitcnt lgkmcnt(6)
    v_mfma_f32_16x16x32_bf16 v[28:31], v[68:71], a[24:27], v[28:31]
    ds_read_b64_tr_b16 v[68:69], v235 offset:44128
    ds_read_b64_tr_b16 v[70:71], v235 offset:45408
    v_mfma_f32_16x16x32_bf16 v[32:35], v[72:75], a[24:27], v[32:35]
    ds_read_b64_tr_b16 v[72:73], v235 offset:44160
    ds_read_b64_tr_b16 v[74:75], v235 offset:45440
    s_waitcnt vmcnt(7)
    s_waitcnt lgkmcnt(4)
    v_mfma_f32_16x16x32_bf16 v[16:19], v[56:59], a[28:31], v[16:19]
    s_add_u32 s36, s56, 15360
    buffer_load_dwordx4 a[60:63], v4, s[8:11], s36 offen
    ds_read_b64_tr_b16 v[56:57], v235 offset:49152
    ds_read_b64_tr_b16 v[58:59], v235 offset:50432
    v_mfma_f32_16x16x32_bf16 v[20:23], v[60:63], a[28:31], v[20:23]
    ds_read_b64_tr_b16 v[60:61], v235 offset:49184
    ds_read_b64_tr_b16 v[62:63], v235 offset:50464
    v_mfma_f32_16x16x32_bf16 v[24:27], v[64:67], a[28:31], v[24:27]
    ds_read_b64_tr_b16 v[64:65], v235 offset:49216
    ds_read_b64_tr_b16 v[66:67], v235 offset:50496
    s_waitcnt lgkmcnt(6)
    v_mfma_f32_16x16x32_bf16 v[28:31], v[68:71], a[28:31], v[28:31]
    ds_read_b64_tr_b16 v[68:69], v235 offset:49248
    ds_read_b64_tr_b16 v[70:71], v235 offset:50528
    v_mfma_f32_16x16x32_bf16 v[32:35], v[72:75], a[28:31], v[32:35]
    ds_read_b64_tr_b16 v[72:73], v235 offset:49280
    ds_read_b64_tr_b16 v[74:75], v235 offset:50560
    s_waitcnt vmcnt(7)
    s_waitcnt lgkmcnt(4)
    v_mfma_f32_16x16x32_bf16 v[16:19], v[56:59], a[32:35], v[16:19]
    s_add_u32 s36, s56, 16384
    buffer_load_dwordx4 a[64:67], v4, s[8:11], s36 offen
    ds_read_b64_tr_b16 v[56:57], v235 offset:54272
    ds_read_b64_tr_b16 v[58:59], v235 offset:55552
    v_mfma_f32_16x16x32_bf16 v[20:23], v[60:63], a[32:35], v[20:23]
    ds_read_b64_tr_b16 v[60:61], v235 offset:54304
    ds_read_b64_tr_b16 v[62:63], v235 offset:55584
    v_mfma_f32_16x16x32_bf16 v[24:27], v[64:67], a[32:35], v[24:27]
    ds_read_b64_tr_b16 v[64:65], v235 offset:54336
    ds_read_b64_tr_b16 v[66:67], v235 offset:55616
    s_waitcnt lgkmcnt(6)
    v_mfma_f32_16x16x32_bf16 v[28:31], v[68:71], a[32:35], v[28:31]
    ds_read_b64_tr_b16 v[68:69], v235 offset:54368
    ds_read_b64_tr_b16 v[70:71], v235 offset:55648
    v_mfma_f32_16x16x32_bf16 v[32:35], v[72:75], a[32:35], v[32:35]
    ds_read_b64_tr_b16 v[72:73], v235 offset:54400
    ds_read_b64_tr_b16 v[74:75], v235 offset:55680
    s_waitcnt vmcnt(7)
    s_waitcnt lgkmcnt(4)
    v_mfma_f32_16x16x32_bf16 v[16:19], v[56:59], a[36:39], v[16:19]
    s_add_u32 s36, s56, 17408
    buffer_load_dwordx4 a[68:71], v4, s[8:11], s36 offen
    ds_read_b64_tr_b16 v[56:57], v235 offset:59392
    ds_read_b64_tr_b16 v[58:59], v235 offset:60672
    v_mfma_f32_16x16x32_bf16 v[20:23], v[60:63], a[36:39], v[20:23]
    ds_read_b64_tr_b16 v[60:61], v235 offset:59424
    ds_read_b64_tr_b16 v[62:63], v235 offset:60704
    v_mfma_f32_16x16x32_bf16 v[24:27], v[64:67], a[36:39], v[24:27]
    ds_read_b64_tr_b16 v[64:65], v235 offset:59456
    ds_read_b64_tr_b16 v[66:67], v235 offset:60736
    s_waitcnt lgkmcnt(6)
    v_mfma_f32_16x16x32_bf16 v[28:31], v[68:71], a[36:39], v[28:31]
    ds_read_b64_tr_b16 v[68:69], v235 offset:59488
    ds_read_b64_tr_b16 v[70:71], v235 offset:60768
    v_mfma_f32_16x16x32_bf16 v[32:35], v[72:75], a[36:39], v[32:35]
    ds_read_b64_tr_b16 v[72:73], v235 offset:59520
    ds_read_b64_tr_b16 v[74:75], v235 offset:60800
    s_waitcnt vmcnt(7)
    s_waitcnt lgkmcnt(4)
    v_mfma_f32_16x16x32_bf16 v[16:19], v[56:59], a[40:43], v[16:19]
    s_add_u32 s36, s56, 18432
    buffer_load_dwordx4 a[72:75], v4, s[8:11], s36 offen
    ds_read_b64_tr_b16 v[56:57], v235 offset:64512
    ds_read_b64_tr_b16 v[58:59], v236 offset:256
    v_mfma_f32_16x16x32_bf16 v[20:23], v[60:63], a[40:43], v[20:23]
    ds_read_b64_tr_b16 v[60:61], v235 offset:64544
    ds_read_b64_tr_b16 v[62:63], v236 offset:288
    v_mfma_f32_16x16x32_bf16 v[24:27], v[64:67], a[40:43], v[24:27]
    ds_read_b64_tr_b16 v[64:65], v235 offset:64576
    ds_read_b64_tr_b16 v[66:67], v236 offset:320
    s_waitcnt lgkmcnt(6)
    v_mfma_f32_16x16x32_bf16 v[28:31], v[68:71], a[40:43], v[28:31]
    ds_read_b64_tr_b16 v[68:69], v235 offset:64608
    ds_read_b64_tr_b16 v[70:71], v236 offset:352
    v_mfma_f32_16x16x32_bf16 v[32:35], v[72:75], a[40:43], v[32:35]
    ds_read_b64_tr_b16 v[72:73], v235 offset:64640
    ds_read_b64_tr_b16 v[74:75], v236 offset:384
    s_waitcnt vmcnt(7)
    s_waitcnt lgkmcnt(4)
    v_mfma_f32_16x16x32_bf16 v[16:19], v[56:59], a[44:47], v[16:19]
    s_add_u32 s36, s56, 19456
    buffer_load_dwordx4 a[76:79], v4, s[8:11], s36 offen
    ds_read_b64_tr_b16 v[56:57], v236 offset:4096
    ds_read_b64_tr_b16 v[58:59], v236 offset:5376
    v_mfma_f32_16x16x32_bf16 v[20:23], v[60:63], a[44:47], v[20:23]
    ds_read_b64_tr_b16 v[60:61], v236 offset:4128
    ds_read_b64_tr_b16 v[62:63], v236 offset:5408
    v_mfma_f32_16x16x32_bf16 v[24:27], v[64:67], a[44:47], v[24:27]
    ds_read_b64_tr_b16 v[64:65], v236 offset:4160
    ds_read_b64_tr_b16 v[66:67], v236 offset:5440
    s_waitcnt lgkmcnt(6)
    v_mfma_f32_16x16x32_bf16 v[28:31], v[68:71], a[44:47], v[28:31]
    ds_read_b64_tr_b16 v[68:69], v236 offset:4192
    ds_read_b64_tr_b16 v[70:71], v236 offset:5472
    v_mfma_f32_16x16x32_bf16 v[32:35], v[72:75], a[44:47], v[32:35]
    ds_read_b64_tr_b16 v[72:73], v236 offset:4224
    ds_read_b64_tr_b16 v[74:75], v236 offset:5504
    s_waitcnt vmcnt(7)
    s_waitcnt lgkmcnt(4)
    v_mfma_f32_16x16x32_bf16 v[16:19], v[56:59], a[48:51], v[16:19]
    ds_read_b64_tr_b16 v[56:57], v236 offset:9216
    ds_read_b64_tr_b16 v[58:59], v236 offset:10496
    v_mfma_f32_16x16x32_bf16 v[20:23], v[60:63], a[48:51], v[20:23]
    ds_read_b64_tr_b16 v[60:61], v236 offset:9248
    ds_read_b64_tr_b16 v[62:63], v236 offset:10528
    v_mfma_f32_16x16x32_bf16 v[24:27], v[64:67], a[48:51], v[24:27]
    ds_read_b64_tr_b16 v[64:65], v236 offset:9280
    ds_read_b64_tr_b16 v[66:67], v236 offset:10560
    s_waitcnt lgkmcnt(6)
    v_mfma_f32_16x16x32_bf16 v[28:31], v[68:71], a[48:51], v[28:31]
    ds_read_b64_tr_b16 v[68:69], v236 offset:9312
    ds_read_b64_tr_b16 v[70:71], v236 offset:10592
    v_mfma_f32_16x16x32_bf16 v[32:35], v[72:75], a[48:51], v[32:35]
    ds_read_b64_tr_b16 v[72:73], v236 offset:9344
    ds_read_b64_tr_b16 v[74:75], v236 offset:10624
    s_waitcnt vmcnt(6)
    s_waitcnt lgkmcnt(4)
    v_mfma_f32_16x16x32_bf16 v[16:19], v[56:59], a[52:55], v[16:19]
    ds_read_b64_tr_b16 v[56:57], v236 offset:14336
    ds_read_b64_tr_b16 v[58:59], v236 offset:15616
    v_mfma_f32_16x16x32_bf16 v[20:23], v[60:63], a[52:55], v[20:23]
    ds_read_b64_tr_b16 v[60:61], v236 offset:14368
    ds_read_b64_tr_b16 v[62:63], v236 offset:15648
    v_mfma_f32_16x16x32_bf16 v[24:27], v[64:67], a[52:55], v[24:27]
    ds_read_b64_tr_b16 v[64:65], v236 offset:14400
    ds_read_b64_tr_b16 v[66:67], v236 offset:15680
    s_waitcnt lgkmcnt(6)
    v_mfma_f32_16x16x32_bf16 v[28:31], v[68:71], a[52:55], v[28:31]
    ds_read_b64_tr_b16 v[68:69], v236 offset:14432
    ds_read_b64_tr_b16 v[70:71], v236 offset:15712
    v_mfma_f32_16x16x32_bf16 v[32:35], v[72:75], a[52:55], v[32:35]
    ds_read_b64_tr_b16 v[72:73], v236 offset:14464
    ds_read_b64_tr_b16 v[74:75], v236 offset:15744
    s_waitcnt vmcnt(5)
    s_waitcnt lgkmcnt(4)
    v_mfma_f32_16x16x32_bf16 v[16:19], v[56:59], a[56:59], v[16:19]
    ds_read_b64_tr_b16 v[56:57], v236 offset:19456
    ds_read_b64_tr_b16 v[58:59], v236 offset:20736
    v_mfma_f32_16x16x32_bf16 v[20:23], v[60:63], a[56:59], v[20:23]
    ds_read_b64_tr_b16 v[60:61], v236 offset:19488
    ds_read_b64_tr_b16 v[62:63], v236 offset:20768
    v_mfma_f32_16x16x32_bf16 v[24:27], v[64:67], a[56:59], v[24:27]
    ds_read_b64_tr_b16 v[64:65], v236 offset:19520
    ds_read_b64_tr_b16 v[66:67], v236 offset:20800
    s_waitcnt lgkmcnt(6)
    v_mfma_f32_16x16x32_bf16 v[28:31], v[68:71], a[56:59], v[28:31]
    ds_read_b64_tr_b16 v[68:69], v236 offset:19552
    ds_read_b64_tr_b16 v[70:71], v236 offset:20832
    v_mfma_f32_16x16x32_bf16 v[32:35], v[72:75], a[56:59], v[32:35]
    ds_read_b64_tr_b16 v[72:73], v236 offset:19584
    ds_read_b64_tr_b16 v[74:75], v236 offset:20864
    s_waitcnt vmcnt(4)
    s_waitcnt lgkmcnt(4)
    v_mfma_f32_16x16x32_bf16 v[16:19], v[56:59], a[60:63], v[16:19]
    ds_read_b64_tr_b16 v[56:57], v224 offset:16704
    ds_read_b64_tr_b16 v[58:59], v224 offset:17984
    v_mfma_f32_16x16x32_bf16 v[20:23], v[60:63], a[60:63], v[20:23]
    ds_read_b64_tr_b16 v[60:61], v224 offset:16736
    ds_read_b64_tr_b16 v[62:63], v224 offset:18016
    v_mfma_f32_16x16x32_bf16 v[24:27], v[64:67], a[60:63], v[24:27]
    ds_read_b64_tr_b16 v[64:65], v224 offset:16768
    ds_read_b64_tr_b16 v[66:67], v224 offset:18048
    s_waitcnt lgkmcnt(6)
    v_mfma_f32_16x16x32_bf16 v[28:31], v[68:71], a[60:63], v[28:31]
    ds_read_b64_tr_b16 v[68:69], v224 offset:16800
    ds_read_b64_tr_b16 v[70:71], v224 offset:18080
    v_mfma_f32_16x16x32_bf16 v[32:35], v[72:75], a[60:63], v[32:35]
    ds_read_b64_tr_b16 v[72:73], v224 offset:16832
    ds_read_b64_tr_b16 v[74:75], v224 offset:18112
    s_waitcnt vmcnt(3)
    s_waitcnt lgkmcnt(4)
    v_mfma_f32_16x16x32_bf16 v[16:19], v[56:59], a[64:67], v[16:19]
    ds_read_b64_tr_b16 v[56:57], v224 offset:21824
    ds_read_b64_tr_b16 v[58:59], v224 offset:23104
    v_mfma_f32_16x16x32_bf16 v[20:23], v[60:63], a[64:67], v[20:23]
    ds_read_b64_tr_b16 v[60:61], v224 offset:21856
    ds_read_b64_tr_b16 v[62:63], v224 offset:23136
    v_mfma_f32_16x16x32_bf16 v[24:27], v[64:67], a[64:67], v[24:27]
    ds_read_b64_tr_b16 v[64:65], v224 offset:21888
    ds_read_b64_tr_b16 v[66:67], v224 offset:23168
    s_waitcnt lgkmcnt(6)
    v_mfma_f32_16x16x32_bf16 v[28:31], v[68:71], a[64:67], v[28:31]
    ds_read_b64_tr_b16 v[68:69], v224 offset:21920
    ds_read_b64_tr_b16 v[70:71], v224 offset:23200
    v_mfma_f32_16x16x32_bf16 v[32:35], v[72:75], a[64:67], v[32:35]
    ds_read_b64_tr_b16 v[72:73], v224 offset:21952
    ds_read_b64_tr_b16 v[74:75], v224 offset:23232
    s_waitcnt vmcnt(2)
    s_waitcnt lgkmcnt(4)
    v_mfma_f32_16x16x32_bf16 v[16:19], v[56:59], a[68:71], v[16:19]
    ds_read_b64_tr_b16 v[56:57], v224 offset:26944
    ds_read_b64_tr_b16 v[58:59], v224 offset:28224
    v_mfma_f32_16x16x32_bf16 v[20:23], v[60:63], a[68:71], v[20:23]
    ds_read_b64_tr_b16 v[60:61], v224 offset:26976
    ds_read_b64_tr_b16 v[62:63], v224 offset:28256
    v_mfma_f32_16x16x32_bf16 v[24:27], v[64:67], a[68:71], v[24:27]
    ds_read_b64_tr_b16 v[64:65], v224 offset:27008
    ds_read_b64_tr_b16 v[66:67], v224 offset:28288
    s_waitcnt lgkmcnt(6)
    v_mfma_f32_16x16x32_bf16 v[28:31], v[68:71], a[68:71], v[28:31]
    ds_read_b64_tr_b16 v[68:69], v224 offset:27040
    ds_read_b64_tr_b16 v[70:71], v224 offset:28320
    v_mfma_f32_16x16x32_bf16 v[32:35], v[72:75], a[68:71], v[32:35]
    ds_read_b64_tr_b16 v[72:73], v224 offset:27072
    ds_read_b64_tr_b16 v[74:75], v224 offset:28352
    s_waitcnt vmcnt(1)
    s_waitcnt lgkmcnt(4)
    v_mfma_f32_16x16x32_bf16 v[16:19], v[56:59], a[72:75], v[16:19]
    ds_read_b64_tr_b16 v[56:57], v224 offset:32064
    ds_read_b64_tr_b16 v[58:59], v224 offset:33344
    v_mfma_f32_16x16x32_bf16 v[20:23], v[60:63], a[72:75], v[20:23]
    ds_read_b64_tr_b16 v[60:61], v224 offset:32096
    ds_read_b64_tr_b16 v[62:63], v224 offset:33376
    v_mfma_f32_16x16x32_bf16 v[24:27], v[64:67], a[72:75], v[24:27]
    ds_read_b64_tr_b16 v[64:65], v224 offset:32128
    ds_read_b64_tr_b16 v[66:67], v224 offset:33408
    s_waitcnt lgkmcnt(6)
    v_mfma_f32_16x16x32_bf16 v[28:31], v[68:71], a[72:75], v[28:31]
    ds_read_b64_tr_b16 v[68:69], v224 offset:32160
    ds_read_b64_tr_b16 v[70:71], v224 offset:33440
    v_mfma_f32_16x16x32_bf16 v[32:35], v[72:75], a[72:75], v[32:35]
    ds_read_b64_tr_b16 v[72:73], v224 offset:32192
    ds_read_b64_tr_b16 v[74:75], v224 offset:33472
    s_waitcnt vmcnt(0)
    s_waitcnt lgkmcnt(4)
    v_mfma_f32_16x16x32_bf16 v[16:19], v[56:59], a[76:79], v[16:19]
    v_mfma_f32_16x16x32_bf16 v[20:23], v[60:63], a[76:79], v[20:23]
    v_mfma_f32_16x16x32_bf16 v[24:27], v[64:67], a[76:79], v[24:27]
    s_waitcnt lgkmcnt(0)
    v_mfma_f32_16x16x32_bf16 v[28:31], v[68:71], a[76:79], v[28:31]
    v_mfma_f32_16x16x32_bf16 v[32:35], v[72:75], a[76:79], v[32:35]
    s_nop 7
    v_cvt_pk_bf16_f32 v92, v16, v17
    v_cvt_pk_bf16_f32 v93, v18, v19
    v_cvt_pk_bf16_f32 v94, v20, v21
    v_cvt_pk_bf16_f32 v95, v22, v23
    v_cvt_pk_bf16_f32 v96, v24, v25
    v_cvt_pk_bf16_f32 v97, v26, v27
    v_cvt_pk_bf16_f32 v98, v28, v29
    v_cvt_pk_bf16_f32 v99, v30, v31
    v_cvt_pk_bf16_f32 v100, v32, v33
    v_cvt_pk_bf16_f32 v101, v34, v35
    s_mul_i32 s21, s60, 163840
    s_add_u32 s21, s21, s55
    v_permlane16_swap_b32 v92, v94
    v_permlane16_swap_b32 v93, v95
    v_permlane16_swap_b32 v96, v98
    v_permlane16_swap_b32 v97, v99
    buffer_store_dwordx4 v[92:95], v245, s[16:19], s21 offen
    buffer_store_dwordx4 v[96:99], v245, s[16:19], s21 offen offset:64
    buffer_store_dwordx2 v[100:101], v205, s[16:19], s21 offen offset:128
    s_cmp_lg_u32 s20, 0
    s_cbranch_scc1 mg_o2_np
    v_mov_b32 v14, s61
    v_lshrrev_b32 v13, 3, v1
    v_cmp_eq_u32 vcc, 1, v13
    v_mov_b32 v15, s62
    s_nop 0
    v_cndmask_b32 v14, v14, v15, vcc
    v_and_b32 v12, 7, v1
    v_lshlrev_b32 v12, 2, v12
    v_lshl_add_u32 v12, v14, 7, v12
    s_mov_b32 s35, 262144
    s_mov_b64 exec, 0xffff
mg_o2_p:
    buffer_load_dword v13, v12, s[44:47], 0 offen sc1
    s_waitcnt vmcnt(0)
    v_cmp_ne_u32 vcc, 0, v13
    s_sub_u32 s35, s35, 1
    s_cmp_eq_u32 s35, 0
    s_cbranch_scc1 mg_o2_d
    s_cmp_eq_u32 vcc_lo, 0xffff
    s_cbranch_scc1 mg_o2_d
    s_branch mg_o2_p
mg_o2_d:
    s_mov_b64 exec, -1
mg_o2_np:
    s_waitcnt vmcnt(0)
    s_barrier
    s_cmp_eq_u32 s63, 2
    s_cbranch_scc1 mg_b2
    s_add_u32 s36, s57, 0
    buffer_load_dwordx4 a[0:3], v4, s[8:11], s36 offen
    s_add_u32 s36, s58, 0
    buffer_load_dwordx4 a[80:83], v4, s[8:11], s36 offen
    s_add_u32 s36, s57, 1024
    buffer_load_dwordx4 a[4:7], v4, s[8:11], s36 offen
    s_add_u32 s36, s58, 1024
    buffer_load_dwordx4 a[84:87], v4, s[8:11], s36 offen
    s_add_u32 s36, s57, 2048
    buffer_load_dwordx4 a[8:11], v4, s[8:11], s36 offen
    s_add_u32 s36, s58, 2048
    buffer_load_dwordx4 a[88:91], v4, s[8:11], s36 offen
    s_add_u32 s36, s57, 3072
    buffer_load_dwordx4 a[12:15], v4, s[8:11], s36 offen
    s_add_u32 s36, s58, 3072
    buffer_load_dwordx4 a[92:95], v4, s[8:11], s36 offen
    s_add_u32 s36, s57, 4096
    buffer_load_dwordx4 a[16:19], v4, s[8:11], s36 offen
    s_add_u32 s36, s58, 4096
    buffer_load_dwordx4 a[96:99], v4, s[8:11], s36 offen
    s_add_u32 s36, s57, 5120
    buffer_load_dwordx4 a[20:23], v4, s[8:11], s36 offen
    s_add_u32 s36, s58, 5120
    buffer_load_dwordx4 a[100:103], v4, s[8:11], s36 offen
    s_add_u32 s36, s57, 6144
    buffer_load_dwordx4 a[24:27], v4, s[8:11], s36 offen
    s_add_u32 s36, s58, 6144
    buffer_load_dwordx4 a[104:107], v4, s[8:11], s36 offen
    s_add_u32 s36, s57, 7168
    buffer_load_dwordx4 a[28:31], v4, s[8:11], s36 offen
    s_add_u32 s36, s58, 7168
    buffer_load_dwordx4 a[108:111], v4, s[8:11], s36 offen
    ds_read_b64_tr_b16 v[56:57], v235 offset:8192
    ds_read_b64_tr_b16 v[58:59], v235 offset:9472
    ds_read_b64_tr_b16 v[60:61], v235 offset:8224
    ds_read_b64_tr_b16 v[62:63], v235 offset:9504
    ds_read_b64_tr_b16 v[64:65], v235 offset:8256
    ds_read_b64_tr_b16 v[66:67], v235 offset:9536
    ds_read_b64_tr_b16 v[68:69], v235 offset:8288
    ds_read_b64_tr_b16 v[70:71], v235 offset:9568
    ds_read_b64_tr_b16 v[72:73], v235 offset:8320
    ds_read_b64_tr_b16 v[74:75], v235 offset:9600
    s_waitcnt vmcnt(14)
    s_waitcnt lgkmcnt(4)
    v_mfma_f32_16x16x32_bf16 v[16:19], v[56:59], a[0:3], 0
    v_mfma_f32_16x16x32_bf16 v[36:39], v[56:59], a[80:83], 0
    s_add_u32 s36, s57, 8192
    buffer_load_dwordx4 a[32:35], v4, s[8:11], s36 offen
    ds_read_b64_tr_b16 v[56:57], v235 offset:13312
    ds_read_b64_tr_b16 v[58:59], v235 offset:14592
    v_mfma_f32_16x16x32_bf16 v[20:23], v[60:63], a[0:3], 0
    v_mfma_f32_16x16x32_bf16 v[40:43], v[60:63], a[80:83], 0
    s_add_u32 s36, s58, 8192
    buffer_load_dwordx4 a[112:115], v4, s[8:11], s36 offen
    ds_read_b64_tr_b16 v[60:61], v235 offset:13344
    ds_read_b64_tr_b16 v[62:63], v235 offset:14624
    v_mfma_f32_16x16x32_bf16 v[24:27], v[64:67], a[0:3], 0
    v_mfma_f32_16x16x32_bf16 v[44:47], v[64:67], a[80:83], 0
    ds_read_b64_tr_b16 v[64:65], v235 offset:13376
    ds_read_b64_tr_b16 v[66:67], v235 offset:14656
    s_waitcnt lgkmcnt(6)
    v_mfma_f32_16x16x32_bf16 v[28:31], v[68:71], a[0:3], 0
    v_mfma_f32_16x16x32_bf16 v[48:51], v[68:71], a[80:83], 0
    ds_read_b64_tr_b16 v[68:69], v235 offset:13408
    ds_read_b64_tr_b16 v[70:71], v235 offset:14688
    v_mfma_f32_16x16x32_bf16 v[32:35], v[72:75], a[0:3], 0
    v_mfma_f32_16x16x32_bf16 v[52:55], v[72:75], a[80:83], 0
    ds_read_b64_tr_b16 v[72:73], v235 offset:13440
    ds_read_b64_tr_b16 v[74:75], v235 offset:14720
    s_waitcnt vmcnt(14)
    s_waitcnt lgkmcnt(4)
    v_mfma_f32_16x16x32_bf16 v[16:19], v[56:59], a[4:7], v[16:19]
    v_mfma_f32_16x16x32_bf16 v[36:39], v[56:59], a[84:87], v[36:39]
    s_add_u32 s36, s57, 9216
    buffer_load_dwordx4 a[36:39], v4, s[8:11], s36 offen
    ds_read_b64_tr_b16 v[56:57], v235 offset:18432
    ds_read_b64_tr_b16 v[58:59], v235 offset:19712
    v_mfma_f32_16x16x32_bf16 v[20:23], v[60:63], a[4:7], v[20:23]
    v_mfma_f32_16x16x32_bf16 v[40:43], v[60:63], a[84:87], v[40:43]
    s_add_u32 s36, s58, 9216
    buffer_load_dwordx4 a[116:119], v4, s[8:11], s36 offen
    ds_read_b64_tr_b16 v[60:61], v235 offset:18464
    ds_read_b64_tr_b16 v[62:63], v235 offset:19744
    v_mfma_f32_16x16x32_bf16 v[24:27], v[64:67], a[4:7], v[24:27]
    v_mfma_f32_16x16x32_bf16 v[44:47], v[64:67], a[84:87], v[44:47]
    ds_read_b64_tr_b16 v[64:65], v235 offset:18496
    ds_read_b64_tr_b16 v[66:67], v235 offset:19776
    s_waitcnt lgkmcnt(6)
    v_mfma_f32_16x16x32_bf16 v[28:31], v[68:71], a[4:7], v[28:31]
    v_mfma_f32_16x16x32_bf16 v[48:51], v[68:71], a[84:87], v[48:51]
    ds_read_b64_tr_b16 v[68:69], v235 offset:18528
    ds_read_b64_tr_b16 v[70:71], v235 offset:19808
    v_mfma_f32_16x16x32_bf16 v[32:35], v[72:75], a[4:7], v[32:35]
    v_mfma_f32_16x16x32_bf16 v[52:55], v[72:75], a[84:87], v[52:55]
    ds_read_b64_tr_b16 v[72:73], v235 offset:18560
    ds_read_b64_tr_b16 v[74:75], v235 offset:19840
    s_waitcnt vmcnt(14)
    s_waitcnt lgkmcnt(4)
    v_mfma_f32_16x16x32_bf16 v[16:19], v[56:59], a[8:11], v[16:19]
    v_mfma_f32_16x16x32_bf16 v[36:39], v[56:59], a[88:91], v[36:39]
    s_add_u32 s36, s57, 10240
    buffer_load_dwordx4 a[40:43], v4, s[8:11], s36 offen
    ds_read_b64_tr_b16 v[56:57], v235 offset:23552
    ds_read_b64_tr_b16 v[58:59], v235 offset:24832
    v_mfma_f32_16x16x32_bf16 v[20:23], v[60:63], a[8:11], v[20:23]
    v_mfma_f32_16x16x32_bf16 v[40:43], v[60:63], a[88:91], v[40:43]
    s_add_u32 s36, s58, 10240
    buffer_load_dwordx4 a[120:123], v4, s[8:11], s36 offen
    ds_read_b64_tr_b16 v[60:61], v235 offset:23584
    ds_read_b64_tr_b16 v[62:63], v235 offset:24864
    v_mfma_f32_16x16x32_bf16 v[24:27], v[64:67], a[8:11], v[24:27]
    v_mfma_f32_16x16x32_bf16 v[44:47], v[64:67], a[88:91], v[44:47]
    ds_read_b64_tr_b16 v[64:65], v235 offset:23616
    ds_read_b64_tr_b16 v[66:67], v235 offset:24896
    s_waitcnt lgkmcnt(6)
    v_mfma_f32_16x16x32_bf16 v[28:31], v[68:71], a[8:11], v[28:31]
    v_mfma_f32_16x16x32_bf16 v[48:51], v[68:71], a[88:91], v[48:51]
    ds_read_b64_tr_b16 v[68:69], v235 offset:23648
    ds_read_b64_tr_b16 v[70:71], v235 offset:24928
    v_mfma_f32_16x16x32_bf16 v[32:35], v[72:75], a[8:11], v[32:35]
    v_mfma_f32_16x16x32_bf16 v[52:55], v[72:75], a[88:91], v[52:55]
    ds_read_b64_tr_b16 v[72:73], v235 offset:23680
    ds_read_b64_tr_b16 v[74:75], v235 offset:24960
    s_waitcnt vmcnt(14)
    s_waitcnt lgkmcnt(4)
    v_mfma_f32_16x16x32_bf16 v[16:19], v[56:59], a[12:15], v[16:19]
    v_mfma_f32_16x16x32_bf16 v[36:39], v[56:59], a[92:95], v[36:39]
    s_add_u32 s36, s57, 11264
    buffer_load_dwordx4 a[44:47], v4, s[8:11], s36 offen
    ds_read_b64_tr_b16 v[56:57], v235 offset:28672
    ds_read_b64_tr_b16 v[58:59], v235 offset:29952
    v_mfma_f32_16x16x32_bf16 v[20:23], v[60:63], a[12:15], v[20:23]
    v_mfma_f32_16x16x32_bf16 v[40:43], v[60:63], a[92:95], v[40:43]
    s_add_u32 s36, s58, 11264
    buffer_load_dwordx4 a[124:127], v4, s[8:11], s36 offen
    ds_read_b64_tr_b16 v[60:61], v235 offset:28704
    ds_read_b64_tr_b16 v[62:63], v235 offset:29984
    v_mfma_f32_16x16x32_bf16 v[24:27], v[64:67], a[12:15], v[24:27]
    v_mfma_f32_16x16x32_bf16 v[44:47], v[64:67], a[92:95], v[44:47]
    ds_read_b64_tr_b16 v[64:65], v235 offset:28736
    ds_read_b64_tr_b16 v[66:67], v235 offset:30016
    s_waitcnt lgkmcnt(6)
    v_mfma_f32_16x16x32_bf16 v[28:31], v[68:71], a[12:15], v[28:31]
    v_mfma_f32_16x16x32_bf16 v[48:51], v[68:71], a[92:95], v[48:51]
    ds_read_b64_tr_b16 v[68:69], v235 offset:28768
    ds_read_b64_tr_b16 v[70:71], v235 offset:30048
    v_mfma_f32_16x16x32_bf16 v[32:35], v[72:75], a[12:15], v[32:35]
    v_mfma_f32_16x16x32_bf16 v[52:55], v[72:75], a[92:95], v[52:55]
    ds_read_b64_tr_b16 v[72:73], v235 offset:28800
    ds_read_b64_tr_b16 v[74:75], v235 offset:30080
    s_waitcnt vmcnt(14)
    s_waitcnt lgkmcnt(4)
    v_mfma_f32_16x16x32_bf16 v[16:19], v[56:59], a[16:19], v[16:19]
    v_mfma_f32_16x16x32_bf16 v[36:39], v[56:59], a[96:99], v[36:39]
    s_add_u32 s36, s57, 12288
    buffer_load_dwordx4 a[48:51], v4, s[8:11], s36 offen
    ds_read_b64_tr_b16 v[56:57], v235 offset:33792
    ds_read_b64_tr_b16 v[58:59], v235 offset:35072
    v_mfma_f32_16x16x32_bf16 v[20:23], v[60:63], a[16:19], v[20:23]
    v_mfma_f32_16x16x32_bf16 v[40:43], v[60:63], a[96:99], v[40:43]
    s_add_u32 s36, s58, 12288
    buffer_load_dwordx4 a[128:131], v4, s[8:11], s36 offen
    ds_read_b64_tr_b16 v[60:61], v235 offset:33824
    ds_read_b64_tr_b16 v[62:63], v235 offset:35104
    v_mfma_f32_16x16x32_bf16 v[24:27], v[64:67], a[16:19], v[24:27]
    v_mfma_f32_16x16x32_bf16 v[44:47], v[64:67], a[96:99], v[44:47]
    ds_read_b64_tr_b16 v[64:65], v235 offset:33856
    ds_read_b64_tr_b16 v[66:67], v235 offset:35136
    s_waitcnt lgkmcnt(6)
    v_mfma_f32_16x16x32_bf16 v[28:31], v[68:71], a[16:19], v[28:31]
    v_mfma_f32_16x16x32_bf16 v[48:51], v[68:71], a[96:99], v[48:51]
    ds_read_b64_tr_b16 v[68:69], v235 offset:33888
    ds_read_b64_tr_b16 v[70:71], v235 offset:35168
    v_mfma_f32_16x16x32_bf16 v[32:35], v[72:75], a[16:19], v[32:35]
    v_mfma_f32_16x16x32_bf16 v[52:55], v[72:75], a[96:99], v[52:55]
    ds_read_b64_tr_b16 v[72:73], v235 offset:33920
    ds_read_b64_tr_b16 v[74:75], v235 offset:35200
    s_waitcnt vmcnt(14)
    s_waitcnt lgkmcnt(4)
    v_mfma_f32_16x16x32_bf16 v[16:19], v[56:59], a[20:23], v[16:19]
    v_mfma_f32_16x16x32_bf16 v[36:39], v[56:59], a[100:103], v[36:39]
    s_add_u32 s36, s57, 13312
    buffer_load_dwordx4 a[52:55], v4, s[8:11], s36 offen
    ds_read_b64_tr_b16 v[56:57], v235 offset:38912
    ds_read_b64_tr_b16 v[58:59], v235 offset:40192
    v_mfma_f32_16x16x32_bf16 v[20:23], v[60:63], a[20:23], v[20:23]
    v_mfma_f32_16x16x32_bf16 v[40:43], v[60:63], a[100:103], v[40:43]
    s_add_u32 s36, s58, 13312
    buffer_load_dwordx4 a[132:135], v4, s[8:11], s36 offen
    ds_read_b64_tr_b16 v[60:61], v235 offset:38944
    ds_read_b64_tr_b16 v[62:63], v235 offset:40224
    v_mfma_f32_16x16x32_bf16 v[24:27], v[64:67], a[20:23], v[24:27]
    v_mfma_f32_16x16x32_bf16 v[44:47], v[64:67], a[100:103], v[44:47]
    ds_read_b64_tr_b16 v[64:65], v235 offset:38976
    ds_read_b64_tr_b16 v[66:67], v235 offset:40256
    s_waitcnt lgkmcnt(6)
    v_mfma_f32_16x16x32_bf16 v[28:31], v[68:71], a[20:23], v[28:31]
    v_mfma_f32_16x16x32_bf16 v[48:51], v[68:71], a[100:103], v[48:51]
    ds_read_b64_tr_b16 v[68:69], v235 offset:39008
    ds_read_b64_tr_b16 v[70:71], v235 offset:40288
    v_mfma_f32_16x16x32_bf16 v[32:35], v[72:75], a[20:23], v[32:35]
    v_mfma_f32_16x16x32_bf16 v[52:55], v[72:75], a[100:103], v[52:55]
    ds_read_b64_tr_b16 v[72:73], v235 offset:39040
    ds_read_b64_tr_b16 v[74:75], v235 offset:40320
    s_waitcnt vmcnt(14)
    s_waitcnt lgkmcnt(4)
    v_mfma_f32_16x16x32_bf16 v[16:19], v[56:59], a[24:27], v[16:19]
    v_mfma_f32_16x16x32_bf16 v[36:39], v[56:59], a[104:107], v[36:39]
    s_add_u32 s36, s57, 14336
    buffer_load_dwordx4 a[56:59], v4, s[8:11], s36 offen
    ds_read_b64_tr_b16 v[56:57], v235 offset:44032
    ds_read_b64_tr_b16 v[58:59], v235 offset:45312
    v_mfma_f32_16x16x32_bf16 v[20:23], v[60:63], a[24:27], v[20:23]
    v_mfma_f32_16x16x32_bf16 v[40:43], v[60:63], a[104:107], v[40:43]
    s_add_u32 s36, s58, 14336
    buffer_load_dwordx4 a[136:139], v4, s[8:11], s36 offen
    ds_read_b64_tr_b16 v[60:61], v235 offset:44064
    ds_read_b64_tr_b16 v[62:63], v235 offset:45344
    v_mfma_f32_16x16x32_bf16 v[24:27], v[64:67], a[24:27], v[24:27]
    v_mfma_f32_16x16x32_bf16 v[44:47], v[64:67], a[104:107], v[44:47]
    ds_read_b64_tr_b16 v[64:65], v235 offset:44096
    ds_read_b64_tr_b16 v[66:67], v235 offset:45376
    s_waitcnt lgkmcnt(6)
    v_mfma_f32_16x16x32_bf16 v[28:31], v[68:71], a[24:27], v[28:31]
    v_mfma_f32_16x16x32_bf16 v[48:51], v[68:71], a[104:107], v[48:51]
    ds_read_b64_tr_b16 v[68:69], v235 offset:44128
    ds_read_b64_tr_b16 v[70:71], v235 offset:45408
    v_mfma_f32_16x16x32_bf16 v[32:35], v[72:75], a[24:27], v[32:35]
    v_mfma_f32_16x16x32_bf16 v[52:55], v[72:75], a[104:107], v[52:55]
    ds_read_b64_tr_b16 v[72:73], v235 offset:44160
    ds_read_b64_tr_b16 v[74:75], v235 offset:45440
    s_waitcnt vmcnt(14)
    s_waitcnt lgkmcnt(4)
    v_mfma_f32_16x16x32_bf16 v[16:19], v[56:59], a[28:31], v[16:19]
    v_mfma_f32_16x16x32_bf16 v[36:39], v[56:59], a[108:111], v[36:39]
    s_add_u32 s36, s57, 15360
    buffer_load_dwordx4 a[60:63], v4, s[8:11], s36 offen
    ds_read_b64_tr_b16 v[56:57], v235 offset:49152
    ds_read_b64_tr_b16 v[58:59], v235 offset:50432
    v_mfma_f32_16x16x32_bf16 v[20:23], v[60:63], a[28:31], v[20:23]
    v_mfma_f32_16x16x32_bf16 v[40:43], v[60:63], a[108:111], v[40:43]
    s_add_u32 s36, s58, 15360
    buffer_load_dwordx4 a[140:143], v4, s[8:11], s36 offen
    ds_read_b64_tr_b16 v[60:61], v235 offset:49184
    ds_read_b64_tr_b16 v[62:63], v235 offset:50464
    v_mfma_f32_16x16x32_bf16 v[24:27], v[64:67], a[28:31], v[24:27]
    v_mfma_f32_16x16x32_bf16 v[44:47], v[64:67], a[108:111], v[44:47]
    ds_read_b64_tr_b16 v[64:65], v235 offset:49216
    ds_read_b64_tr_b16 v[66:67], v235 offset:50496
    s_waitcnt lgkmcnt(6)
    v_mfma_f32_16x16x32_bf16 v[28:31], v[68:71], a[28:31], v[28:31]
    v_mfma_f32_16x16x32_bf16 v[48:51], v[68:71], a[108:111], v[48:51]
    ds_read_b64_tr_b16 v[68:69], v235 offset:49248
    ds_read_b64_tr_b16 v[70:71], v235 offset:50528
    v_mfma_f32_16x16x32_bf16 v[32:35], v[72:75], a[28:31], v[32:35]
    v_mfma_f32_16x16x32_bf16 v[52:55], v[72:75], a[108:111], v[52:55]
    ds_read_b64_tr_b16 v[72:73], v235 offset:49280
    ds_read_b64_tr_b16 v[74:75], v235 offset:50560
    s_waitcnt vmcnt(14)
    s_waitcnt lgkmcnt(4)
    v_mfma_f32_16x16x32_bf16 v[16:19], v[56:59], a[32:35], v[16:19]
    v_mfma_f32_16x16x32_bf16 v[36:39], v[56:59], a[112:115], v[36:39]
    s_add_u32 s36, s57, 16384
    buffer_load_dwordx4 a[64:67], v4, s[8:11], s36 offen
    ds_read_b64_tr_b16 v[56:57], v235 offset:54272
    ds_read_b64_tr_b16 v[58:59], v235 offset:55552
    v_mfma_f32_16x16x32_bf16 v[20:23], v[60:63], a[32:35], v[20:23]
    v_mfma_f32_16x16x32_bf16 v[40:43], v[60:63], a[112:115], v[40:43]
    s_add_u32 s36, s58, 16384
    buffer_load_dwordx4 a[144:147], v4, s[8:11], s36 offen
    ds_read_b64_tr_b16 v[60:61], v235 offset:54304
    ds_read_b64_tr_b16 v[62:63], v235 offset:55584
    v_mfma_f32_16x16x32_bf16 v[24:27], v[64:67], a[32:35], v[24:27]
    v_mfma_f32_16x16x32_bf16 v[44:47], v[64:67], a[112:115], v[44:47]
    ds_read_b64_tr_b16 v[64:65], v235 offset:54336
    ds_read_b64_tr_b16 v[66:67], v235 offset:55616
    s_waitcnt lgkmcnt(6)
    v_mfma_f32_16x16x32_bf16 v[28:31], v[68:71], a[32:35], v[28:31]
    v_mfma_f32_16x16x32_bf16 v[48:51], v[68:71], a[112:115], v[48:51]
    ds_read_b64_tr_b16 v[68:69], v235 offset:54368
    ds_read_b64_tr_b16 v[70:71], v235 offset:55648
    v_mfma_f32_16x16x32_bf16 v[32:35], v[72:75], a[32:35], v[32:35]
    v_mfma_f32_16x16x32_bf16 v[52:55], v[72:75], a[112:115], v[52:55]
    ds_read_b64_tr_b16 v[72:73], v235 offset:54400
    ds_read_b64_tr_b16 v[74:75], v235 offset:55680
    s_waitcnt vmcnt(14)
    s_waitcnt lgkmcnt(4)
    v_mfma_f32_16x16x32_bf16 v[16:19], v[56:59], a[36:39], v[16:19]
    v_mfma_f32_16x16x32_bf16 v[36:39], v[56:59], a[116:119], v[36:39]
    s_add_u32 s36, s57, 17408
    buffer_load_dwordx4 a[68:71], v4, s[8:11], s36 offen
    ds_read_b64_tr_b16 v[56:57], v235 offset:59392
    ds_read_b64_tr_b16 v[58:59], v235 offset:60672
    v_mfma_f32_16x16x32_bf16 v[20:23], v[60:63], a[36:39], v[20:23]
    v_mfma_f32_16x16x32_bf16 v[40:43], v[60:63], a[116:119], v[40:43]
    s_add_u32 s36, s58, 17408
    buffer_load_dwordx4 a[148:151], v4, s[8:11], s36 offen
    ds_read_b64_tr_b16 v[60:61], v235 offset:59424
    ds_read_b64_tr_b16 v[62:63], v235 offset:60704
    v_mfma_f32_16x16x32_bf16 v[24:27], v[64:67], a[36:39], v[24:27]
    v_mfma_f32_16x16x32_bf16 v[44:47], v[64:67], a[116:119], v[44:47]
    ds_read_b64_tr_b16 v[64:65], v235 offset:59456
    ds_read_b64_tr_b16 v[66:67], v235 offset:60736
    s_waitcnt lgkmcnt(6)
    v_mfma_f32_16x16x32_bf16 v[28:31], v[68:71], a[36:39], v[28:31]
    v_mfma_f32_16x16x32_bf16 v[48:51], v[68:71], a[116:119], v[48:51]
    ds_read_b64_tr_b16 v[68:69], v235 offset:59488
    ds_read_b64_tr_b16 v[70:71], v235 offset:60768
    v_mfma_f32_16x16x32_bf16 v[32:35], v[72:75], a[36:39], v[32:35]
    v_mfma_f32_16x16x32_bf16 v[52:55], v[72:75], a[116:119], v[52:55]
    ds_read_b64_tr_b16 v[72:73], v235 offset:59520
    ds_read_b64_tr_b16 v[74:75], v235 offset:60800
    s_waitcnt vmcnt(14)
    s_waitcnt lgkmcnt(4)
    v_mfma_f32_16x16x32_bf16 v[16:19], v[56:59], a[40:43], v[16:19]
    v_mfma_f32_16x16x32_bf16 v[36:39], v[56:59], a[120:123], v[36:39]
    s_add_u32 s36, s57, 18432
    buffer_load_dwordx4 a[72:75], v4, s[8:11], s36 offen
    ds_read_b64_tr_b16 v[56:57], v235 offset:64512
    ds_read_b64_tr_b16 v[58:59], v236 offset:256
    v_mfma_f32_16x16x32_bf16 v[20:23], v[60:63], a[40:43], v[20:23]
    v_mfma_f32_16x16x32_bf16 v[40:43], v[60:63], a[120:123], v[40:43]
    s_add_u32 s36, s58, 18432
    buffer_load_dwordx4 a[152:155], v4, s[8:11], s36 offen
    ds_read_b64_tr_b16 v[60:61], v235 offset:64544
    ds_read_b64_tr_b16 v[62:63], v236 offset:288
    v_mfma_f32_16x16x32_bf16 v[24:27], v[64:67], a[40:43], v[24:27]
    v_mfma_f32_16x16x32_bf16 v[44:47], v[64:67], a[120:123], v[44:47]
    ds_read_b64_tr_b16 v[64:65], v235 offset:64576
    ds_read_b64_tr_b16 v[66:67], v236 offset:320
    s_waitcnt lgkmcnt(6)
    v_mfma_f32_16x16x32_bf16 v[28:31], v[68:71], a[40:43], v[28:31]
    v_mfma_f32_16x16x32_bf16 v[48:51], v[68:71], a[120:123], v[48:51]
    ds_read_b64_tr_b16 v[68:69], v235 offset:64608
    ds_read_b64_tr_b16 v[70:71], v236 offset:352
    v_mfma_f32_16x16x32_bf16 v[32:35], v[72:75], a[40:43], v[32:35]
    v_mfma_f32_16x16x32_bf16 v[52:55], v[72:75], a[120:123], v[52:55]
    ds_read_b64_tr_b16 v[72:73], v235 offset:64640
    ds_read_b64_tr_b16 v[74:75], v236 offset:384
    s_waitcnt vmcnt(14)
    s_waitcnt lgkmcnt(4)
    v_mfma_f32_16x16x32_bf16 v[16:19], v[56:59], a[44:47], v[16:19]
    v_mfma_f32_16x16x32_bf16 v[36:39], v[56:59], a[124:127], v[36:39]
    s_add_u32 s36, s57, 19456
    buffer_load_dwordx4 a[76:79], v4, s[8:11], s36 offen
    ds_read_b64_tr_b16 v[56:57], v236 offset:4096
    ds_read_b64_tr_b16 v[58:59], v236 offset:5376
    v_mfma_f32_16x16x32_bf16 v[20:23], v[60:63], a[44:47], v[20:23]
    v_mfma_f32_16x16x32_bf16 v[40:43], v[60:63], a[124:127], v[40:43]
    s_add_u32 s36, s58, 19456
    buffer_load_dwordx4 a[156:159], v4, s[8:11], s36 offen
    ds_read_b64_tr_b16 v[60:61], v236 offset:4128
    ds_read_b64_tr_b16 v[62:63], v236 offset:5408
    v_mfma_f32_16x16x32_bf16 v[24:27], v[64:67], a[44:47], v[24:27]
    v_mfma_f32_16x16x32_bf16 v[44:47], v[64:67], a[124:127], v[44:47]
    ds_read_b64_tr_b16 v[64:65], v236 offset:4160
    ds_read_b64_tr_b16 v[66:67], v236 offset:5440
    s_waitcnt lgkmcnt(6)
    v_mfma_f32_16x16x32_bf16 v[28:31], v[68:71], a[44:47], v[28:31]
    v_mfma_f32_16x16x32_bf16 v[48:51], v[68:71], a[124:127], v[48:51]
    ds_read_b64_tr_b16 v[68:69], v236 offset:4192
    ds_read_b64_tr_b16 v[70:71], v236 offset:5472
    v_mfma_f32_16x16x32_bf16 v[32:35], v[72:75], a[44:47], v[32:35]
    v_mfma_f32_16x16x32_bf16 v[52:55], v[72:75], a[124:127], v[52:55]
    ds_read_b64_tr_b16 v[72:73], v236 offset:4224
    ds_read_b64_tr_b16 v[74:75], v236 offset:5504
    s_waitcnt vmcnt(14)
    s_waitcnt lgkmcnt(4)
    v_mfma_f32_16x16x32_bf16 v[16:19], v[56:59], a[48:51], v[16:19]
    v_mfma_f32_16x16x32_bf16 v[36:39], v[56:59], a[128:131], v[36:39]
    ds_read_b64_tr_b16 v[56:57], v236 offset:9216
    ds_read_b64_tr_b16 v[58:59], v236 offset:10496
    v_mfma_f32_16x16x32_bf16 v[20:23], v[60:63], a[48:51], v[20:23]
    v_mfma_f32_16x16x32_bf16 v[40:43], v[60:63], a[128:131], v[40:43]
    ds_read_b64_tr_b16 v[60:61], v236 offset:9248
    ds_read_b64_tr_b16 v[62:63], v236 offset:10528
    v_mfma_f32_16x16x32_bf16 v[24:27], v[64:67], a[48:51], v[24:27]
    v_mfma_f32_16x16x32_bf16 v[44:47], v[64:67], a[128:131], v[44:47]
    ds_read_b64_tr_b16 v[64:65], v236 offset:9280
    ds_read_b64_tr_b16 v[66:67], v236 offset:10560
    s_waitcnt lgkmcnt(6)
    v_mfma_f32_16x16x32_bf16 v[28:31], v[68:71], a[48:51], v[28:31]
    v_mfma_f32_16x16x32_bf16 v[48:51], v[68:71], a[128:131], v[48:51]
    ds_read_b64_tr_b16 v[68:69], v236 offset:9312
    ds_read_b64_tr_b16 v[70:71], v236 offset:10592
    v_mfma_f32_16x16x32_bf16 v[32:35], v[72:75], a[48:51], v[32:35]
    v_mfma_f32_16x16x32_bf16 v[52:55], v[72:75], a[128:131], v[52:55]
    ds_read_b64_tr_b16 v[72:73], v236 offset:9344
    ds_read_b64_tr_b16 v[74:75], v236 offset:10624
    s_waitcnt vmcnt(12)
    s_waitcnt lgkmcnt(4)
    v_mfma_f32_16x16x32_bf16 v[16:19], v[56:59], a[52:55], v[16:19]
    v_mfma_f32_16x16x32_bf16 v[36:39], v[56:59], a[132:135], v[36:39]
    ds_read_b64_tr_b16 v[56:57], v236 offset:14336
    ds_read_b64_tr_b16 v[58:59], v236 offset:15616
    v_mfma_f32_16x16x32_bf16 v[20:23], v[60:63], a[52:55], v[20:23]
    v_mfma_f32_16x16x32_bf16 v[40:43], v[60:63], a[132:135], v[40:43]
    ds_read_b64_tr_b16 v[60:61], v236 offset:14368
    ds_read_b64_tr_b16 v[62:63], v236 offset:15648
    v_mfma_f32_16x16x32_bf16 v[24:27], v[64:67], a[52:55], v[24:27]
    v_mfma_f32_16x16x32_bf16 v[44:47], v[64:67], a[132:135], v[44:47]
    ds_read_b64_tr_b16 v[64:65], v236 offset:14400
    ds_read_b64_tr_b16 v[66:67], v236 offset:15680
    s_waitcnt lgkmcnt(6)
    v_mfma_f32_16x16x32_bf16 v[28:31], v[68:71], a[52:55], v[28:31]
    v_mfma_f32_16x16x32_bf16 v[48:51], v[68:71], a[132:135], v[48:51]
    ds_read_b64_tr_b16 v[68:69], v236 offset:14432
    ds_read_b64_tr_b16 v[70:71], v236 offset:15712
    v_mfma_f32_16x16x32_bf16 v[32:35], v[72:75], a[52:55], v[32:35]
    v_mfma_f32_16x16x32_bf16 v[52:55], v[72:75], a[132:135], v[52:55]
    ds_read_b64_tr_b16 v[72:73], v236 offset:14464
    ds_read_b64_tr_b16 v[74:75], v236 offset:15744
    s_waitcnt vmcnt(10)
    s_waitcnt lgkmcnt(4)
    v_mfma_f32_16x16x32_bf16 v[16:19], v[56:59], a[56:59], v[16:19]
    v_mfma_f32_16x16x32_bf16 v[36:39], v[56:59], a[136:139], v[36:39]
    ds_read_b64_tr_b16 v[56:57], v236 offset:19456
    ds_read_b64_tr_b16 v[58:59], v236 offset:20736
    v_mfma_f32_16x16x32_bf16 v[20:23], v[60:63], a[56:59], v[20:23]
    v_mfma_f32_16x16x32_bf16 v[40:43], v[60:63], a[136:139], v[40:43]
    ds_read_b64_tr_b16 v[60:61], v236 offset:19488
    ds_read_b64_tr_b16 v[62:63], v236 offset:20768
    v_mfma_f32_16x16x32_bf16 v[24:27], v[64:67], a[56:59], v[24:27]
    v_mfma_f32_16x16x32_bf16 v[44:47], v[64:67], a[136:139], v[44:47]
    ds_read_b64_tr_b16 v[64:65], v236 offset:19520
    ds_read_b64_tr_b16 v[66:67], v236 offset:20800
    s_waitcnt lgkmcnt(6)
    v_mfma_f32_16x16x32_bf16 v[28:31], v[68:71], a[56:59], v[28:31]
    v_mfma_f32_16x16x32_bf16 v[48:51], v[68:71], a[136:139], v[48:51]
    ds_read_b64_tr_b16 v[68:69], v236 offset:19552
    ds_read_b64_tr_b16 v[70:71], v236 offset:20832
    v_mfma_f32_16x16x32_bf16 v[32:35], v[72:75], a[56:59], v[32:35]
    v_mfma_f32_16x16x32_bf16 v[52:55], v[72:75], a[136:139], v[52:55]
    ds_read_b64_tr_b16 v[72:73], v236 offset:19584
    ds_read_b64_tr_b16 v[74:75], v236 offset:20864
    s_waitcnt vmcnt(8)
    s_waitcnt lgkmcnt(4)
    v_mfma_f32_16x16x32_bf16 v[16:19], v[56:59], a[60:63], v[16:19]
    v_mfma_f32_16x16x32_bf16 v[36:39], v[56:59], a[140:143], v[36:39]
    ds_read_b64_tr_b16 v[56:57], v224 offset:16704
    ds_read_b64_tr_b16 v[58:59], v224 offset:17984
    v_mfma_f32_16x16x32_bf16 v[20:23], v[60:63], a[60:63], v[20:23]
    v_mfma_f32_16x16x32_bf16 v[40:43], v[60:63], a[140:143], v[40:43]
    ds_read_b64_tr_b16 v[60:61], v224 offset:16736
    ds_read_b64_tr_b16 v[62:63], v224 offset:18016
    v_mfma_f32_16x16x32_bf16 v[24:27], v[64:67], a[60:63], v[24:27]
    v_mfma_f32_16x16x32_bf16 v[44:47], v[64:67], a[140:143], v[44:47]
    ds_read_b64_tr_b16 v[64:65], v224 offset:16768
    ds_read_b64_tr_b16 v[66:67], v224 offset:18048
    s_waitcnt lgkmcnt(6)
    v_mfma_f32_16x16x32_bf16 v[28:31], v[68:71], a[60:63], v[28:31]
    v_mfma_f32_16x16x32_bf16 v[48:51], v[68:71], a[140:143], v[48:51]
    ds_read_b64_tr_b16 v[68:69], v224 offset:16800
    ds_read_b64_tr_b16 v[70:71], v224 offset:18080
    v_mfma_f32_16x16x32_bf16 v[32:35], v[72:75], a[60:63], v[32:35]
    v_mfma_f32_16x16x32_bf16 v[52:55], v[72:75], a[140:143], v[52:55]
    ds_read_b64_tr_b16 v[72:73], v224 offset:16832
    ds_read_b64_tr_b16 v[74:75], v224 offset:18112
    s_waitcnt vmcnt(6)
    s_waitcnt lgkmcnt(4)
    v_mfma_f32_16x16x32_bf16 v[16:19], v[56:59], a[64:67], v[16:19]
    v_mfma_f32_16x16x32_bf16 v[36:39], v[56:59], a[144:147], v[36:39]
    ds_read_b64_tr_b16 v[56:57], v224 offset:21824
    ds_read_b64_tr_b16 v[58:59], v224 offset:23104
    v_mfma_f32_16x16x32_bf16 v[20:23], v[60:63], a[64:67], v[20:23]
    v_mfma_f32_16x16x32_bf16 v[40:43], v[60:63], a[144:147], v[40:43]
    ds_read_b64_tr_b16 v[60:61], v224 offset:21856
    ds_read_b64_tr_b16 v[62:63], v224 offset:23136
    v_mfma_f32_16x16x32_bf16 v[24:27], v[64:67], a[64:67], v[24:27]
    v_mfma_f32_16x16x32_bf16 v[44:47], v[64:67], a[144:147], v[44:47]
    ds_read_b64_tr_b16 v[64:65], v224 offset:21888
    ds_read_b64_tr_b16 v[66:67], v224 offset:23168
    s_waitcnt lgkmcnt(6)
    v_mfma_f32_16x16x32_bf16 v[28:31], v[68:71], a[64:67], v[28:31]
    v_mfma_f32_16x16x32_bf16 v[48:51], v[68:71], a[144:147], v[48:51]
    ds_read_b64_tr_b16 v[68:69], v224 offset:21920
    ds_read_b64_tr_b16 v[70:71], v224 offset:23200
    v_mfma_f32_16x16x32_bf16 v[32:35], v[72:75], a[64:67], v[32:35]
    v_mfma_f32_16x16x32_bf16 v[52:55], v[72:75], a[144:147], v[52:55]
    ds_read_b64_tr_b16 v[72:73], v224 offset:21952
    ds_read_b64_tr_b16 v[74:75], v224 offset:23232
    s_waitcnt vmcnt(4)
    s_waitcnt lgkmcnt(4)
    v_mfma_f32_16x16x32_bf16 v[16:19], v[56:59], a[68:71], v[16:19]
    v_mfma_f32_16x16x32_bf16 v[36:39], v[56:59], a[148:151], v[36:39]
    ds_read_b64_tr_b16 v[56:57], v224 offset:26944
    ds_read_b64_tr_b16 v[58:59], v224 offset:28224
    v_mfma_f32_16x16x32_bf16 v[20:23], v[60:63], a[68:71], v[20:23]
    v_mfma_f32_16x16x32_bf16 v[40:43], v[60:63], a[148:151], v[40:43]
    ds_read_b64_tr_b16 v[60:61], v224 offset:26976
    ds_read_b64_tr_b16 v[62:63], v224 offset:28256
    v_mfma_f32_16x16x32_bf16 v[24:27], v[64:67], a[68:71], v[24:27]
    v_mfma_f32_16x16x32_bf16 v[44:47], v[64:67], a[148:151], v[44:47]
    ds_read_b64_tr_b16 v[64:65], v224 offset:27008
    ds_read_b64_tr_b16 v[66:67], v224 offset:28288
    s_waitcnt lgkmcnt(6)
    v_mfma_f32_16x16x32_bf16 v[28:31], v[68:71], a[68:71], v[28:31]
    v_mfma_f32_16x16x32_bf16 v[48:51], v[68:71], a[148:151], v[48:51]
    ds_read_b64_tr_b16 v[68:69], v224 offset:27040
    ds_read_b64_tr_b16 v[70:71], v224 offset:28320
    v_mfma_f32_16x16x32_bf16 v[32:35], v[72:75], a[68:71], v[32:35]
    v_mfma_f32_16x16x32_bf16 v[52:55], v[72:75], a[148:151], v[52:55]
    ds_read_b64_tr_b16 v[72:73], v224 offset:27072
    ds_read_b64_tr_b16 v[74:75], v224 offset:28352
    s_waitcnt vmcnt(2)
    s_waitcnt lgkmcnt(4)
    v_mfma_f32_16x16x32_bf16 v[16:19], v[56:59], a[72:75], v[16:19]
    v_mfma_f32_16x16x32_bf16 v[36:39], v[56:59], a[152:155], v[36:39]
    ds_read_b64_tr_b16 v[56:57], v224 offset:32064
    ds_read_b64_tr_b16 v[58:59], v224 offset:33344
    v_mfma_f32_16x16x32_bf16 v[20:23], v[60:63], a[72:75], v[20:23]
    v_mfma_f32_16x16x32_bf16 v[40:43], v[60:63], a[152:155], v[40:43]
    ds_read_b64_tr_b16 v[60:61], v224 offset:32096
    ds_read_b64_tr_b16 v[62:63], v224 offset:33376
    v_mfma_f32_16x16x32_bf16 v[24:27], v[64:67], a[72:75], v[24:27]
    v_mfma_f32_16x16x32_bf16 v[44:47], v[64:67], a[152:155], v[44:47]
    ds_read_b64_tr_b16 v[64:65], v224 offset:32128
    ds_read_b64_tr_b16 v[66:67], v224 offset:33408
    s_waitcnt lgkmcnt(6)
    v_mfma_f32_16x16x32_bf16 v[28:31], v[68:71], a[72:75], v[28:31]
    v_mfma_f32_16x16x32_bf16 v[48:51], v[68:71], a[152:155], v[48:51]
    ds_read_b64_tr_b16 v[68:69], v224 offset:32160
    ds_read_b64_tr_b16 v[70:71], v224 offset:33440
    v_mfma_f32_16x16x32_bf16 v[32:35], v[72:75], a[72:75], v[32:35]
    v_mfma_f32_16x16x32_bf16 v[52:55], v[72:75], a[152:155], v[52:55]
    ds_read_b64_tr_b16 v[72:73], v224 offset:32192
    ds_read_b64_tr_b16 v[74:75], v224 offset:33472
    s_waitcnt vmcnt(0)
    s_waitcnt lgkmcnt(4)
    v_mfma_f32_16x16x32_bf16 v[16:19], v[56:59], a[76:79], v[16:19]
    v_mfma_f32_16x16x32_bf16 v[36:39], v[56:59], a[156:159], v[36:39]
    v_mfma_f32_16x16x32_bf16 v[20:23], v[60:63], a[76:79], v[20:23]
    v_mfma_f32_16x16x32_bf16 v[40:43], v[60:63], a[156:159], v[40:43]
    v_mfma_f32_16x16x32_bf16 v[24:27], v[64:67], a[76:79], v[24:27]
    v_mfma_f32_16x16x32_bf16 v[44:47], v[64:67], a[156:159], v[44:47]
    s_waitcnt lgkmcnt(0)
    v_mfma_f32_16x16x32_bf16 v[28:31], v[68:71], a[76:79], v[28:31]
    v_mfma_f32_16x16x32_bf16 v[48:51], v[68:71], a[156:159], v[48:51]
    v_mfma_f32_16x16x32_bf16 v[32:35], v[72:75], a[76:79], v[32:35]
    v_mfma_f32_16x16x32_bf16 v[52:55], v[72:75], a[156:159], v[52:55]
    s_nop 7
    v_cvt_pk_bf16_f32 v92, v16, v17
    v_cvt_pk_bf16_f32 v93, v18, v19
    v_cvt_pk_bf16_f32 v94, v20, v21
    v_cvt_pk_bf16_f32 v95, v22, v23
    v_cvt_pk_bf16_f32 v96, v24, v25
    v_cvt_pk_bf16_f32 v97, v26, v27
    v_cvt_pk_bf16_f32 v98, v28, v29
    v_cvt_pk_bf16_f32 v99, v30, v31
    v_cvt_pk_bf16_f32 v100, v32, v33
    v_cvt_pk_bf16_f32 v101, v34, v35
    v_cvt_pk_bf16_f32 v104, v36, v37
    v_cvt_pk_bf16_f32 v105, v38, v39
    v_cvt_pk_bf16_f32 v106, v40, v41
    v_cvt_pk_bf16_f32 v107, v42, v43
    v_cvt_pk_bf16_f32 v108, v44, v45
    v_cvt_pk_bf16_f32 v109, v46, v47
    v_cvt_pk_bf16_f32 v110, v48, v49
    v_cvt_pk_bf16_f32 v111, v50, v51
    v_cvt_pk_bf16_f32 v112, v52, v53
    v_cvt_pk_bf16_f32 v113, v54, v55
    s_mul_i32 s21, s61, 163840
    s_add_u32 s21, s21, s55
    v_permlane16_swap_b32 v92, v94
    v_permlane16_swap_b32 v93, v95
    v_permlane16_swap_b32 v96, v98
    v_permlane16_swap_b32 v97, v99
    buffer_store_dwordx4 v[92:95], v245, s[16:19], s21 offen
    buffer_store_dwordx4 v[96:99], v245, s[16:19], s21 offen offset:64
    buffer_store_dwordx2 v[100:101], v205, s[16:19], s21 offen offset:128
    s_mul_i32 s21, s62, 163840
    s_add_u32 s21, s21, s55
    v_permlane16_swap_b32 v104, v106
    v_permlane16_swap_b32 v105, v107
    v_permlane16_swap_b32 v108, v110
    v_permlane16_swap_b32 v109, v111
    buffer_store_dwordx4 v[104:107], v245, s[16:19], s21 offen
    buffer_store_dwordx4 v[108:111], v245, s[16:19], s21 offen offset:64
    buffer_store_dwordx2 v[112:113], v205, s[16:19], s21 offen offset:128
    s_endpgm
mg_b2:
    s_add_u32 s36, s57, 0
    buffer_load_dwordx4 a[0:3], v4, s[8:11], s36 offen
    s_add_u32 s36, s57, 1024
    buffer_load_dwordx4 a[4:7], v4, s[8:11], s36 offen
    s_add_u32 s36, s57, 2048
    buffer_load_dwordx4 a[8:11], v4, s[8:11], s36 offen
    s_add_u32 s36, s57, 3072
    buffer_load_dwordx4 a[12:15], v4, s[8:11], s36 offen
    s_add_u32 s36, s57, 4096
    buffer_load_dwordx4 a[16:19], v4, s[8:11], s36 offen
    s_add_u32 s36, s57, 5120
    buffer_load_dwordx4 a[20:23], v4, s[8:11], s36 offen
    s_add_u32 s36, s57, 6144
    buffer_load_dwordx4 a[24:27], v4, s[8:11], s36 offen
    s_add_u32 s36, s57, 7168
    buffer_load_dwordx4 a[28:31], v4, s[8:11], s36 offen
    ds_read_b64_tr_b16 v[56:57], v235 offset:8192
    ds_read_b64_tr_b16 v[58:59], v235 offset:9472
    ds_read_b64_tr_b16 v[60:61], v235 offset:8224
    ds_read_b64_tr_b16 v[62:63], v235 offset:9504
    ds_read_b64_tr_b16 v[64:65], v235 offset:8256
    ds_read_b64_tr_b16 v[66:67], v235 offset:9536
    ds_read_b64_tr_b16 v[68:69], v235 offset:8288
    ds_read_b64_tr_b16 v[70:71], v235 offset:9568
    ds_read_b64_tr_b16 v[72:73], v235 offset:8320
    ds_read_b64_tr_b16 v[74:75], v235 offset:9600
    s_waitcnt vmcnt(7)
    s_waitcnt lgkmcnt(4)
    v_mfma_f32_16x16x32_bf16 v[16:19], v[56:59], a[0:3], 0
    s_add_u32 s36, s57, 8192
    buffer_load_dwordx4 a[32:35], v4, s[8:11], s36 offen
    ds_read_b64_tr_b16 v[56:57], v235 offset:13312
    ds_read_b64_tr_b16 v[58:59], v235 offset:14592
    v_mfma_f32_16x16x32_bf16 v[20:23], v[60:63], a[0:3], 0
    ds_read_b64_tr_b16 v[60:61], v235 offset:13344
    ds_read_b64_tr_b16 v[62:63], v235 offset:14624
    v_mfma_f32_16x16x32_bf16 v[24:27], v[64:67], a[0:3], 0
    ds_read_b64_tr_b16 v[64:65], v235 offset:13376
    ds_read_b64_tr_b16 v[66:67], v235 offset:14656
    s_waitcnt lgkmcnt(6)
    v_mfma_f32_16x16x32_bf16 v[28:31], v[68:71], a[0:3], 0
    ds_read_b64_tr_b16 v[68:69], v235 offset:13408
    ds_read_b64_tr_b16 v[70:71], v235 offset:14688
    v_mfma_f32_16x16x32_bf16 v[32:35], v[72:75], a[0:3], 0
    ds_read_b64_tr_b16 v[72:73], v235 offset:13440
    ds_read_b64_tr_b16 v[74:75], v235 offset:14720
    s_waitcnt vmcnt(7)
    s_waitcnt lgkmcnt(4)
    v_mfma_f32_16x16x32_bf16 v[16:19], v[56:59], a[4:7], v[16:19]
    s_add_u32 s36, s57, 9216
    buffer_load_dwordx4 a[36:39], v4, s[8:11], s36 offen
    ds_read_b64_tr_b16 v[56:57], v235 offset:18432
    ds_read_b64_tr_b16 v[58:59], v235 offset:19712
    v_mfma_f32_16x16x32_bf16 v[20:23], v[60:63], a[4:7], v[20:23]
    ds_read_b64_tr_b16 v[60:61], v235 offset:18464
    ds_read_b64_tr_b16 v[62:63], v235 offset:19744
    v_mfma_f32_16x16x32_bf16 v[24:27], v[64:67], a[4:7], v[24:27]
    ds_read_b64_tr_b16 v[64:65], v235 offset:18496
    ds_read_b64_tr_b16 v[66:67], v235 offset:19776
    s_waitcnt lgkmcnt(6)
    v_mfma_f32_16x16x32_bf16 v[28:31], v[68:71], a[4:7], v[28:31]
    ds_read_b64_tr_b16 v[68:69], v235 offset:18528
    ds_read_b64_tr_b16 v[70:71], v235 offset:19808
    v_mfma_f32_16x16x32_bf16 v[32:35], v[72:75], a[4:7], v[32:35]
    ds_read_b64_tr_b16 v[72:73], v235 offset:18560
    ds_read_b64_tr_b16 v[74:75], v235 offset:19840
    s_waitcnt vmcnt(7)
    s_waitcnt lgkmcnt(4)
    v_mfma_f32_16x16x32_bf16 v[16:19], v[56:59], a[8:11], v[16:19]
    s_add_u32 s36, s57, 10240
    buffer_load_dwordx4 a[40:43], v4, s[8:11], s36 offen
    ds_read_b64_tr_b16 v[56:57], v235 offset:23552
    ds_read_b64_tr_b16 v[58:59], v235 offset:24832
    v_mfma_f32_16x16x32_bf16 v[20:23], v[60:63], a[8:11], v[20:23]
    ds_read_b64_tr_b16 v[60:61], v235 offset:23584
    ds_read_b64_tr_b16 v[62:63], v235 offset:24864
    v_mfma_f32_16x16x32_bf16 v[24:27], v[64:67], a[8:11], v[24:27]
    ds_read_b64_tr_b16 v[64:65], v235 offset:23616
    ds_read_b64_tr_b16 v[66:67], v235 offset:24896
    s_waitcnt lgkmcnt(6)
    v_mfma_f32_16x16x32_bf16 v[28:31], v[68:71], a[8:11], v[28:31]
    ds_read_b64_tr_b16 v[68:69], v235 offset:23648
    ds_read_b64_tr_b16 v[70:71], v235 offset:24928
    v_mfma_f32_16x16x32_bf16 v[32:35], v[72:75], a[8:11], v[32:35]
    ds_read_b64_tr_b16 v[72:73], v235 offset:23680
    ds_read_b64_tr_b16 v[74:75], v235 offset:24960
    s_waitcnt vmcnt(7)
    s_waitcnt lgkmcnt(4)
    v_mfma_f32_16x16x32_bf16 v[16:19], v[56:59], a[12:15], v[16:19]
    s_add_u32 s36, s57, 11264
    buffer_load_dwordx4 a[44:47], v4, s[8:11], s36 offen
    ds_read_b64_tr_b16 v[56:57], v235 offset:28672
    ds_read_b64_tr_b16 v[58:59], v235 offset:29952
    v_mfma_f32_16x16x32_bf16 v[20:23], v[60:63], a[12:15], v[20:23]
    ds_read_b64_tr_b16 v[60:61], v235 offset:28704
    ds_read_b64_tr_b16 v[62:63], v235 offset:29984
    v_mfma_f32_16x16x32_bf16 v[24:27], v[64:67], a[12:15], v[24:27]
    ds_read_b64_tr_b16 v[64:65], v235 offset:28736
    ds_read_b64_tr_b16 v[66:67], v235 offset:30016
    s_waitcnt lgkmcnt(6)
    v_mfma_f32_16x16x32_bf16 v[28:31], v[68:71], a[12:15], v[28:31]
    ds_read_b64_tr_b16 v[68:69], v235 offset:28768
    ds_read_b64_tr_b16 v[70:71], v235 offset:30048
    v_mfma_f32_16x16x32_bf16 v[32:35], v[72:75], a[12:15], v[32:35]
    ds_read_b64_tr_b16 v[72:73], v235 offset:28800
    ds_read_b64_tr_b16 v[74:75], v235 offset:30080
    s_waitcnt vmcnt(7)
    s_waitcnt lgkmcnt(4)
    v_mfma_f32_16x16x32_bf16 v[16:19], v[56:59], a[16:19], v[16:19]
    s_add_u32 s36, s57, 12288
    buffer_load_dwordx4 a[48:51], v4, s[8:11], s36 offen
    ds_read_b64_tr_b16 v[56:57], v235 offset:33792
    ds_read_b64_tr_b16 v[58:59], v235 offset:35072
    v_mfma_f32_16x16x32_bf16 v[20:23], v[60:63], a[16:19], v[20:23]
    ds_read_b64_tr_b16 v[60:61], v235 offset:33824
    ds_read_b64_tr_b16 v[62:63], v235 offset:35104
    v_mfma_f32_16x16x32_bf16 v[24:27], v[64:67], a[16:19], v[24:27]
    ds_read_b64_tr_b16 v[64:65], v235 offset:33856
    ds_read_b64_tr_b16 v[66:67], v235 offset:35136
    s_waitcnt lgkmcnt(6)
    v_mfma_f32_16x16x32_bf16 v[28:31], v[68:71], a[16:19], v[28:31]
    ds_read_b64_tr_b16 v[68:69], v235 offset:33888
    ds_read_b64_tr_b16 v[70:71], v235 offset:35168
    v_mfma_f32_16x16x32_bf16 v[32:35], v[72:75], a[16:19], v[32:35]
    ds_read_b64_tr_b16 v[72:73], v235 offset:33920
    ds_read_b64_tr_b16 v[74:75], v235 offset:35200
    s_waitcnt vmcnt(7)
    s_waitcnt lgkmcnt(4)
    v_mfma_f32_16x16x32_bf16 v[16:19], v[56:59], a[20:23], v[16:19]
    s_add_u32 s36, s57, 13312
    buffer_load_dwordx4 a[52:55], v4, s[8:11], s36 offen
    ds_read_b64_tr_b16 v[56:57], v235 offset:38912
    ds_read_b64_tr_b16 v[58:59], v235 offset:40192
    v_mfma_f32_16x16x32_bf16 v[20:23], v[60:63], a[20:23], v[20:23]
    ds_read_b64_tr_b16 v[60:61], v235 offset:38944
    ds_read_b64_tr_b16 v[62:63], v235 offset:40224
    v_mfma_f32_16x16x32_bf16 v[24:27], v[64:67], a[20:23], v[24:27]
    ds_read_b64_tr_b16 v[64:65], v235 offset:38976
    ds_read_b64_tr_b16 v[66:67], v235 offset:40256
    s_waitcnt lgkmcnt(6)
    v_mfma_f32_16x16x32_bf16 v[28:31], v[68:71], a[20:23], v[28:31]
    ds_read_b64_tr_b16 v[68:69], v235 offset:39008
    ds_read_b64_tr_b16 v[70:71], v235 offset:40288
    v_mfma_f32_16x16x32_bf16 v[32:35], v[72:75], a[20:23], v[32:35]
    ds_read_b64_tr_b16 v[72:73], v235 offset:39040
    ds_read_b64_tr_b16 v[74:75], v235 offset:40320
    s_waitcnt vmcnt(7)
    s_waitcnt lgkmcnt(4)
    v_mfma_f32_16x16x32_bf16 v[16:19], v[56:59], a[24:27], v[16:19]
    s_add_u32 s36, s57, 14336
    buffer_load_dwordx4 a[56:59], v4, s[8:11], s36 offen
    ds_read_b64_tr_b16 v[56:57], v235 offset:44032
    ds_read_b64_tr_b16 v[58:59], v235 offset:45312
    v_mfma_f32_16x16x32_bf16 v[20:23], v[60:63], a[24:27], v[20:23]
    ds_read_b64_tr_b16 v[60:61], v235 offset:44064
    ds_read_b64_tr_b16 v[62:63], v235 offset:45344
    v_mfma_f32_16x16x32_bf16 v[24:27], v[64:67], a[24:27], v[24:27]
    ds_read_b64_tr_b16 v[64:65], v235 offset:44096
    ds_read_b64_tr_b16 v[66:67], v235 offset:45376
    s_waitcnt lgkmcnt(6)
    v_mfma_f32_16x16x32_bf16 v[28:31], v[68:71], a[24:27], v[28:31]
    ds_read_b64_tr_b16 v[68:69], v235 offset:44128
    ds_read_b64_tr_b16 v[70:71], v235 offset:45408
    v_mfma_f32_16x16x32_bf16 v[32:35], v[72:75], a[24:27], v[32:35]
    ds_read_b64_tr_b16 v[72:73], v235 offset:44160
    ds_read_b64_tr_b16 v[74:75], v235 offset:45440
    s_waitcnt vmcnt(7)
    s_waitcnt lgkmcnt(4)
    v_mfma_f32_16x16x32_bf16 v[16:19], v[56:59], a[28:31], v[16:19]
    s_add_u32 s36, s57, 15360
    buffer_load_dwordx4 a[60:63], v4, s[8:11], s36 offen
    ds_read_b64_tr_b16 v[56:57], v235 offset:49152
    ds_read_b64_tr_b16 v[58:59], v235 offset:50432
    v_mfma_f32_16x16x32_bf16 v[20:23], v[60:63], a[28:31], v[20:23]
    ds_read_b64_tr_b16 v[60:61], v235 offset:49184
    ds_read_b64_tr_b16 v[62:63], v235 offset:50464
    v_mfma_f32_16x16x32_bf16 v[24:27], v[64:67], a[28:31], v[24:27]
    ds_read_b64_tr_b16 v[64:65], v235 offset:49216
    ds_read_b64_tr_b16 v[66:67], v235 offset:50496
    s_waitcnt lgkmcnt(6)
    v_mfma_f32_16x16x32_bf16 v[28:31], v[68:71], a[28:31], v[28:31]
    ds_read_b64_tr_b16 v[68:69], v235 offset:49248
    ds_read_b64_tr_b16 v[70:71], v235 offset:50528
    v_mfma_f32_16x16x32_bf16 v[32:35], v[72:75], a[28:31], v[32:35]
    ds_read_b64_tr_b16 v[72:73], v235 offset:49280
    ds_read_b64_tr_b16 v[74:75], v235 offset:50560
    s_waitcnt vmcnt(7)
    s_waitcnt lgkmcnt(4)
    v_mfma_f32_16x16x32_bf16 v[16:19], v[56:59], a[32:35], v[16:19]
    s_add_u32 s36, s57, 16384
    buffer_load_dwordx4 a[64:67], v4, s[8:11], s36 offen
    ds_read_b64_tr_b16 v[56:57], v235 offset:54272
    ds_read_b64_tr_b16 v[58:59], v235 offset:55552
    v_mfma_f32_16x16x32_bf16 v[20:23], v[60:63], a[32:35], v[20:23]
    ds_read_b64_tr_b16 v[60:61], v235 offset:54304
    ds_read_b64_tr_b16 v[62:63], v235 offset:55584
    v_mfma_f32_16x16x32_bf16 v[24:27], v[64:67], a[32:35], v[24:27]
    ds_read_b64_tr_b16 v[64:65], v235 offset:54336
    ds_read_b64_tr_b16 v[66:67], v235 offset:55616
    s_waitcnt lgkmcnt(6)
    v_mfma_f32_16x16x32_bf16 v[28:31], v[68:71], a[32:35], v[28:31]
    ds_read_b64_tr_b16 v[68:69], v235 offset:54368
    ds_read_b64_tr_b16 v[70:71], v235 offset:55648
    v_mfma_f32_16x16x32_bf16 v[32:35], v[72:75], a[32:35], v[32:35]
    ds_read_b64_tr_b16 v[72:73], v235 offset:54400
    ds_read_b64_tr_b16 v[74:75], v235 offset:55680
    s_waitcnt vmcnt(7)
    s_waitcnt lgkmcnt(4)
    v_mfma_f32_16x16x32_bf16 v[16:19], v[56:59], a[36:39], v[16:19]
    s_add_u32 s36, s57, 17408
    buffer_load_dwordx4 a[68:71], v4, s[8:11], s36 offen
    ds_read_b64_tr_b16 v[56:57], v235 offset:59392
    ds_read_b64_tr_b16 v[58:59], v235 offset:60672
    v_mfma_f32_16x16x32_bf16 v[20:23], v[60:63], a[36:39], v[20:23]
    ds_read_b64_tr_b16 v[60:61], v235 offset:59424
    ds_read_b64_tr_b16 v[62:63], v235 offset:60704
    v_mfma_f32_16x16x32_bf16 v[24:27], v[64:67], a[36:39], v[24:27]
    ds_read_b64_tr_b16 v[64:65], v235 offset:59456
    ds_read_b64_tr_b16 v[66:67], v235 offset:60736
    s_waitcnt lgkmcnt(6)
    v_mfma_f32_16x16x32_bf16 v[28:31], v[68:71], a[36:39], v[28:31]
    ds_read_b64_tr_b16 v[68:69], v235 offset:59488
    ds_read_b64_tr_b16 v[70:71], v235 offset:60768
    v_mfma_f32_16x16x32_bf16 v[32:35], v[72:75], a[36:39], v[32:35]
    ds_read_b64_tr_b16 v[72:73], v235 offset:59520
    ds_read_b64_tr_b16 v[74:75], v235 offset:60800
    s_waitcnt vmcnt(7)
    s_waitcnt lgkmcnt(4)
    v_mfma_f32_16x16x32_bf16 v[16:19], v[56:59], a[40:43], v[16:19]
    s_add_u32 s36, s57, 18432
    buffer_load_dwordx4 a[72:75], v4, s[8:11], s36 offen
    ds_read_b64_tr_b16 v[56:57], v235 offset:64512
    ds_read_b64_tr_b16 v[58:59], v236 offset:256
    v_mfma_f32_16x16x32_bf16 v[20:23], v[60:63], a[40:43], v[20:23]
    ds_read_b64_tr_b16 v[60:61], v235 offset:64544
    ds_read_b64_tr_b16 v[62:63], v236 offset:288
    v_mfma_f32_16x16x32_bf16 v[24:27], v[64:67], a[40:43], v[24:27]
    ds_read_b64_tr_b16 v[64:65], v235 offset:64576
    ds_read_b64_tr_b16 v[66:67], v236 offset:320
    s_waitcnt lgkmcnt(6)
    v_mfma_f32_16x16x32_bf16 v[28:31], v[68:71], a[40:43], v[28:31]
    ds_read_b64_tr_b16 v[68:69], v235 offset:64608
    ds_read_b64_tr_b16 v[70:71], v236 offset:352
    v_mfma_f32_16x16x32_bf16 v[32:35], v[72:75], a[40:43], v[32:35]
    ds_read_b64_tr_b16 v[72:73], v235 offset:64640
    ds_read_b64_tr_b16 v[74:75], v236 offset:384
    s_waitcnt vmcnt(7)
    s_waitcnt lgkmcnt(4)
    v_mfma_f32_16x16x32_bf16 v[16:19], v[56:59], a[44:47], v[16:19]
    s_add_u32 s36, s57, 19456
    buffer_load_dwordx4 a[76:79], v4, s[8:11], s36 offen
    ds_read_b64_tr_b16 v[56:57], v236 offset:4096
    ds_read_b64_tr_b16 v[58:59], v236 offset:5376
    v_mfma_f32_16x16x32_bf16 v[20:23], v[60:63], a[44:47], v[20:23]
    ds_read_b64_tr_b16 v[60:61], v236 offset:4128
    ds_read_b64_tr_b16 v[62:63], v236 offset:5408
    v_mfma_f32_16x16x32_bf16 v[24:27], v[64:67], a[44:47], v[24:27]
    ds_read_b64_tr_b16 v[64:65], v236 offset:4160
    ds_read_b64_tr_b16 v[66:67], v236 offset:5440
    s_waitcnt lgkmcnt(6)
    v_mfma_f32_16x16x32_bf16 v[28:31], v[68:71], a[44:47], v[28:31]
    ds_read_b64_tr_b16 v[68:69], v236 offset:4192
    ds_read_b64_tr_b16 v[70:71], v236 offset:5472
    v_mfma_f32_16x16x32_bf16 v[32:35], v[72:75], a[44:47], v[32:35]
    ds_read_b64_tr_b16 v[72:73], v236 offset:4224
    ds_read_b64_tr_b16 v[74:75], v236 offset:5504
    s_waitcnt vmcnt(7)
    s_waitcnt lgkmcnt(4)
    v_mfma_f32_16x16x32_bf16 v[16:19], v[56:59], a[48:51], v[16:19]
    ds_read_b64_tr_b16 v[56:57], v236 offset:9216
    ds_read_b64_tr_b16 v[58:59], v236 offset:10496
    v_mfma_f32_16x16x32_bf16 v[20:23], v[60:63], a[48:51], v[20:23]
    ds_read_b64_tr_b16 v[60:61], v236 offset:9248
    ds_read_b64_tr_b16 v[62:63], v236 offset:10528
    v_mfma_f32_16x16x32_bf16 v[24:27], v[64:67], a[48:51], v[24:27]
    ds_read_b64_tr_b16 v[64:65], v236 offset:9280
    ds_read_b64_tr_b16 v[66:67], v236 offset:10560
    s_waitcnt lgkmcnt(6)
    v_mfma_f32_16x16x32_bf16 v[28:31], v[68:71], a[48:51], v[28:31]
    ds_read_b64_tr_b16 v[68:69], v236 offset:9312
    ds_read_b64_tr_b16 v[70:71], v236 offset:10592
    v_mfma_f32_16x16x32_bf16 v[32:35], v[72:75], a[48:51], v[32:35]
    ds_read_b64_tr_b16 v[72:73], v236 offset:9344
    ds_read_b64_tr_b16 v[74:75], v236 offset:10624
    s_waitcnt vmcnt(6)
    s_waitcnt lgkmcnt(4)
    v_mfma_f32_16x16x32_bf16 v[16:19], v[56:59], a[52:55], v[16:19]
    ds_read_b64_tr_b16 v[56:57], v236 offset:14336
    ds_read_b64_tr_b16 v[58:59], v236 offset:15616
    v_mfma_f32_16x16x32_bf16 v[20:23], v[60:63], a[52:55], v[20:23]
    ds_read_b64_tr_b16 v[60:61], v236 offset:14368
    ds_read_b64_tr_b16 v[62:63], v236 offset:15648
    v_mfma_f32_16x16x32_bf16 v[24:27], v[64:67], a[52:55], v[24:27]
    ds_read_b64_tr_b16 v[64:65], v236 offset:14400
    ds_read_b64_tr_b16 v[66:67], v236 offset:15680
    s_waitcnt lgkmcnt(6)
    v_mfma_f32_16x16x32_bf16 v[28:31], v[68:71], a[52:55], v[28:31]
    ds_read_b64_tr_b16 v[68:69], v236 offset:14432
    ds_read_b64_tr_b16 v[70:71], v236 offset:15712
    v_mfma_f32_16x16x32_bf16 v[32:35], v[72:75], a[52:55], v[32:35]
    ds_read_b64_tr_b16 v[72:73], v236 offset:14464
    ds_read_b64_tr_b16 v[74:75], v236 offset:15744
    s_waitcnt vmcnt(5)
    s_waitcnt lgkmcnt(4)
    v_mfma_f32_16x16x32_bf16 v[16:19], v[56:59], a[56:59], v[16:19]
    ds_read_b64_tr_b16 v[56:57], v236 offset:19456
    ds_read_b64_tr_b16 v[58:59], v236 offset:20736
    v_mfma_f32_16x16x32_bf16 v[20:23], v[60:63], a[56:59], v[20:23]
    ds_read_b64_tr_b16 v[60:61], v236 offset:19488
    ds_read_b64_tr_b16 v[62:63], v236 offset:20768
    v_mfma_f32_16x16x32_bf16 v[24:27], v[64:67], a[56:59], v[24:27]
    ds_read_b64_tr_b16 v[64:65], v236 offset:19520
    ds_read_b64_tr_b16 v[66:67], v236 offset:20800
    s_waitcnt lgkmcnt(6)
    v_mfma_f32_16x16x32_bf16 v[28:31], v[68:71], a[56:59], v[28:31]
    ds_read_b64_tr_b16 v[68:69], v236 offset:19552
    ds_read_b64_tr_b16 v[70:71], v236 offset:20832
    v_mfma_f32_16x16x32_bf16 v[32:35], v[72:75], a[56:59], v[32:35]
    ds_read_b64_tr_b16 v[72:73], v236 offset:19584
    ds_read_b64_tr_b16 v[74:75], v236 offset:20864
    s_waitcnt vmcnt(4)
    s_waitcnt lgkmcnt(4)
    v_mfma_f32_16x16x32_bf16 v[16:19], v[56:59], a[60:63], v[16:19]
    ds_read_b64_tr_b16 v[56:57], v224 offset:16704
    ds_read_b64_tr_b16 v[58:59], v224 offset:17984
    v_mfma_f32_16x16x32_bf16 v[20:23], v[60:63], a[60:63], v[20:23]
    ds_read_b64_tr_b16 v[60:61], v224 offset:16736
    ds_read_b64_tr_b16 v[62:63], v224 offset:18016
    v_mfma_f32_16x16x32_bf16 v[24:27], v[64:67], a[60:63], v[24:27]
    ds_read_b64_tr_b16 v[64:65], v224 offset:16768
    ds_read_b64_tr_b16 v[66:67], v224 offset:18048
    s_waitcnt lgkmcnt(6)
    v_mfma_f32_16x16x32_bf16 v[28:31], v[68:71], a[60:63], v[28:31]
    ds_read_b64_tr_b16 v[68:69], v224 offset:16800
    ds_read_b64_tr_b16 v[70:71], v224 offset:18080
    v_mfma_f32_16x16x32_bf16 v[32:35], v[72:75], a[60:63], v[32:35]
    ds_read_b64_tr_b16 v[72:73], v224 offset:16832
    ds_read_b64_tr_b16 v[74:75], v224 offset:18112
    s_waitcnt vmcnt(3)
    s_waitcnt lgkmcnt(4)
    v_mfma_f32_16x16x32_bf16 v[16:19], v[56:59], a[64:67], v[16:19]
    ds_read_b64_tr_b16 v[56:57], v224 offset:21824
    ds_read_b64_tr_b16 v[58:59], v224 offset:23104
    v_mfma_f32_16x16x32_bf16 v[20:23], v[60:63], a[64:67], v[20:23]
    ds_read_b64_tr_b16 v[60:61], v224 offset:21856
    ds_read_b64_tr_b16 v[62:63], v224 offset:23136
    v_mfma_f32_16x16x32_bf16 v[24:27], v[64:67], a[64:67], v[24:27]
    ds_read_b64_tr_b16 v[64:65], v224 offset:21888
    ds_read_b64_tr_b16 v[66:67], v224 offset:23168
    s_waitcnt lgkmcnt(6)
    v_mfma_f32_16x16x32_bf16 v[28:31], v[68:71], a[64:67], v[28:31]
    ds_read_b64_tr_b16 v[68:69], v224 offset:21920
    ds_read_b64_tr_b16 v[70:71], v224 offset:23200
    v_mfma_f32_16x16x32_bf16 v[32:35], v[72:75], a[64:67], v[32:35]
    ds_read_b64_tr_b16 v[72:73], v224 offset:21952
    ds_read_b64_tr_b16 v[74:75], v224 offset:23232
    s_waitcnt vmcnt(2)
    s_waitcnt lgkmcnt(4)
    v_mfma_f32_16x16x32_bf16 v[16:19], v[56:59], a[68:71], v[16:19]
    ds_read_b64_tr_b16 v[56:57], v224 offset:26944
    ds_read_b64_tr_b16 v[58:59], v224 offset:28224
    v_mfma_f32_16x16x32_bf16 v[20:23], v[60:63], a[68:71], v[20:23]
    ds_read_b64_tr_b16 v[60:61], v224 offset:26976
    ds_read_b64_tr_b16 v[62:63], v224 offset:28256
    v_mfma_f32_16x16x32_bf16 v[24:27], v[64:67], a[68:71], v[24:27]
    ds_read_b64_tr_b16 v[64:65], v224 offset:27008
    ds_read_b64_tr_b16 v[66:67], v224 offset:28288
    s_waitcnt lgkmcnt(6)
    v_mfma_f32_16x16x32_bf16 v[28:31], v[68:71], a[68:71], v[28:31]
    ds_read_b64_tr_b16 v[68:69], v224 offset:27040
    ds_read_b64_tr_b16 v[70:71], v224 offset:28320
    v_mfma_f32_16x16x32_bf16 v[32:35], v[72:75], a[68:71], v[32:35]
    ds_read_b64_tr_b16 v[72:73], v224 offset:27072
    ds_read_b64_tr_b16 v[74:75], v224 offset:28352
    s_waitcnt vmcnt(1)
    s_waitcnt lgkmcnt(4)
    v_mfma_f32_16x16x32_bf16 v[16:19], v[56:59], a[72:75], v[16:19]
    ds_read_b64_tr_b16 v[56:57], v224 offset:32064
    ds_read_b64_tr_b16 v[58:59], v224 offset:33344
    v_mfma_f32_16x16x32_bf16 v[20:23], v[60:63], a[72:75], v[20:23]
    ds_read_b64_tr_b16 v[60:61], v224 offset:32096
    ds_read_b64_tr_b16 v[62:63], v224 offset:33376
    v_mfma_f32_16x16x32_bf16 v[24:27], v[64:67], a[72:75], v[24:27]
    ds_read_b64_tr_b16 v[64:65], v224 offset:32128
    ds_read_b64_tr_b16 v[66:67], v224 offset:33408
    s_waitcnt lgkmcnt(6)
    v_mfma_f32_16x16x32_bf16 v[28:31], v[68:71], a[72:75], v[28:31]
    ds_read_b64_tr_b16 v[68:69], v224 offset:32160
    ds_read_b64_tr_b16 v[70:71], v224 offset:33440
    v_mfma_f32_16x16x32_bf16 v[32:35], v[72:75], a[72:75], v[32:35]
    ds_read_b64_tr_b16 v[72:73], v224 offset:32192
    ds_read_b64_tr_b16 v[74:75], v224 offset:33472
    s_waitcnt vmcnt(0)
    s_waitcnt lgkmcnt(4)
    v_mfma_f32_16x16x32_bf16 v[16:19], v[56:59], a[76:79], v[16:19]
    v_mfma_f32_16x16x32_bf16 v[20:23], v[60:63], a[76:79], v[20:23]
    v_mfma_f32_16x16x32_bf16 v[24:27], v[64:67], a[76:79], v[24:27]
    s_waitcnt lgkmcnt(0)
    v_mfma_f32_16x16x32_bf16 v[28:31], v[68:71], a[76:79], v[28:31]
    v_mfma_f32_16x16x32_bf16 v[32:35], v[72:75], a[76:79], v[32:35]
    s_nop 7
    v_cvt_pk_bf16_f32 v92, v16, v17
    v_cvt_pk_bf16_f32 v93, v18, v19
    v_cvt_pk_bf16_f32 v94, v20, v21
    v_cvt_pk_bf16_f32 v95, v22, v23
    v_cvt_pk_bf16_f32 v96, v24, v25
    v_cvt_pk_bf16_f32 v97, v26, v27
    v_cvt_pk_bf16_f32 v98, v28, v29
    v_cvt_pk_bf16_f32 v99, v30, v31
    v_cvt_pk_bf16_f32 v100, v32, v33
    v_cvt_pk_bf16_f32 v101, v34, v35
    s_mul_i32 s21, s61, 163840
    s_add_u32 s21, s21, s55
    v_permlane16_swap_b32 v92, v94
    v_permlane16_swap_b32 v93, v95
    v_permlane16_swap_b32 v96, v98
    v_permlane16_swap_b32 v97, v99
    buffer_store_dwordx4 v[92:95], v245, s[16:19], s21 offen
    buffer_store_dwordx4 v[96:99], v245, s[16:19], s21 offen offset:64
    buffer_store_dwordx2 v[100:101], v205, s[16:19], s21 offen offset:128
    s_endpgm
mg_slow:
    s_barrier
    s_cmp_lg_u32 s20, 0
    s_cbranch_scc1 mg_sl_nodump
    v_lshlrev_b32 v13, 3, v1
    ds_write_b128 v4, v[128:131] offset:13312
    ds_write_b64 v13, v[132:133] offset:14336
    ds_write_b128 v4, v[134:137] offset:14848
    ds_write_b64 v13, v[138:139] offset:15872
    ds_write_b128 v4, v[140:143] offset:16384
    ds_write_b64 v13, v[144:145] offset:17408
    ds_write_b128 v4, v[146:149] offset:17920
    ds_write_b64 v13, v[150:151] offset:18944
    ds_write_b128 v4, v[152:155] offset:19456
    ds_write_b64 v13, v[156:157] offset:20480
    ds_write_b128 v4, v[158:161] offset:20992
    ds_write_b64 v13, v[162:163] offset:22016
    ds_write_b128 v4, v[164:167] offset:10240
    ds_write_b64 v13, v[168:169] offset:11264
    ds_write_b128 v4, v[170:173] offset:11776
    ds_write_b64 v13, v[174:175] offset:12800
    s_waitcnt lgkmcnt(0)
mg_sl_nodump:
    s_barrier
    s_mov_b32 s56, 0
    v_and_b32 v12, 31, v1
    v_lshlrev_b32 v12, 2, v12
    s_lshl_b32 s21, s20, 7
    s_add_u32 s21, s21, 22528
    v_add_u32 v72, s21, v12
    v_add_u32 v73, 22528, v12
    s_mul_i32 s21, s20, 3072
    s_add_u32 s21, s21, 24576
    v_add_u32 v74, s21, v4
    v_add_u32 v75, 24576, v4
mg_sl_loop:
    s_mul_i32 s21, s56, 1536
    s_add_u32 s21, s21, 10240
    v_add_u32 v14, s21, v4
    v_lshlrev_b32 v15, 3, v1
    v_add_u32 v15, s21, v15
    ds_read_b128 v[64:67], v14
    ds_read_b64 v[68:69], v15 offset:1024
    v_mov_b32 v70, 0xff800000
    s_waitcnt lgkmcnt(0)
    v_mfma_f32_32x32x16_bf16 v[16:31], a[0:3], v[64:67], 0
    v_mfma_f32_32x32x8_bf16 v[16:31], a[64:65], v[68:69], v[16:31]
    s_nop 11
    v_max3_f32 v70, v70, v16, v17
    v_max3_f32 v70, v70, v18, v19
    v_max3_f32 v70, v70, v20, v21
    v_max3_f32 v70, v70, v22, v23
    v_max3_f32 v70, v70, v24, v25
    v_max3_f32 v70, v70, v26, v27
    v_max3_f32 v70, v70, v28, v29
    v_max3_f32 v70, v70, v30, v31
    s_nop 6
    v_mfma_f32_32x32x16_bf16 v[16:31], a[4:7], v[64:67], 0
    v_mfma_f32_32x32x8_bf16 v[16:31], a[66:67], v[68:69], v[16:31]
    s_nop 11
    v_max3_f32 v70, v70, v16, v17
    v_max3_f32 v70, v70, v18, v19
    v_max3_f32 v70, v70, v20, v21
    v_max3_f32 v70, v70, v22, v23
    v_max3_f32 v70, v70, v24, v25
    v_max3_f32 v70, v70, v26, v27
    v_max3_f32 v70, v70, v28, v29
    v_max3_f32 v70, v70, v30, v31
    s_nop 6
    v_mfma_f32_32x32x16_bf16 v[16:31], a[8:11], v[64:67], 0
    v_mfma_f32_32x32x8_bf16 v[16:31], a[68:69], v[68:69], v[16:31]
    s_nop 11
    v_max3_f32 v70, v70, v16, v17
    v_max3_f32 v70, v70, v18, v19
    v_max3_f32 v70, v70, v20, v21
    v_max3_f32 v70, v70, v22, v23
    v_max3_f32 v70, v70, v24, v25
    v_max3_f32 v70, v70, v26, v27
    v_max3_f32 v70, v70, v28, v29
    v_max3_f32 v70, v70, v30, v31
    s_nop 6
    v_mfma_f32_32x32x16_bf16 v[16:31], a[12:15], v[64:67], 0
    v_mfma_f32_32x32x8_bf16 v[16:31], a[70:71], v[68:69], v[16:31]
    s_nop 11
    v_max3_f32 v70, v70, v16, v17
    v_max3_f32 v70, v70, v18, v19
    v_max3_f32 v70, v70, v20, v21
    v_max3_f32 v70, v70, v22, v23
    v_max3_f32 v70, v70, v24, v25
    v_max3_f32 v70, v70, v26, v27
    v_max3_f32 v70, v70, v28, v29
    v_max3_f32 v70, v70, v30, v31
    s_nop 6
    v_mfma_f32_32x32x16_bf16 v[16:31], a[16:19], v[64:67], 0
    v_mfma_f32_32x32x8_bf16 v[16:31], a[72:73], v[68:69], v[16:31]
    s_nop 11
    v_max3_f32 v70, v70, v16, v17
    v_max3_f32 v70, v70, v18, v19
    v_max3_f32 v70, v70, v20, v21
    v_max3_f32 v70, v70, v22, v23
    v_max3_f32 v70, v70, v24, v25
    v_max3_f32 v70, v70, v26, v27
    v_max3_f32 v70, v70, v28, v29
    v_max3_f32 v70, v70, v30, v31
    s_nop 6
    v_mfma_f32_32x32x16_bf16 v[16:31], a[20:23], v[64:67], 0
    v_mfma_f32_32x32x8_bf16 v[16:31], a[74:75], v[68:69], v[16:31]
    s_nop 11
    v_max3_f32 v70, v70, v16, v17
    v_max3_f32 v70, v70, v18, v19
    v_max3_f32 v70, v70, v20, v21
    v_max3_f32 v70, v70, v22, v23
    v_max3_f32 v70, v70, v24, v25
    v_max3_f32 v70, v70, v26, v27
    v_max3_f32 v70, v70, v28, v29
    v_max3_f32 v70, v70, v30, v31
    s_nop 6
    v_mfma_f32_32x32x16_bf16 v[16:31], a[24:27], v[64:67], 0
    v_mfma_f32_32x32x8_bf16 v[16:31], a[76:77], v[68:69], v[16:31]
    s_nop 11
    v_max3_f32 v70, v70, v16, v17
    v_max3_f32 v70, v70, v18, v19
    v_max3_f32 v70, v70, v20, v21
    v_max3_f32 v70, v70, v22, v23
    v_max3_f32 v70, v70, v24, v25
    v_max3_f32 v70, v70, v26, v27
    v_max3_f32 v70, v70, v28, v29
    v_max3_f32 v70, v70, v30, v31
    s_nop 6
    v_mfma_f32_32x32x16_bf16 v[16:31], a[28:31], v[64:67], 0
    v_mfma_f32_32x32x8_bf16 v[16:31], a[78:79], v[68:69], v[16:31]
    s_nop 11
    v_max3_f32 v70, v70, v16, v17
    v_max3_f32 v70, v70, v18, v19
    v_max3_f32 v70, v70, v20, v21
    v_max3_f32 v70, v70, v22, v23
    v_max3_f32 v70, v70, v24, v25
    v_max3_f32 v70, v70, v26, v27
    v_max3_f32 v70, v70, v28, v29
    v_max3_f32 v70, v70, v30, v31
    s_nop 6
    v_mfma_f32_32x32x16_bf16 v[16:31], a[32:35], v[64:67], 0
    v_mfma_f32_32x32x8_bf16 v[16:31], a[80:81], v[68:69], v[16:31]
    s_nop 11
    v_max3_f32 v70, v70, v16, v17
    v_max3_f32 v70, v70, v18, v19
    v_max3_f32 v70, v70, v20, v21
    v_max3_f32 v70, v70, v22, v23
    v_max3_f32 v70, v70, v24, v25
    v_max3_f32 v70, v70, v26, v27
    v_max3_f32 v70, v70, v28, v29
    v_max3_f32 v70, v70, v30, v31
    s_nop 6
    v_mfma_f32_32x32x16_bf16 v[16:31], a[36:39], v[64:67], 0
    v_mfma_f32_32x32x8_bf16 v[16:31], a[82:83], v[68:69], v[16:31]
    s_nop 11
    v_max3_f32 v70, v70, v16, v17
    v_max3_f32 v70, v70, v18, v19
    v_max3_f32 v70, v70, v20, v21
    v_max3_f32 v70, v70, v22, v23
    v_max3_f32 v70, v70, v24, v25
    v_max3_f32 v70, v70, v26, v27
    v_max3_f32 v70, v70, v28, v29
    v_max3_f32 v70, v70, v30, v31
    s_nop 6
    v_mfma_f32_32x32x16_bf16 v[16:31], a[40:43], v[64:67], 0
    v_mfma_f32_32x32x8_bf16 v[16:31], a[84:85], v[68:69], v[16:31]
    s_nop 11
    v_max3_f32 v70, v70, v16, v17
    v_max3_f32 v70, v70, v18, v19
    v_max3_f32 v70, v70, v20, v21
    v_max3_f32 v70, v70, v22, v23
    v_max3_f32 v70, v70, v24, v25
    v_max3_f32 v70, v70, v26, v27
    v_max3_f32 v70, v70, v28, v29
    v_max3_f32 v70, v70, v30, v31
    s_nop 6
    v_mfma_f32_32x32x16_bf16 v[16:31], a[44:47], v[64:67], 0
    v_mfma_f32_32x32x8_bf16 v[16:31], a[86:87], v[68:69], v[16:31]
    s_nop 11
    v_max3_f32 v70, v70, v16, v17
    v_max3_f32 v70, v70, v18, v19
    v_max3_f32 v70, v70, v20, v21
    v_max3_f32 v70, v70, v22, v23
    v_max3_f32 v70, v70, v24, v25
    v_max3_f32 v70, v70, v26, v27
    v_max3_f32 v70, v70, v28, v29
    v_max3_f32 v70, v70, v30, v31
    s_nop 6
    v_mfma_f32_32x32x16_bf16 v[16:31], a[48:51], v[64:67], 0
    v_mfma_f32_32x32x8_bf16 v[16:31], a[88:89], v[68:69], v[16:31]
    s_nop 11
    v_max3_f32 v70, v70, v16, v17
    v_max3_f32 v70, v70, v18, v19
    v_max3_f32 v70, v70, v20, v21
    v_max3_f32 v70, v70, v22, v23
    v_max3_f32 v70, v70, v24, v25
    v_max3_f32 v70, v70, v26, v27
    v_max3_f32 v70, v70, v28, v29
    v_max3_f32 v70, v70, v30, v31
    s_nop 6
    v_mfma_f32_32x32x16_bf16 v[16:31], a[52:55], v[64:67], 0
    v_mfma_f32_32x32x8_bf16 v[16:31], a[90:91], v[68:69], v[16:31]
    s_nop 11
    v_max3_f32 v70, v70, v16, v17
    v_max3_f32 v70, v70, v18, v19
    v_max3_f32 v70, v70, v20, v21
    v_max3_f32 v70, v70, v22, v23
    v_max3_f32 v70, v70, v24, v25
    v_max3_f32 v70, v70, v26, v27
    v_max3_f32 v70, v70, v28, v29
    v_max3_f32 v70, v70, v30, v31
    s_nop 6
    v_mfma_f32_32x32x16_bf16 v[16:31], a[56:59], v[64:67], 0
    v_mfma_f32_32x32x8_bf16 v[16:31], a[92:93], v[68:69], v[16:31]
    s_nop 11
    v_max3_f32 v70, v70, v16, v17
    v_max3_f32 v70, v70, v18, v19
    v_max3_f32 v70, v70, v20, v21
    v_max3_f32 v70, v70, v22, v23
    v_max3_f32 v70, v70, v24, v25
    v_max3_f32 v70, v70, v26, v27
    v_max3_f32 v70, v70, v28, v29
    v_max3_f32 v70, v70, v30, v31
    s_nop 6
    v_mfma_f32_32x32x16_bf16 v[16:31], a[60:63], v[64:67], 0
    v_mfma_f32_32x32x8_bf16 v[16:31], a[94:95], v[68:69], v[16:31]
    s_nop 11
    v_max3_f32 v70, v70, v16, v17
    v_max3_f32 v70, v70, v18, v19
    v_max3_f32 v70, v70, v20, v21
    v_max3_f32 v70, v70, v22, v23
    v_max3_f32 v70, v70, v24, v25
    v_max3_f32 v70, v70, v26, v27
    v_max3_f32 v70, v70, v28, v29
    v_max3_f32 v70, v70, v30, v31
    s_nop 6
    v_mov_b32 v71, v70
    v_mov_b32 v76, v70
    s_nop 1
    v_permlane32_swap_b32 v71, v76
    s_nop 1
    v_max3_f32 v70, v70, v71, v76
    ds_write_b32 v72, v70
    s_waitcnt lgkmcnt(0)
    s_barrier
    ds_read_b32 v76, v73 offset:0
    ds_read_b32 v77, v73 offset:128
    ds_read_b32 v78, v73 offset:256
    ds_read_b32 v79, v73 offset:384
    s_waitcnt lgkmcnt(0)
    v_max3_f32 v71, v76, v77, v78
    v_max_f32 v71, v71, v79
    v_mfma_f32_32x32x16_bf16 v[16:31], a[0:3], v[64:67], 0
    v_mfma_f32_32x32x8_bf16 v[16:31], a[64:65], v[68:69], v[16:31]
    s_nop 11
    v_sub_f32 v16, v16, v71
    v_sub_f32 v17, v17, v71
    v_sub_f32 v18, v18, v71
    v_sub_f32 v19, v19, v71
    v_sub_f32 v20, v20, v71
    v_sub_f32 v21, v21, v71
    v_sub_f32 v22, v22, v71
    v_sub_f32 v23, v23, v71
    v_sub_f32 v24, v24, v71
    v_sub_f32 v25, v25, v71
    v_sub_f32 v26, v26, v71
    v_sub_f32 v27, v27, v71
    v_sub_f32 v28, v28, v71
    v_sub_f32 v29, v29, v71
    v_sub_f32 v30, v30, v71
    v_sub_f32 v31, v31, v71
    v_exp_f32 v16, v16
    v_exp_f32 v17, v17
    v_exp_f32 v18, v18
    v_exp_f32 v19, v19
    v_exp_f32 v20, v20
    v_exp_f32 v21, v21
    v_exp_f32 v22, v22
    v_exp_f32 v23, v23
    v_exp_f32 v24, v24
    v_exp_f32 v25, v25
    v_exp_f32 v26, v26
    v_exp_f32 v27, v27
    v_exp_f32 v28, v28
    v_exp_f32 v29, v29
    v_exp_f32 v30, v30
    v_exp_f32 v31, v31
    s_nop 0
    v_cvt_pk_bf16_f32 v48, v16, v17
    v_cvt_pk_bf16_f32 v49, v18, v19
    v_cvt_pk_bf16_f32 v50, v20, v21
    v_cvt_pk_bf16_f32 v51, v22, v23
    v_cvt_pk_bf16_f32 v52, v24, v25
    v_cvt_pk_bf16_f32 v53, v26, v27
    v_cvt_pk_bf16_f32 v54, v28, v29
    v_cvt_pk_bf16_f32 v55, v30, v31
    s_nop 1
    v_mfma_f32_32x32x16_bf16 v[80:95], a[96:99], v[48:51], 0
    v_mfma_f32_32x32x16_bf16 v[80:95], a[100:103], v[52:55], v[80:95]
    s_nop 6
    v_mfma_f32_32x32x16_bf16 v[16:31], a[4:7], v[64:67], 0
    v_mfma_f32_32x32x8_bf16 v[16:31], a[66:67], v[68:69], v[16:31]
    s_nop 11
    v_sub_f32 v16, v16, v71
    v_sub_f32 v17, v17, v71
    v_sub_f32 v18, v18, v71
    v_sub_f32 v19, v19, v71
    v_sub_f32 v20, v20, v71
    v_sub_f32 v21, v21, v71
    v_sub_f32 v22, v22, v71
    v_sub_f32 v23, v23, v71
    v_sub_f32 v24, v24, v71
    v_sub_f32 v25, v25, v71
    v_sub_f32 v26, v26, v71
    v_sub_f32 v27, v27, v71
    v_sub_f32 v28, v28, v71
    v_sub_f32 v29, v29, v71
    v_sub_f32 v30, v30, v71
    v_sub_f32 v31, v31, v71
    v_exp_f32 v16, v16
    v_exp_f32 v17, v17
    v_exp_f32 v18, v18
    v_exp_f32 v19, v19
    v_exp_f32 v20, v20
    v_exp_f32 v21, v21
    v_exp_f32 v22, v22
    v_exp_f32 v23, v23
    v_exp_f32 v24, v24
    v_exp_f32 v25, v25
    v_exp_f32 v26, v26
    v_exp_f32 v27, v27
    v_exp_f32 v28, v28
    v_exp_f32 v29, v29
    v_exp_f32 v30, v30
    v_exp_f32 v31, v31
    s_nop 0
    v_cvt_pk_bf16_f32 v48, v16, v17
    v_cvt_pk_bf16_f32 v49, v18, v19
    v_cvt_pk_bf16_f32 v50, v20, v21
    v_cvt_pk_bf16_f32 v51, v22, v23
    v_cvt_pk_bf16_f32 v52, v24, v25
    v_cvt_pk_bf16_f32 v53, v26, v27
    v_cvt_pk_bf16_f32 v54, v28, v29
    v_cvt_pk_bf16_f32 v55, v30, v31
    s_nop 1
    v_mfma_f32_32x32x16_bf16 v[80:95], a[104:107], v[48:51], v[80:95]
    v_mfma_f32_32x32x16_bf16 v[80:95], a[108:111], v[52:55], v[80:95]
    s_nop 6
    v_mfma_f32_32x32x16_bf16 v[16:31], a[8:11], v[64:67], 0
    v_mfma_f32_32x32x8_bf16 v[16:31], a[68:69], v[68:69], v[16:31]
    s_nop 11
    v_sub_f32 v16, v16, v71
    v_sub_f32 v17, v17, v71
    v_sub_f32 v18, v18, v71
    v_sub_f32 v19, v19, v71
    v_sub_f32 v20, v20, v71
    v_sub_f32 v21, v21, v71
    v_sub_f32 v22, v22, v71
    v_sub_f32 v23, v23, v71
    v_sub_f32 v24, v24, v71
    v_sub_f32 v25, v25, v71
    v_sub_f32 v26, v26, v71
    v_sub_f32 v27, v27, v71
    v_sub_f32 v28, v28, v71
    v_sub_f32 v29, v29, v71
    v_sub_f32 v30, v30, v71
    v_sub_f32 v31, v31, v71
    v_exp_f32 v16, v16
    v_exp_f32 v17, v17
    v_exp_f32 v18, v18
    v_exp_f32 v19, v19
    v_exp_f32 v20, v20
    v_exp_f32 v21, v21
    v_exp_f32 v22, v22
    v_exp_f32 v23, v23
    v_exp_f32 v24, v24
    v_exp_f32 v25, v25
    v_exp_f32 v26, v26
    v_exp_f32 v27, v27
    v_exp_f32 v28, v28
    v_exp_f32 v29, v29
    v_exp_f32 v30, v30
    v_exp_f32 v31, v31
    s_nop 0
    v_cvt_pk_bf16_f32 v48, v16, v17
    v_cvt_pk_bf16_f32 v49, v18, v19
    v_cvt_pk_bf16_f32 v50, v20, v21
    v_cvt_pk_bf16_f32 v51, v22, v23
    v_cvt_pk_bf16_f32 v52, v24, v25
    v_cvt_pk_bf16_f32 v53, v26, v27
    v_cvt_pk_bf16_f32 v54, v28, v29
    v_cvt_pk_bf16_f32 v55, v30, v31
    s_nop 1
    v_mfma_f32_32x32x16_bf16 v[80:95], a[112:115], v[48:51], v[80:95]
    v_mfma_f32_32x32x16_bf16 v[80:95], a[116:119], v[52:55], v[80:95]
    s_nop 6
    v_mfma_f32_32x32x16_bf16 v[16:31], a[12:15], v[64:67], 0
    v_mfma_f32_32x32x8_bf16 v[16:31], a[70:71], v[68:69], v[16:31]
    s_nop 11
    v_sub_f32 v16, v16, v71
    v_sub_f32 v17, v17, v71
    v_sub_f32 v18, v18, v71
    v_sub_f32 v19, v19, v71
    v_sub_f32 v20, v20, v71
    v_sub_f32 v21, v21, v71
    v_sub_f32 v22, v22, v71
    v_sub_f32 v23, v23, v71
    v_sub_f32 v24, v24, v71
    v_sub_f32 v25, v25, v71
    v_sub_f32 v26, v26, v71
    v_sub_f32 v27, v27, v71
    v_sub_f32 v28, v28, v71
    v_sub_f32 v29, v29, v71
    v_sub_f32 v30, v30, v71
    v_sub_f32 v31, v31, v71
    v_exp_f32 v16, v16
    v_exp_f32 v17, v17
    v_exp_f32 v18, v18
    v_exp_f32 v19, v19
    v_exp_f32 v20, v20
    v_exp_f32 v21, v21
    v_exp_f32 v22, v22
    v_exp_f32 v23, v23
    v_exp_f32 v24, v24
    v_exp_f32 v25, v25
    v_exp_f32 v26, v26
    v_exp_f32 v27, v27
    v_exp_f32 v28, v28
    v_exp_f32 v29, v29
    v_exp_f32 v30, v30
    v_exp_f32 v31, v31
    s_nop 0
    v_cvt_pk_bf16_f32 v48, v16, v17
    v_cvt_pk_bf16_f32 v49, v18, v19
    v_cvt_pk_bf16_f32 v50, v20, v21
    v_cvt_pk_bf16_f32 v51, v22, v23
    v_cvt_pk_bf16_f32 v52, v24, v25
    v_cvt_pk_bf16_f32 v53, v26, v27
    v_cvt_pk_bf16_f32 v54, v28, v29
    v_cvt_pk_bf16_f32 v55, v30, v31
    s_nop 1
    v_mfma_f32_32x32x16_bf16 v[80:95], a[120:123], v[48:51], v[80:95]
    v_mfma_f32_32x32x16_bf16 v[80:95], a[124:127], v[52:55], v[80:95]
    s_nop 6
    v_mfma_f32_32x32x16_bf16 v[16:31], a[16:19], v[64:67], 0
    v_mfma_f32_32x32x8_bf16 v[16:31], a[72:73], v[68:69], v[16:31]
    s_nop 11
    v_sub_f32 v16, v16, v71
    v_sub_f32 v17, v17, v71
    v_sub_f32 v18, v18, v71
    v_sub_f32 v19, v19, v71
    v_sub_f32 v20, v20, v71
    v_sub_f32 v21, v21, v71
    v_sub_f32 v22, v22, v71
    v_sub_f32 v23, v23, v71
    v_sub_f32 v24, v24, v71
    v_sub_f32 v25, v25, v71
    v_sub_f32 v26, v26, v71
    v_sub_f32 v27, v27, v71
    v_sub_f32 v28, v28, v71
    v_sub_f32 v29, v29, v71
    v_sub_f32 v30, v30, v71
    v_sub_f32 v31, v31, v71
    v_exp_f32 v16, v16
    v_exp_f32 v17, v17
    v_exp_f32 v18, v18
    v_exp_f32 v19, v19
    v_exp_f32 v20, v20
    v_exp_f32 v21, v21
    v_exp_f32 v22, v22
    v_exp_f32 v23, v23
    v_exp_f32 v24, v24
    v_exp_f32 v25, v25
    v_exp_f32 v26, v26
    v_exp_f32 v27, v27
    v_exp_f32 v28, v28
    v_exp_f32 v29, v29
    v_exp_f32 v30, v30
    v_exp_f32 v31, v31
    s_nop 0
    v_cvt_pk_bf16_f32 v48, v16, v17
    v_cvt_pk_bf16_f32 v49, v18, v19
    v_cvt_pk_bf16_f32 v50, v20, v21
    v_cvt_pk_bf16_f32 v51, v22, v23
    v_cvt_pk_bf16_f32 v52, v24, v25
    v_cvt_pk_bf16_f32 v53, v26, v27
    v_cvt_pk_bf16_f32 v54, v28, v29
    v_cvt_pk_bf16_f32 v55, v30, v31
    s_nop 1
    v_mfma_f32_32x32x16_bf16 v[80:95], a[128:131], v[48:51], v[80:95]
    v_mfma_f32_32x32x16_bf16 v[80:95], a[132:135], v[52:55], v[80:95]
    s_nop 6
    v_mfma_f32_32x32x16_bf16 v[16:31], a[20:23], v[64:67], 0
    v_mfma_f32_32x32x8_bf16 v[16:31], a[74:75], v[68:69], v[16:31]
    s_nop 11
    v_sub_f32 v16, v16, v71
    v_sub_f32 v17, v17, v71
    v_sub_f32 v18, v18, v71
    v_sub_f32 v19, v19, v71
    v_sub_f32 v20, v20, v71
    v_sub_f32 v21, v21, v71
    v_sub_f32 v22, v22, v71
    v_sub_f32 v23, v23, v71
    v_sub_f32 v24, v24, v71
    v_sub_f32 v25, v25, v71
    v_sub_f32 v26, v26, v71
    v_sub_f32 v27, v27, v71
    v_sub_f32 v28, v28, v71
    v_sub_f32 v29, v29, v71
    v_sub_f32 v30, v30, v71
    v_sub_f32 v31, v31, v71
    v_exp_f32 v16, v16
    v_exp_f32 v17, v17
    v_exp_f32 v18, v18
    v_exp_f32 v19, v19
    v_exp_f32 v20, v20
    v_exp_f32 v21, v21
    v_exp_f32 v22, v22
    v_exp_f32 v23, v23
    v_exp_f32 v24, v24
    v_exp_f32 v25, v25
    v_exp_f32 v26, v26
    v_exp_f32 v27, v27
    v_exp_f32 v28, v28
    v_exp_f32 v29, v29
    v_exp_f32 v30, v30
    v_exp_f32 v31, v31
    s_nop 0
    v_cvt_pk_bf16_f32 v48, v16, v17
    v_cvt_pk_bf16_f32 v49, v18, v19
    v_cvt_pk_bf16_f32 v50, v20, v21
    v_cvt_pk_bf16_f32 v51, v22, v23
    v_cvt_pk_bf16_f32 v52, v24, v25
    v_cvt_pk_bf16_f32 v53, v26, v27
    v_cvt_pk_bf16_f32 v54, v28, v29
    v_cvt_pk_bf16_f32 v55, v30, v31
    s_nop 1
    v_mfma_f32_32x32x16_bf16 v[80:95], a[136:139], v[48:51], v[80:95]
    v_mfma_f32_32x32x16_bf16 v[80:95], a[140:143], v[52:55], v[80:95]
    s_nop 6
    v_mfma_f32_32x32x16_bf16 v[16:31], a[24:27], v[64:67], 0
    v_mfma_f32_32x32x8_bf16 v[16:31], a[76:77], v[68:69], v[16:31]
    s_nop 11
    v_sub_f32 v16, v16, v71
    v_sub_f32 v17, v17, v71
    v_sub_f32 v18, v18, v71
    v_sub_f32 v19, v19, v71
    v_sub_f32 v20, v20, v71
    v_sub_f32 v21, v21, v71
    v_sub_f32 v22, v22, v71
    v_sub_f32 v23, v23, v71
    v_sub_f32 v24, v24, v71
    v_sub_f32 v25, v25, v71
    v_sub_f32 v26, v26, v71
    v_sub_f32 v27, v27, v71
    v_sub_f32 v28, v28, v71
    v_sub_f32 v29, v29, v71
    v_sub_f32 v30, v30, v71
    v_sub_f32 v31, v31, v71
    v_exp_f32 v16, v16
    v_exp_f32 v17, v17
    v_exp_f32 v18, v18
    v_exp_f32 v19, v19
    v_exp_f32 v20, v20
    v_exp_f32 v21, v21
    v_exp_f32 v22, v22
    v_exp_f32 v23, v23
    v_exp_f32 v24, v24
    v_exp_f32 v25, v25
    v_exp_f32 v26, v26
    v_exp_f32 v27, v27
    v_exp_f32 v28, v28
    v_exp_f32 v29, v29
    v_exp_f32 v30, v30
    v_exp_f32 v31, v31
    s_nop 0
    v_cvt_pk_bf16_f32 v48, v16, v17
    v_cvt_pk_bf16_f32 v49, v18, v19
    v_cvt_pk_bf16_f32 v50, v20, v21
    v_cvt_pk_bf16_f32 v51, v22, v23
    v_cvt_pk_bf16_f32 v52, v24, v25
    v_cvt_pk_bf16_f32 v53, v26, v27
    v_cvt_pk_bf16_f32 v54, v28, v29
    v_cvt_pk_bf16_f32 v55, v30, v31
    s_nop 1
    v_mfma_f32_32x32x16_bf16 v[80:95], a[144:147], v[48:51], v[80:95]
    v_mfma_f32_32x32x16_bf16 v[80:95], a[148:151], v[52:55], v[80:95]
    s_nop 6
    v_mfma_f32_32x32x16_bf16 v[16:31], a[28:31], v[64:67], 0
    v_mfma_f32_32x32x8_bf16 v[16:31], a[78:79], v[68:69], v[16:31]
    s_nop 11
    v_sub_f32 v16, v16, v71
    v_sub_f32 v17, v17, v71
    v_sub_f32 v18, v18, v71
    v_sub_f32 v19, v19, v71
    v_sub_f32 v20, v20, v71
    v_sub_f32 v21, v21, v71
    v_sub_f32 v22, v22, v71
    v_sub_f32 v23, v23, v71
    v_sub_f32 v24, v24, v71
    v_sub_f32 v25, v25, v71
    v_sub_f32 v26, v26, v71
    v_sub_f32 v27, v27, v71
    v_sub_f32 v28, v28, v71
    v_sub_f32 v29, v29, v71
    v_sub_f32 v30, v30, v71
    v_sub_f32 v31, v31, v71
    v_exp_f32 v16, v16
    v_exp_f32 v17, v17
    v_exp_f32 v18, v18
    v_exp_f32 v19, v19
    v_exp_f32 v20, v20
    v_exp_f32 v21, v21
    v_exp_f32 v22, v22
    v_exp_f32 v23, v23
    v_exp_f32 v24, v24
    v_exp_f32 v25, v25
    v_exp_f32 v26, v26
    v_exp_f32 v27, v27
    v_exp_f32 v28, v28
    v_exp_f32 v29, v29
    v_exp_f32 v30, v30
    v_exp_f32 v31, v31
    s_nop 0
    v_cvt_pk_bf16_f32 v48, v16, v17
    v_cvt_pk_bf16_f32 v49, v18, v19
    v_cvt_pk_bf16_f32 v50, v20, v21
    v_cvt_pk_bf16_f32 v51, v22, v23
    v_cvt_pk_bf16_f32 v52, v24, v25
    v_cvt_pk_bf16_f32 v53, v26, v27
    v_cvt_pk_bf16_f32 v54, v28, v29
    v_cvt_pk_bf16_f32 v55, v30, v31
    s_nop 1
    v_mfma_f32_32x32x16_bf16 v[80:95], a[152:155], v[48:51], v[80:95]
    v_mfma_f32_32x32x16_bf16 v[80:95], a[156:159], v[52:55], v[80:95]
    s_nop 6
    v_mfma_f32_32x32x16_bf16 v[16:31], a[32:35], v[64:67], 0
    v_mfma_f32_32x32x8_bf16 v[16:31], a[80:81], v[68:69], v[16:31]
    s_nop 11
    v_sub_f32 v16, v16, v71
    v_sub_f32 v17, v17, v71
    v_sub_f32 v18, v18, v71
    v_sub_f32 v19, v19, v71
    v_sub_f32 v20, v20, v71
    v_sub_f32 v21, v21, v71
    v_sub_f32 v22, v22, v71
    v_sub_f32 v23, v23, v71
    v_sub_f32 v24, v24, v71
    v_sub_f32 v25, v25, v71
    v_sub_f32 v26, v26, v71
    v_sub_f32 v27, v27, v71
    v_sub_f32 v28, v28, v71
    v_sub_f32 v29, v29, v71
    v_sub_f32 v30, v30, v71
    v_sub_f32 v31, v31, v71
    v_exp_f32 v16, v16
    v_exp_f32 v17, v17
    v_exp_f32 v18, v18
    v_exp_f32 v19, v19
    v_exp_f32 v20, v20
    v_exp_f32 v21, v21
    v_exp_f32 v22, v22
    v_exp_f32 v23, v23
    v_exp_f32 v24, v24
    v_exp_f32 v25, v25
    v_exp_f32 v26, v26
    v_exp_f32 v27, v27
    v_exp_f32 v28, v28
    v_exp_f32 v29, v29
    v_exp_f32 v30, v30
    v_exp_f32 v31, v31
    s_nop 0
    v_cvt_pk_bf16_f32 v48, v16, v17
    v_cvt_pk_bf16_f32 v49, v18, v19
    v_cvt_pk_bf16_f32 v50, v20, v21
    v_cvt_pk_bf16_f32 v51, v22, v23
    v_cvt_pk_bf16_f32 v52, v24, v25
    v_cvt_pk_bf16_f32 v53, v26, v27
    v_cvt_pk_bf16_f32 v54, v28, v29
    v_cvt_pk_bf16_f32 v55, v30, v31
    s_nop 1
    v_mfma_f32_32x32x16_bf16 v[80:95], a[160:163], v[48:51], v[80:95]
    v_mfma_f32_32x32x16_bf16 v[80:95], a[164:167], v[52:55], v[80:95]
    s_nop 6
    v_mfma_f32_32x32x16_bf16 v[16:31], a[36:39], v[64:67], 0
    v_mfma_f32_32x32x8_bf16 v[16:31], a[82:83], v[68:69], v[16:31]
    s_nop 11
    v_sub_f32 v16, v16, v71
    v_sub_f32 v17, v17, v71
    v_sub_f32 v18, v18, v71
    v_sub_f32 v19, v19, v71
    v_sub_f32 v20, v20, v71
    v_sub_f32 v21, v21, v71
    v_sub_f32 v22, v22, v71
    v_sub_f32 v23, v23, v71
    v_sub_f32 v24, v24, v71
    v_sub_f32 v25, v25, v71
    v_sub_f32 v26, v26, v71
    v_sub_f32 v27, v27, v71
    v_sub_f32 v28, v28, v71
    v_sub_f32 v29, v29, v71
    v_sub_f32 v30, v30, v71
    v_sub_f32 v31, v31, v71
    v_exp_f32 v16, v16
    v_exp_f32 v17, v17
    v_exp_f32 v18, v18
    v_exp_f32 v19, v19
    v_exp_f32 v20, v20
    v_exp_f32 v21, v21
    v_exp_f32 v22, v22
    v_exp_f32 v23, v23
    v_exp_f32 v24, v24
    v_exp_f32 v25, v25
    v_exp_f32 v26, v26
    v_exp_f32 v27, v27
    v_exp_f32 v28, v28
    v_exp_f32 v29, v29
    v_exp_f32 v30, v30
    v_exp_f32 v31, v31
    s_nop 0
    v_cvt_pk_bf16_f32 v48, v16, v17
    v_cvt_pk_bf16_f32 v49, v18, v19
    v_cvt_pk_bf16_f32 v50, v20, v21
    v_cvt_pk_bf16_f32 v51, v22, v23
    v_cvt_pk_bf16_f32 v52, v24, v25
    v_cvt_pk_bf16_f32 v53, v26, v27
    v_cvt_pk_bf16_f32 v54, v28, v29
    v_cvt_pk_bf16_f32 v55, v30, v31
    s_nop 1
    v_mfma_f32_32x32x16_bf16 v[80:95], a[168:171], v[48:51], v[80:95]
    v_mfma_f32_32x32x16_bf16 v[80:95], a[172:175], v[52:55], v[80:95]
    s_nop 6
    v_mfma_f32_32x32x16_bf16 v[16:31], a[40:43], v[64:67], 0
    v_mfma_f32_32x32x8_bf16 v[16:31], a[84:85], v[68:69], v[16:31]
    s_nop 11
    v_sub_f32 v16, v16, v71
    v_sub_f32 v17, v17, v71
    v_sub_f32 v18, v18, v71
    v_sub_f32 v19, v19, v71
    v_sub_f32 v20, v20, v71
    v_sub_f32 v21, v21, v71
    v_sub_f32 v22, v22, v71
    v_sub_f32 v23, v23, v71
    v_sub_f32 v24, v24, v71
    v_sub_f32 v25, v25, v71
    v_sub_f32 v26, v26, v71
    v_sub_f32 v27, v27, v71
    v_sub_f32 v28, v28, v71
    v_sub_f32 v29, v29, v71
    v_sub_f32 v30, v30, v71
    v_sub_f32 v31, v31, v71
    v_exp_f32 v16, v16
    v_exp_f32 v17, v17
    v_exp_f32 v18, v18
    v_exp_f32 v19, v19
    v_exp_f32 v20, v20
    v_exp_f32 v21, v21
    v_exp_f32 v22, v22
    v_exp_f32 v23, v23
    v_exp_f32 v24, v24
    v_exp_f32 v25, v25
    v_exp_f32 v26, v26
    v_exp_f32 v27, v27
    v_exp_f32 v28, v28
    v_exp_f32 v29, v29
    v_exp_f32 v30, v30
    v_exp_f32 v31, v31
    s_nop 0
    v_cvt_pk_bf16_f32 v48, v16, v17
    v_cvt_pk_bf16_f32 v49, v18, v19
    v_cvt_pk_bf16_f32 v50, v20, v21
    v_cvt_pk_bf16_f32 v51, v22, v23
    v_cvt_pk_bf16_f32 v52, v24, v25
    v_cvt_pk_bf16_f32 v53, v26, v27
    v_cvt_pk_bf16_f32 v54, v28, v29
    v_cvt_pk_bf16_f32 v55, v30, v31
    s_nop 1
    v_mfma_f32_32x32x16_bf16 v[80:95], a[176:179], v[48:51], v[80:95]
    v_mfma_f32_32x32x16_bf16 v[80:95], a[180:183], v[52:55], v[80:95]
    s_nop 6
    v_mfma_f32_32x32x16_bf16 v[16:31], a[44:47], v[64:67], 0
    v_mfma_f32_32x32x8_bf16 v[16:31], a[86:87], v[68:69], v[16:31]
    s_nop 11
    v_sub_f32 v16, v16, v71
    v_sub_f32 v17, v17, v71
    v_sub_f32 v18, v18, v71
    v_sub_f32 v19, v19, v71
    v_sub_f32 v20, v20, v71
    v_sub_f32 v21, v21, v71
    v_sub_f32 v22, v22, v71
    v_sub_f32 v23, v23, v71
    v_sub_f32 v24, v24, v71
    v_sub_f32 v25, v25, v71
    v_sub_f32 v26, v26, v71
    v_sub_f32 v27, v27, v71
    v_sub_f32 v28, v28, v71
    v_sub_f32 v29, v29, v71
    v_sub_f32 v30, v30, v71
    v_sub_f32 v31, v31, v71
    v_exp_f32 v16, v16
    v_exp_f32 v17, v17
    v_exp_f32 v18, v18
    v_exp_f32 v19, v19
    v_exp_f32 v20, v20
    v_exp_f32 v21, v21
    v_exp_f32 v22, v22
    v_exp_f32 v23, v23
    v_exp_f32 v24, v24
    v_exp_f32 v25, v25
    v_exp_f32 v26, v26
    v_exp_f32 v27, v27
    v_exp_f32 v28, v28
    v_exp_f32 v29, v29
    v_exp_f32 v30, v30
    v_exp_f32 v31, v31
    s_nop 0
    v_cvt_pk_bf16_f32 v48, v16, v17
    v_cvt_pk_bf16_f32 v49, v18, v19
    v_cvt_pk_bf16_f32 v50, v20, v21
    v_cvt_pk_bf16_f32 v51, v22, v23
    v_cvt_pk_bf16_f32 v52, v24, v25
    v_cvt_pk_bf16_f32 v53, v26, v27
    v_cvt_pk_bf16_f32 v54, v28, v29
    v_cvt_pk_bf16_f32 v55, v30, v31
    s_nop 1
    v_mfma_f32_32x32x16_bf16 v[80:95], a[184:187], v[48:51], v[80:95]
    v_mfma_f32_32x32x16_bf16 v[80:95], a[188:191], v[52:55], v[80:95]
    s_nop 6
    v_mfma_f32_32x32x16_bf16 v[16:31], a[48:51], v[64:67], 0
    v_mfma_f32_32x32x8_bf16 v[16:31], a[88:89], v[68:69], v[16:31]
    s_nop 11
    v_sub_f32 v16, v16, v71
    v_sub_f32 v17, v17, v71
    v_sub_f32 v18, v18, v71
    v_sub_f32 v19, v19, v71
    v_sub_f32 v20, v20, v71
    v_sub_f32 v21, v21, v71
    v_sub_f32 v22, v22, v71
    v_sub_f32 v23, v23, v71
    v_sub_f32 v24, v24, v71
    v_sub_f32 v25, v25, v71
    v_sub_f32 v26, v26, v71
    v_sub_f32 v27, v27, v71
    v_sub_f32 v28, v28, v71
    v_sub_f32 v29, v29, v71
    v_sub_f32 v30, v30, v71
    v_sub_f32 v31, v31, v71
    v_exp_f32 v16, v16
    v_exp_f32 v17, v17
    v_exp_f32 v18, v18
    v_exp_f32 v19, v19
    v_exp_f32 v20, v20
    v_exp_f32 v21, v21
    v_exp_f32 v22, v22
    v_exp_f32 v23, v23
    v_exp_f32 v24, v24
    v_exp_f32 v25, v25
    v_exp_f32 v26, v26
    v_exp_f32 v27, v27
    v_exp_f32 v28, v28
    v_exp_f32 v29, v29
    v_exp_f32 v30, v30
    v_exp_f32 v31, v31
    s_nop 0
    v_cvt_pk_bf16_f32 v48, v16, v17
    v_cvt_pk_bf16_f32 v49, v18, v19
    v_cvt_pk_bf16_f32 v50, v20, v21
    v_cvt_pk_bf16_f32 v51, v22, v23
    v_cvt_pk_bf16_f32 v52, v24, v25
    v_cvt_pk_bf16_f32 v53, v26, v27
    v_cvt_pk_bf16_f32 v54, v28, v29
    v_cvt_pk_bf16_f32 v55, v30, v31
    s_nop 1
    v_mfma_f32_32x32x16_bf16 v[80:95], a[192:195], v[48:51], v[80:95]
    v_mfma_f32_32x32x16_bf16 v[80:95], a[196:199], v[52:55], v[80:95]
    s_nop 6
    v_mfma_f32_32x32x16_bf16 v[16:31], a[52:55], v[64:67], 0
    v_mfma_f32_32x32x8_bf16 v[16:31], a[90:91], v[68:69], v[16:31]
    s_nop 11
    v_sub_f32 v16, v16, v71
    v_sub_f32 v17, v17, v71
    v_sub_f32 v18, v18, v71
    v_sub_f32 v19, v19, v71
    v_sub_f32 v20, v20, v71
    v_sub_f32 v21, v21, v71
    v_sub_f32 v22, v22, v71
    v_sub_f32 v23, v23, v71
    v_sub_f32 v24, v24, v71
    v_sub_f32 v25, v25, v71
    v_sub_f32 v26, v26, v71
    v_sub_f32 v27, v27, v71
    v_sub_f32 v28, v28, v71
    v_sub_f32 v29, v29, v71
    v_sub_f32 v30, v30, v71
    v_sub_f32 v31, v31, v71
    v_exp_f32 v16, v16
    v_exp_f32 v17, v17
    v_exp_f32 v18, v18
    v_exp_f32 v19, v19
    v_exp_f32 v20, v20
    v_exp_f32 v21, v21
    v_exp_f32 v22, v22
    v_exp_f32 v23, v23
    v_exp_f32 v24, v24
    v_exp_f32 v25, v25
    v_exp_f32 v26, v26
    v_exp_f32 v27, v27
    v_exp_f32 v28, v28
    v_exp_f32 v29, v29
    v_exp_f32 v30, v30
    v_exp_f32 v31, v31
    s_nop 0
    v_cvt_pk_bf16_f32 v48, v16, v17
    v_cvt_pk_bf16_f32 v49, v18, v19
    v_cvt_pk_bf16_f32 v50, v20, v21
    v_cvt_pk_bf16_f32 v51, v22, v23
    v_cvt_pk_bf16_f32 v52, v24, v25
    v_cvt_pk_bf16_f32 v53, v26, v27
    v_cvt_pk_bf16_f32 v54, v28, v29
    v_cvt_pk_bf16_f32 v55, v30, v31
    s_nop 1
    v_mfma_f32_32x32x16_bf16 v[80:95], a[200:203], v[48:51], v[80:95]
    v_mfma_f32_32x32x16_bf16 v[80:95], a[204:207], v[52:55], v[80:95]
    s_nop 6
    v_mfma_f32_32x32x16_bf16 v[16:31], a[56:59], v[64:67], 0
    v_mfma_f32_32x32x8_bf16 v[16:31], a[92:93], v[68:69], v[16:31]
    s_nop 11
    v_sub_f32 v16, v16, v71
    v_sub_f32 v17, v17, v71
    v_sub_f32 v18, v18, v71
    v_sub_f32 v19, v19, v71
    v_sub_f32 v20, v20, v71
    v_sub_f32 v21, v21, v71
    v_sub_f32 v22, v22, v71
    v_sub_f32 v23, v23, v71
    v_sub_f32 v24, v24, v71
    v_sub_f32 v25, v25, v71
    v_sub_f32 v26, v26, v71
    v_sub_f32 v27, v27, v71
    v_sub_f32 v28, v28, v71
    v_sub_f32 v29, v29, v71
    v_sub_f32 v30, v30, v71
    v_sub_f32 v31, v31, v71
    v_exp_f32 v16, v16
    v_exp_f32 v17, v17
    v_exp_f32 v18, v18
    v_exp_f32 v19, v19
    v_exp_f32 v20, v20
    v_exp_f32 v21, v21
    v_exp_f32 v22, v22
    v_exp_f32 v23, v23
    v_exp_f32 v24, v24
    v_exp_f32 v25, v25
    v_exp_f32 v26, v26
    v_exp_f32 v27, v27
    v_exp_f32 v28, v28
    v_exp_f32 v29, v29
    v_exp_f32 v30, v30
    v_exp_f32 v31, v31
    s_nop 0
    v_cvt_pk_bf16_f32 v48, v16, v17
    v_cvt_pk_bf16_f32 v49, v18, v19
    v_cvt_pk_bf16_f32 v50, v20, v21
    v_cvt_pk_bf16_f32 v51, v22, v23
    v_cvt_pk_bf16_f32 v52, v24, v25
    v_cvt_pk_bf16_f32 v53, v26, v27
    v_cvt_pk_bf16_f32 v54, v28, v29
    v_cvt_pk_bf16_f32 v55, v30, v31
    s_nop 1
    v_mfma_f32_32x32x16_bf16 v[80:95], a[208:211], v[48:51], v[80:95]
    v_mfma_f32_32x32x16_bf16 v[80:95], a[212:215], v[52:55], v[80:95]
    s_nop 6
    v_mfma_f32_32x32x16_bf16 v[16:31], a[60:63], v[64:67], 0
    v_mfma_f32_32x32x8_bf16 v[16:31], a[94:95], v[68:69], v[16:31]
    s_nop 11
    v_sub_f32 v16, v16, v71
    v_sub_f32 v17, v17, v71
    v_sub_f32 v18, v18, v71
    v_sub_f32 v19, v19, v71
    v_sub_f32 v20, v20, v71
    v_sub_f32 v21, v21, v71
    v_sub_f32 v22, v22, v71
    v_sub_f32 v23, v23, v71
    v_sub_f32 v24, v24, v71
    v_sub_f32 v25, v25, v71
    v_sub_f32 v26, v26, v71
    v_sub_f32 v27, v27, v71
    v_sub_f32 v28, v28, v71
    v_sub_f32 v29, v29, v71
    v_sub_f32 v30, v30, v71
    v_sub_f32 v31, v31, v71
    v_exp_f32 v16, v16
    v_exp_f32 v17, v17
    v_exp_f32 v18, v18
    v_exp_f32 v19, v19
    v_exp_f32 v20, v20
    v_exp_f32 v21, v21
    v_exp_f32 v22, v22
    v_exp_f32 v23, v23
    v_exp_f32 v24, v24
    v_exp_f32 v25, v25
    v_exp_f32 v26, v26
    v_exp_f32 v27, v27
    v_exp_f32 v28, v28
    v_exp_f32 v29, v29
    v_exp_f32 v30, v30
    v_exp_f32 v31, v31
    s_nop 0
    v_cvt_pk_bf16_f32 v48, v16, v17
    v_cvt_pk_bf16_f32 v49, v18, v19
    v_cvt_pk_bf16_f32 v50, v20, v21
    v_cvt_pk_bf16_f32 v51, v22, v23
    v_cvt_pk_bf16_f32 v52, v24, v25
    v_cvt_pk_bf16_f32 v53, v26, v27
    v_cvt_pk_bf16_f32 v54, v28, v29
    v_cvt_pk_bf16_f32 v55, v30, v31
    s_nop 1
    v_mfma_f32_32x32x16_bf16 v[80:95], a[216:219], v[48:51], v[80:95]
    v_mfma_f32_32x32x16_bf16 v[80:95], a[220:223], v[52:55], v[80:95]
    s_nop 6
    s_nop 11
    ds_write_b128 v74, v[80:83] offset:0
    ds_write_b128 v74, v[84:87] offset:1024
    ds_write_b128 v74, v[88:91] offset:2048
    s_waitcnt lgkmcnt(0)
    s_barrier
    s_lshr_b32 s21, s56, 1
    s_cmp_lg_u32 s21, s20
    s_cbranch_scc1 mg_sl_next
    ds_read_b128 v[16:19], v75 offset:0
    ds_read_b128 v[20:23], v75 offset:1024
    ds_read_b128 v[24:27], v75 offset:2048
    ds_read_b128 v[28:31], v75 offset:3072
    ds_read_b128 v[32:35], v75 offset:4096
    ds_read_b128 v[36:39], v75 offset:5120
    ds_read_b128 v[40:43], v75 offset:6144
    ds_read_b128 v[44:47], v75 offset:7168
    ds_read_b128 v[48:51], v75 offset:8192
    ds_read_b128 v[52:55], v75 offset:9216
    ds_read_b128 v[56:59], v75 offset:10240
    ds_read_b128 v[60:63], v75 offset:11264
    s_waitcnt lgkmcnt(0)
    v_add_f32 v16, v16, v28
    v_add_f32 v17, v17, v29
    v_add_f32 v18, v18, v30
    v_add_f32 v19, v19, v31
    v_add_f32 v20, v20, v32
    v_add_f32 v21, v21, v33
    v_add_f32 v22, v22, v34
    v_add_f32 v23, v23, v35
    v_add_f32 v24, v24, v36
    v_add_f32 v25, v25, v37
    v_add_f32 v26, v26, v38
    v_add_f32 v27, v27, v39
    v_add_f32 v16, v16, v40
    v_add_f32 v17, v17, v41
    v_add_f32 v18, v18, v42
    v_add_f32 v19, v19, v43
    v_add_f32 v20, v20, v44
    v_add_f32 v21, v21, v45
    v_add_f32 v22, v22, v46
    v_add_f32 v23, v23, v47
    v_add_f32 v24, v24, v48
    v_add_f32 v25, v25, v49
    v_add_f32 v26, v26, v50
    v_add_f32 v27, v27, v51
    v_add_f32 v16, v16, v52
    v_add_f32 v17, v17, v53
    v_add_f32 v18, v18, v54
    v_add_f32 v19, v19, v55
    v_add_f32 v20, v20, v56
    v_add_f32 v21, v21, v57
    v_add_f32 v22, v22, v58
    v_add_f32 v23, v23, v59
    v_add_f32 v24, v24, v60
    v_add_f32 v25, v25, v61
    v_add_f32 v26, v26, v62
    v_add_f32 v27, v27, v63
    v_mov_b32 v76, v24
    v_mov_b32 v77, v24
    s_nop 1
    v_permlane32_swap_b32 v76, v77
    s_nop 1
    v_rcp_f32 v77, v77
    s_nop 0
    v_mul_f32 v16, v16, v77
    v_mul_f32 v17, v17, v77
    v_mul_f32 v18, v18, v77
    v_mul_f32 v19, v19, v77
    v_mul_f32 v20, v20, v77
    v_mul_f32 v21, v21, v77
    v_mul_f32 v22, v22, v77
    v_mul_f32 v23, v23, v77
    v_mul_f32 v24, v24, v77
    v_mul_f32 v25, v25, v77
    v_mul_f32 v26, v26, v77
    v_mul_f32 v27, v27, v77
    v_cvt_pk_bf16_f32 v32, v16, v17
    v_cvt_pk_bf16_f32 v33, v18, v19
    v_cvt_pk_bf16_f32 v34, v20, v21
    v_cvt_pk_bf16_f32 v35, v22, v23
    v_cvt_pk_bf16_f32 v36, v24, v25
    v_cvt_pk_bf16_f32 v37, v26, v27
    s_and_b32 s21, s56, 1
    s_mul_i32 s21, s21, 5120
    v_add_u32 v14, s21, v207
    ds_write_b64 v14, v[32:33]
    ds_write_b64 v14, v[34:35] offset:16
    s_mov_b32 exec_hi, 0
    ds_write_b64 v14, v[36:37] offset:32
    s_mov_b32 exec_hi, -1
    s_waitcnt lgkmcnt(0)
mg_sl_next:
    s_barrier
    s_add_u32 s56, s56, 1
    s_cmp_lt_u32 s56, 8
    s_cbranch_scc1 mg_sl_loop
    s_branch mg_staged
mg_end:
    s_endpgm
.section .rodata,"a"
.p2align 6
.amdhsa_kernel concat_heads__ssm_conv_s4__grouped_kv_mqa__prompt_kernel
  .amdhsa_next_free_vgpr 512
  .amdhsa_next_free_sgpr 102
  .amdhsa_accum_offset 256
  .amdhsa_group_segment_fixed_size 0
  .amdhsa_kernarg_size 136
  .amdhsa_user_sgpr_count 2
  .amdhsa_user_sgpr_kernarg_segment_ptr 1
  .amdhsa_system_sgpr_workgroup_id_x 1
  .amdhsa_float_denorm_mode_32 3
.end_amdhsa_kernel
```
